```python
import torch

def _softmax(x, axis=-1):
    return torch.softmax(x, dim=axis)

def _gelu(x):
    return torch.nn.functional.gelu(x, approximate='tanh')

def _silu(x):
    return torch.nn.functional.silu(x)

def _sigmoid(x):
    return torch.sigmoid(x)

def _layernorm(x, axis=-1, eps=1e-05):
    m = x.mean(dim=axis, keepdim=True)
    v = x.var(dim=axis, keepdim=True, unbiased=False)
    return (x - m) / torch.sqrt(v + eps)

def _scatter_add(tgt, idx, src, axis=0):
    return tgt.clone().index_add_(axis, idx, src)

def _segment_sum(src, seg, n):
    out = torch.zeros((n,) + src.shape[1:], dtype=src.dtype)
    return out.index_add_(0, seg, src)

def _pad(x, pw):
    flat = tuple((v for pair in reversed(pw) for v in pair))
    return torch.nn.functional.pad(x, flat)
kernel_name = 'concat_heads__memory_aug_recurrent_mem_tr__mha_block__prompt'

def setup_inputs():

    _w = lambda a: (lambda t: t.to(torch.bfloat16) if t.is_floating_point() else t)(torch.as_tensor(a))

    def _A_setup():
        B, S, Dm = (1, 2048, 1024)
        H, Dh = (32, 128)
        M, seg = (8, 32)
        seg = min(seg, S)
        S = S // seg * seg
        return {'x': _w((lambda *s: torch.randn(*s, dtype=torch.bfloat16) * 0.05)(B, S, Dm)), 'mem0': _w((lambda *s: torch.randn(*s, dtype=torch.bfloat16) * 1.6)(B, M, Dm)), 'Wq': _w((lambda *s: torch.randn(*s, dtype=torch.bfloat16) * 0.8)(Dm, H, Dh) * Dm ** (-0.5)), 'Wk': _w((lambda *s: torch.randn(*s, dtype=torch.bfloat16) * 0.8)(Dm, H, Dh) * Dm ** (-0.5)), 'Wv': _w((lambda *s: torch.randn(*s, dtype=torch.bfloat16) * 1.6)(Dm, H, Dh) * Dm ** (-0.5)), 'Wo': _w((lambda *s: torch.randn(*s, dtype=torch.bfloat16) * 1.6)(H, Dh, Dm) * (H * Dh) ** (-0.5)), 'seg_len': seg}
    _A_in = _A_setup()

    def _B_setup():
        B, S, D, H = (1, 2048, 1024, 32)
        return {'x': _w((lambda *s: torch.randn(*s, dtype=torch.bfloat16) * 0.2)(B, S, D)), 'wqkv': _w((lambda *s: torch.randn(*s, dtype=torch.bfloat16) * 0.2)(D, 3 * D)), 'wo': _w((lambda *s: torch.randn(*s, dtype=torch.bfloat16) * 0.05)(D, D))}
    _B_in = _B_setup()
    return {'A_x': _A_in['x'], 'A_mem0': _A_in['mem0'], 'A_Wq': _A_in['Wq'], 'A_Wk': _A_in['Wk'], 'A_Wv': _A_in['Wv'], 'A_Wo': _A_in['Wo'], 'A_seg_len': _A_in['seg_len'], 'B_x': _B_in['x'], 'B_wqkv': _B_in['wqkv'], 'B_wo': _B_in['wo']}

def reference(A_x, A_mem0, A_Wq, A_Wk, A_Wv, A_Wo, A_seg_len, B_x, B_wqkv, B_wo):

    def _A_ref(x, mem0, Wq, Wk, Wv, Wo, seg_len):
        B, S, Dm = x.shape
        H, Dh = (Wq.shape[1], Wq.shape[2])
        M = mem0.shape[1]
        scale = Dh ** (-0.5)
        n_seg = S // seg_len
        L = M + seg_len
        idx = torch.arange(L)
        mask = (idx[:, None] < M) | (idx[:, None] >= idx[None, :])
        mem = mem0
        outs = []
        for s in range(n_seg):
            xs = x[:, s * seg_len:(s + 1) * seg_len, :].clone()
            h = torch.concatenate([mem, xs], axis=1)
            q = torch.einsum('btd,dhe->bhte', h, Wq)
            k = torch.einsum('btd,dhe->bhte', h, Wk)
            v = torch.einsum('btd,dhe->bhte', h, Wv)
            scores = torch.einsum('bhqe,bhke->bhqk', q, k) * scale
            scores = torch.where(mask[None, None], scores, -1000000000.0)
            p = _softmax(scores, axis=-1)
            o = torch.einsum('bhqk,bhke->bhqe', p, v)
            o = torch.einsum('bhte,hed->btd', o, Wo)
            mem = o[:, :M, :].clone()
            outs.append(o[:, M:, :])
        return torch.concatenate(outs, axis=1)

    def _B_ref(x, wqkv, wo):
        B, S, D = x.shape
        H = 32
        Dh = D // H
        qkv = (lambda x, *d: x.permute(*d))((x @ wqkv).reshape(B, S, 3, H, Dh), 2, 0, 3, 1, 4)
        q, k, v = (qkv[0], qkv[1], qkv[2])
        scores = torch.einsum('bhqd,bhkd->bhqk', q, k) * Dh ** (-0.5)
        p = _softmax(scores, axis=-1)
        o = torch.einsum('bhqk,bhkd->bhqd', p, v)
        return (lambda x, *d: x.permute(*d))(o, 0, 2, 1, 3).reshape(B, S, D) @ wo
    a = _A_ref(A_x, A_mem0, A_Wq, A_Wk, A_Wv, A_Wo, A_seg_len)
    b = _B_ref(B_x, B_wqkv, B_wo)
    return torch.concatenate([a, b], axis=-1)
```

```asm
; @launch grid=(256,1,1) block=(256,1,1) lds=163840
.amdgcn_target "amdgcn-amd-amdhsa--gfx950"
.text
.globl concat_heads__memory_aug_recurrent_mem_tr__mha_block__prompt_kernel
.p2align 8
.type concat_heads__memory_aug_recurrent_mem_tr__mha_block__prompt_kernel,@function
concat_heads__memory_aug_recurrent_mem_tr__mha_block__prompt_kernel:
  s_cmp_ge_u32 s2, 256
  s_cbranch_scc1 L_done
  v_lshrrev_b32 v1, 6, v0
  s_nop 0
  v_readfirstlane_b32 s28, v1
  s_load_dwordx2 s[4:5], s[0:1], 96
  s_waitcnt lgkmcnt(0)
  s_mov_b32 s8, s4
  s_and_b32 s9, s5, 0xffff
  s_mov_b32 s10, 0x10000000
  s_mov_b32 s11, 0x20000
  s_load_dwordx2 s[4:5], s[0:1], 88
  s_waitcnt lgkmcnt(0)
  s_mov_b32 s12, s4
  s_and_b32 s13, s5, 0xffff
  s_mov_b32 s14, 0x100
  s_mov_b32 s15, 0x20000
  s_mov_b32 s48, 400000
  v_mov_b32 v2, 0
  s_cmp_lg_u32 s28, 0
  s_cbranch_scc1 R_join
  s_getreg_b32 s36, hwreg(HW_REG_XCC_ID)
  s_and_b32 s36, s36, 7
  s_and_b32 s37, s36, 3
  s_lshl_b32 s37, s37, 3
  s_lshl_b32 s38, 1, s37
  s_and_b32 s39, s36, 4
  s_lshl_b32 s39, s39, 5
  v_mov_b32 v3, s38
  s_mov_b64 exec, 1
  buffer_atomic_add v3, v2, s[12:15], s39 offen offset:32 sc0 sc1
  s_waitcnt vmcnt(0)
  v_readfirstlane_b32 s38, v3
  s_nop 3
  s_lshr_b32 s38, s38, s37
  s_and_b32 s38, s38, 0xff
  s_cmp_lt_u32 s38, 32
  s_cbranch_scc1 R_have
  v_mov_b32 v3, 1
  buffer_atomic_add v3, v2, s[12:15], 0 offen offset:168 sc0 sc1
  s_waitcnt vmcnt(0)
  v_readfirstlane_b32 s40, v3
R_wait:
  s_sub_u32 s48, s48, 1
  s_cbranch_scc1 L_fail
  s_sleep 8
  buffer_load_dword v4, v2, s[12:15], 0 offen offset:32 sc1
  buffer_load_dword v5, v2, s[12:15], 0 offen offset:160 sc1
  s_waitcnt vmcnt(0)
  v_readfirstlane_b32 s42, v4
  v_readfirstlane_b32 s43, v5
  s_nop 3
  s_mov_b32 s41, 0
  s_bfe_u32 s37, s42, 0x80000
  s_add_u32 s41, s41, s37
  s_bfe_u32 s37, s42, 0x80008
  s_add_u32 s41, s41, s37
  s_bfe_u32 s37, s42, 0x80010
  s_add_u32 s41, s41, s37
  s_bfe_u32 s37, s42, 0x80018
  s_add_u32 s41, s41, s37
  s_bfe_u32 s37, s43, 0x80000
  s_add_u32 s41, s41, s37
  s_bfe_u32 s37, s43, 0x80008
  s_add_u32 s41, s41, s37
  s_bfe_u32 s37, s43, 0x80010
  s_add_u32 s41, s41, s37
  s_bfe_u32 s37, s43, 0x80018
  s_add_u32 s41, s41, s37
  s_cmp_lt_u32 s41, 256
  s_cbranch_scc1 R_wait
  s_bfe_u32 s37, s42, 0x80000
  s_min_u32 s37, s37, 32
  s_mov_b32 s36, 0
  s_add_u32 s38, s37, s40
  s_cmp_lt_u32 s38, 32
  s_cbranch_scc1 R_have
  s_sub_u32 s40, s38, 32
  s_bfe_u32 s37, s42, 0x80008
  s_min_u32 s37, s37, 32
  s_mov_b32 s36, 1
  s_add_u32 s38, s37, s40
  s_cmp_lt_u32 s38, 32
  s_cbranch_scc1 R_have
  s_sub_u32 s40, s38, 32
  s_bfe_u32 s37, s42, 0x80010
  s_min_u32 s37, s37, 32
  s_mov_b32 s36, 2
  s_add_u32 s38, s37, s40
  s_cmp_lt_u32 s38, 32
  s_cbranch_scc1 R_have
  s_sub_u32 s40, s38, 32
  s_bfe_u32 s37, s42, 0x80018
  s_min_u32 s37, s37, 32
  s_mov_b32 s36, 3
  s_add_u32 s38, s37, s40
  s_cmp_lt_u32 s38, 32
  s_cbranch_scc1 R_have
  s_sub_u32 s40, s38, 32
  s_bfe_u32 s37, s43, 0x80000
  s_min_u32 s37, s37, 32
  s_mov_b32 s36, 4
  s_add_u32 s38, s37, s40
  s_cmp_lt_u32 s38, 32
  s_cbranch_scc1 R_have
  s_sub_u32 s40, s38, 32
  s_bfe_u32 s37, s43, 0x80008
  s_min_u32 s37, s37, 32
  s_mov_b32 s36, 5
  s_add_u32 s38, s37, s40
  s_cmp_lt_u32 s38, 32
  s_cbranch_scc1 R_have
  s_sub_u32 s40, s38, 32
  s_bfe_u32 s37, s43, 0x80010
  s_min_u32 s37, s37, 32
  s_mov_b32 s36, 6
  s_add_u32 s38, s37, s40
  s_cmp_lt_u32 s38, 32
  s_cbranch_scc1 R_have
  s_sub_u32 s40, s38, 32
  s_bfe_u32 s37, s43, 0x80018
  s_min_u32 s37, s37, 32
  s_mov_b32 s36, 7
  s_add_u32 s38, s37, s40
  s_cmp_lt_u32 s38, 32
  s_cbranch_scc1 R_have
  s_sub_u32 s40, s38, 32
  s_mov_b32 s38, 0x1000
R_have:
  s_lshl_b32 s38, s38, 3
  s_add_u32 s38, s38, s36
  v_mov_b32 v3, s38
  ds_write_b32 v2, v3
  s_mov_b64 exec, -1
  s_waitcnt lgkmcnt(0)
R_join:
  s_barrier
  ds_read_b32 v3, v2
  s_waitcnt lgkmcnt(0)
  v_readfirstlane_b32 s2, v3
  s_nop 3
  s_cmp_ge_u32 s2, 256
  s_cbranch_scc1 L_fail
  s_barrier
  s_and_b32 s29, s2, 7
  s_mov_b32 s58, s29
  s_lshr_b32 s30, s2, 3
  s_mov_b32 s31, 0
  s_cmp_ge_u32 s29, 4
  s_cbranch_scc1 L_W
  s_cmp_ge_u32 s30, 24
  s_cbranch_scc1 L_W
  s_cmp_lt_u32 s30, 8
  s_cbranch_scc1 L_S
  s_sub_u32 s30, s30, 8
  s_lshl_b32 s49, s29, 3
  s_lshr_b32 s36, s30, 1
  s_add_u32 s49, s49, s36
  s_load_dwordx2 s[4:5], s[0:1], 32
  s_waitcnt lgkmcnt(0)
  s_mov_b32 s16, s4
  s_and_b32 s17, s5, 0xffff
  s_mov_b32 s18, 0x800000
  s_mov_b32 s19, 0x20000
  s_load_dwordx2 s[4:5], s[0:1], 40
  s_waitcnt lgkmcnt(0)
  s_mov_b32 s20, s4
  s_and_b32 s21, s5, 0xffff
  s_mov_b32 s22, 0x800000
  s_mov_b32 s23, 0x20000
  s_load_dwordx2 s[4:5], s[0:1], 8
  s_waitcnt lgkmcnt(0)
  s_mov_b32 s24, s4
  s_and_b32 s25, s5, 0xffff
  s_mov_b32 s26, 0x4000
  s_mov_b32 s27, 0x20000
  v_and_b32 v0, 63, v0
  v_lshlrev_b32 v3, 4, v0
  v_lshlrev_b32 v12, 2, v0
  v_mov_b32 v120, -1
  v_mov_b32 v121, -1
  v_mov_b32 v122, -1
  v_mov_b32 v123, -1
  s_lshl_b32 s42, s29, 20
  s_add_u32 s42, s42, 0x4000000
  s_lshl_b32 s36, s30, 10
  s_add_u32 s46, s42, s36
  s_lshl_b32 s44, s49, 11
  s_and_b32 s37, s30, 1
  s_lshl_b32 s37, s37, 10
  s_add_u32 s43, s44, s37
  s_and_b32 s36, s30, 3
  s_lshl_b32 s45, s36, 11
  s_lshr_b32 s36, s30, 2
  s_lshl_b32 s36, s36, 14
  s_add_u32 s45, s45, s36
  s_add_u32 s45, s45, 0x5000000
  s_lshl_b32 s36, s29, 16
  s_add_u32 s47, s45, s36
  s_add_u32 s41, s28, 0
  s_lshl_b32 s36, s41, 14
  s_add_u32 s36, s36, s46
  buffer_store_dwordx4 v[120:123], v3, s[8:11], s36 offen sc1
  s_lshl_b32 s36, s41, 16
  s_add_u32 s36, s36, s43
  s_add_u32 s37, s36, 0x4400000
  buffer_store_dwordx4 v[120:123], v3, s[8:11], s37 offen sc1
  s_add_u32 s37, s36, 0x4800000
  buffer_store_dwordx4 v[120:123], v3, s[8:11], s37 offen sc1
  s_add_u32 s37, s36, 0x4d00000
  buffer_store_dwordx4 v[120:123], v3, s[8:11], s37 offen sc1
  s_lshl_b32 s36, s41, 18
  s_add_u32 s36, s36, s47
  buffer_store_dwordx4 v[120:123], v3, s[8:11], s36 offen sc1
  buffer_store_dwordx4 v[120:123], v3, s[8:11], s36 offen offset:1024 sc1
  s_add_u32 s36, s36, 0x2000
  buffer_store_dwordx4 v[120:123], v3, s[8:11], s36 offen sc1
  buffer_store_dwordx4 v[120:123], v3, s[8:11], s36 offen offset:1024 sc1
  s_add_u32 s41, s28, 4
  s_lshl_b32 s36, s41, 14
  s_add_u32 s36, s36, s46
  buffer_store_dwordx4 v[120:123], v3, s[8:11], s36 offen sc1
  s_lshl_b32 s36, s41, 16
  s_add_u32 s36, s36, s43
  s_add_u32 s37, s36, 0x4400000
  buffer_store_dwordx4 v[120:123], v3, s[8:11], s37 offen sc1
  s_add_u32 s37, s36, 0x4800000
  buffer_store_dwordx4 v[120:123], v3, s[8:11], s37 offen sc1
  s_add_u32 s37, s36, 0x4d00000
  buffer_store_dwordx4 v[120:123], v3, s[8:11], s37 offen sc1
  s_lshl_b32 s36, s41, 18
  s_add_u32 s36, s36, s47
  buffer_store_dwordx4 v[120:123], v3, s[8:11], s36 offen sc1
  buffer_store_dwordx4 v[120:123], v3, s[8:11], s36 offen offset:1024 sc1
  s_add_u32 s36, s36, 0x2000
  buffer_store_dwordx4 v[120:123], v3, s[8:11], s36 offen sc1
  buffer_store_dwordx4 v[120:123], v3, s[8:11], s36 offen offset:1024 sc1
  v_mov_b32 v32, 0
  v_mov_b32 v33, 0
  v_mov_b32 v34, 0
  v_mov_b32 v35, 0
  s_lshl_b32 s36, s29, 4
  s_add_u32 s36, s36, s30
  s_lshl_b32 s36, s36, 9
  s_lshl_b32 s37, s28, 7
  s_add_u32 s36, s36, s37
  s_add_u32 s36, s36, 0x4c00000
  s_mov_b64 exec, 0xff
  buffer_store_dwordx4 v[32:35], v3, s[8:11], s36 offen sc1
  s_mov_b64 exec, -1
  s_lshl_b32 s36, s29, 4
  s_add_u32 s36, s36, s30
  s_cmp_ge_u32 s36, 8
  s_cbranch_scc1 pr_1
  s_cmp_lg_u32 s28, 3
  s_cbranch_scc1 pr_1
  s_add_u32 s37, s47, 0x1c0000
  s_add_u32 s38, s37, 0x2000
  buffer_store_dwordx4 v[120:123], v3, s[8:11], s37 offen sc1
  buffer_store_dwordx4 v[120:123], v3, s[8:11], s38 offen sc1
  v_mov_b32 v5, 0
  s_mov_b32 s60, -1
  s_mov_b32 s61, -1
  s_waitcnt vmcnt(0)
  s_mov_b32 s66, 0
pl_2:
  s_memtime s[62:63]
  s_waitcnt lgkmcnt(0)
  buffer_load_dword v4, v5, s[8:11], s37 offen sc1
  s_waitcnt vmcnt(0)
  s_memtime s[64:65]
  s_waitcnt lgkmcnt(0)
  s_sub_u32 s64, s64, s62
  s_min_u32 s60, s60, s64
  s_add_u32 s37, s37, 256
  s_memtime s[62:63]
  s_waitcnt lgkmcnt(0)
  buffer_load_dword v4, v5, s[8:11], s38 offen sc1
  s_waitcnt vmcnt(0)
  s_memtime s[64:65]
  s_waitcnt lgkmcnt(0)
  s_sub_u32 s64, s64, s62
  s_min_u32 s61, s61, s64
  s_add_u32 s38, s38, 256
  s_add_u32 s66, s66, 1
  s_cmp_lt_u32 s66, 8
  s_cbranch_scc1 pl_2
  s_cmp_lt_u32 s61, s60
  s_cselect_b32 s37, 1, 0
  s_lshl_b32 s37, s37, s30
  v_mov_b32 v4, s37
  s_mov_b64 exec, 1
  buffer_atomic_or v4, v5, s[12:15], 0 offen offset:12 sc1
  s_mov_b64 exec, -1
pr_1:
  s_waitcnt vmcnt(0)
  s_barrier
  s_cmp_lg_u32 s28, 0
  s_cbranch_scc1 ar_3
  v_mov_b32 v38, 0
  s_getreg_b32 s36, hwreg(HW_REG_XCC_ID)
  s_and_b32 s36, s36, 7
  s_lshl_b32 s37, s29, 3
  s_lshl_b32 s37, 1, s37
  s_cmp_eq_u32 s36, s29
  s_cselect_b32 s37, 0, s37
  v_mov_b32 v36, 1
  v_mov_b32 v37, s37
  s_mov_b64 exec, 1
  buffer_atomic_add_x2 v[36:37], v38, s[12:15], 0 offen sc1
  s_mov_b64 exec, -1
ar_3:
  s_load_dwordx2 s[4:5], s[0:1], 24
  s_waitcnt lgkmcnt(0)
  s_mov_b32 s84, s4
  s_and_b32 s85, s5, 0xffff
  s_mov_b32 s86, 0x800000
  s_mov_b32 s87, 0x20000
  v_lshrrev_b32 v4, 3, v0
  v_lshlrev_b32 v13, 13, v4
  v_lshlrev_b32 v112, 11, v4
  v_and_b32 v4, 7, v0
  v_lshl_add_u32 v13, v4, 4, v13
  v_lshl_add_u32 v112, v4, 4, v112
  s_lshl_b32 s36, s49, 8
  s_and_b32 s37, s30, 1
  s_lshl_b32 s37, s37, 7
  s_add_u32 s36, s36, s37
  s_lshl_b32 s37, s28, 21
  s_add_u32 s36, s36, s37
  v_add_u32 v13, s36, v13
  s_lshl_b32 s36, s29, 21
  s_lshl_b32 s37, s30, 7
  s_add_u32 s36, s36, s37
  s_lshl_b32 s37, s28, 19
  s_add_u32 s36, s36, s37
  v_add_u32 v112, s36, v112
  s_lshl_b32 s38, s28, 15
  s_add_u32 s38, s38, 0x8000
  v_and_b32 v4, 3, v0
  v_lshlrev_b32 v113, 3, v4
  v_bfe_u32 v4, v0, 5, 1
  v_lshl_add_u32 v113, v4, 11, v113
  v_bfe_u32 v4, v0, 3, 1
  v_lshl_add_u32 v113, v4, 10, v113
  v_bfe_u32 v4, v0, 4, 1
  v_lshl_add_u32 v113, v4, 9, v113
  v_bfe_u32 v4, v0, 2, 1
  v_lshl_add_u32 v113, v4, 7, v113
  v_add_u32 v113, s38, v113
  v_and_b32 v4, 3, v0
  v_lshlrev_b32 v114, 3, v4
  v_bfe_u32 v4, v0, 3, 1
  v_lshl_add_u32 v114, v4, 12, v114
  v_bfe_u32 v4, v0, 4, 1
  v_lshl_add_u32 v114, v4, 11, v114
  v_bfe_u32 v4, v0, 5, 1
  v_lshl_add_u32 v114, v4, 9, v114
  v_bfe_u32 v4, v0, 2, 1
  v_lshl_add_u32 v114, v4, 7, v114
  v_add_u32 v114, s38, v114
  s_add_u32 m0, s38, 0
  s_mov_b32 s40, 0x0
  buffer_load_dwordx4 v13, s[84:87], s40 offen lds
  s_add_u32 m0, s38, 1024
  s_mov_b32 s40, 0x10000
  buffer_load_dwordx4 v13, s[84:87], s40 offen lds
  s_add_u32 m0, s38, 2048
  s_mov_b32 s40, 0x20000
  buffer_load_dwordx4 v13, s[84:87], s40 offen lds
  s_add_u32 m0, s38, 3072
  s_mov_b32 s40, 0x30000
  buffer_load_dwordx4 v13, s[84:87], s40 offen lds
  s_add_u32 m0, s38, 4096
  s_mov_b32 s40, 0x40000
  buffer_load_dwordx4 v13, s[84:87], s40 offen lds
  s_add_u32 m0, s38, 5120
  s_mov_b32 s40, 0x50000
  buffer_load_dwordx4 v13, s[84:87], s40 offen lds
  s_add_u32 m0, s38, 6144
  s_mov_b32 s40, 0x60000
  buffer_load_dwordx4 v13, s[84:87], s40 offen lds
  s_add_u32 m0, s38, 7168
  s_mov_b32 s40, 0x70000
  buffer_load_dwordx4 v13, s[84:87], s40 offen lds
  s_add_u32 m0, s38, 8192
  s_mov_b32 s40, 0x80000
  buffer_load_dwordx4 v13, s[84:87], s40 offen lds
  s_add_u32 m0, s38, 9216
  s_mov_b32 s40, 0x90000
  buffer_load_dwordx4 v13, s[84:87], s40 offen lds
  s_add_u32 m0, s38, 10240
  s_mov_b32 s40, 0xa0000
  buffer_load_dwordx4 v13, s[84:87], s40 offen lds
  s_add_u32 m0, s38, 11264
  s_mov_b32 s40, 0xb0000
  buffer_load_dwordx4 v13, s[84:87], s40 offen lds
  s_add_u32 m0, s38, 12288
  s_mov_b32 s40, 0xc0000
  buffer_load_dwordx4 v13, s[84:87], s40 offen lds
  s_add_u32 m0, s38, 13312
  s_mov_b32 s40, 0xd0000
  buffer_load_dwordx4 v13, s[84:87], s40 offen lds
  s_add_u32 m0, s38, 14336
  s_mov_b32 s40, 0xe0000
  buffer_load_dwordx4 v13, s[84:87], s40 offen lds
  s_add_u32 m0, s38, 15360
  s_mov_b32 s40, 0xf0000
  buffer_load_dwordx4 v13, s[84:87], s40 offen lds
  s_add_u32 m0, s38, 16384
  s_mov_b32 s40, 0x100000
  buffer_load_dwordx4 v13, s[84:87], s40 offen lds
  s_add_u32 m0, s38, 17408
  s_mov_b32 s40, 0x110000
  buffer_load_dwordx4 v13, s[84:87], s40 offen lds
  s_add_u32 m0, s38, 18432
  s_mov_b32 s40, 0x120000
  buffer_load_dwordx4 v13, s[84:87], s40 offen lds
  s_add_u32 m0, s38, 19456
  s_mov_b32 s40, 0x130000
  buffer_load_dwordx4 v13, s[84:87], s40 offen lds
  s_add_u32 m0, s38, 20480
  s_mov_b32 s40, 0x140000
  buffer_load_dwordx4 v13, s[84:87], s40 offen lds
  s_add_u32 m0, s38, 21504
  s_mov_b32 s40, 0x150000
  buffer_load_dwordx4 v13, s[84:87], s40 offen lds
  s_add_u32 m0, s38, 22528
  s_mov_b32 s40, 0x160000
  buffer_load_dwordx4 v13, s[84:87], s40 offen lds
  s_add_u32 m0, s38, 23552
  s_mov_b32 s40, 0x170000
  buffer_load_dwordx4 v13, s[84:87], s40 offen lds
  s_add_u32 m0, s38, 24576
  s_mov_b32 s40, 0x180000
  buffer_load_dwordx4 v13, s[84:87], s40 offen lds
  s_add_u32 m0, s38, 25600
  s_mov_b32 s40, 0x190000
  buffer_load_dwordx4 v13, s[84:87], s40 offen lds
  s_add_u32 m0, s38, 26624
  s_mov_b32 s40, 0x1a0000
  buffer_load_dwordx4 v13, s[84:87], s40 offen lds
  s_add_u32 m0, s38, 27648
  s_mov_b32 s40, 0x1b0000
  buffer_load_dwordx4 v13, s[84:87], s40 offen lds
  s_add_u32 m0, s38, 28672
  s_mov_b32 s40, 0x1c0000
  buffer_load_dwordx4 v13, s[84:87], s40 offen lds
  s_add_u32 m0, s38, 29696
  s_mov_b32 s40, 0x1d0000
  buffer_load_dwordx4 v13, s[84:87], s40 offen lds
  s_add_u32 m0, s38, 30720
  s_mov_b32 s40, 0x1e0000
  buffer_load_dwordx4 v13, s[84:87], s40 offen lds
  s_add_u32 m0, s38, 31744
  s_mov_b32 s40, 0x1f0000
  buffer_load_dwordx4 v13, s[84:87], s40 offen lds
  s_waitcnt vmcnt(24)
  ds_read_b64_tr_b16 a[0:1], v113 offset:0
  ds_read_b64_tr_b16 a[2:3], v113 offset:256
  ds_read_b64_tr_b16 a[4:5], v113 offset:4096
  ds_read_b64_tr_b16 a[6:7], v113 offset:4352
  ds_read_b64_tr_b16 a[8:9], v113 offset:32
  ds_read_b64_tr_b16 a[10:11], v113 offset:288
  ds_read_b64_tr_b16 a[12:13], v113 offset:4128
  ds_read_b64_tr_b16 a[14:15], v113 offset:4384
  ds_read_b64_tr_b16 a[16:17], v113 offset:64
  ds_read_b64_tr_b16 a[18:19], v113 offset:320
  ds_read_b64_tr_b16 a[20:21], v113 offset:4160
  ds_read_b64_tr_b16 a[22:23], v113 offset:4416
  s_waitcnt lgkmcnt(4)
  ds_read_b64_tr_b16 a[24:25], v113 offset:96
  ds_read_b64_tr_b16 a[26:27], v113 offset:352
  ds_read_b64_tr_b16 a[28:29], v113 offset:4192
  ds_read_b64_tr_b16 a[30:31], v113 offset:4448
  s_waitcnt lgkmcnt(0)
  s_add_u32 m0, s38, 0
  s_mov_b32 s40, 0x0
  buffer_load_dwordx4 v13, s[16:19], s40 offen lds
  s_add_u32 m0, s38, 1024
  s_mov_b32 s40, 0x10000
  buffer_load_dwordx4 v13, s[16:19], s40 offen lds
  s_add_u32 m0, s38, 2048
  s_mov_b32 s40, 0x20000
  buffer_load_dwordx4 v13, s[16:19], s40 offen lds
  s_add_u32 m0, s38, 3072
  s_mov_b32 s40, 0x30000
  buffer_load_dwordx4 v13, s[16:19], s40 offen lds
  s_add_u32 m0, s38, 4096
  s_mov_b32 s40, 0x40000
  buffer_load_dwordx4 v13, s[16:19], s40 offen lds
  s_add_u32 m0, s38, 5120
  s_mov_b32 s40, 0x50000
  buffer_load_dwordx4 v13, s[16:19], s40 offen lds
  s_add_u32 m0, s38, 6144
  s_mov_b32 s40, 0x60000
  buffer_load_dwordx4 v13, s[16:19], s40 offen lds
  s_add_u32 m0, s38, 7168
  s_mov_b32 s40, 0x70000
  buffer_load_dwordx4 v13, s[16:19], s40 offen lds
  s_waitcnt vmcnt(24)
  ds_read_b64_tr_b16 a[32:33], v113 offset:8192
  ds_read_b64_tr_b16 a[34:35], v113 offset:8448
  ds_read_b64_tr_b16 a[36:37], v113 offset:12288
  ds_read_b64_tr_b16 a[38:39], v113 offset:12544
  ds_read_b64_tr_b16 a[40:41], v113 offset:8224
  ds_read_b64_tr_b16 a[42:43], v113 offset:8480
  ds_read_b64_tr_b16 a[44:45], v113 offset:12320
  ds_read_b64_tr_b16 a[46:47], v113 offset:12576
  ds_read_b64_tr_b16 a[48:49], v113 offset:8256
  ds_read_b64_tr_b16 a[50:51], v113 offset:8512
  ds_read_b64_tr_b16 a[52:53], v113 offset:12352
  ds_read_b64_tr_b16 a[54:55], v113 offset:12608
  s_waitcnt lgkmcnt(4)
  ds_read_b64_tr_b16 a[56:57], v113 offset:8288
  ds_read_b64_tr_b16 a[58:59], v113 offset:8544
  ds_read_b64_tr_b16 a[60:61], v113 offset:12384
  ds_read_b64_tr_b16 a[62:63], v113 offset:12640
  s_waitcnt lgkmcnt(0)
  s_add_u32 m0, s38, 8192
  s_mov_b32 s40, 0x80000
  buffer_load_dwordx4 v13, s[16:19], s40 offen lds
  s_add_u32 m0, s38, 9216
  s_mov_b32 s40, 0x90000
  buffer_load_dwordx4 v13, s[16:19], s40 offen lds
  s_add_u32 m0, s38, 10240
  s_mov_b32 s40, 0xa0000
  buffer_load_dwordx4 v13, s[16:19], s40 offen lds
  s_add_u32 m0, s38, 11264
  s_mov_b32 s40, 0xb0000
  buffer_load_dwordx4 v13, s[16:19], s40 offen lds
  s_add_u32 m0, s38, 12288
  s_mov_b32 s40, 0xc0000
  buffer_load_dwordx4 v13, s[16:19], s40 offen lds
  s_add_u32 m0, s38, 13312
  s_mov_b32 s40, 0xd0000
  buffer_load_dwordx4 v13, s[16:19], s40 offen lds
  s_add_u32 m0, s38, 14336
  s_mov_b32 s40, 0xe0000
  buffer_load_dwordx4 v13, s[16:19], s40 offen lds
  s_add_u32 m0, s38, 15360
  s_mov_b32 s40, 0xf0000
  buffer_load_dwordx4 v13, s[16:19], s40 offen lds
  s_waitcnt vmcnt(24)
  ds_read_b64_tr_b16 a[64:65], v113 offset:16384
  ds_read_b64_tr_b16 a[66:67], v113 offset:16640
  ds_read_b64_tr_b16 a[68:69], v113 offset:20480
  ds_read_b64_tr_b16 a[70:71], v113 offset:20736
  ds_read_b64_tr_b16 a[72:73], v113 offset:16416
  ds_read_b64_tr_b16 a[74:75], v113 offset:16672
  ds_read_b64_tr_b16 a[76:77], v113 offset:20512
  ds_read_b64_tr_b16 a[78:79], v113 offset:20768
  ds_read_b64_tr_b16 a[80:81], v113 offset:16448
  ds_read_b64_tr_b16 a[82:83], v113 offset:16704
  ds_read_b64_tr_b16 a[84:85], v113 offset:20544
  ds_read_b64_tr_b16 a[86:87], v113 offset:20800
  s_waitcnt lgkmcnt(4)
  ds_read_b64_tr_b16 a[88:89], v113 offset:16480
  ds_read_b64_tr_b16 a[90:91], v113 offset:16736
  ds_read_b64_tr_b16 a[92:93], v113 offset:20576
  ds_read_b64_tr_b16 a[94:95], v113 offset:20832
  s_waitcnt lgkmcnt(0)
  s_add_u32 m0, s38, 16384
  s_mov_b32 s40, 0x100000
  buffer_load_dwordx4 v13, s[16:19], s40 offen lds
  s_add_u32 m0, s38, 17408
  s_mov_b32 s40, 0x110000
  buffer_load_dwordx4 v13, s[16:19], s40 offen lds
  s_add_u32 m0, s38, 18432
  s_mov_b32 s40, 0x120000
  buffer_load_dwordx4 v13, s[16:19], s40 offen lds
  s_add_u32 m0, s38, 19456
  s_mov_b32 s40, 0x130000
  buffer_load_dwordx4 v13, s[16:19], s40 offen lds
  s_add_u32 m0, s38, 20480
  s_mov_b32 s40, 0x140000
  buffer_load_dwordx4 v13, s[16:19], s40 offen lds
  s_add_u32 m0, s38, 21504
  s_mov_b32 s40, 0x150000
  buffer_load_dwordx4 v13, s[16:19], s40 offen lds
  s_add_u32 m0, s38, 22528
  s_mov_b32 s40, 0x160000
  buffer_load_dwordx4 v13, s[16:19], s40 offen lds
  s_add_u32 m0, s38, 23552
  s_mov_b32 s40, 0x170000
  buffer_load_dwordx4 v13, s[16:19], s40 offen lds
  s_waitcnt vmcnt(24)
  ds_read_b64_tr_b16 a[96:97], v113 offset:24576
  ds_read_b64_tr_b16 a[98:99], v113 offset:24832
  ds_read_b64_tr_b16 a[100:101], v113 offset:28672
  ds_read_b64_tr_b16 a[102:103], v113 offset:28928
  ds_read_b64_tr_b16 a[104:105], v113 offset:24608
  ds_read_b64_tr_b16 a[106:107], v113 offset:24864
  ds_read_b64_tr_b16 a[108:109], v113 offset:28704
  ds_read_b64_tr_b16 a[110:111], v113 offset:28960
  ds_read_b64_tr_b16 a[112:113], v113 offset:24640
  ds_read_b64_tr_b16 a[114:115], v113 offset:24896
  ds_read_b64_tr_b16 a[116:117], v113 offset:28736
  ds_read_b64_tr_b16 a[118:119], v113 offset:28992
  s_waitcnt lgkmcnt(4)
  ds_read_b64_tr_b16 a[120:121], v113 offset:24672
  ds_read_b64_tr_b16 a[122:123], v113 offset:24928
  ds_read_b64_tr_b16 a[124:125], v113 offset:28768
  ds_read_b64_tr_b16 a[126:127], v113 offset:29024
  s_waitcnt lgkmcnt(0)
  s_add_u32 m0, s38, 24576
  s_mov_b32 s40, 0x180000
  buffer_load_dwordx4 v13, s[16:19], s40 offen lds
  s_add_u32 m0, s38, 25600
  s_mov_b32 s40, 0x190000
  buffer_load_dwordx4 v13, s[16:19], s40 offen lds
  s_add_u32 m0, s38, 26624
  s_mov_b32 s40, 0x1a0000
  buffer_load_dwordx4 v13, s[16:19], s40 offen lds
  s_add_u32 m0, s38, 27648
  s_mov_b32 s40, 0x1b0000
  buffer_load_dwordx4 v13, s[16:19], s40 offen lds
  s_add_u32 m0, s38, 28672
  s_mov_b32 s40, 0x1c0000
  buffer_load_dwordx4 v13, s[16:19], s40 offen lds
  s_add_u32 m0, s38, 29696
  s_mov_b32 s40, 0x1d0000
  buffer_load_dwordx4 v13, s[16:19], s40 offen lds
  s_add_u32 m0, s38, 30720
  s_mov_b32 s40, 0x1e0000
  buffer_load_dwordx4 v13, s[16:19], s40 offen lds
  s_add_u32 m0, s38, 31744
  s_mov_b32 s40, 0x1f0000
  buffer_load_dwordx4 v13, s[16:19], s40 offen lds
  s_waitcnt vmcnt(24)
  ds_read_b64_tr_b16 v[128:129], v113 offset:0
  ds_read_b64_tr_b16 v[130:131], v113 offset:256
  ds_read_b64_tr_b16 v[132:133], v113 offset:4096
  ds_read_b64_tr_b16 v[134:135], v113 offset:4352
  ds_read_b64_tr_b16 v[136:137], v113 offset:32
  ds_read_b64_tr_b16 v[138:139], v113 offset:288
  ds_read_b64_tr_b16 v[140:141], v113 offset:4128
  ds_read_b64_tr_b16 v[142:143], v113 offset:4384
  ds_read_b64_tr_b16 v[144:145], v113 offset:64
  ds_read_b64_tr_b16 v[146:147], v113 offset:320
  ds_read_b64_tr_b16 v[148:149], v113 offset:4160
  ds_read_b64_tr_b16 v[150:151], v113 offset:4416
  s_waitcnt lgkmcnt(4)
  ds_read_b64_tr_b16 v[152:153], v113 offset:96
  ds_read_b64_tr_b16 v[154:155], v113 offset:352
  ds_read_b64_tr_b16 v[156:157], v113 offset:4192
  ds_read_b64_tr_b16 v[158:159], v113 offset:4448
  s_waitcnt lgkmcnt(0)
  s_add_u32 m0, s38, 0
  s_mov_b32 s40, 0x0
  buffer_load_dwordx4 v112, s[20:23], s40 offen lds
  s_add_u32 m0, s38, 1024
  s_mov_b32 s40, 0x4000
  buffer_load_dwordx4 v112, s[20:23], s40 offen lds
  s_add_u32 m0, s38, 2048
  s_mov_b32 s40, 0x8000
  buffer_load_dwordx4 v112, s[20:23], s40 offen lds
  s_add_u32 m0, s38, 3072
  s_mov_b32 s40, 0xc000
  buffer_load_dwordx4 v112, s[20:23], s40 offen lds
  s_add_u32 m0, s38, 4096
  s_mov_b32 s40, 0x10000
  buffer_load_dwordx4 v112, s[20:23], s40 offen lds
  s_add_u32 m0, s38, 5120
  s_mov_b32 s40, 0x14000
  buffer_load_dwordx4 v112, s[20:23], s40 offen lds
  s_add_u32 m0, s38, 6144
  s_mov_b32 s40, 0x18000
  buffer_load_dwordx4 v112, s[20:23], s40 offen lds
  s_add_u32 m0, s38, 7168
  s_mov_b32 s40, 0x1c000
  buffer_load_dwordx4 v112, s[20:23], s40 offen lds
  s_waitcnt vmcnt(24)
  ds_read_b64_tr_b16 v[160:161], v113 offset:8192
  ds_read_b64_tr_b16 v[162:163], v113 offset:8448
  ds_read_b64_tr_b16 v[164:165], v113 offset:12288
  ds_read_b64_tr_b16 v[166:167], v113 offset:12544
  ds_read_b64_tr_b16 v[168:169], v113 offset:8224
  ds_read_b64_tr_b16 v[170:171], v113 offset:8480
  ds_read_b64_tr_b16 v[172:173], v113 offset:12320
  ds_read_b64_tr_b16 v[174:175], v113 offset:12576
  ds_read_b64_tr_b16 v[176:177], v113 offset:8256
  ds_read_b64_tr_b16 v[178:179], v113 offset:8512
  ds_read_b64_tr_b16 v[180:181], v113 offset:12352
  ds_read_b64_tr_b16 v[182:183], v113 offset:12608
  s_waitcnt lgkmcnt(4)
  ds_read_b64_tr_b16 v[184:185], v113 offset:8288
  ds_read_b64_tr_b16 v[186:187], v113 offset:8544
  ds_read_b64_tr_b16 v[188:189], v113 offset:12384
  ds_read_b64_tr_b16 v[190:191], v113 offset:12640
  s_waitcnt lgkmcnt(0)
  s_add_u32 m0, s38, 8192
  s_mov_b32 s40, 0x20000
  buffer_load_dwordx4 v112, s[20:23], s40 offen lds
  s_add_u32 m0, s38, 9216
  s_mov_b32 s40, 0x24000
  buffer_load_dwordx4 v112, s[20:23], s40 offen lds
  s_add_u32 m0, s38, 10240
  s_mov_b32 s40, 0x28000
  buffer_load_dwordx4 v112, s[20:23], s40 offen lds
  s_add_u32 m0, s38, 11264
  s_mov_b32 s40, 0x2c000
  buffer_load_dwordx4 v112, s[20:23], s40 offen lds
  s_add_u32 m0, s38, 12288
  s_mov_b32 s40, 0x30000
  buffer_load_dwordx4 v112, s[20:23], s40 offen lds
  s_add_u32 m0, s38, 13312
  s_mov_b32 s40, 0x34000
  buffer_load_dwordx4 v112, s[20:23], s40 offen lds
  s_add_u32 m0, s38, 14336
  s_mov_b32 s40, 0x38000
  buffer_load_dwordx4 v112, s[20:23], s40 offen lds
  s_add_u32 m0, s38, 15360
  s_mov_b32 s40, 0x3c000
  buffer_load_dwordx4 v112, s[20:23], s40 offen lds
  s_waitcnt vmcnt(24)
  ds_read_b64_tr_b16 v[192:193], v113 offset:16384
  ds_read_b64_tr_b16 v[194:195], v113 offset:16640
  ds_read_b64_tr_b16 v[196:197], v113 offset:20480
  ds_read_b64_tr_b16 v[198:199], v113 offset:20736
  ds_read_b64_tr_b16 v[200:201], v113 offset:16416
  ds_read_b64_tr_b16 v[202:203], v113 offset:16672
  ds_read_b64_tr_b16 v[204:205], v113 offset:20512
  ds_read_b64_tr_b16 v[206:207], v113 offset:20768
  ds_read_b64_tr_b16 v[208:209], v113 offset:16448
  ds_read_b64_tr_b16 v[210:211], v113 offset:16704
  ds_read_b64_tr_b16 v[212:213], v113 offset:20544
  ds_read_b64_tr_b16 v[214:215], v113 offset:20800
  s_waitcnt lgkmcnt(4)
  ds_read_b64_tr_b16 v[216:217], v113 offset:16480
  ds_read_b64_tr_b16 v[218:219], v113 offset:16736
  ds_read_b64_tr_b16 v[220:221], v113 offset:20576
  ds_read_b64_tr_b16 v[222:223], v113 offset:20832
  s_waitcnt lgkmcnt(0)
  s_add_u32 m0, s38, 16384
  s_mov_b32 s40, 0x40000
  buffer_load_dwordx4 v112, s[20:23], s40 offen lds
  s_add_u32 m0, s38, 17408
  s_mov_b32 s40, 0x44000
  buffer_load_dwordx4 v112, s[20:23], s40 offen lds
  s_add_u32 m0, s38, 18432
  s_mov_b32 s40, 0x48000
  buffer_load_dwordx4 v112, s[20:23], s40 offen lds
  s_add_u32 m0, s38, 19456
  s_mov_b32 s40, 0x4c000
  buffer_load_dwordx4 v112, s[20:23], s40 offen lds
  s_add_u32 m0, s38, 20480
  s_mov_b32 s40, 0x50000
  buffer_load_dwordx4 v112, s[20:23], s40 offen lds
  s_add_u32 m0, s38, 21504
  s_mov_b32 s40, 0x54000
  buffer_load_dwordx4 v112, s[20:23], s40 offen lds
  s_add_u32 m0, s38, 22528
  s_mov_b32 s40, 0x58000
  buffer_load_dwordx4 v112, s[20:23], s40 offen lds
  s_add_u32 m0, s38, 23552
  s_mov_b32 s40, 0x5c000
  buffer_load_dwordx4 v112, s[20:23], s40 offen lds
  s_waitcnt vmcnt(24)
  ds_read_b64_tr_b16 v[224:225], v113 offset:24576
  ds_read_b64_tr_b16 v[226:227], v113 offset:24832
  ds_read_b64_tr_b16 v[228:229], v113 offset:28672
  ds_read_b64_tr_b16 v[230:231], v113 offset:28928
  ds_read_b64_tr_b16 v[232:233], v113 offset:24608
  ds_read_b64_tr_b16 v[234:235], v113 offset:24864
  ds_read_b64_tr_b16 v[236:237], v113 offset:28704
  ds_read_b64_tr_b16 v[238:239], v113 offset:28960
  ds_read_b64_tr_b16 v[240:241], v113 offset:24640
  ds_read_b64_tr_b16 v[242:243], v113 offset:24896
  ds_read_b64_tr_b16 v[244:245], v113 offset:28736
  ds_read_b64_tr_b16 v[246:247], v113 offset:28992
  s_waitcnt lgkmcnt(4)
  ds_read_b64_tr_b16 v[248:249], v113 offset:24672
  ds_read_b64_tr_b16 v[250:251], v113 offset:24928
  ds_read_b64_tr_b16 v[252:253], v113 offset:28768
  ds_read_b64_tr_b16 v[254:255], v113 offset:29024
  s_waitcnt lgkmcnt(0)
  s_add_u32 m0, s38, 24576
  s_mov_b32 s40, 0x60000
  buffer_load_dwordx4 v112, s[20:23], s40 offen lds
  s_add_u32 m0, s38, 25600
  s_mov_b32 s40, 0x64000
  buffer_load_dwordx4 v112, s[20:23], s40 offen lds
  s_add_u32 m0, s38, 26624
  s_mov_b32 s40, 0x68000
  buffer_load_dwordx4 v112, s[20:23], s40 offen lds
  s_add_u32 m0, s38, 27648
  s_mov_b32 s40, 0x6c000
  buffer_load_dwordx4 v112, s[20:23], s40 offen lds
  s_add_u32 m0, s38, 28672
  s_mov_b32 s40, 0x70000
  buffer_load_dwordx4 v112, s[20:23], s40 offen lds
  s_add_u32 m0, s38, 29696
  s_mov_b32 s40, 0x74000
  buffer_load_dwordx4 v112, s[20:23], s40 offen lds
  s_add_u32 m0, s38, 30720
  s_mov_b32 s40, 0x78000
  buffer_load_dwordx4 v112, s[20:23], s40 offen lds
  s_add_u32 m0, s38, 31744
  s_mov_b32 s40, 0x7c000
  buffer_load_dwordx4 v112, s[20:23], s40 offen lds
  s_waitcnt vmcnt(24)
  ds_read_b64_tr_b16 a[128:129], v114 offset:0
  ds_read_b64_tr_b16 a[130:131], v114 offset:256
  ds_read_b64_tr_b16 a[132:133], v114 offset:1024
  ds_read_b64_tr_b16 a[134:135], v114 offset:1280
  ds_read_b64_tr_b16 a[136:137], v114 offset:32
  ds_read_b64_tr_b16 a[138:139], v114 offset:288
  ds_read_b64_tr_b16 a[140:141], v114 offset:1056
  ds_read_b64_tr_b16 a[142:143], v114 offset:1312
  ds_read_b64_tr_b16 a[144:145], v114 offset:64
  ds_read_b64_tr_b16 a[146:147], v114 offset:320
  ds_read_b64_tr_b16 a[148:149], v114 offset:1088
  ds_read_b64_tr_b16 a[150:151], v114 offset:1344
  s_waitcnt lgkmcnt(4)
  ds_read_b64_tr_b16 a[152:153], v114 offset:96
  ds_read_b64_tr_b16 a[154:155], v114 offset:352
  ds_read_b64_tr_b16 a[156:157], v114 offset:1120
  ds_read_b64_tr_b16 a[158:159], v114 offset:1376
  s_waitcnt lgkmcnt(0)
  s_waitcnt vmcnt(16)
  ds_read_b64_tr_b16 a[160:161], v114 offset:8192
  ds_read_b64_tr_b16 a[162:163], v114 offset:8448
  ds_read_b64_tr_b16 a[164:165], v114 offset:9216
  ds_read_b64_tr_b16 a[166:167], v114 offset:9472
  ds_read_b64_tr_b16 a[168:169], v114 offset:8224
  ds_read_b64_tr_b16 a[170:171], v114 offset:8480
  ds_read_b64_tr_b16 a[172:173], v114 offset:9248
  ds_read_b64_tr_b16 a[174:175], v114 offset:9504
  ds_read_b64_tr_b16 a[176:177], v114 offset:8256
  ds_read_b64_tr_b16 a[178:179], v114 offset:8512
  ds_read_b64_tr_b16 a[180:181], v114 offset:9280
  ds_read_b64_tr_b16 a[182:183], v114 offset:9536
  s_waitcnt lgkmcnt(4)
  ds_read_b64_tr_b16 a[184:185], v114 offset:8288
  ds_read_b64_tr_b16 a[186:187], v114 offset:8544
  ds_read_b64_tr_b16 a[188:189], v114 offset:9312
  ds_read_b64_tr_b16 a[190:191], v114 offset:9568
  s_waitcnt lgkmcnt(0)
  s_waitcnt vmcnt(8)
  ds_read_b64_tr_b16 a[192:193], v114 offset:16384
  ds_read_b64_tr_b16 a[194:195], v114 offset:16640
  ds_read_b64_tr_b16 a[196:197], v114 offset:17408
  ds_read_b64_tr_b16 a[198:199], v114 offset:17664
  ds_read_b64_tr_b16 a[200:201], v114 offset:16416
  ds_read_b64_tr_b16 a[202:203], v114 offset:16672
  ds_read_b64_tr_b16 a[204:205], v114 offset:17440
  ds_read_b64_tr_b16 a[206:207], v114 offset:17696
  ds_read_b64_tr_b16 a[208:209], v114 offset:16448
  ds_read_b64_tr_b16 a[210:211], v114 offset:16704
  ds_read_b64_tr_b16 a[212:213], v114 offset:17472
  ds_read_b64_tr_b16 a[214:215], v114 offset:17728
  s_waitcnt lgkmcnt(4)
  ds_read_b64_tr_b16 a[216:217], v114 offset:16480
  ds_read_b64_tr_b16 a[218:219], v114 offset:16736
  ds_read_b64_tr_b16 a[220:221], v114 offset:17504
  ds_read_b64_tr_b16 a[222:223], v114 offset:17760
  s_waitcnt lgkmcnt(0)
  s_waitcnt vmcnt(0)
  ds_read_b64_tr_b16 a[224:225], v114 offset:24576
  ds_read_b64_tr_b16 a[226:227], v114 offset:24832
  ds_read_b64_tr_b16 a[228:229], v114 offset:25600
  ds_read_b64_tr_b16 a[230:231], v114 offset:25856
  ds_read_b64_tr_b16 a[232:233], v114 offset:24608
  ds_read_b64_tr_b16 a[234:235], v114 offset:24864
  ds_read_b64_tr_b16 a[236:237], v114 offset:25632
  ds_read_b64_tr_b16 a[238:239], v114 offset:25888
  ds_read_b64_tr_b16 a[240:241], v114 offset:24640
  ds_read_b64_tr_b16 a[242:243], v114 offset:24896
  ds_read_b64_tr_b16 a[244:245], v114 offset:25664
  ds_read_b64_tr_b16 a[246:247], v114 offset:25920
  s_waitcnt lgkmcnt(4)
  ds_read_b64_tr_b16 a[248:249], v114 offset:24672
  ds_read_b64_tr_b16 a[250:251], v114 offset:24928
  ds_read_b64_tr_b16 a[252:253], v114 offset:25696
  ds_read_b64_tr_b16 a[254:255], v114 offset:25952
  s_waitcnt lgkmcnt(0)
  s_lshl_b32 s36, s28, 12
  v_add_u32 v1, s36, v3
  v_and_b32 v4, 8, v0
  v_cmp_eq_u32 vcc, 0, v4
  v_mov_b32 v2, 0xeeeeeeee
  v_mov_b32 v4, 0x44444444
  v_cndmask_b32 v2, v2, v4, vcc
  v_and_b32 v4, 31, v0
  v_lshlrev_b32 v6, 4, v4
  v_lshrrev_b32 v4, 5, v0
  v_lshl_add_u32 v6, v4, 2, v6
  s_lshr_b32 s36, s28, 1
  s_lshl_b32 s36, s36, 9
  s_and_b32 s37, s28, 1
  s_lshl_b32 s37, s37, 3
  s_add_u32 s36, s36, s37
  v_add_u32 v6, s36, v6
  s_lshl_b32 s36, s29, 14
  v_add_u32 v7, s36, v1
  s_lshl_b32 s36, s28, 11
  v_add_u32 v8, s36, v12
  v_bfe_u32 v4, v0, 2, 2
  v_lshlrev_b32 v9, 9, v4
  v_bfe_u32 v4, v0, 2, 1
  v_lshl_add_u32 v9, v4, 5, v9
  v_bfe_u32 v4, v0, 3, 1
  v_lshl_add_u32 v9, v4, 7, v9
  v_bfe_u32 v4, v0, 4, 1
  v_lshl_add_u32 v9, v4, 6, v9
  v_lshrrev_b32 v4, 5, v0
  v_lshl_add_u32 v9, v4, 5, v9
  v_and_b32 v4, 3, v0
  v_lshl_add_u32 v9, v4, 3, v9
  s_lshr_b32 s36, s28, 1
  s_lshl_b32 s36, s36, 11
  s_and_b32 s37, s28, 1
  s_lshl_b32 s37, s37, 7
  s_add_u32 s36, s36, s37
  v_add_u32 v9, s36, v9
  v_and_b32 v4, 31, v0
  v_lshlrev_b32 v124, 2, v4
  v_lshrrev_b32 v4, 5, v0
  v_lshl_add_u32 v124, v4, 10, v124
  v_add_u32 v124, s36, v124
  v_bfe_u32 v4, v0, 2, 3
  v_lshlrev_b32 v125, 4, v4
  v_lshrrev_b32 v4, 5, v0
  v_lshl_add_u32 v125, v4, 8, v125
  v_bfe_u32 v4, v0, 1, 1
  v_lshl_add_u32 v125, v4, 7, v125
  v_and_b32 v4, 1, v0
  v_lshl_add_u32 v125, v4, 2, v125
  s_lshr_b32 s36, s28, 1
  s_lshl_b32 s36, s36, 9
  s_and_b32 s37, s28, 1
  s_lshl_b32 s37, s37, 3
  s_add_u32 s36, s36, s37
  v_add_u32 v125, s36, v125
  v_lshlrev_b32 v10, 3, v0
  s_lshl_b32 s36, s28, 9
  v_add_u32 v10, s36, v10
  s_lshl_b32 s36, s28, 8
  v_add_u32 v11, s36, v12
  v_add_u32 v14, s36, v3
  v_bfe_u32 v4, v0, 2, 3
  v_lshlrev_b32 v5, 11, v4
  v_lshrrev_b32 v4, 5, v0
  v_lshl_add_u32 v5, v4, 4, v5
  v_and_b32 v4, 3, v0
  v_lshl_add_u32 v5, v4, 2, v5
  s_lshl_b32 s36, s30, 7
  s_lshl_b32 s37, s28, 5
  s_add_u32 s36, s36, s37
  buffer_load_dword v104, v5, s[24:27], s36 offen
  s_waitcnt vmcnt(0)
  s_waitcnt lgkmcnt(0)
  v_mov_b32 v118, 0
sb_4:
  s_sub_u32 s48, s48, 1
  s_cbranch_scc1 L_fail
  buffer_load_dwordx4 v[114:117], v118, s[12:15], 0 offen sc1
  s_waitcnt vmcnt(0)
  v_readfirstlane_b32 s36, v114
  s_nop 3
  s_cmp_ge_u32 s36, 96
  s_cbranch_scc1 sb_5
  s_sleep 8
  s_branch sb_4
sb_5:
  v_readfirstlane_b32 s37, v115
  v_readfirstlane_b32 s81, v117
  s_nop 3
  s_lshl_b32 s38, s29, 3
  s_lshr_b32 s37, s37, s38
  s_and_b32 s37, s37, 0xff
  s_cmp_eq_u32 s37, 0
  s_cselect_b32 s31, 1, 0
  s_bcnt1_i32_b32 s36, s81
  s_cmp_ge_u32 s36, 4
  s_cselect_b32 s36, 0x2000, 0
  s_add_u32 s47, s47, s36
  s_lshl_b32 m0, s28, 12
  s_barrier
  s_cmp_eq_u32 s31, 1
  s_cbranch_scc0 sm_6
  buffer_store_dword v104, v11, s[8:11], s46 offen
sm_7:
  s_mov_b32 s32, 0
  v_mov_b32 v48, 0
  v_mov_b32 v49, 0
  v_mov_b32 v50, 0
  v_mov_b32 v51, 0
  v_mov_b32 v52, 0
  v_mov_b32 v53, 0
  v_mov_b32 v54, 0
  v_mov_b32 v55, 0
  v_mov_b32 v56, 0
  v_mov_b32 v57, 0
  v_mov_b32 v58, 0
  v_mov_b32 v59, 0
  v_mov_b32 v60, 0
  v_mov_b32 v61, 0
  v_mov_b32 v62, 0
  v_mov_b32 v63, 0
  v_mov_b32 v64, 0
  v_mov_b32 v65, 0
  v_mov_b32 v66, 0
  v_mov_b32 v67, 0
  v_mov_b32 v68, 0
  v_mov_b32 v69, 0
  v_mov_b32 v70, 0
  v_mov_b32 v71, 0
  v_mov_b32 v72, 0
  v_mov_b32 v73, 0
  v_mov_b32 v74, 0
  v_mov_b32 v75, 0
  v_mov_b32 v76, 0
  v_mov_b32 v77, 0
  v_mov_b32 v78, 0
  v_mov_b32 v79, 0
  v_mov_b32 v32, -1
  v_mov_b32 v33, -1
  v_mov_b32 v34, -1
  v_mov_b32 v35, -1
  v_mov_b32 v36, -1
  v_mov_b32 v37, -1
  v_mov_b32 v38, -1
  v_mov_b32 v39, -1
  v_mov_b32 v40, -1
  v_mov_b32 v41, -1
  v_mov_b32 v42, -1
  v_mov_b32 v43, -1
  v_mov_b32 v44, -1
  v_mov_b32 v45, -1
  v_mov_b32 v46, -1
  v_mov_b32 v47, -1
V_loop:
  s_add_u32 s85, s43, 0x4d00000
  s_add_u32 s86, s43, 0x4400000
  buffer_load_dwordx4 v[32:35], v1, s[8:11], s42 offen offset:0 sc1
  v_mov_b32 v13, v13
  v_mov_b32 v13, v13
  v_mov_b32 v13, v13
  v_mov_b32 v13, v13
  buffer_load_dwordx4 v[36:39], v1, s[8:11], s42 offen offset:1024 sc1
  v_mov_b32 v13, v13
  v_mov_b32 v13, v13
  v_mov_b32 v13, v13
  v_mov_b32 v13, v13
  buffer_load_dwordx4 v[40:43], v1, s[8:11], s42 offen offset:2048 sc1
  v_mov_b32 v13, v13
  v_mov_b32 v13, v13
  v_mov_b32 v13, v13
  v_mov_b32 v13, v13
rp_9:
  buffer_load_dwordx4 v[44:47], v1, s[8:11], s42 offen offset:3072 sc1
  s_sub_u32 s48, s48, 1
  s_cbranch_scc1 L_fail
  s_waitcnt vmcnt(3)
  v_max3_u32 v4, v32, v33, v34
  v_max_u32 v4, v4, v35
  v_cmp_eq_u32 vcc, -1, v4
  v_mov_b32 v13, v13
  v_mov_b32 v13, v13
  v_mov_b32 v13, v13
  v_mov_b32 v13, v13
  v_mov_b32 v13, v13
  s_cbranch_vccz rc_13
rp_10:
  buffer_load_dwordx4 v[32:35], v1, s[8:11], s42 offen offset:0 sc1
  s_waitcnt vmcnt(3)
  v_max3_u32 v4, v36, v37, v38
  v_max_u32 v4, v4, v39
  v_cmp_eq_u32 vcc, -1, v4
  v_mov_b32 v13, v13
  v_mov_b32 v13, v13
  v_mov_b32 v13, v13
  v_mov_b32 v13, v13
  v_mov_b32 v13, v13
  s_cbranch_vccz rc_14
rp_11:
  buffer_load_dwordx4 v[36:39], v1, s[8:11], s42 offen offset:1024 sc1
  s_waitcnt vmcnt(3)
  v_max3_u32 v4, v40, v41, v42
  v_max_u32 v4, v4, v43
  v_cmp_eq_u32 vcc, -1, v4
  v_mov_b32 v13, v13
  v_mov_b32 v13, v13
  v_mov_b32 v13, v13
  v_mov_b32 v13, v13
  v_mov_b32 v13, v13
  s_cbranch_vccz rc_15
rp_12:
  buffer_load_dwordx4 v[40:43], v1, s[8:11], s42 offen offset:2048 sc1
  s_waitcnt vmcnt(3)
  v_max3_u32 v4, v44, v45, v46
  v_max_u32 v4, v4, v47
  v_cmp_eq_u32 vcc, -1, v4
  v_mov_b32 v13, v13
  v_mov_b32 v13, v13
  v_mov_b32 v13, v13
  v_mov_b32 v13, v13
  v_mov_b32 v13, v13
  s_cbranch_vccnz rp_9
rc_16:
  v_smfmac_f32_16x16x64_bf16 v[48:51], v[44:47], a[96:103], v2
  v_max3_u32 v4, v32, v33, v34
  v_smfmac_f32_16x16x64_bf16 v[52:55], v[44:47], a[104:111], v2
  v_max_u32 v4, v4, v35
  v_smfmac_f32_16x16x64_bf16 v[56:59], v[44:47], a[112:119], v2
  v_cmp_eq_u32 vcc, -1, v4
  v_smfmac_f32_16x16x64_bf16 v[60:63], v[44:47], a[120:127], v2
  s_cbranch_vccnz rr_17
rb_18:
  v_smfmac_f32_16x16x64_bf16 v[48:51], v[32:35], a[0:7], v2
  v_max3_u32 v4, v36, v37, v38
  v_smfmac_f32_16x16x64_bf16 v[52:55], v[32:35], a[8:15], v2
  v_max_u32 v4, v4, v39
  v_smfmac_f32_16x16x64_bf16 v[56:59], v[32:35], a[16:23], v2
  v_cmp_eq_u32 vcc, -1, v4
  v_smfmac_f32_16x16x64_bf16 v[60:63], v[32:35], a[24:31], v2
  s_cbranch_vccnz rr_19
rb_20:
  v_smfmac_f32_16x16x64_bf16 v[48:51], v[36:39], a[32:39], v2
  v_max3_u32 v4, v40, v41, v42
  v_smfmac_f32_16x16x64_bf16 v[52:55], v[36:39], a[40:47], v2
  v_max_u32 v4, v4, v43
  v_smfmac_f32_16x16x64_bf16 v[56:59], v[36:39], a[48:55], v2
  v_cmp_eq_u32 vcc, -1, v4
  v_smfmac_f32_16x16x64_bf16 v[60:63], v[36:39], a[56:63], v2
  s_cbranch_vccnz rr_21
rb_22:
  v_smfmac_f32_16x16x64_bf16 v[48:51], v[40:43], a[64:71], v2
  v_smfmac_f32_16x16x64_bf16 v[52:55], v[40:43], a[72:79], v2
  v_smfmac_f32_16x16x64_bf16 v[56:59], v[40:43], a[80:87], v2
  v_smfmac_f32_16x16x64_bf16 v[60:63], v[40:43], a[88:95], v2
kj_8:
  v_permlane32_swap_b32 v48, v52
  v_permlane32_swap_b32 v49, v53
  v_permlane32_swap_b32 v50, v54
  v_permlane32_swap_b32 v51, v55
  v_add_f32 v48, v48, v52
  v_add_f32 v49, v49, v53
  v_add_f32 v50, v50, v54
  v_add_f32 v51, v51, v55
  v_permlane32_swap_b32 v56, v60
  ds_write_addtid_b32 v48 offset:32768
  v_permlane32_swap_b32 v57, v61
  ds_write_addtid_b32 v49 offset:33312
  v_permlane32_swap_b32 v58, v62
  ds_write_addtid_b32 v50 offset:33920
  v_permlane32_swap_b32 v59, v63
  ds_write_addtid_b32 v51 offset:34464
  v_add_f32 v56, v56, v60
  v_add_f32 v57, v57, v61
  v_add_f32 v58, v58, v62
  v_add_f32 v59, v59, v63
  v_smfmac_f32_16x16x64_bf16 v[64:67], v[32:35], v[128:135], v2
  ds_write_addtid_b32 v56 offset:34816
  ds_write_addtid_b32 v57 offset:35360
  ds_write_addtid_b32 v58 offset:35968
  ds_write_addtid_b32 v59 offset:36512
  v_smfmac_f32_16x16x64_bf16 v[68:71], v[32:35], v[136:143], v2
  v_smfmac_f32_16x16x64_bf16 v[64:67], v[36:39], v[160:167], v2
  v_smfmac_f32_16x16x64_bf16 v[68:71], v[36:39], v[168:175], v2
  s_waitcnt lgkmcnt(0)
  s_barrier
  s_cmp_eq_u32 s31, 1
  ds_read_b64 v[96:97], v9 offset:32768
  ds_read_b64 v[98:99], v9 offset:36864
  v_smfmac_f32_16x16x64_bf16 v[64:67], v[40:43], v[192:199], v2
  ds_read_b64 v[100:101], v9 offset:40960
  ds_read_b64 v[102:103], v9 offset:45056
  v_smfmac_f32_16x16x64_bf16 v[68:71], v[40:43], v[200:207], v2
  v_smfmac_f32_16x16x64_bf16 v[64:67], v[44:47], v[224:231], v2
  v_smfmac_f32_16x16x64_bf16 v[68:71], v[44:47], v[232:239], v2
  s_waitcnt lgkmcnt(2)
  v_add_f32 v96, v96, v98
  v_add_f32 v97, v97, v99
  s_waitcnt lgkmcnt(0)
  v_add_f32 v100, v100, v102
  v_add_f32 v101, v101, v103
  v_add_f32 v96, v96, v100
  v_add_f32 v97, v97, v101
  v_cvt_pk_bf16_f32 v112, v96, v97
  s_cbranch_scc0 sm_23
  buffer_store_dword v112, v125, s[8:11], s85 offen
sm_24:
  v_smfmac_f32_16x16x64_bf16 v[72:75], v[32:35], v[144:151], v2
  v_smfmac_f32_16x16x64_bf16 v[76:79], v[32:35], v[152:159], v2
  v_smfmac_f32_16x16x64_bf16 v[72:75], v[36:39], v[176:183], v2
  v_smfmac_f32_16x16x64_bf16 v[76:79], v[36:39], v[184:191], v2
  v_smfmac_f32_16x16x64_bf16 v[72:75], v[40:43], v[208:215], v2
  v_smfmac_f32_16x16x64_bf16 v[76:79], v[40:43], v[216:223], v2
  v_smfmac_f32_16x16x64_bf16 v[72:75], v[44:47], v[240:247], v2
  v_smfmac_f32_16x16x64_bf16 v[76:79], v[44:47], v[248:255], v2
  v_permlane32_swap_b32 v64, v68
  v_permlane32_swap_b32 v65, v69
  v_permlane32_swap_b32 v66, v70
  v_permlane32_swap_b32 v67, v71
  v_add_f32 v64, v64, v68
  v_add_f32 v65, v65, v69
  v_add_f32 v66, v66, v70
  v_add_f32 v67, v67, v71
  v_permlane32_swap_b32 v72, v76
  ds_write_addtid_b32 v64 offset:0
  v_permlane32_swap_b32 v73, v77
  ds_write_addtid_b32 v65 offset:512
  v_permlane32_swap_b32 v74, v78
  ds_write_addtid_b32 v66 offset:1024
  v_permlane32_swap_b32 v75, v79
  ds_write_addtid_b32 v67 offset:1536
  v_add_f32 v72, v72, v76
  v_add_f32 v73, v73, v77
  v_add_f32 v74, v74, v78
  v_add_f32 v75, v75, v79
  v_mfma_f32_32x32x16_bf16 v[16:31], v[120:123], v[120:123], v[16:31]
  ds_write_addtid_b32 v72 offset:2048
  ds_write_addtid_b32 v73 offset:2560
  ds_write_addtid_b32 v74 offset:3072
  ds_write_addtid_b32 v75 offset:3584
  v_mfma_f32_32x32x16_bf16 v[16:31], v[120:123], v[120:123], v[16:31]
  s_waitcnt lgkmcnt(0)
  s_barrier
  ds_read2st64_b32 v[96:97], v124 offset0:0 offset1:2
  ds_read2st64_b32 v[98:99], v124 offset0:16 offset1:18
  v_mfma_f32_32x32x16_bf16 v[16:31], v[120:123], v[120:123], v[16:31]
  ds_read2st64_b32 v[100:101], v124 offset0:32 offset1:34
  ds_read2st64_b32 v[102:103], v124 offset0:48 offset1:50
  v_mfma_f32_32x32x16_bf16 v[16:31], v[120:123], v[120:123], v[16:31]
  s_waitcnt lgkmcnt(2)
  v_add_f32 v96, v96, v98
  v_add_f32 v97, v97, v99
  s_waitcnt lgkmcnt(0)
  v_add_f32 v100, v100, v102
  v_add_f32 v101, v101, v103
  v_add_f32 v96, v96, v100
  v_add_f32 v97, v97, v101
  v_cvt_pk_bf16_f32 v113, v96, v97
  s_cbranch_scc0 sm_25
  buffer_store_dword v113, v6, s[8:11], s86 offen
sm_26:
  s_cmp_eq_u32 s32, 63
  s_cbranch_scc1 L_done
  s_waitcnt vmcnt(2)
  v_mov_b32 v48, 0
  v_mov_b32 v49, 0
  v_mov_b32 v50, 0
  v_mov_b32 v51, 0
  v_mov_b32 v52, 0
  v_mov_b32 v53, 0
  v_mov_b32 v54, 0
  v_mov_b32 v55, 0
  v_mov_b32 v56, 0
  v_mov_b32 v57, 0
  v_mov_b32 v58, 0
  v_mov_b32 v59, 0
  v_mov_b32 v60, 0
  v_mov_b32 v61, 0
  v_mov_b32 v62, 0
  v_mov_b32 v63, 0
  v_mov_b32 v64, 0
  v_mov_b32 v65, 0
  v_mov_b32 v66, 0
  v_mov_b32 v67, 0
  v_mov_b32 v68, 0
  v_mov_b32 v69, 0
  v_mov_b32 v70, 0
  v_mov_b32 v71, 0
  v_mov_b32 v72, 0
  v_mov_b32 v73, 0
  v_mov_b32 v74, 0
  v_mov_b32 v75, 0
  v_mov_b32 v76, 0
  v_mov_b32 v77, 0
  v_mov_b32 v78, 0
  v_mov_b32 v79, 0
  v_mov_b32 v32, -1
  v_mov_b32 v80, -1
  v_mov_b32 v33, -1
  v_mov_b32 v81, -1
  v_mov_b32 v34, -1
  v_mov_b32 v82, -1
  v_mov_b32 v35, -1
  v_mov_b32 v83, -1
  v_mov_b32 v36, -1
  v_mov_b32 v84, -1
  v_mov_b32 v37, -1
  v_mov_b32 v85, -1
  v_mov_b32 v38, -1
  v_mov_b32 v86, -1
  v_mov_b32 v39, -1
  v_mov_b32 v87, -1
  v_mov_b32 v40, -1
  v_mov_b32 v88, -1
  v_mov_b32 v41, -1
  v_mov_b32 v89, -1
  v_mov_b32 v42, -1
  v_mov_b32 v90, -1
  v_mov_b32 v43, -1
  v_mov_b32 v91, -1
  v_mov_b32 v44, -1
  v_mov_b32 v92, -1
  v_mov_b32 v45, -1
  v_mov_b32 v93, -1
  v_mov_b32 v46, -1
  v_mov_b32 v94, -1
  v_mov_b32 v47, -1
  v_mov_b32 v95, -1
  v_mov_b32 v104, -1
  v_mov_b32 v105, -1
  v_mov_b32 v106, -1
  v_mov_b32 v107, -1
  v_mov_b32 v108, -1
  v_mov_b32 v109, -1
  s_and_b32 s88, s32, 7
  s_lshl_b32 s88, s88, 16
  s_add_u32 s88, s88, 0x4800000
  s_mov_b32 s82, s47
  s_xor_b32 s37, s82, 0x10000
  s_xor_b32 s38, s82, 0x20000
  s_xor_b32 s39, s82, 0x30000
  buffer_load_dwordx4 v[80:83], v7, s[8:11], s88 offen offset:0 sc1
  v_mov_b32 v13, v13
  v_mov_b32 v13, v13
  v_mov_b32 v13, v13
  v_mov_b32 v13, v13
  buffer_load_dwordx4 v[84:87], v7, s[8:11], s88 offen offset:1024 sc1
  v_mov_b32 v13, v13
  v_mov_b32 v13, v13
  v_mov_b32 v13, v13
  v_mov_b32 v13, v13
  buffer_load_dwordx4 v[88:91], v7, s[8:11], s88 offen offset:2048 sc1
  v_mov_b32 v13, v13
  v_mov_b32 v13, v13
  v_mov_b32 v13, v13
  v_mov_b32 v13, v13
rp_28:
  buffer_load_dwordx4 v[92:95], v7, s[8:11], s88 offen offset:3072 sc1
  s_sub_u32 s48, s48, 1
  s_cbranch_scc1 L_fail
  s_waitcnt vmcnt(3)
  v_max3_u32 v4, v80, v81, v82
  v_max_u32 v4, v4, v83
  v_cmp_eq_u32 vcc, -1, v4
  v_mov_b32 v13, v13
  v_mov_b32 v13, v13
  v_mov_b32 v13, v13
  v_mov_b32 v13, v13
  v_mov_b32 v13, v13
  s_cbranch_vccz rc_32
rp_29:
  buffer_load_dwordx4 v[80:83], v7, s[8:11], s88 offen offset:0 sc1
  s_waitcnt vmcnt(3)
  v_max3_u32 v4, v84, v85, v86
  v_max_u32 v4, v4, v87
  v_cmp_eq_u32 vcc, -1, v4
  v_mov_b32 v13, v13
  v_mov_b32 v13, v13
  v_mov_b32 v13, v13
  v_mov_b32 v13, v13
  v_mov_b32 v13, v13
  s_cbranch_vccz rc_33
rp_30:
  buffer_load_dwordx4 v[84:87], v7, s[8:11], s88 offen offset:1024 sc1
  s_waitcnt vmcnt(3)
  v_max3_u32 v4, v88, v89, v90
  v_max_u32 v4, v4, v91
  v_cmp_eq_u32 vcc, -1, v4
  v_mov_b32 v13, v13
  v_mov_b32 v13, v13
  v_mov_b32 v13, v13
  v_mov_b32 v13, v13
  v_mov_b32 v13, v13
  s_cbranch_vccz rc_34
rp_31:
  buffer_load_dwordx4 v[88:91], v7, s[8:11], s88 offen offset:2048 sc1
  s_waitcnt vmcnt(3)
  v_max3_u32 v4, v92, v93, v94
  v_max_u32 v4, v4, v95
  v_cmp_eq_u32 vcc, -1, v4
  v_mov_b32 v13, v13
  v_mov_b32 v13, v13
  v_mov_b32 v13, v13
  v_mov_b32 v13, v13
  v_mov_b32 v13, v13
  s_cbranch_vccnz rp_28
rc_35:
  v_smfmac_f32_16x16x64_bf16 v[48:51], v[92:95], a[224:231], v2
  v_max3_u32 v4, v80, v81, v82
  v_smfmac_f32_16x16x64_bf16 v[52:55], v[92:95], a[232:239], v2
  v_max_u32 v4, v4, v83
  v_smfmac_f32_16x16x64_bf16 v[56:59], v[92:95], a[240:247], v2
  v_cmp_eq_u32 vcc, -1, v4
  v_smfmac_f32_16x16x64_bf16 v[60:63], v[92:95], a[248:255], v2
  s_cbranch_vccnz rr_36
rb_37:
  v_smfmac_f32_16x16x64_bf16 v[48:51], v[80:83], a[128:135], v2
  v_max3_u32 v4, v84, v85, v86
  v_smfmac_f32_16x16x64_bf16 v[52:55], v[80:83], a[136:143], v2
  v_max_u32 v4, v4, v87
  v_smfmac_f32_16x16x64_bf16 v[56:59], v[80:83], a[144:151], v2
  v_cmp_eq_u32 vcc, -1, v4
  v_smfmac_f32_16x16x64_bf16 v[60:63], v[80:83], a[152:159], v2
  s_cbranch_vccnz rr_38
rb_39:
  v_smfmac_f32_16x16x64_bf16 v[48:51], v[84:87], a[160:167], v2
  v_max3_u32 v4, v88, v89, v90
  v_smfmac_f32_16x16x64_bf16 v[52:55], v[84:87], a[168:175], v2
  v_max_u32 v4, v4, v91
  v_smfmac_f32_16x16x64_bf16 v[56:59], v[84:87], a[176:183], v2
  v_cmp_eq_u32 vcc, -1, v4
  v_smfmac_f32_16x16x64_bf16 v[60:63], v[84:87], a[184:191], v2
  s_cbranch_vccnz rr_40
rb_41:
  v_smfmac_f32_16x16x64_bf16 v[48:51], v[88:91], a[192:199], v2
  v_smfmac_f32_16x16x64_bf16 v[52:55], v[88:91], a[200:207], v2
  v_smfmac_f32_16x16x64_bf16 v[56:59], v[88:91], a[208:215], v2
  v_smfmac_f32_16x16x64_bf16 v[60:63], v[88:91], a[216:223], v2
kj_27:
  v_permlane32_swap_b32 v48, v52
  v_permlane32_swap_b32 v49, v53
  v_permlane32_swap_b32 v50, v54
  v_permlane32_swap_b32 v51, v55
  v_add_f32 v48, v48, v52
  v_add_f32 v49, v49, v53
  v_add_f32 v50, v50, v54
  v_add_f32 v51, v51, v55
  v_permlane32_swap_b32 v56, v60
  ds_write_addtid_b32 v48 offset:16384
  v_permlane32_swap_b32 v57, v61
  ds_write_addtid_b32 v49 offset:16928
  v_permlane32_swap_b32 v58, v62
  ds_write_addtid_b32 v50 offset:17536
  v_permlane32_swap_b32 v59, v63
  ds_write_addtid_b32 v51 offset:18080
  v_add_f32 v56, v56, v60
  v_add_f32 v57, v57, v61
  v_add_f32 v58, v58, v62
  v_add_f32 v59, v59, v63
  v_mfma_f32_32x32x16_bf16 v[16:31], v[120:123], v[120:123], v[16:31]
  ds_write_addtid_b32 v56 offset:18432
  ds_write_addtid_b32 v57 offset:18976
  ds_write_addtid_b32 v58 offset:19584
  ds_write_addtid_b32 v59 offset:20128
  v_mfma_f32_32x32x16_bf16 v[16:31], v[120:123], v[120:123], v[16:31]
  s_waitcnt lgkmcnt(0)
  s_barrier
  ds_read_b64 v[96:97], v9 offset:16384
  ds_read_b64 v[98:99], v9 offset:20480
  v_mfma_f32_32x32x16_bf16 v[16:31], v[120:123], v[120:123], v[16:31]
  ds_read_b64 v[100:101], v9 offset:24576
  ds_read_b64 v[102:103], v9 offset:28672
  v_mfma_f32_32x32x16_bf16 v[16:31], v[120:123], v[120:123], v[16:31]
  s_waitcnt lgkmcnt(2)
  v_add_f32 v96, v96, v98
  v_add_f32 v97, v97, v99
  s_waitcnt lgkmcnt(0)
  v_add_f32 v100, v100, v102
  v_add_f32 v101, v101, v103
  v_add_f32 v96, v96, v100
  v_add_f32 v97, v97, v101
  buffer_store_dwordx2 v[96:97], v10, s[8:11], s82 offen sc1
  s_add_u32 s46, s46, 0x4000
  s_bitset0_b32 s46, 17
  s_add_u32 s42, s42, 0x4000
  s_bitset0_b32 s42, 17
  s_add_u32 s43, s43, 0x10000
  s_bitset0_b32 s43, 19
  s_add_u32 s47, s47, 0x40000
  s_bitset0_b32 s47, 21
  s_sleep 3
  v_mov_b32 v48, 0
  v_mov_b32 v49, 0
  v_mov_b32 v50, 0
  v_mov_b32 v51, 0
  v_mov_b32 v52, 0
  v_mov_b32 v53, 0
  v_mov_b32 v54, 0
  v_mov_b32 v55, 0
  v_mov_b32 v56, 0
  v_mov_b32 v57, 0
  v_mov_b32 v58, 0
  v_mov_b32 v59, 0
  v_mov_b32 v60, 0
  v_mov_b32 v61, 0
  v_mov_b32 v62, 0
  v_mov_b32 v63, 0
  v_mov_b32 v13, v13
  v_mov_b32 v13, v13
  v_mov_b32 v13, v13
  v_mov_b32 v13, v13
  v_mov_b32 v13, v13
  v_mov_b32 v13, v13
  v_mov_b32 v13, v13
  v_mov_b32 v13, v13
  v_mov_b32 v13, v13
  v_mov_b32 v13, v13
  v_mov_b32 v13, v13
  v_mov_b32 v13, v13
sp_42:
  v_mov_b32 v13, v13
  buffer_load_dwordx2 v[104:105], v10, s[8:11], s37 offen sc1
  buffer_load_dwordx2 v[106:107], v10, s[8:11], s38 offen sc1
  buffer_load_dwordx2 v[108:109], v10, s[8:11], s39 offen sc1
  v_mov_b32 v13, v13
  s_sub_u32 s48, s48, 1
  s_cbranch_scc1 L_fail
  s_waitcnt vmcnt(30)
  v_max3_u32 v4, v104, v105, v106
  v_max3_u32 v4, v4, v107, v108
  v_max_u32 v4, v4, v109
  v_cmp_eq_u32 vcc, -1, v4
  v_mov_b32 v13, v13
  v_mov_b32 v13, v13
  v_mov_b32 v13, v13
  v_mov_b32 v13, v13
  v_mov_b32 v13, v13
  s_cbranch_vccz so_43
  v_max3_u32 v4, v104, v105, v106
  v_max3_u32 v4, v4, v107, v108
  v_max_u32 v4, v4, v109
  v_cmp_eq_u32 vcc, -1, v4
  v_mov_b32 v13, v13
  v_mov_b32 v13, v13
  v_mov_b32 v13, v13
  v_mov_b32 v13, v13
  v_mov_b32 v13, v13
  s_cbranch_vccz so_43
  v_max3_u32 v4, v104, v105, v106
  v_max3_u32 v4, v4, v107, v108
  v_max_u32 v4, v4, v109
  v_cmp_eq_u32 vcc, -1, v4
  v_mov_b32 v13, v13
  v_mov_b32 v13, v13
  v_mov_b32 v13, v13
  v_mov_b32 v13, v13
  v_mov_b32 v13, v13
  s_cbranch_vccz so_43
  v_max3_u32 v4, v104, v105, v106
  v_max3_u32 v4, v4, v107, v108
  v_max_u32 v4, v4, v109
  v_cmp_eq_u32 vcc, -1, v4
  v_mov_b32 v13, v13
  v_mov_b32 v13, v13
  v_mov_b32 v13, v13
  v_mov_b32 v13, v13
  v_mov_b32 v13, v13
  s_cbranch_vccz so_43
  v_max3_u32 v4, v104, v105, v106
  v_max3_u32 v4, v4, v107, v108
  v_max_u32 v4, v4, v109
  v_cmp_eq_u32 vcc, -1, v4
  v_mov_b32 v13, v13
  v_mov_b32 v13, v13
  v_mov_b32 v13, v13
  v_mov_b32 v13, v13
  v_mov_b32 v13, v13
  s_cbranch_vccnz sp_42
so_43:
  s_cmp_eq_u32 s31, 1
  v_pk_add_f32 v[96:97], v[96:97], v[104:105]
  v_pk_add_f32 v[98:99], v[106:107], v[108:109]
  v_pk_add_f32 v[96:97], v[96:97], v[98:99]
  v_cvt_pk_bf16_f32 v112, v96, v97
  s_cbranch_scc0 sm_44
  buffer_store_dword v112, v11, s[8:11], s46 offen
sm_45:
  s_add_u32 s32, s32, 1
  s_branch V_loop
sm_6:
  buffer_store_dword v104, v11, s[8:11], s46 offen sc1
  s_branch sm_7
rr_17:
  buffer_load_dwordx4 v[32:35], v1, s[8:11], s42 offen offset:0 sc1
  buffer_load_dwordx4 v[36:39], v1, s[8:11], s42 offen offset:1024 sc1
  buffer_load_dwordx4 v[40:43], v1, s[8:11], s42 offen offset:2048 sc1
  v_max3_u32 v4, v32, v33, v34
  v_max_u32 v4, v4, v35
  v_cmp_eq_u32 vcc, -1, v4
  v_mov_b32 v13, v13
  v_mov_b32 v13, v13
  v_mov_b32 v13, v13
  v_mov_b32 v13, v13
  v_mov_b32 v13, v13
  s_cbranch_vccz rb_18
  v_max3_u32 v4, v32, v33, v34
  v_max_u32 v4, v4, v35
  v_cmp_eq_u32 vcc, -1, v4
  v_mov_b32 v13, v13
  v_mov_b32 v13, v13
  v_mov_b32 v13, v13
  v_mov_b32 v13, v13
  v_mov_b32 v13, v13
  s_cbranch_vccz rb_18
  v_max3_u32 v4, v32, v33, v34
  v_max_u32 v4, v4, v35
  v_cmp_eq_u32 vcc, -1, v4
  v_mov_b32 v13, v13
  v_mov_b32 v13, v13
  v_mov_b32 v13, v13
  v_mov_b32 v13, v13
  v_mov_b32 v13, v13
  s_cbranch_vccz rb_18
  s_sub_u32 s48, s48, 1
  s_cbranch_scc1 L_fail
  s_waitcnt vmcnt(8)
  s_branch rr_17
rr_19:
  buffer_load_dwordx4 v[36:39], v1, s[8:11], s42 offen offset:1024 sc1
  buffer_load_dwordx4 v[40:43], v1, s[8:11], s42 offen offset:2048 sc1
  v_max3_u32 v4, v36, v37, v38
  v_max_u32 v4, v4, v39
  v_cmp_eq_u32 vcc, -1, v4
  v_mov_b32 v13, v13
  v_mov_b32 v13, v13
  v_mov_b32 v13, v13
  v_mov_b32 v13, v13
  v_mov_b32 v13, v13
  s_cbranch_vccz rb_20
  v_max3_u32 v4, v36, v37, v38
  v_max_u32 v4, v4, v39
  v_cmp_eq_u32 vcc, -1, v4
  v_mov_b32 v13, v13
  v_mov_b32 v13, v13
  v_mov_b32 v13, v13
  v_mov_b32 v13, v13
  v_mov_b32 v13, v13
  s_cbranch_vccz rb_20
  s_sub_u32 s48, s48, 1
  s_cbranch_scc1 L_fail
  s_waitcnt vmcnt(8)
  s_branch rr_19
rr_21:
  buffer_load_dwordx4 v[40:43], v1, s[8:11], s42 offen offset:2048 sc1
  v_max3_u32 v4, v40, v41, v42
  v_max_u32 v4, v4, v43
  v_cmp_eq_u32 vcc, -1, v4
  v_mov_b32 v13, v13
  v_mov_b32 v13, v13
  v_mov_b32 v13, v13
  v_mov_b32 v13, v13
  v_mov_b32 v13, v13
  s_cbranch_vccz rb_22
  s_sub_u32 s48, s48, 1
  s_cbranch_scc1 L_fail
  s_waitcnt vmcnt(8)
  s_branch rr_21
rc_13:
  v_smfmac_f32_16x16x64_bf16 v[48:51], v[32:35], a[0:7], v2
  v_max3_u32 v4, v36, v37, v38
  v_smfmac_f32_16x16x64_bf16 v[52:55], v[32:35], a[8:15], v2
  v_max_u32 v4, v4, v39
  v_smfmac_f32_16x16x64_bf16 v[56:59], v[32:35], a[16:23], v2
  v_cmp_eq_u32 vcc, -1, v4
  v_smfmac_f32_16x16x64_bf16 v[60:63], v[32:35], a[24:31], v2
  s_cbranch_vccnz rr_46
rb_47:
  v_smfmac_f32_16x16x64_bf16 v[48:51], v[36:39], a[32:39], v2
  v_max3_u32 v4, v40, v41, v42
  v_smfmac_f32_16x16x64_bf16 v[52:55], v[36:39], a[40:47], v2
  v_max_u32 v4, v4, v43
  v_smfmac_f32_16x16x64_bf16 v[56:59], v[36:39], a[48:55], v2
  v_cmp_eq_u32 vcc, -1, v4
  v_smfmac_f32_16x16x64_bf16 v[60:63], v[36:39], a[56:63], v2
  s_cbranch_vccnz rr_48
rb_49:
  v_smfmac_f32_16x16x64_bf16 v[48:51], v[40:43], a[64:71], v2
  v_max3_u32 v4, v44, v45, v46
  v_smfmac_f32_16x16x64_bf16 v[52:55], v[40:43], a[72:79], v2
  v_max_u32 v4, v4, v47
  v_smfmac_f32_16x16x64_bf16 v[56:59], v[40:43], a[80:87], v2
  v_cmp_eq_u32 vcc, -1, v4
  v_smfmac_f32_16x16x64_bf16 v[60:63], v[40:43], a[88:95], v2
  s_cbranch_vccnz rr_50
rb_51:
  v_smfmac_f32_16x16x64_bf16 v[48:51], v[44:47], a[96:103], v2
  v_smfmac_f32_16x16x64_bf16 v[52:55], v[44:47], a[104:111], v2
  v_smfmac_f32_16x16x64_bf16 v[56:59], v[44:47], a[112:119], v2
  v_smfmac_f32_16x16x64_bf16 v[60:63], v[44:47], a[120:127], v2
  s_branch kj_8
rc_14:
  v_smfmac_f32_16x16x64_bf16 v[48:51], v[36:39], a[32:39], v2
  v_max3_u32 v4, v40, v41, v42
  v_smfmac_f32_16x16x64_bf16 v[52:55], v[36:39], a[40:47], v2
  v_max_u32 v4, v4, v43
  v_smfmac_f32_16x16x64_bf16 v[56:59], v[36:39], a[48:55], v2
  v_cmp_eq_u32 vcc, -1, v4
  v_smfmac_f32_16x16x64_bf16 v[60:63], v[36:39], a[56:63], v2
  s_cbranch_vccnz rr_52
rb_53:
  v_smfmac_f32_16x16x64_bf16 v[48:51], v[40:43], a[64:71], v2
  v_max3_u32 v4, v44, v45, v46
  v_smfmac_f32_16x16x64_bf16 v[52:55], v[40:43], a[72:79], v2
  v_max_u32 v4, v4, v47
  v_smfmac_f32_16x16x64_bf16 v[56:59], v[40:43], a[80:87], v2
  v_cmp_eq_u32 vcc, -1, v4
  v_smfmac_f32_16x16x64_bf16 v[60:63], v[40:43], a[88:95], v2
  s_cbranch_vccnz rr_54
rb_55:
  v_smfmac_f32_16x16x64_bf16 v[48:51], v[44:47], a[96:103], v2
  v_max3_u32 v4, v32, v33, v34
  v_smfmac_f32_16x16x64_bf16 v[52:55], v[44:47], a[104:111], v2
  v_max_u32 v4, v4, v35
  v_smfmac_f32_16x16x64_bf16 v[56:59], v[44:47], a[112:119], v2
  v_cmp_eq_u32 vcc, -1, v4
  v_smfmac_f32_16x16x64_bf16 v[60:63], v[44:47], a[120:127], v2
  s_cbranch_vccnz rr_56
rb_57:
  v_smfmac_f32_16x16x64_bf16 v[48:51], v[32:35], a[0:7], v2
  v_smfmac_f32_16x16x64_bf16 v[52:55], v[32:35], a[8:15], v2
  v_smfmac_f32_16x16x64_bf16 v[56:59], v[32:35], a[16:23], v2
  v_smfmac_f32_16x16x64_bf16 v[60:63], v[32:35], a[24:31], v2
  s_branch kj_8
rc_15:
  v_smfmac_f32_16x16x64_bf16 v[48:51], v[40:43], a[64:71], v2
  v_max3_u32 v4, v44, v45, v46
  v_smfmac_f32_16x16x64_bf16 v[52:55], v[40:43], a[72:79], v2
  v_max_u32 v4, v4, v47
  v_smfmac_f32_16x16x64_bf16 v[56:59], v[40:43], a[80:87], v2
  v_cmp_eq_u32 vcc, -1, v4
  v_smfmac_f32_16x16x64_bf16 v[60:63], v[40:43], a[88:95], v2
  s_cbranch_vccnz rr_58
rb_59:
  v_smfmac_f32_16x16x64_bf16 v[48:51], v[44:47], a[96:103], v2
  v_max3_u32 v4, v32, v33, v34
  v_smfmac_f32_16x16x64_bf16 v[52:55], v[44:47], a[104:111], v2
  v_max_u32 v4, v4, v35
  v_smfmac_f32_16x16x64_bf16 v[56:59], v[44:47], a[112:119], v2
  v_cmp_eq_u32 vcc, -1, v4
  v_smfmac_f32_16x16x64_bf16 v[60:63], v[44:47], a[120:127], v2
  s_cbranch_vccnz rr_60
rb_61:
  v_smfmac_f32_16x16x64_bf16 v[48:51], v[32:35], a[0:7], v2
  v_max3_u32 v4, v36, v37, v38
  v_smfmac_f32_16x16x64_bf16 v[52:55], v[32:35], a[8:15], v2
  v_max_u32 v4, v4, v39
  v_smfmac_f32_16x16x64_bf16 v[56:59], v[32:35], a[16:23], v2
  v_cmp_eq_u32 vcc, -1, v4
  v_smfmac_f32_16x16x64_bf16 v[60:63], v[32:35], a[24:31], v2
  s_cbranch_vccnz rr_62
rb_63:
  v_smfmac_f32_16x16x64_bf16 v[48:51], v[36:39], a[32:39], v2
  v_smfmac_f32_16x16x64_bf16 v[52:55], v[36:39], a[40:47], v2
  v_smfmac_f32_16x16x64_bf16 v[56:59], v[36:39], a[48:55], v2
  v_smfmac_f32_16x16x64_bf16 v[60:63], v[36:39], a[56:63], v2
  s_branch kj_8
sm_23:
  buffer_store_dword v112, v125, s[8:11], s85 offen sc1
  s_branch sm_24
sm_25:
  buffer_store_dword v113, v6, s[8:11], s86 offen sc1
  s_branch sm_26
rr_36:
  buffer_load_dwordx4 v[80:83], v7, s[8:11], s88 offen offset:0 sc1
  buffer_load_dwordx4 v[84:87], v7, s[8:11], s88 offen offset:1024 sc1
  buffer_load_dwordx4 v[88:91], v7, s[8:11], s88 offen offset:2048 sc1
  v_max3_u32 v4, v80, v81, v82
  v_max_u32 v4, v4, v83
  v_cmp_eq_u32 vcc, -1, v4
  v_mov_b32 v13, v13
  v_mov_b32 v13, v13
  v_mov_b32 v13, v13
  v_mov_b32 v13, v13
  v_mov_b32 v13, v13
  s_cbranch_vccz rb_37
  v_max3_u32 v4, v80, v81, v82
  v_max_u32 v4, v4, v83
  v_cmp_eq_u32 vcc, -1, v4
  v_mov_b32 v13, v13
  v_mov_b32 v13, v13
  v_mov_b32 v13, v13
  v_mov_b32 v13, v13
  v_mov_b32 v13, v13
  s_cbranch_vccz rb_37
  v_max3_u32 v4, v80, v81, v82
  v_max_u32 v4, v4, v83
  v_cmp_eq_u32 vcc, -1, v4
  v_mov_b32 v13, v13
  v_mov_b32 v13, v13
  v_mov_b32 v13, v13
  v_mov_b32 v13, v13
  v_mov_b32 v13, v13
  s_cbranch_vccz rb_37
  s_sub_u32 s48, s48, 1
  s_cbranch_scc1 L_fail
  s_waitcnt vmcnt(8)
  s_branch rr_36
rr_38:
  buffer_load_dwordx4 v[84:87], v7, s[8:11], s88 offen offset:1024 sc1
  buffer_load_dwordx4 v[88:91], v7, s[8:11], s88 offen offset:2048 sc1
  v_max3_u32 v4, v84, v85, v86
  v_max_u32 v4, v4, v87
  v_cmp_eq_u32 vcc, -1, v4
  v_mov_b32 v13, v13
  v_mov_b32 v13, v13
  v_mov_b32 v13, v13
  v_mov_b32 v13, v13
  v_mov_b32 v13, v13
  s_cbranch_vccz rb_39
  v_max3_u32 v4, v84, v85, v86
  v_max_u32 v4, v4, v87
  v_cmp_eq_u32 vcc, -1, v4
  v_mov_b32 v13, v13
  v_mov_b32 v13, v13
  v_mov_b32 v13, v13
  v_mov_b32 v13, v13
  v_mov_b32 v13, v13
  s_cbranch_vccz rb_39
  s_sub_u32 s48, s48, 1
  s_cbranch_scc1 L_fail
  s_waitcnt vmcnt(8)
  s_branch rr_38
rr_40:
  buffer_load_dwordx4 v[88:91], v7, s[8:11], s88 offen offset:2048 sc1
  v_max3_u32 v4, v88, v89, v90
  v_max_u32 v4, v4, v91
  v_cmp_eq_u32 vcc, -1, v4
  v_mov_b32 v13, v13
  v_mov_b32 v13, v13
  v_mov_b32 v13, v13
  v_mov_b32 v13, v13
  v_mov_b32 v13, v13
  s_cbranch_vccz rb_41
  s_sub_u32 s48, s48, 1
  s_cbranch_scc1 L_fail
  s_waitcnt vmcnt(8)
  s_branch rr_40
rc_32:
  v_smfmac_f32_16x16x64_bf16 v[48:51], v[80:83], a[128:135], v2
  v_max3_u32 v4, v84, v85, v86
  v_smfmac_f32_16x16x64_bf16 v[52:55], v[80:83], a[136:143], v2
  v_max_u32 v4, v4, v87
  v_smfmac_f32_16x16x64_bf16 v[56:59], v[80:83], a[144:151], v2
  v_cmp_eq_u32 vcc, -1, v4
  v_smfmac_f32_16x16x64_bf16 v[60:63], v[80:83], a[152:159], v2
  s_cbranch_vccnz rr_64
rb_65:
  v_smfmac_f32_16x16x64_bf16 v[48:51], v[84:87], a[160:167], v2
  v_max3_u32 v4, v88, v89, v90
  v_smfmac_f32_16x16x64_bf16 v[52:55], v[84:87], a[168:175], v2
  v_max_u32 v4, v4, v91
  v_smfmac_f32_16x16x64_bf16 v[56:59], v[84:87], a[176:183], v2
  v_cmp_eq_u32 vcc, -1, v4
  v_smfmac_f32_16x16x64_bf16 v[60:63], v[84:87], a[184:191], v2
  s_cbranch_vccnz rr_66
rb_67:
  v_smfmac_f32_16x16x64_bf16 v[48:51], v[88:91], a[192:199], v2
  v_max3_u32 v4, v92, v93, v94
  v_smfmac_f32_16x16x64_bf16 v[52:55], v[88:91], a[200:207], v2
  v_max_u32 v4, v4, v95
  v_smfmac_f32_16x16x64_bf16 v[56:59], v[88:91], a[208:215], v2
  v_cmp_eq_u32 vcc, -1, v4
  v_smfmac_f32_16x16x64_bf16 v[60:63], v[88:91], a[216:223], v2
  s_cbranch_vccnz rr_68
rb_69:
  v_smfmac_f32_16x16x64_bf16 v[48:51], v[92:95], a[224:231], v2
  v_smfmac_f32_16x16x64_bf16 v[52:55], v[92:95], a[232:239], v2
  v_smfmac_f32_16x16x64_bf16 v[56:59], v[92:95], a[240:247], v2
  v_smfmac_f32_16x16x64_bf16 v[60:63], v[92:95], a[248:255], v2
  s_branch kj_27
rc_33:
  v_smfmac_f32_16x16x64_bf16 v[48:51], v[84:87], a[160:167], v2
  v_max3_u32 v4, v88, v89, v90
  v_smfmac_f32_16x16x64_bf16 v[52:55], v[84:87], a[168:175], v2
  v_max_u32 v4, v4, v91
  v_smfmac_f32_16x16x64_bf16 v[56:59], v[84:87], a[176:183], v2
  v_cmp_eq_u32 vcc, -1, v4
  v_smfmac_f32_16x16x64_bf16 v[60:63], v[84:87], a[184:191], v2
  s_cbranch_vccnz rr_70
rb_71:
  v_smfmac_f32_16x16x64_bf16 v[48:51], v[88:91], a[192:199], v2
  v_max3_u32 v4, v92, v93, v94
  v_smfmac_f32_16x16x64_bf16 v[52:55], v[88:91], a[200:207], v2
  v_max_u32 v4, v4, v95
  v_smfmac_f32_16x16x64_bf16 v[56:59], v[88:91], a[208:215], v2
  v_cmp_eq_u32 vcc, -1, v4
  v_smfmac_f32_16x16x64_bf16 v[60:63], v[88:91], a[216:223], v2
  s_cbranch_vccnz rr_72
rb_73:
  v_smfmac_f32_16x16x64_bf16 v[48:51], v[92:95], a[224:231], v2
  v_max3_u32 v4, v80, v81, v82
  v_smfmac_f32_16x16x64_bf16 v[52:55], v[92:95], a[232:239], v2
  v_max_u32 v4, v4, v83
  v_smfmac_f32_16x16x64_bf16 v[56:59], v[92:95], a[240:247], v2
  v_cmp_eq_u32 vcc, -1, v4
  v_smfmac_f32_16x16x64_bf16 v[60:63], v[92:95], a[248:255], v2
  s_cbranch_vccnz rr_74
rb_75:
  v_smfmac_f32_16x16x64_bf16 v[48:51], v[80:83], a[128:135], v2
  v_smfmac_f32_16x16x64_bf16 v[52:55], v[80:83], a[136:143], v2
  v_smfmac_f32_16x16x64_bf16 v[56:59], v[80:83], a[144:151], v2
  v_smfmac_f32_16x16x64_bf16 v[60:63], v[80:83], a[152:159], v2
  s_branch kj_27
rc_34:
  v_smfmac_f32_16x16x64_bf16 v[48:51], v[88:91], a[192:199], v2
  v_max3_u32 v4, v92, v93, v94
  v_smfmac_f32_16x16x64_bf16 v[52:55], v[88:91], a[200:207], v2
  v_max_u32 v4, v4, v95
  v_smfmac_f32_16x16x64_bf16 v[56:59], v[88:91], a[208:215], v2
  v_cmp_eq_u32 vcc, -1, v4
  v_smfmac_f32_16x16x64_bf16 v[60:63], v[88:91], a[216:223], v2
  s_cbranch_vccnz rr_76
rb_77:
  v_smfmac_f32_16x16x64_bf16 v[48:51], v[92:95], a[224:231], v2
  v_max3_u32 v4, v80, v81, v82
  v_smfmac_f32_16x16x64_bf16 v[52:55], v[92:95], a[232:239], v2
  v_max_u32 v4, v4, v83
  v_smfmac_f32_16x16x64_bf16 v[56:59], v[92:95], a[240:247], v2
  v_cmp_eq_u32 vcc, -1, v4
  v_smfmac_f32_16x16x64_bf16 v[60:63], v[92:95], a[248:255], v2
  s_cbranch_vccnz rr_78
rb_79:
  v_smfmac_f32_16x16x64_bf16 v[48:51], v[80:83], a[128:135], v2
  v_max3_u32 v4, v84, v85, v86
  v_smfmac_f32_16x16x64_bf16 v[52:55], v[80:83], a[136:143], v2
  v_max_u32 v4, v4, v87
  v_smfmac_f32_16x16x64_bf16 v[56:59], v[80:83], a[144:151], v2
  v_cmp_eq_u32 vcc, -1, v4
  v_smfmac_f32_16x16x64_bf16 v[60:63], v[80:83], a[152:159], v2
  s_cbranch_vccnz rr_80
rb_81:
  v_smfmac_f32_16x16x64_bf16 v[48:51], v[84:87], a[160:167], v2
  v_smfmac_f32_16x16x64_bf16 v[52:55], v[84:87], a[168:175], v2
  v_smfmac_f32_16x16x64_bf16 v[56:59], v[84:87], a[176:183], v2
  v_smfmac_f32_16x16x64_bf16 v[60:63], v[84:87], a[184:191], v2
  s_branch kj_27
sm_44:
  buffer_store_dword v112, v11, s[8:11], s46 offen sc1
  s_branch sm_45
rr_46:
  buffer_load_dwordx4 v[36:39], v1, s[8:11], s42 offen offset:1024 sc1
  buffer_load_dwordx4 v[40:43], v1, s[8:11], s42 offen offset:2048 sc1
  buffer_load_dwordx4 v[44:47], v1, s[8:11], s42 offen offset:3072 sc1
  v_max3_u32 v4, v36, v37, v38
  v_max_u32 v4, v4, v39
  v_cmp_eq_u32 vcc, -1, v4
  v_mov_b32 v13, v13
  v_mov_b32 v13, v13
  v_mov_b32 v13, v13
  v_mov_b32 v13, v13
  v_mov_b32 v13, v13
  s_cbranch_vccz rb_47
  v_max3_u32 v4, v36, v37, v38
  v_max_u32 v4, v4, v39
  v_cmp_eq_u32 vcc, -1, v4
  v_mov_b32 v13, v13
  v_mov_b32 v13, v13
  v_mov_b32 v13, v13
  v_mov_b32 v13, v13
  v_mov_b32 v13, v13
  s_cbranch_vccz rb_47
  v_max3_u32 v4, v36, v37, v38
  v_max_u32 v4, v4, v39
  v_cmp_eq_u32 vcc, -1, v4
  v_mov_b32 v13, v13
  v_mov_b32 v13, v13
  v_mov_b32 v13, v13
  v_mov_b32 v13, v13
  v_mov_b32 v13, v13
  s_cbranch_vccz rb_47
  s_sub_u32 s48, s48, 1
  s_cbranch_scc1 L_fail
  s_waitcnt vmcnt(8)
  s_branch rr_46
rr_48:
  buffer_load_dwordx4 v[40:43], v1, s[8:11], s42 offen offset:2048 sc1
  buffer_load_dwordx4 v[44:47], v1, s[8:11], s42 offen offset:3072 sc1
  v_max3_u32 v4, v40, v41, v42
  v_max_u32 v4, v4, v43
  v_cmp_eq_u32 vcc, -1, v4
  v_mov_b32 v13, v13
  v_mov_b32 v13, v13
  v_mov_b32 v13, v13
  v_mov_b32 v13, v13
  v_mov_b32 v13, v13
  s_cbranch_vccz rb_49
  v_max3_u32 v4, v40, v41, v42
  v_max_u32 v4, v4, v43
  v_cmp_eq_u32 vcc, -1, v4
  v_mov_b32 v13, v13
  v_mov_b32 v13, v13
  v_mov_b32 v13, v13
  v_mov_b32 v13, v13
  v_mov_b32 v13, v13
  s_cbranch_vccz rb_49
  s_sub_u32 s48, s48, 1
  s_cbranch_scc1 L_fail
  s_waitcnt vmcnt(8)
  s_branch rr_48
rr_50:
  buffer_load_dwordx4 v[44:47], v1, s[8:11], s42 offen offset:3072 sc1
  v_max3_u32 v4, v44, v45, v46
  v_max_u32 v4, v4, v47
  v_cmp_eq_u32 vcc, -1, v4
  v_mov_b32 v13, v13
  v_mov_b32 v13, v13
  v_mov_b32 v13, v13
  v_mov_b32 v13, v13
  v_mov_b32 v13, v13
  s_cbranch_vccz rb_51
  s_sub_u32 s48, s48, 1
  s_cbranch_scc1 L_fail
  s_waitcnt vmcnt(8)
  s_branch rr_50
rr_52:
  buffer_load_dwordx4 v[40:43], v1, s[8:11], s42 offen offset:2048 sc1
  buffer_load_dwordx4 v[44:47], v1, s[8:11], s42 offen offset:3072 sc1
  buffer_load_dwordx4 v[32:35], v1, s[8:11], s42 offen offset:0 sc1
  v_max3_u32 v4, v40, v41, v42
  v_max_u32 v4, v4, v43
  v_cmp_eq_u32 vcc, -1, v4
  v_mov_b32 v13, v13
  v_mov_b32 v13, v13
  v_mov_b32 v13, v13
  v_mov_b32 v13, v13
  v_mov_b32 v13, v13
  s_cbranch_vccz rb_53
  v_max3_u32 v4, v40, v41, v42
  v_max_u32 v4, v4, v43
  v_cmp_eq_u32 vcc, -1, v4
  v_mov_b32 v13, v13
  v_mov_b32 v13, v13
  v_mov_b32 v13, v13
  v_mov_b32 v13, v13
  v_mov_b32 v13, v13
  s_cbranch_vccz rb_53
  v_max3_u32 v4, v40, v41, v42
  v_max_u32 v4, v4, v43
  v_cmp_eq_u32 vcc, -1, v4
  v_mov_b32 v13, v13
  v_mov_b32 v13, v13
  v_mov_b32 v13, v13
  v_mov_b32 v13, v13
  v_mov_b32 v13, v13
  s_cbranch_vccz rb_53
  s_sub_u32 s48, s48, 1
  s_cbranch_scc1 L_fail
  s_waitcnt vmcnt(8)
  s_branch rr_52
rr_54:
  buffer_load_dwordx4 v[44:47], v1, s[8:11], s42 offen offset:3072 sc1
  buffer_load_dwordx4 v[32:35], v1, s[8:11], s42 offen offset:0 sc1
  v_max3_u32 v4, v44, v45, v46
  v_max_u32 v4, v4, v47
  v_cmp_eq_u32 vcc, -1, v4
  v_mov_b32 v13, v13
  v_mov_b32 v13, v13
  v_mov_b32 v13, v13
  v_mov_b32 v13, v13
  v_mov_b32 v13, v13
  s_cbranch_vccz rb_55
  v_max3_u32 v4, v44, v45, v46
  v_max_u32 v4, v4, v47
  v_cmp_eq_u32 vcc, -1, v4
  v_mov_b32 v13, v13
  v_mov_b32 v13, v13
  v_mov_b32 v13, v13
  v_mov_b32 v13, v13
  v_mov_b32 v13, v13
  s_cbranch_vccz rb_55
  s_sub_u32 s48, s48, 1
  s_cbranch_scc1 L_fail
  s_waitcnt vmcnt(8)
  s_branch rr_54
rr_56:
  buffer_load_dwordx4 v[32:35], v1, s[8:11], s42 offen offset:0 sc1
  v_max3_u32 v4, v32, v33, v34
  v_max_u32 v4, v4, v35
  v_cmp_eq_u32 vcc, -1, v4
  v_mov_b32 v13, v13
  v_mov_b32 v13, v13
  v_mov_b32 v13, v13
  v_mov_b32 v13, v13
  v_mov_b32 v13, v13
  s_cbranch_vccz rb_57
  s_sub_u32 s48, s48, 1
  s_cbranch_scc1 L_fail
  s_waitcnt vmcnt(8)
  s_branch rr_56
rr_58:
  buffer_load_dwordx4 v[44:47], v1, s[8:11], s42 offen offset:3072 sc1
  buffer_load_dwordx4 v[32:35], v1, s[8:11], s42 offen offset:0 sc1
  buffer_load_dwordx4 v[36:39], v1, s[8:11], s42 offen offset:1024 sc1
  v_max3_u32 v4, v44, v45, v46
  v_max_u32 v4, v4, v47
  v_cmp_eq_u32 vcc, -1, v4
  v_mov_b32 v13, v13
  v_mov_b32 v13, v13
  v_mov_b32 v13, v13
  v_mov_b32 v13, v13
  v_mov_b32 v13, v13
  s_cbranch_vccz rb_59
  v_max3_u32 v4, v44, v45, v46
  v_max_u32 v4, v4, v47
  v_cmp_eq_u32 vcc, -1, v4
  v_mov_b32 v13, v13
  v_mov_b32 v13, v13
  v_mov_b32 v13, v13
  v_mov_b32 v13, v13
  v_mov_b32 v13, v13
  s_cbranch_vccz rb_59
  v_max3_u32 v4, v44, v45, v46
  v_max_u32 v4, v4, v47
  v_cmp_eq_u32 vcc, -1, v4
  v_mov_b32 v13, v13
  v_mov_b32 v13, v13
  v_mov_b32 v13, v13
  v_mov_b32 v13, v13
  v_mov_b32 v13, v13
  s_cbranch_vccz rb_59
  s_sub_u32 s48, s48, 1
  s_cbranch_scc1 L_fail
  s_waitcnt vmcnt(8)
  s_branch rr_58
rr_60:
  buffer_load_dwordx4 v[32:35], v1, s[8:11], s42 offen offset:0 sc1
  buffer_load_dwordx4 v[36:39], v1, s[8:11], s42 offen offset:1024 sc1
  v_max3_u32 v4, v32, v33, v34
  v_max_u32 v4, v4, v35
  v_cmp_eq_u32 vcc, -1, v4
  v_mov_b32 v13, v13
  v_mov_b32 v13, v13
  v_mov_b32 v13, v13
  v_mov_b32 v13, v13
  v_mov_b32 v13, v13
  s_cbranch_vccz rb_61
  v_max3_u32 v4, v32, v33, v34
  v_max_u32 v4, v4, v35
  v_cmp_eq_u32 vcc, -1, v4
  v_mov_b32 v13, v13
  v_mov_b32 v13, v13
  v_mov_b32 v13, v13
  v_mov_b32 v13, v13
  v_mov_b32 v13, v13
  s_cbranch_vccz rb_61
  s_sub_u32 s48, s48, 1
  s_cbranch_scc1 L_fail
  s_waitcnt vmcnt(8)
  s_branch rr_60
rr_62:
  buffer_load_dwordx4 v[36:39], v1, s[8:11], s42 offen offset:1024 sc1
  v_max3_u32 v4, v36, v37, v38
  v_max_u32 v4, v4, v39
  v_cmp_eq_u32 vcc, -1, v4
  v_mov_b32 v13, v13
  v_mov_b32 v13, v13
  v_mov_b32 v13, v13
  v_mov_b32 v13, v13
  v_mov_b32 v13, v13
  s_cbranch_vccz rb_63
  s_sub_u32 s48, s48, 1
  s_cbranch_scc1 L_fail
  s_waitcnt vmcnt(8)
  s_branch rr_62
rr_64:
  buffer_load_dwordx4 v[84:87], v7, s[8:11], s88 offen offset:1024 sc1
  buffer_load_dwordx4 v[88:91], v7, s[8:11], s88 offen offset:2048 sc1
  buffer_load_dwordx4 v[92:95], v7, s[8:11], s88 offen offset:3072 sc1
  v_max3_u32 v4, v84, v85, v86
  v_max_u32 v4, v4, v87
  v_cmp_eq_u32 vcc, -1, v4
  v_mov_b32 v13, v13
  v_mov_b32 v13, v13
  v_mov_b32 v13, v13
  v_mov_b32 v13, v13
  v_mov_b32 v13, v13
  s_cbranch_vccz rb_65
  v_max3_u32 v4, v84, v85, v86
  v_max_u32 v4, v4, v87
  v_cmp_eq_u32 vcc, -1, v4
  v_mov_b32 v13, v13
  v_mov_b32 v13, v13
  v_mov_b32 v13, v13
  v_mov_b32 v13, v13
  v_mov_b32 v13, v13
  s_cbranch_vccz rb_65
  v_max3_u32 v4, v84, v85, v86
  v_max_u32 v4, v4, v87
  v_cmp_eq_u32 vcc, -1, v4
  v_mov_b32 v13, v13
  v_mov_b32 v13, v13
  v_mov_b32 v13, v13
  v_mov_b32 v13, v13
  v_mov_b32 v13, v13
  s_cbranch_vccz rb_65
  s_sub_u32 s48, s48, 1
  s_cbranch_scc1 L_fail
  s_waitcnt vmcnt(8)
  s_branch rr_64
rr_66:
  buffer_load_dwordx4 v[88:91], v7, s[8:11], s88 offen offset:2048 sc1
  buffer_load_dwordx4 v[92:95], v7, s[8:11], s88 offen offset:3072 sc1
  v_max3_u32 v4, v88, v89, v90
  v_max_u32 v4, v4, v91
  v_cmp_eq_u32 vcc, -1, v4
  v_mov_b32 v13, v13
  v_mov_b32 v13, v13
  v_mov_b32 v13, v13
  v_mov_b32 v13, v13
  v_mov_b32 v13, v13
  s_cbranch_vccz rb_67
  v_max3_u32 v4, v88, v89, v90
  v_max_u32 v4, v4, v91
  v_cmp_eq_u32 vcc, -1, v4
  v_mov_b32 v13, v13
  v_mov_b32 v13, v13
  v_mov_b32 v13, v13
  v_mov_b32 v13, v13
  v_mov_b32 v13, v13
  s_cbranch_vccz rb_67
  s_sub_u32 s48, s48, 1
  s_cbranch_scc1 L_fail
  s_waitcnt vmcnt(8)
  s_branch rr_66
rr_68:
  buffer_load_dwordx4 v[92:95], v7, s[8:11], s88 offen offset:3072 sc1
  v_max3_u32 v4, v92, v93, v94
  v_max_u32 v4, v4, v95
  v_cmp_eq_u32 vcc, -1, v4
  v_mov_b32 v13, v13
  v_mov_b32 v13, v13
  v_mov_b32 v13, v13
  v_mov_b32 v13, v13
  v_mov_b32 v13, v13
  s_cbranch_vccz rb_69
  s_sub_u32 s48, s48, 1
  s_cbranch_scc1 L_fail
  s_waitcnt vmcnt(8)
  s_branch rr_68
rr_70:
  buffer_load_dwordx4 v[88:91], v7, s[8:11], s88 offen offset:2048 sc1
  buffer_load_dwordx4 v[92:95], v7, s[8:11], s88 offen offset:3072 sc1
  buffer_load_dwordx4 v[80:83], v7, s[8:11], s88 offen offset:0 sc1
  v_max3_u32 v4, v88, v89, v90
  v_max_u32 v4, v4, v91
  v_cmp_eq_u32 vcc, -1, v4
  v_mov_b32 v13, v13
  v_mov_b32 v13, v13
  v_mov_b32 v13, v13
  v_mov_b32 v13, v13
  v_mov_b32 v13, v13
  s_cbranch_vccz rb_71
  v_max3_u32 v4, v88, v89, v90
  v_max_u32 v4, v4, v91
  v_cmp_eq_u32 vcc, -1, v4
  v_mov_b32 v13, v13
  v_mov_b32 v13, v13
  v_mov_b32 v13, v13
  v_mov_b32 v13, v13
  v_mov_b32 v13, v13
  s_cbranch_vccz rb_71
  v_max3_u32 v4, v88, v89, v90
  v_max_u32 v4, v4, v91
  v_cmp_eq_u32 vcc, -1, v4
  v_mov_b32 v13, v13
  v_mov_b32 v13, v13
  v_mov_b32 v13, v13
  v_mov_b32 v13, v13
  v_mov_b32 v13, v13
  s_cbranch_vccz rb_71
  s_sub_u32 s48, s48, 1
  s_cbranch_scc1 L_fail
  s_waitcnt vmcnt(8)
  s_branch rr_70
rr_72:
  buffer_load_dwordx4 v[92:95], v7, s[8:11], s88 offen offset:3072 sc1
  buffer_load_dwordx4 v[80:83], v7, s[8:11], s88 offen offset:0 sc1
  v_max3_u32 v4, v92, v93, v94
  v_max_u32 v4, v4, v95
  v_cmp_eq_u32 vcc, -1, v4
  v_mov_b32 v13, v13
  v_mov_b32 v13, v13
  v_mov_b32 v13, v13
  v_mov_b32 v13, v13
  v_mov_b32 v13, v13
  s_cbranch_vccz rb_73
  v_max3_u32 v4, v92, v93, v94
  v_max_u32 v4, v4, v95
  v_cmp_eq_u32 vcc, -1, v4
  v_mov_b32 v13, v13
  v_mov_b32 v13, v13
  v_mov_b32 v13, v13
  v_mov_b32 v13, v13
  v_mov_b32 v13, v13
  s_cbranch_vccz rb_73
  s_sub_u32 s48, s48, 1
  s_cbranch_scc1 L_fail
  s_waitcnt vmcnt(8)
  s_branch rr_72
rr_74:
  buffer_load_dwordx4 v[80:83], v7, s[8:11], s88 offen offset:0 sc1
  v_max3_u32 v4, v80, v81, v82
  v_max_u32 v4, v4, v83
  v_cmp_eq_u32 vcc, -1, v4
  v_mov_b32 v13, v13
  v_mov_b32 v13, v13
  v_mov_b32 v13, v13
  v_mov_b32 v13, v13
  v_mov_b32 v13, v13
  s_cbranch_vccz rb_75
  s_sub_u32 s48, s48, 1
  s_cbranch_scc1 L_fail
  s_waitcnt vmcnt(8)
  s_branch rr_74
rr_76:
  buffer_load_dwordx4 v[92:95], v7, s[8:11], s88 offen offset:3072 sc1
  buffer_load_dwordx4 v[80:83], v7, s[8:11], s88 offen offset:0 sc1
  buffer_load_dwordx4 v[84:87], v7, s[8:11], s88 offen offset:1024 sc1
  v_max3_u32 v4, v92, v93, v94
  v_max_u32 v4, v4, v95
  v_cmp_eq_u32 vcc, -1, v4
  v_mov_b32 v13, v13
  v_mov_b32 v13, v13
  v_mov_b32 v13, v13
  v_mov_b32 v13, v13
  v_mov_b32 v13, v13
  s_cbranch_vccz rb_77
  v_max3_u32 v4, v92, v93, v94
  v_max_u32 v4, v4, v95
  v_cmp_eq_u32 vcc, -1, v4
  v_mov_b32 v13, v13
  v_mov_b32 v13, v13
  v_mov_b32 v13, v13
  v_mov_b32 v13, v13
  v_mov_b32 v13, v13
  s_cbranch_vccz rb_77
  v_max3_u32 v4, v92, v93, v94
  v_max_u32 v4, v4, v95
  v_cmp_eq_u32 vcc, -1, v4
  v_mov_b32 v13, v13
  v_mov_b32 v13, v13
  v_mov_b32 v13, v13
  v_mov_b32 v13, v13
  v_mov_b32 v13, v13
  s_cbranch_vccz rb_77
  s_sub_u32 s48, s48, 1
  s_cbranch_scc1 L_fail
  s_waitcnt vmcnt(8)
  s_branch rr_76
rr_78:
  buffer_load_dwordx4 v[80:83], v7, s[8:11], s88 offen offset:0 sc1
  buffer_load_dwordx4 v[84:87], v7, s[8:11], s88 offen offset:1024 sc1
  v_max3_u32 v4, v80, v81, v82
  v_max_u32 v4, v4, v83
  v_cmp_eq_u32 vcc, -1, v4
  v_mov_b32 v13, v13
  v_mov_b32 v13, v13
  v_mov_b32 v13, v13
  v_mov_b32 v13, v13
  v_mov_b32 v13, v13
  s_cbranch_vccz rb_79
  v_max3_u32 v4, v80, v81, v82
  v_max_u32 v4, v4, v83
  v_cmp_eq_u32 vcc, -1, v4
  v_mov_b32 v13, v13
  v_mov_b32 v13, v13
  v_mov_b32 v13, v13
  v_mov_b32 v13, v13
  v_mov_b32 v13, v13
  s_cbranch_vccz rb_79
  s_sub_u32 s48, s48, 1
  s_cbranch_scc1 L_fail
  s_waitcnt vmcnt(8)
  s_branch rr_78
rr_80:
  buffer_load_dwordx4 v[84:87], v7, s[8:11], s88 offen offset:1024 sc1
  v_max3_u32 v4, v84, v85, v86
  v_max_u32 v4, v4, v87
  v_cmp_eq_u32 vcc, -1, v4
  v_mov_b32 v13, v13
  v_mov_b32 v13, v13
  v_mov_b32 v13, v13
  v_mov_b32 v13, v13
  v_mov_b32 v13, v13
  s_cbranch_vccz rb_81
  s_sub_u32 s48, s48, 1
  s_cbranch_scc1 L_fail
  s_waitcnt vmcnt(8)
  s_branch rr_80
L_S:
  s_lshl_b32 s49, s29, 3
  s_add_u32 s49, s49, s30
  s_load_dwordx2 s[4:5], s[0:1], 16
  s_waitcnt lgkmcnt(0)
  s_mov_b32 s16, s4
  s_and_b32 s17, s5, 0xffff
  s_mov_b32 s18, 0x800000
  s_mov_b32 s19, 0x20000
  s_cmp_lg_u32 s28, 0
  s_cbranch_scc1 ar_82
  v_mov_b32 v22, 0
  s_getreg_b32 s36, hwreg(HW_REG_XCC_ID)
  s_and_b32 s36, s36, 7
  s_lshl_b32 s37, s29, 3
  s_lshl_b32 s37, 1, s37
  s_cmp_eq_u32 s36, s29
  s_cselect_b32 s37, 0, s37
  v_mov_b32 v20, 1
  v_mov_b32 v21, s37
  s_mov_b64 exec, 1
  buffer_atomic_add_x2 v[20:21], v22, s[12:15], 0 offen sc1
  s_mov_b64 exec, -1
ar_82:
  v_and_b32 v14, 63, v0
  v_lshlrev_b32 v1, 4, v14
  v_lshrrev_b32 v0, 4, v14
  v_lshlrev_b32 v236, 13, v0
  v_and_b32 v0, 15, v14
  v_lshl_add_u32 v236, v0, 4, v236
  s_lshl_b32 s36, s49, 8
  s_lshl_b32 s37, s28, 21
  s_add_u32 s36, s36, s37
  v_add_u32 v236, s36, v236
  s_lshl_b32 s38, s28, 14
  v_bfe_u32 v0, v14, 5, 1
  v_lshlrev_b32 v237, 12, v0
  v_bfe_u32 v0, v14, 3, 1
  v_lshl_add_u32 v237, v0, 11, v237
  v_bfe_u32 v0, v14, 4, 1
  v_lshl_add_u32 v237, v0, 10, v237
  v_bfe_u32 v0, v14, 2, 1
  v_lshl_add_u32 v237, v0, 8, v237
  v_and_b32 v0, 3, v14
  v_lshl_add_u32 v237, v0, 3, v237
  s_lshl_b32 s36, s28, 6
  s_add_u32 s36, s36, s38
  v_add_u32 v237, s36, v237
  v_xor_b32 v240, 0xc000, v237
  v_add_u32 v240, 0x8000, v240
  v_xor_b32 v239, 0x8000, v237
  v_add_u32 v239, 0x8000, v239
  v_xor_b32 v238, 0x4000, v237
  v_add_u32 v238, 0x8000, v238
  v_xor_b32 v237, 0x0, v237
  v_add_u32 v237, 0x8000, v237
  s_add_u32 m0, s38, 32768
  s_mov_b32 s40, 0x0
  buffer_load_dwordx4 v236, s[16:19], s40 offen lds
  s_add_u32 m0, s38, 33792
  s_mov_b32 s40, 0x8000
  buffer_load_dwordx4 v236, s[16:19], s40 offen lds
  s_add_u32 m0, s38, 34816
  s_mov_b32 s40, 0x10000
  buffer_load_dwordx4 v236, s[16:19], s40 offen lds
  s_add_u32 m0, s38, 35840
  s_mov_b32 s40, 0x18000
  buffer_load_dwordx4 v236, s[16:19], s40 offen lds
  s_add_u32 m0, s38, 36864
  s_mov_b32 s40, 0x20000
  buffer_load_dwordx4 v236, s[16:19], s40 offen lds
  s_add_u32 m0, s38, 37888
  s_mov_b32 s40, 0x28000
  buffer_load_dwordx4 v236, s[16:19], s40 offen lds
  s_add_u32 m0, s38, 38912
  s_mov_b32 s40, 0x30000
  buffer_load_dwordx4 v236, s[16:19], s40 offen lds
  s_add_u32 m0, s38, 39936
  s_mov_b32 s40, 0x38000
  buffer_load_dwordx4 v236, s[16:19], s40 offen lds
  s_add_u32 m0, s38, 40960
  s_mov_b32 s40, 0x40000
  buffer_load_dwordx4 v236, s[16:19], s40 offen lds
  s_add_u32 m0, s38, 41984
  s_mov_b32 s40, 0x48000
  buffer_load_dwordx4 v236, s[16:19], s40 offen lds
  s_add_u32 m0, s38, 43008
  s_mov_b32 s40, 0x50000
  buffer_load_dwordx4 v236, s[16:19], s40 offen lds
  s_add_u32 m0, s38, 44032
  s_mov_b32 s40, 0x58000
  buffer_load_dwordx4 v236, s[16:19], s40 offen lds
  s_add_u32 m0, s38, 45056
  s_mov_b32 s40, 0x60000
  buffer_load_dwordx4 v236, s[16:19], s40 offen lds
  s_add_u32 m0, s38, 46080
  s_mov_b32 s40, 0x68000
  buffer_load_dwordx4 v236, s[16:19], s40 offen lds
  s_add_u32 m0, s38, 47104
  s_mov_b32 s40, 0x70000
  buffer_load_dwordx4 v236, s[16:19], s40 offen lds
  s_add_u32 m0, s38, 48128
  s_mov_b32 s40, 0x78000
  buffer_load_dwordx4 v236, s[16:19], s40 offen lds
  s_add_u32 m0, s38, 98304
  s_mov_b32 s40, 0x80000
  buffer_load_dwordx4 v236, s[16:19], s40 offen lds
  s_add_u32 m0, s38, 99328
  s_mov_b32 s40, 0x88000
  buffer_load_dwordx4 v236, s[16:19], s40 offen lds
  s_add_u32 m0, s38, 100352
  s_mov_b32 s40, 0x90000
  buffer_load_dwordx4 v236, s[16:19], s40 offen lds
  s_add_u32 m0, s38, 101376
  s_mov_b32 s40, 0x98000
  buffer_load_dwordx4 v236, s[16:19], s40 offen lds
  s_add_u32 m0, s38, 102400
  s_mov_b32 s40, 0xa0000
  buffer_load_dwordx4 v236, s[16:19], s40 offen lds
  s_add_u32 m0, s38, 103424
  s_mov_b32 s40, 0xa8000
  buffer_load_dwordx4 v236, s[16:19], s40 offen lds
  s_add_u32 m0, s38, 104448
  s_mov_b32 s40, 0xb0000
  buffer_load_dwordx4 v236, s[16:19], s40 offen lds
  s_add_u32 m0, s38, 105472
  s_mov_b32 s40, 0xb8000
  buffer_load_dwordx4 v236, s[16:19], s40 offen lds
  s_add_u32 m0, s38, 106496
  s_mov_b32 s40, 0xc0000
  buffer_load_dwordx4 v236, s[16:19], s40 offen lds
  s_add_u32 m0, s38, 107520
  s_mov_b32 s40, 0xc8000
  buffer_load_dwordx4 v236, s[16:19], s40 offen lds
  s_add_u32 m0, s38, 108544
  s_mov_b32 s40, 0xd0000
  buffer_load_dwordx4 v236, s[16:19], s40 offen lds
  s_add_u32 m0, s38, 109568
  s_mov_b32 s40, 0xd8000
  buffer_load_dwordx4 v236, s[16:19], s40 offen lds
  s_add_u32 m0, s38, 110592
  s_mov_b32 s40, 0xe0000
  buffer_load_dwordx4 v236, s[16:19], s40 offen lds
  s_add_u32 m0, s38, 111616
  s_mov_b32 s40, 0xe8000
  buffer_load_dwordx4 v236, s[16:19], s40 offen lds
  s_add_u32 m0, s38, 112640
  s_mov_b32 s40, 0xf0000
  buffer_load_dwordx4 v236, s[16:19], s40 offen lds
  s_add_u32 m0, s38, 113664
  s_mov_b32 s40, 0xf8000
  buffer_load_dwordx4 v236, s[16:19], s40 offen lds
  s_waitcnt vmcnt(16)
  s_barrier
  ds_read_b64_tr_b16 a[0:1], v237 offset:0
  ds_read_b64_tr_b16 a[2:3], v237 offset:512
  ds_read_b64_tr_b16 a[4:5], v237 offset:8192
  ds_read_b64_tr_b16 a[6:7], v237 offset:8704
  s_waitcnt lgkmcnt(8)
  ds_read_b64_tr_b16 a[8:9], v237 offset:32
  ds_read_b64_tr_b16 a[10:11], v237 offset:544
  ds_read_b64_tr_b16 a[12:13], v237 offset:8224
  ds_read_b64_tr_b16 a[14:15], v237 offset:8736
  s_waitcnt lgkmcnt(8)
  ds_read_b64_tr_b16 a[64:65], v238 offset:0
  ds_read_b64_tr_b16 a[66:67], v238 offset:512
  ds_read_b64_tr_b16 a[68:69], v238 offset:8192
  ds_read_b64_tr_b16 a[70:71], v238 offset:8704
  s_waitcnt lgkmcnt(8)
  ds_read_b64_tr_b16 a[72:73], v238 offset:32
  ds_read_b64_tr_b16 a[74:75], v238 offset:544
  ds_read_b64_tr_b16 a[76:77], v238 offset:8224
  ds_read_b64_tr_b16 a[78:79], v238 offset:8736
  s_waitcnt lgkmcnt(8)
  ds_read_b64_tr_b16 a[128:129], v239 offset:0
  ds_read_b64_tr_b16 a[130:131], v239 offset:512
  ds_read_b64_tr_b16 a[132:133], v239 offset:8192
  ds_read_b64_tr_b16 a[134:135], v239 offset:8704
  s_waitcnt lgkmcnt(8)
  ds_read_b64_tr_b16 a[136:137], v239 offset:32
  ds_read_b64_tr_b16 a[138:139], v239 offset:544
  ds_read_b64_tr_b16 a[140:141], v239 offset:8224
  ds_read_b64_tr_b16 a[142:143], v239 offset:8736
  s_waitcnt lgkmcnt(8)
  ds_read_b64_tr_b16 a[192:193], v240 offset:0
  ds_read_b64_tr_b16 a[194:195], v240 offset:512
  ds_read_b64_tr_b16 a[196:197], v240 offset:8192
  ds_read_b64_tr_b16 a[198:199], v240 offset:8704
  s_waitcnt lgkmcnt(8)
  ds_read_b64_tr_b16 a[200:201], v240 offset:32
  ds_read_b64_tr_b16 a[202:203], v240 offset:544
  ds_read_b64_tr_b16 a[204:205], v240 offset:8224
  ds_read_b64_tr_b16 a[206:207], v240 offset:8736
  s_waitcnt lgkmcnt(8)
  s_waitcnt lgkmcnt(0)
  s_barrier
  v_add_u32 v237, 0x10000, v237
  v_add_u32 v238, 0x10000, v238
  v_add_u32 v239, 0x10000, v239
  v_add_u32 v240, 0x10000, v240
  s_add_u32 m0, s38, 32768
  s_mov_b32 s40, 0x100000
  buffer_load_dwordx4 v236, s[16:19], s40 offen lds
  s_add_u32 m0, s38, 33792
  s_mov_b32 s40, 0x108000
  buffer_load_dwordx4 v236, s[16:19], s40 offen lds
  s_add_u32 m0, s38, 34816
  s_mov_b32 s40, 0x110000
  buffer_load_dwordx4 v236, s[16:19], s40 offen lds
  s_add_u32 m0, s38, 35840
  s_mov_b32 s40, 0x118000
  buffer_load_dwordx4 v236, s[16:19], s40 offen lds
  s_add_u32 m0, s38, 36864
  s_mov_b32 s40, 0x120000
  buffer_load_dwordx4 v236, s[16:19], s40 offen lds
  s_add_u32 m0, s38, 37888
  s_mov_b32 s40, 0x128000
  buffer_load_dwordx4 v236, s[16:19], s40 offen lds
  s_add_u32 m0, s38, 38912
  s_mov_b32 s40, 0x130000
  buffer_load_dwordx4 v236, s[16:19], s40 offen lds
  s_add_u32 m0, s38, 39936
  s_mov_b32 s40, 0x138000
  buffer_load_dwordx4 v236, s[16:19], s40 offen lds
  s_add_u32 m0, s38, 40960
  s_mov_b32 s40, 0x140000
  buffer_load_dwordx4 v236, s[16:19], s40 offen lds
  s_add_u32 m0, s38, 41984
  s_mov_b32 s40, 0x148000
  buffer_load_dwordx4 v236, s[16:19], s40 offen lds
  s_add_u32 m0, s38, 43008
  s_mov_b32 s40, 0x150000
  buffer_load_dwordx4 v236, s[16:19], s40 offen lds
  s_add_u32 m0, s38, 44032
  s_mov_b32 s40, 0x158000
  buffer_load_dwordx4 v236, s[16:19], s40 offen lds
  s_add_u32 m0, s38, 45056
  s_mov_b32 s40, 0x160000
  buffer_load_dwordx4 v236, s[16:19], s40 offen lds
  s_add_u32 m0, s38, 46080
  s_mov_b32 s40, 0x168000
  buffer_load_dwordx4 v236, s[16:19], s40 offen lds
  s_add_u32 m0, s38, 47104
  s_mov_b32 s40, 0x170000
  buffer_load_dwordx4 v236, s[16:19], s40 offen lds
  s_add_u32 m0, s38, 48128
  s_mov_b32 s40, 0x178000
  buffer_load_dwordx4 v236, s[16:19], s40 offen lds
  s_waitcnt vmcnt(16)
  s_barrier
  ds_read_b64_tr_b16 a[16:17], v237 offset:0
  ds_read_b64_tr_b16 a[18:19], v237 offset:512
  ds_read_b64_tr_b16 a[20:21], v237 offset:8192
  ds_read_b64_tr_b16 a[22:23], v237 offset:8704
  s_waitcnt lgkmcnt(8)
  ds_read_b64_tr_b16 a[24:25], v237 offset:32
  ds_read_b64_tr_b16 a[26:27], v237 offset:544
  ds_read_b64_tr_b16 a[28:29], v237 offset:8224
  ds_read_b64_tr_b16 a[30:31], v237 offset:8736
  s_waitcnt lgkmcnt(8)
  ds_read_b64_tr_b16 a[80:81], v238 offset:0
  ds_read_b64_tr_b16 a[82:83], v238 offset:512
  ds_read_b64_tr_b16 a[84:85], v238 offset:8192
  ds_read_b64_tr_b16 a[86:87], v238 offset:8704
  s_waitcnt lgkmcnt(8)
  ds_read_b64_tr_b16 a[88:89], v238 offset:32
  ds_read_b64_tr_b16 a[90:91], v238 offset:544
  ds_read_b64_tr_b16 a[92:93], v238 offset:8224
  ds_read_b64_tr_b16 a[94:95], v238 offset:8736
  s_waitcnt lgkmcnt(8)
  ds_read_b64_tr_b16 a[144:145], v239 offset:0
  ds_read_b64_tr_b16 a[146:147], v239 offset:512
  ds_read_b64_tr_b16 a[148:149], v239 offset:8192
  ds_read_b64_tr_b16 a[150:151], v239 offset:8704
  s_waitcnt lgkmcnt(8)
  ds_read_b64_tr_b16 a[152:153], v239 offset:32
  ds_read_b64_tr_b16 a[154:155], v239 offset:544
  ds_read_b64_tr_b16 a[156:157], v239 offset:8224
  ds_read_b64_tr_b16 a[158:159], v239 offset:8736
  s_waitcnt lgkmcnt(8)
  ds_read_b64_tr_b16 a[208:209], v240 offset:0
  ds_read_b64_tr_b16 a[210:211], v240 offset:512
  ds_read_b64_tr_b16 a[212:213], v240 offset:8192
  ds_read_b64_tr_b16 a[214:215], v240 offset:8704
  s_waitcnt lgkmcnt(8)
  ds_read_b64_tr_b16 a[216:217], v240 offset:32
  ds_read_b64_tr_b16 a[218:219], v240 offset:544
  ds_read_b64_tr_b16 a[220:221], v240 offset:8224
  ds_read_b64_tr_b16 a[222:223], v240 offset:8736
  s_waitcnt lgkmcnt(8)
  s_waitcnt lgkmcnt(0)
  s_barrier
  v_add_u32 v237, 0xffff0000, v237
  v_add_u32 v238, 0xffff0000, v238
  v_add_u32 v239, 0xffff0000, v239
  v_add_u32 v240, 0xffff0000, v240
  s_add_u32 m0, s38, 98304
  s_mov_b32 s40, 0x180000
  buffer_load_dwordx4 v236, s[16:19], s40 offen lds
  s_add_u32 m0, s38, 99328
  s_mov_b32 s40, 0x188000
  buffer_load_dwordx4 v236, s[16:19], s40 offen lds
  s_add_u32 m0, s38, 100352
  s_mov_b32 s40, 0x190000
  buffer_load_dwordx4 v236, s[16:19], s40 offen lds
  s_add_u32 m0, s38, 101376
  s_mov_b32 s40, 0x198000
  buffer_load_dwordx4 v236, s[16:19], s40 offen lds
  s_add_u32 m0, s38, 102400
  s_mov_b32 s40, 0x1a0000
  buffer_load_dwordx4 v236, s[16:19], s40 offen lds
  s_add_u32 m0, s38, 103424
  s_mov_b32 s40, 0x1a8000
  buffer_load_dwordx4 v236, s[16:19], s40 offen lds
  s_add_u32 m0, s38, 104448
  s_mov_b32 s40, 0x1b0000
  buffer_load_dwordx4 v236, s[16:19], s40 offen lds
  s_add_u32 m0, s38, 105472
  s_mov_b32 s40, 0x1b8000
  buffer_load_dwordx4 v236, s[16:19], s40 offen lds
  s_add_u32 m0, s38, 106496
  s_mov_b32 s40, 0x1c0000
  buffer_load_dwordx4 v236, s[16:19], s40 offen lds
  s_add_u32 m0, s38, 107520
  s_mov_b32 s40, 0x1c8000
  buffer_load_dwordx4 v236, s[16:19], s40 offen lds
  s_add_u32 m0, s38, 108544
  s_mov_b32 s40, 0x1d0000
  buffer_load_dwordx4 v236, s[16:19], s40 offen lds
  s_add_u32 m0, s38, 109568
  s_mov_b32 s40, 0x1d8000
  buffer_load_dwordx4 v236, s[16:19], s40 offen lds
  s_add_u32 m0, s38, 110592
  s_mov_b32 s40, 0x1e0000
  buffer_load_dwordx4 v236, s[16:19], s40 offen lds
  s_add_u32 m0, s38, 111616
  s_mov_b32 s40, 0x1e8000
  buffer_load_dwordx4 v236, s[16:19], s40 offen lds
  s_add_u32 m0, s38, 112640
  s_mov_b32 s40, 0x1f0000
  buffer_load_dwordx4 v236, s[16:19], s40 offen lds
  s_add_u32 m0, s38, 113664
  s_mov_b32 s40, 0x1f8000
  buffer_load_dwordx4 v236, s[16:19], s40 offen lds
  s_waitcnt vmcnt(16)
  s_barrier
  ds_read_b64_tr_b16 a[32:33], v237 offset:0
  ds_read_b64_tr_b16 a[34:35], v237 offset:512
  ds_read_b64_tr_b16 a[36:37], v237 offset:8192
  ds_read_b64_tr_b16 a[38:39], v237 offset:8704
  s_waitcnt lgkmcnt(8)
  ds_read_b64_tr_b16 a[40:41], v237 offset:32
  ds_read_b64_tr_b16 a[42:43], v237 offset:544
  ds_read_b64_tr_b16 a[44:45], v237 offset:8224
  ds_read_b64_tr_b16 a[46:47], v237 offset:8736
  s_waitcnt lgkmcnt(8)
  ds_read_b64_tr_b16 a[96:97], v238 offset:0
  ds_read_b64_tr_b16 a[98:99], v238 offset:512
  ds_read_b64_tr_b16 a[100:101], v238 offset:8192
  ds_read_b64_tr_b16 a[102:103], v238 offset:8704
  s_waitcnt lgkmcnt(8)
  ds_read_b64_tr_b16 a[104:105], v238 offset:32
  ds_read_b64_tr_b16 a[106:107], v238 offset:544
  ds_read_b64_tr_b16 a[108:109], v238 offset:8224
  ds_read_b64_tr_b16 a[110:111], v238 offset:8736
  s_waitcnt lgkmcnt(8)
  ds_read_b64_tr_b16 a[160:161], v239 offset:0
  ds_read_b64_tr_b16 a[162:163], v239 offset:512
  ds_read_b64_tr_b16 a[164:165], v239 offset:8192
  ds_read_b64_tr_b16 a[166:167], v239 offset:8704
  s_waitcnt lgkmcnt(8)
  ds_read_b64_tr_b16 a[168:169], v239 offset:32
  ds_read_b64_tr_b16 a[170:171], v239 offset:544
  ds_read_b64_tr_b16 a[172:173], v239 offset:8224
  ds_read_b64_tr_b16 a[174:175], v239 offset:8736
  s_waitcnt lgkmcnt(8)
  ds_read_b64_tr_b16 a[224:225], v240 offset:0
  ds_read_b64_tr_b16 a[226:227], v240 offset:512
  ds_read_b64_tr_b16 a[228:229], v240 offset:8192
  ds_read_b64_tr_b16 a[230:231], v240 offset:8704
  s_waitcnt lgkmcnt(8)
  ds_read_b64_tr_b16 a[232:233], v240 offset:32
  ds_read_b64_tr_b16 a[234:235], v240 offset:544
  ds_read_b64_tr_b16 a[236:237], v240 offset:8224
  ds_read_b64_tr_b16 a[238:239], v240 offset:8736
  s_waitcnt lgkmcnt(8)
  s_waitcnt lgkmcnt(0)
  s_barrier
  v_add_u32 v237, 0x10000, v237
  v_add_u32 v238, 0x10000, v238
  v_add_u32 v239, 0x10000, v239
  v_add_u32 v240, 0x10000, v240
  s_waitcnt vmcnt(0)
  s_barrier
  ds_read_b64_tr_b16 a[48:49], v237 offset:0
  ds_read_b64_tr_b16 a[50:51], v237 offset:512
  ds_read_b64_tr_b16 a[52:53], v237 offset:8192
  ds_read_b64_tr_b16 a[54:55], v237 offset:8704
  s_waitcnt lgkmcnt(8)
  ds_read_b64_tr_b16 a[56:57], v237 offset:32
  ds_read_b64_tr_b16 a[58:59], v237 offset:544
  ds_read_b64_tr_b16 a[60:61], v237 offset:8224
  ds_read_b64_tr_b16 a[62:63], v237 offset:8736
  s_waitcnt lgkmcnt(8)
  ds_read_b64_tr_b16 a[112:113], v238 offset:0
  ds_read_b64_tr_b16 a[114:115], v238 offset:512
  ds_read_b64_tr_b16 a[116:117], v238 offset:8192
  ds_read_b64_tr_b16 a[118:119], v238 offset:8704
  s_waitcnt lgkmcnt(8)
  ds_read_b64_tr_b16 a[120:121], v238 offset:32
  ds_read_b64_tr_b16 a[122:123], v238 offset:544
  ds_read_b64_tr_b16 a[124:125], v238 offset:8224
  ds_read_b64_tr_b16 a[126:127], v238 offset:8736
  s_waitcnt lgkmcnt(8)
  ds_read_b64_tr_b16 a[176:177], v239 offset:0
  ds_read_b64_tr_b16 a[178:179], v239 offset:512
  ds_read_b64_tr_b16 a[180:181], v239 offset:8192
  ds_read_b64_tr_b16 a[182:183], v239 offset:8704
  s_waitcnt lgkmcnt(8)
  ds_read_b64_tr_b16 a[184:185], v239 offset:32
  ds_read_b64_tr_b16 a[186:187], v239 offset:544
  ds_read_b64_tr_b16 a[188:189], v239 offset:8224
  ds_read_b64_tr_b16 a[190:191], v239 offset:8736
  s_waitcnt lgkmcnt(8)
  ds_read_b64_tr_b16 a[240:241], v240 offset:0
  ds_read_b64_tr_b16 a[242:243], v240 offset:512
  ds_read_b64_tr_b16 a[244:245], v240 offset:8192
  ds_read_b64_tr_b16 a[246:247], v240 offset:8704
  s_waitcnt lgkmcnt(8)
  ds_read_b64_tr_b16 a[248:249], v240 offset:32
  ds_read_b64_tr_b16 a[250:251], v240 offset:544
  ds_read_b64_tr_b16 a[252:253], v240 offset:8224
  ds_read_b64_tr_b16 a[254:255], v240 offset:8736
  s_waitcnt lgkmcnt(8)
  s_waitcnt lgkmcnt(0)
  s_barrier
  v_add_u32 v237, 0xffff0000, v237
  v_add_u32 v238, 0xffff0000, v238
  v_add_u32 v239, 0xffff0000, v239
  v_add_u32 v240, 0xffff0000, v240
  s_lshl_b32 s36, s28, 12
  v_add_u32 v2, s36, v1
  v_xor_b32 v3, 0x1000, v2
  v_xor_b32 v4, 0x2000, v2
  v_xor_b32 v5, 0x3000, v2
  v_and_b32 v0, 8, v14
  v_cmp_eq_u32 vcc, 0, v0
  v_mov_b32 v8, 0xeeeeeeee
  v_mov_b32 v0, 0x44444444
  v_cndmask_b32 v8, v8, v0, vcc
  v_lshrrev_b32 v0, 5, v14
  v_lshlrev_b32 v6, 8, v0
  v_and_b32 v0, 15, v14
  v_lshl_add_u32 v6, v0, 4, v6
  v_bfe_u32 v0, v14, 4, 1
  v_lshl_add_u32 v6, v0, 3, v6
  s_lshl_b32 s36, s28, 9
  v_add_u32 v6, s36, v6
  v_lshrrev_b32 v0, 2, v14
  v_lshlrev_b32 v7, 4, v0
  v_and_b32 v0, 1, v14
  v_lshl_add_u32 v7, v0, 3, v7
  s_lshr_b32 s36, s28, 1
  s_lshl_b32 s36, s36, 10
  s_and_b32 s37, s28, 1
  s_lshl_b32 s37, s37, 7
  s_add_u32 s36, s36, s37
  s_add_u32 s80, s36, 0x4800000
  s_lshl_b32 s36, s28, 9
  v_add_u32 v10, s36, v1
  v_mov_b32 v0, 0x7f000000
  v_cmp_gt_u32 vcc, 32, v14
  s_nop 1
  v_cndmask_b32 v10, v0, v10, vcc
  v_and_b32 v228, 0xfffffdff, v10
  v_mov_b32 v15, 0xff800000
  v_cndmask_b32 v216, v15, 0, vcc
  v_cndmask_b32 v217, v15, 0, vcc
  v_cndmask_b32 v218, v15, 0, vcc
  v_cndmask_b32 v219, v15, 0, vcc
  v_lshrrev_b32 v0, 4, v14
  v_lshlrev_b32 v11, 7, v0
  v_lshlrev_b32 v0, 2, v0
  v_and_b32 v9, 15, v14
  v_sub_u32 v0, v9, v0
  s_and_b32 s39, s28, 1
  s_lshl_b32 s36, s39, 4
  v_add_u32 v0, s36, v0
  v_cmp_le_i32 vcc, 0, v0
  s_nop 1
  v_cndmask_b32 v220, v15, 0, vcc
  v_cmp_le_i32 vcc, 1, v0
  s_nop 1
  v_cndmask_b32 v221, v15, 0, vcc
  v_cmp_le_i32 vcc, 2, v0
  s_nop 1
  v_cndmask_b32 v222, v15, 0, vcc
  v_cmp_le_i32 vcc, 3, v0
  s_nop 1
  v_cndmask_b32 v223, v15, 0, vcc
  v_cmp_le_i32 vcc, 16, v0
  s_nop 1
  v_cndmask_b32 v224, v15, 0, vcc
  v_cmp_le_i32 vcc, 17, v0
  s_nop 1
  v_cndmask_b32 v225, v15, 0, vcc
  v_cmp_le_i32 vcc, 18, v0
  s_nop 1
  v_cndmask_b32 v226, v15, 0, vcc
  v_cmp_le_i32 vcc, 19, v0
  s_nop 1
  v_cndmask_b32 v227, v15, 0, vcc
  v_and_b32 v0, 7, v14
  v_lshl_add_u32 v11, v0, 4, v11
  v_lshlrev_b32 v9, 6, v9
  v_lshrrev_b32 v0, 4, v14
  v_lshl_add_u32 v9, v0, 4, v9
  s_lshl_b32 s36, s49, 15
  s_lshr_b32 s38, s28, 1
  s_lshl_b32 s37, s38, 14
  s_add_u32 s36, s36, s37
  s_lshl_b32 s37, s39, 10
  s_add_u32 s36, s36, s37
  v_add_u32 v9, s36, v9
  s_lshl_b32 s89, s39, 12
  s_lshl_b32 s90, s38, 12
  s_lshl_b32 s91, s49, 12
  s_lshl_b32 s37, s38, 11
  s_add_u32 s91, s91, s37
  s_lshl_b32 s37, s39, 17
  s_add_u32 s91, s91, s37
  s_add_u32 s91, s91, 0x9000000
  s_cmp_eq_u32 s38, 0
  s_mov_b32 s93, 0x4400000
  s_cselect_b32 s93, 0x4d00000, s93
  s_lshl_b32 s37, s39, 10
  s_add_u32 s93, s93, s37
  v_mov_b32 v13, 0
  v_mov_b32 v204, 0x3f803f80
  v_mov_b32 v232, -1
  v_mov_b32 v248, 0
  v_mov_b32 v205, 0x3f803f80
  v_mov_b32 v233, -1
  v_mov_b32 v249, 0
  v_mov_b32 v206, 0x3f803f80
  v_mov_b32 v234, -1
  v_mov_b32 v250, 0
  v_mov_b32 v207, 0x3f803f80
  v_mov_b32 v235, -1
  v_mov_b32 v251, 0
  v_mov_b32 v208, 0x3f003f00
  v_mov_b32 v209, 0x3f003f00
  s_mov_b32 s34, 0x3e0293ee
  s_mov_b32 s35, 0x3e0293ee
  s_mov_b32 s32, 0
  s_lshl_b32 s42, s29, 20
  s_add_u32 s42, s42, 0x4000000
  s_lshl_b32 s44, s49, 11
  v_mov_b32 v248, 0
sb_83:
  s_sub_u32 s48, s48, 1
  s_cbranch_scc1 L_fail
  buffer_load_dwordx4 v[244:247], v248, s[12:15], 0 offen sc1
  s_waitcnt vmcnt(0)
  v_readfirstlane_b32 s36, v244
  s_nop 3
  s_cmp_ge_u32 s36, 96
  s_cbranch_scc1 sb_84
  s_sleep 8
  s_branch sb_83
sb_84:
  v_readfirstlane_b32 s37, v245
  v_readfirstlane_b32 s81, v247
  s_nop 3
  s_lshl_b32 s38, s29, 3
  s_lshr_b32 s37, s37, s38
  s_and_b32 s37, s37, 0xff
  s_cmp_eq_u32 s37, 0
  s_cselect_b32 s31, 1, 0
  s_bcnt1_i32_b32 s36, s81
  s_cmp_ge_u32 s36, 4
  s_cselect_b32 s47, 0x2000, 0
  s_and_b32 s36, s30, 1
  s_lshl_b32 s36, s36, 12
  s_add_u32 s47, s47, s36
  s_lshr_b32 s36, s30, 1
  s_lshl_b32 s36, s36, 14
  s_add_u32 s47, s47, s36
  s_lshl_b32 s36, s29, 16
  s_add_u32 s47, s47, s36
  s_lshl_b32 s36, s28, 10
  s_add_u32 s47, s47, s36
  s_add_u32 s47, s47, 0x5000000
  s_lshl_b32 s46, s30, 11
  s_lshl_b32 s36, s28, 9
  s_add_u32 s46, s46, s36
  s_lshl_b32 s36, s28, 17
  s_add_u32 s36, s36, s44
  s_add_u32 s37, s36, 0x4d00000
  s_add_u32 s38, s36, 0x4400000
  buffer_load_dwordx4 v[72:75], v1, s[8:11], s37 offen offset:0 sc1
  buffer_load_dwordx4 v[72:75], v1, s[8:11], s37 offen offset:1024 sc1
  buffer_load_dwordx4 v[72:75], v1, s[8:11], s38 offen offset:0 sc1
  buffer_load_dwordx4 v[72:75], v1, s[8:11], s38 offen offset:1024 sc1
  s_lshl_b32 s36, s28, 17
  s_add_u32 s36, s36, s44
  s_add_u32 s37, s36, 0x4d10000
  s_add_u32 s38, s36, 0x4410000
  buffer_load_dwordx4 v[72:75], v1, s[8:11], s37 offen offset:0 sc1
  buffer_load_dwordx4 v[72:75], v1, s[8:11], s37 offen offset:1024 sc1
  buffer_load_dwordx4 v[72:75], v1, s[8:11], s38 offen offset:0 sc1
  buffer_load_dwordx4 v[72:75], v1, s[8:11], s38 offen offset:1024 sc1
  s_add_u32 s43, s32, 0
  s_mov_b32 s36, s43
  s_cmp_ge_u32 s36, 64
  s_cbranch_scc1 wx_85
  s_cmp_lt_u32 s36, 8
  s_cselect_b32 s37, 3, 7
  s_and_b32 s37, s36, s37
  s_cmp_lg_u32 s37, 0
  s_cbranch_scc1 wx_85
  s_lshr_b32 s37, s36, 3
  s_add_u32 s37, s37, 1
  s_cmp_lt_u32 s36, 4
  s_cselect_b32 s37, 0, s37
  s_cmp_lt_u32 s36, 8
  s_cselect_b32 s38, 6, 3
  s_lshl_b32 s37, s37, 4
  s_lshr_b32 s39, s49, 1
  s_add_u32 s37, s37, s39
  s_lshl_b32 s37, s37, 7
  s_add_u32 s37, s37, 0x4c00000
wx_86:
  s_sub_u32 s48, s48, 1
  s_cbranch_scc1 L_fail
  v_mov_b32 v0, 0
  buffer_load_dword v0, v0, s[8:11], s37 offen sc1
  s_waitcnt vmcnt(0)
  v_readfirstlane_b32 s39, v0
  s_nop 3
  s_cmp_ge_u32 s39, s38
  s_cbranch_scc1 wx_85
  s_sleep 4
  s_branch wx_86
wx_85:
  s_lshl_b32 s36, s43, 18
  s_lshl_b32 s37, s49, 13
  s_add_u32 s36, s36, s37
  s_lshl_b32 s38, s28, 11
  s_add_u32 s36, s36, s38
  s_cmp_ge_u32 s43, 64
  s_cselect_b32 s36, 0x7f000000, s36
  s_and_b32 s37, s43, 3
  s_lshl_b32 s37, s37, 15
  s_add_u32 s37, s37, s38
  s_add_u32 m0, s37, 0x8000
  s_add_u32 s39, s36, 0x1000000
  buffer_load_dwordx4 v1, s[8:11], s39 offen offset:0 sc1 lds
  buffer_load_dwordx4 v1, s[8:11], s39 offen offset:1024 sc1 lds
  s_add_u32 m0, s37, 0xa000
  s_add_u32 s39, s36, 0x0
  buffer_load_dwordx4 v1, s[8:11], s39 offen offset:0 sc1 lds
  buffer_load_dwordx4 v1, s[8:11], s39 offen offset:1024 sc1 lds
  s_add_u32 m0, s37, 0xc000
  s_add_u32 s39, s36, 0x2000000
  buffer_load_dwordx4 v1, s[8:11], s39 offen offset:0 sc1 lds
  buffer_load_dwordx4 v1, s[8:11], s39 offen offset:1024 sc1 lds
  s_add_u32 s43, s32, 1
  s_mov_b32 s36, s43
  s_cmp_ge_u32 s36, 64
  s_cbranch_scc1 wx_87
  s_cmp_lt_u32 s36, 8
  s_cselect_b32 s37, 3, 7
  s_and_b32 s37, s36, s37
  s_cmp_lg_u32 s37, 0
  s_cbranch_scc1 wx_87
  s_lshr_b32 s37, s36, 3
  s_add_u32 s37, s37, 1
  s_cmp_lt_u32 s36, 4
  s_cselect_b32 s37, 0, s37
  s_cmp_lt_u32 s36, 8
  s_cselect_b32 s38, 6, 3
  s_lshl_b32 s37, s37, 4
  s_lshr_b32 s39, s49, 1
  s_add_u32 s37, s37, s39
  s_lshl_b32 s37, s37, 7
  s_add_u32 s37, s37, 0x4c00000
wx_88:
  s_sub_u32 s48, s48, 1
  s_cbranch_scc1 L_fail
  v_mov_b32 v0, 0
  buffer_load_dword v0, v0, s[8:11], s37 offen sc1
  s_waitcnt vmcnt(0)
  v_readfirstlane_b32 s39, v0
  s_nop 3
  s_cmp_ge_u32 s39, s38
  s_cbranch_scc1 wx_87
  s_sleep 4
  s_branch wx_88
wx_87:
  s_lshl_b32 s36, s43, 18
  s_lshl_b32 s37, s49, 13
  s_add_u32 s36, s36, s37
  s_lshl_b32 s38, s28, 11
  s_add_u32 s36, s36, s38
  s_cmp_ge_u32 s43, 64
  s_cselect_b32 s36, 0x7f000000, s36
  s_and_b32 s37, s43, 3
  s_lshl_b32 s37, s37, 15
  s_add_u32 s37, s37, s38
  s_add_u32 m0, s37, 0x8000
  s_add_u32 s39, s36, 0x1000000
  buffer_load_dwordx4 v1, s[8:11], s39 offen offset:0 sc1 lds
  buffer_load_dwordx4 v1, s[8:11], s39 offen offset:1024 sc1 lds
  s_add_u32 m0, s37, 0xa000
  s_add_u32 s39, s36, 0x0
  buffer_load_dwordx4 v1, s[8:11], s39 offen offset:0 sc1 lds
  buffer_load_dwordx4 v1, s[8:11], s39 offen offset:1024 sc1 lds
  s_add_u32 m0, s37, 0xc000
  s_add_u32 s39, s36, 0x2000000
  buffer_load_dwordx4 v1, s[8:11], s39 offen offset:0 sc1 lds
  buffer_load_dwordx4 v1, s[8:11], s39 offen offset:1024 sc1 lds
  s_waitcnt vmcnt(6)
  s_barrier
S_loop:
  s_and_b32 s36, s32, 3
  s_lshl_b32 s36, s36, 15
  s_add_u32 s36, s36, 0x8000
  v_add_u32 v12, s36, v1
  s_lshl_b32 s37, s28, 11
  v_add_u32 v15, s37, v12
  ds_read_b128 v[16:19], v12 offset:8192
  ds_read_b128 v[20:23], v12 offset:9216
  ds_read_b128 v[24:27], v12 offset:10240
  ds_read_b128 v[28:31], v12 offset:11264
  ds_read_b128 v[32:35], v12 offset:12288
  ds_read_b128 v[36:39], v12 offset:13312
  ds_read_b128 v[40:43], v12 offset:14336
  ds_read_b128 v[44:47], v12 offset:15360
  ds_read_b128 v[48:51], v15 offset:16384
  ds_read_b128 v[52:55], v15 offset:17408
  v_mov_b32 v120, 0
  v_mov_b32 v121, 0
  v_mov_b32 v122, 0
  v_mov_b32 v123, 0
  v_mov_b32 v124, 0
  v_mov_b32 v125, 0
  v_mov_b32 v126, 0
  v_mov_b32 v127, 0
  v_mov_b32 v56, -1
  v_mov_b32 v144, -1
  v_mov_b32 v57, -1
  v_mov_b32 v145, -1
  v_mov_b32 v58, -1
  v_mov_b32 v146, -1
  v_mov_b32 v59, -1
  v_mov_b32 v147, -1
  v_mov_b32 v60, -1
  v_mov_b32 v148, -1
  v_mov_b32 v61, -1
  v_mov_b32 v149, -1
  v_mov_b32 v62, -1
  v_mov_b32 v150, -1
  v_mov_b32 v63, -1
  v_mov_b32 v151, -1
  v_mov_b32 v64, -1
  v_mov_b32 v152, -1
  v_mov_b32 v65, -1
  v_mov_b32 v153, -1
  v_mov_b32 v66, -1
  v_mov_b32 v154, -1
  v_mov_b32 v67, -1
  v_mov_b32 v155, -1
  v_mov_b32 v68, -1
  v_mov_b32 v156, -1
  v_mov_b32 v69, -1
  v_mov_b32 v157, -1
  v_mov_b32 v70, -1
  v_mov_b32 v158, -1
  v_mov_b32 v71, -1
  v_mov_b32 v159, -1
  v_mov_b32 v172, -1
  v_mov_b32 v173, -1
  v_mov_b32 v174, -1
  v_mov_b32 v175, -1
  s_add_u32 s41, s44, 0x4400000
  s_add_u32 s40, s44, s80
  s_add_u32 s45, s44, 0x4d00000
  s_waitcnt lgkmcnt(0)
  buffer_load_dwordx4 v[56:59], v2, s[8:11], s42 offen offset:0 sc1
  v_mov_b32 v13, v13
  v_mov_b32 v13, v13
  v_mov_b32 v13, v13
  v_mov_b32 v13, v13
  buffer_load_dwordx4 v[60:63], v2, s[8:11], s42 offen offset:1024 sc1
  v_mov_b32 v13, v13
  v_mov_b32 v13, v13
  v_mov_b32 v13, v13
  v_mov_b32 v13, v13
  buffer_load_dwordx4 v[64:67], v2, s[8:11], s42 offen offset:2048 sc1
  v_mov_b32 v13, v13
  v_mov_b32 v13, v13
  v_mov_b32 v13, v13
  v_mov_b32 v13, v13
rp_90:
  buffer_load_dwordx4 v[68:71], v2, s[8:11], s42 offen offset:3072 sc1
  s_sub_u32 s48, s48, 1
  s_cbranch_scc1 L_fail
  s_waitcnt vmcnt(3)
  v_max3_u32 v0, v56, v57, v58
  v_max_u32 v0, v0, v59
  v_cmp_eq_u32 vcc, -1, v0
  v_mov_b32 v13, v13
  v_mov_b32 v13, v13
  v_mov_b32 v13, v13
  v_mov_b32 v13, v13
  v_mov_b32 v13, v13
  s_cbranch_vccz rc_94
rp_91:
  buffer_load_dwordx4 v[56:59], v2, s[8:11], s42 offen offset:0 sc1
  s_waitcnt vmcnt(3)
  v_max3_u32 v0, v60, v61, v62
  v_max_u32 v0, v0, v63
  v_cmp_eq_u32 vcc, -1, v0
  v_mov_b32 v13, v13
  v_mov_b32 v13, v13
  v_mov_b32 v13, v13
  v_mov_b32 v13, v13
  v_mov_b32 v13, v13
  s_cbranch_vccz rc_95
rp_92:
  buffer_load_dwordx4 v[60:63], v2, s[8:11], s42 offen offset:1024 sc1
  s_waitcnt vmcnt(3)
  v_max3_u32 v0, v64, v65, v66
  v_max_u32 v0, v0, v67
  v_cmp_eq_u32 vcc, -1, v0
  v_mov_b32 v13, v13
  v_mov_b32 v13, v13
  v_mov_b32 v13, v13
  v_mov_b32 v13, v13
  v_mov_b32 v13, v13
  s_cbranch_vccz rc_96
rp_93:
  buffer_load_dwordx4 v[64:67], v2, s[8:11], s42 offen offset:2048 sc1
  s_waitcnt vmcnt(3)
  v_max3_u32 v0, v68, v69, v70
  v_max_u32 v0, v0, v71
  v_cmp_eq_u32 vcc, -1, v0
  v_mov_b32 v13, v13
  v_mov_b32 v13, v13
  v_mov_b32 v13, v13
  v_mov_b32 v13, v13
  v_mov_b32 v13, v13
  s_cbranch_vccnz rp_90
rc_97:
  ds_write_b128 v2, v[68:71] offset:3072
  v_max3_u32 v0, v56, v57, v58
  v_max_u32 v0, v0, v59
  v_cmp_eq_u32 vcc, -1, v0
  v_smfmac_f32_16x16x64_bf16 v[120:123], v[68:71], a[48:55], v8
  s_cbranch_vccnz rr_98
rb_99:
  ds_write_b128 v2, v[56:59] offset:0
  v_max3_u32 v0, v60, v61, v62
  v_max_u32 v0, v0, v63
  v_cmp_eq_u32 vcc, -1, v0
  v_smfmac_f32_16x16x64_bf16 v[120:123], v[56:59], a[0:7], v8
  s_cbranch_vccnz rr_100
rb_101:
  ds_write_b128 v2, v[60:63] offset:1024
  v_max3_u32 v0, v64, v65, v66
  v_max_u32 v0, v0, v67
  v_cmp_eq_u32 vcc, -1, v0
  v_smfmac_f32_16x16x64_bf16 v[120:123], v[60:63], a[16:23], v8
  s_cbranch_vccnz rr_102
rb_103:
  ds_write_b128 v2, v[64:67] offset:2048
  v_smfmac_f32_16x16x64_bf16 v[120:123], v[64:67], a[32:39], v8
sj_89:
  v_smfmac_f32_16x16x64_bf16 v[124:127], v[56:59], a[8:15], v8
  v_smfmac_f32_16x16x64_bf16 v[124:127], v[60:63], a[24:31], v8
  s_waitcnt lgkmcnt(0)
  s_barrier
  ds_read_b128 v[72:75], v3 offset:0
  ds_read_b128 v[76:79], v3 offset:1024
  ds_read_b128 v[80:83], v3 offset:2048
  v_smfmac_f32_16x16x64_bf16 v[124:127], v[64:67], a[40:47], v8
  ds_read_b128 v[84:87], v3 offset:3072
  ds_read_b128 v[88:91], v4 offset:0
  ds_read_b128 v[92:95], v4 offset:1024
  v_smfmac_f32_16x16x64_bf16 v[124:127], v[68:71], a[56:63], v8
  s_waitcnt lgkmcnt(5)
  v_smfmac_f32_16x16x64_bf16 v[120:123], v[72:75], a[64:71], v8
  ds_read_b128 v[96:99], v4 offset:2048
  v_smfmac_f32_16x16x64_bf16 v[124:127], v[72:75], a[72:79], v8
  s_waitcnt lgkmcnt(5)
  v_smfmac_f32_16x16x64_bf16 v[120:123], v[76:79], a[80:87], v8
  ds_read_b128 v[100:103], v4 offset:3072
  v_smfmac_f32_16x16x64_bf16 v[124:127], v[76:79], a[88:95], v8
  s_waitcnt lgkmcnt(5)
  v_smfmac_f32_16x16x64_bf16 v[120:123], v[80:83], a[96:103], v8
  ds_read_b128 v[104:107], v5 offset:0
  v_smfmac_f32_16x16x64_bf16 v[124:127], v[80:83], a[104:111], v8
  s_waitcnt lgkmcnt(5)
  v_smfmac_f32_16x16x64_bf16 v[120:123], v[84:87], a[112:119], v8
  ds_read_b128 v[108:111], v5 offset:1024
  v_smfmac_f32_16x16x64_bf16 v[124:127], v[84:87], a[120:127], v8
  s_waitcnt lgkmcnt(5)
  v_smfmac_f32_16x16x64_bf16 v[120:123], v[88:91], a[128:135], v8
  ds_read_b128 v[112:115], v5 offset:2048
  v_smfmac_f32_16x16x64_bf16 v[124:127], v[88:91], a[136:143], v8
  s_waitcnt lgkmcnt(5)
  v_smfmac_f32_16x16x64_bf16 v[120:123], v[92:95], a[144:151], v8
  ds_read_b128 v[116:119], v5 offset:3072
  v_smfmac_f32_16x16x64_bf16 v[124:127], v[92:95], a[152:159], v8
  s_waitcnt lgkmcnt(5)
  v_smfmac_f32_16x16x64_bf16 v[120:123], v[96:99], a[160:167], v8
  v_smfmac_f32_16x16x64_bf16 v[124:127], v[96:99], a[168:175], v8
  s_waitcnt lgkmcnt(4)
  v_smfmac_f32_16x16x64_bf16 v[120:123], v[100:103], a[176:183], v8
  v_smfmac_f32_16x16x64_bf16 v[124:127], v[100:103], a[184:191], v8
  s_waitcnt lgkmcnt(3)
  v_smfmac_f32_16x16x64_bf16 v[120:123], v[104:107], a[192:199], v8
  v_smfmac_f32_16x16x64_bf16 v[124:127], v[104:107], a[200:207], v8
  s_waitcnt lgkmcnt(2)
  v_smfmac_f32_16x16x64_bf16 v[120:123], v[108:111], a[208:215], v8
  v_smfmac_f32_16x16x64_bf16 v[124:127], v[108:111], a[216:223], v8
  s_waitcnt lgkmcnt(1)
  v_smfmac_f32_16x16x64_bf16 v[120:123], v[112:115], a[224:231], v8
  v_smfmac_f32_16x16x64_bf16 v[124:127], v[112:115], a[232:239], v8
  s_waitcnt lgkmcnt(0)
  v_smfmac_f32_16x16x64_bf16 v[120:123], v[116:119], a[240:247], v8
  v_smfmac_f32_16x16x64_bf16 v[124:127], v[116:119], a[248:255], v8
  v_mov_b32 v13, v13
  v_mov_b32 v13, v13
  v_mov_b32 v13, v13
  v_mov_b32 v13, v13
  v_mov_b32 v13, v13
  v_mov_b32 v13, v13
  v_mov_b32 v13, v13
  v_mov_b32 v13, v13
  v_permlane32_swap_b32 v120, v124
  v_permlane32_swap_b32 v121, v125
  v_permlane32_swap_b32 v122, v126
  v_permlane32_swap_b32 v123, v127
  v_add_f32 v120, v120, v124
  v_add_f32 v121, v121, v125
  v_add_f32 v122, v122, v126
  v_add_f32 v123, v123, v127
  v_cvt_pk_bf16_f32 v124, v120, v121
  v_cvt_pk_bf16_f32 v125, v122, v123
  ds_write_b64 v6, v[124:125] offset:16384
  v_mfma_f32_16x16x32_bf16 v[248:251], v[204:207], v[204:207], v[248:251]
  v_mfma_f32_16x16x32_bf16 v[248:251], v[204:207], v[204:207], v[248:251]
  v_mfma_f32_16x16x32_bf16 v[248:251], v[204:207], v[204:207], v[248:251]
  s_waitcnt lgkmcnt(0)
  s_waitcnt vmcnt(0)
  s_barrier
  ds_read_b64_tr_b16 v[128:129], v7 offset:16384
  ds_read_b64_tr_b16 v[130:131], v7 offset:16640
  v_mfma_f32_16x16x32_bf16 v[248:251], v[204:207], v[204:207], v[248:251]
  ds_read_b64_tr_b16 v[132:133], v7 offset:16896
  ds_read_b64_tr_b16 v[134:135], v7 offset:17152
  ds_read_b64_tr_b16 v[136:137], v7 offset:17408
  ds_read_b64_tr_b16 v[138:139], v7 offset:17664
  v_mfma_f32_16x16x32_bf16 v[248:251], v[204:207], v[204:207], v[248:251]
  ds_read_b64_tr_b16 v[140:141], v7 offset:17920
  ds_read_b64_tr_b16 v[142:143], v7 offset:18176
  buffer_load_dwordx4 v[144:147], v11, s[8:11], s45 offen offset:0 sc1
  buffer_load_dwordx4 v[148:151], v11, s[8:11], s45 offen offset:512 sc1
  buffer_load_dwordx4 v[152:155], v11, s[8:11], s45 offen offset:1024 sc1
  buffer_load_dwordx4 v[156:159], v11, s[8:11], s45 offen offset:1536 sc1
  v_mfma_f32_16x16x32_bf16 v[248:251], v[204:207], v[204:207], v[248:251]
  s_waitcnt lgkmcnt(6)
  v_mfma_f32_16x16x32_bf16 v[164:167], v[16:19], v[128:131], 0
  v_mfma_f32_16x16x32_bf16 v[168:171], v[32:35], v[128:131], 0
  s_waitcnt lgkmcnt(4)
  v_mfma_f32_16x16x32_bf16 v[164:167], v[20:23], v[132:135], v[164:167]
  v_mfma_f32_16x16x32_bf16 v[168:171], v[36:39], v[132:135], v[168:171]
  s_waitcnt lgkmcnt(2)
  v_mfma_f32_16x16x32_bf16 v[164:167], v[24:27], v[136:139], v[164:167]
  v_mfma_f32_16x16x32_bf16 v[168:171], v[40:43], v[136:139], v[168:171]
  buffer_load_dwordx4 v[144:147], v11, s[8:11], s45 offen offset:0 sc1
  buffer_load_dwordx4 v[148:151], v11, s[8:11], s45 offen offset:512 sc1
  buffer_load_dwordx4 v[152:155], v11, s[8:11], s45 offen offset:1024 sc1
  buffer_load_dwordx4 v[156:159], v11, s[8:11], s45 offen offset:1536 sc1
  s_waitcnt lgkmcnt(0)
  v_mfma_f32_16x16x32_bf16 v[164:167], v[28:31], v[140:143], v[164:167]
  v_mfma_f32_16x16x32_bf16 v[168:171], v[44:47], v[140:143], v[168:171]
  v_mov_b32 v13, v13
  v_mov_b32 v13, v13
  v_mov_b32 v13, v13
  v_mov_b32 v13, v13
  v_max3_f32 v210, v164, v165, v166
  v_mov_b32 v13, v13
  v_mov_b32 v13, v13
  v_mov_b32 v13, v13
  v_max3_f32 v211, v168, v169, v170
  v_max3_f32 v210, v210, v167, v171
  v_max_f32 v214, v210, v211
  v_max_f32 v211, v210, v211
  s_nop 1
  v_permlane32_swap_b32 v214, v211
  v_max3_u32 v0, v144, v145, v146
  v_max3_u32 v0, v0, v147, v148
  v_max3_u32 v0, v0, v149, v150
  v_max3_u32 v0, v0, v151, v152
  v_max3_u32 v0, v0, v153, v154
  v_max3_u32 v0, v0, v155, v156
  v_max3_u32 v0, v0, v157, v158
  v_max_u32 v0, v0, v159
  v_cmp_eq_u32 vcc, -1, v0
  buffer_load_dwordx4 v[172:175], v10, s[8:11], s41 offen sc1
  v_mov_b32 v13, v13
  v_mov_b32 v13, v13
  v_mov_b32 v13, v13
  v_mov_b32 v13, v13
  s_cbranch_vccnz sp_104
sb_105:
  v_mfma_f32_16x16x32_bf16 v[160:163], v[144:147], v[128:131], 0
  v_mfma_f32_16x16x32_bf16 v[160:163], v[148:151], v[132:135], v[160:163]
  v_mfma_f32_16x16x32_bf16 v[160:163], v[152:155], v[136:139], v[160:163]
  v_mfma_f32_16x16x32_bf16 v[160:163], v[156:159], v[140:143], v[160:163]
  buffer_load_dwordx4 v[172:175], v10, s[8:11], s41 offen sc1
  v_mov_b32 v13, v13
  v_mov_b32 v13, v13
  v_mov_b32 v13, v13
  v_mov_b32 v13, v13
  v_mov_b32 v13, v13
  v_mov_b32 v13, v13
  v_mov_b32 v13, v13
  v_max3_f32 v210, v160, v161, v162
  v_max3_f32 v211, v214, v211, v163
  v_max_f32 v214, v210, v211
  v_max_f32 v210, v210, v211
  s_nop 1
  v_permlane16_swap_b32 v210, v214
  v_max_f32 v211, v210, v214
  v_mul_f32 v212, s34, v211
  v_pk_fma_f32 v[164:165], v[164:165], s[34:35], v[212:213] op_sel_hi:[1,1,0] neg_lo:[0,0,1] neg_hi:[0,0,1]
  v_pk_fma_f32 v[166:167], v[166:167], s[34:35], v[212:213] op_sel_hi:[1,1,0] neg_lo:[0,0,1] neg_hi:[0,0,1]
  v_pk_fma_f32 v[168:169], v[168:169], s[34:35], v[212:213] op_sel_hi:[1,1,0] neg_lo:[0,0,1] neg_hi:[0,0,1]
  v_pk_fma_f32 v[170:171], v[170:171], s[34:35], v[212:213] op_sel_hi:[1,1,0] neg_lo:[0,0,1] neg_hi:[0,0,1]
  v_pk_fma_f32 v[160:161], v[160:161], s[34:35], v[212:213] op_sel_hi:[1,1,0] neg_lo:[0,0,1] neg_hi:[0,0,1]
  v_pk_fma_f32 v[162:163], v[162:163], s[34:35], v[212:213] op_sel_hi:[1,1,0] neg_lo:[0,0,1] neg_hi:[0,0,1]
  buffer_load_dwordx4 v[172:175], v10, s[8:11], s41 offen sc1
  v_exp_f32 v164, v164
  v_exp_f32 v165, v165
  v_exp_f32 v166, v166
  v_cvt_pk_bf16_f32 v176, v164, v165
  v_exp_f32 v167, v167
  v_exp_f32 v168, v168
  v_cvt_pk_bf16_f32 v177, v166, v167
  v_exp_f32 v169, v169
  v_exp_f32 v170, v170
  v_cvt_pk_bf16_f32 v178, v168, v169
  v_exp_f32 v171, v171
  v_exp_f32 v160, v160
  v_cvt_pk_bf16_f32 v179, v170, v171
  v_exp_f32 v161, v161
  v_exp_f32 v162, v162
  v_mfma_f32_16x16x32_bf16 v[200:203], v[204:207], v[176:179], 0
  v_exp_f32 v163, v163
  v_mfma_f32_16x16x32_bf16 v[184:187], v[48:51], v[176:179], 0
  v_cvt_pk_bf16_f32 v180, v160, v161
  v_cvt_pk_bf16_f32 v181, v162, v163
  v_mfma_f32_16x16x32_bf16 v[188:191], v[52:55], v[176:179], 0
  v_max3_u32 v0, v172, v173, v174
  v_max_u32 v0, v0, v175
  v_mfma_f32_16x16x16_bf16 v[200:203], v[208:209], v[180:181], v[200:203]
  v_cmp_eq_u32 vcc, -1, v0
pv_106:
  v_mfma_f32_16x16x16_bf16 v[192:195], v[172:173], v[180:181], v[184:187]
  v_mfma_f32_16x16x16_bf16 v[196:199], v[174:175], v[180:181], v[188:191]
  s_cbranch_vccnz vr_107
  s_cmp_eq_u32 s31, 1
  s_nop 1
  v_rcp_f32 v212, v200
  s_mov_b32 exec_lo, 0x00ff00ff
  s_mov_b32 exec_hi, 0x00ff00ff
  v_pk_mul_f32 v[192:193], v[192:193], v[212:213] op_sel_hi:[1,0]
  v_pk_mul_f32 v[194:195], v[194:195], v[212:213] op_sel_hi:[1,0]
  v_cvt_pk_bf16_f32 v176, v192, v193
  v_pk_mul_f32 v[196:197], v[196:197], v[212:213] op_sel_hi:[1,0]
  v_cvt_pk_bf16_f32 v177, v194, v195
  v_pk_mul_f32 v[198:199], v[198:199], v[212:213] op_sel_hi:[1,0]
  v_cvt_pk_bf16_f32 v178, v196, v197
  v_cvt_pk_bf16_f32 v179, v198, v199
  s_cbranch_scc0 sm_108
  buffer_store_dwordx4 v[176:179], v1, s[8:11], s40 offen
sm_109:
  s_mov_b64 exec, -1
  buffer_load_dwordx4 v[88:91], v228, s[8:11], s41 offen offset:0 sc1
  buffer_load_dwordx4 v[92:95], v228, s[8:11], s41 offen offset:512 sc1
  v_add_u32 v15, s89, v12
  v_add_u32 v0, s90, v12
  ds_read_b128 v[128:131], v15 offset:0
  ds_read_b128 v[132:135], v15 offset:1024
  ds_read_b128 v[136:139], v15 offset:2048
  ds_read_b128 v[140:143], v15 offset:3072
  ds_read_b128 v[72:75], v0 offset:16384
  ds_read_b128 v[76:79], v0 offset:17408
  ds_read_b128 v[80:83], v0 offset:18432
  ds_read_b128 v[84:87], v0 offset:19456
  s_waitcnt lgkmcnt(7)
  v_mfma_f32_16x16x32_bf16 v[164:167], v[16:19], v[128:131], v[220:223]
  v_mfma_f32_16x16x32_bf16 v[168:171], v[32:35], v[128:131], v[224:227]
  v_mfma_f32_16x16x32_bf16 v[160:163], v[144:147], v[128:131], v[216:219]
  s_waitcnt lgkmcnt(6)
  v_mfma_f32_16x16x32_bf16 v[164:167], v[20:23], v[132:135], v[164:167]
  v_mfma_f32_16x16x32_bf16 v[168:171], v[36:39], v[132:135], v[168:171]
  v_mfma_f32_16x16x32_bf16 v[160:163], v[148:151], v[132:135], v[160:163]
  s_waitcnt lgkmcnt(5)
  v_mfma_f32_16x16x32_bf16 v[164:167], v[24:27], v[136:139], v[164:167]
  v_mfma_f32_16x16x32_bf16 v[168:171], v[40:43], v[136:139], v[168:171]
  v_mfma_f32_16x16x32_bf16 v[160:163], v[152:155], v[136:139], v[160:163]
  s_waitcnt lgkmcnt(4)
  v_mfma_f32_16x16x32_bf16 v[164:167], v[28:31], v[140:143], v[164:167]
  v_mfma_f32_16x16x32_bf16 v[168:171], v[44:47], v[140:143], v[168:171]
  v_mfma_f32_16x16x32_bf16 v[160:163], v[156:159], v[140:143], v[160:163]
  s_waitcnt vmcnt(0) lgkmcnt(0)
  s_cmp_lg_u32 s28, 0
  s_cbranch_scc1 po_110
  s_cmp_lt_u32 s32, 59
  s_cbranch_scc1 po_110
  s_sub_u32 s36, s32, 1
  s_lshr_b32 s37, s36, 2
  s_add_u32 s37, s37, 156
  s_add_u32 s38, s36, 128
  s_cmp_lt_u32 s36, 40
  s_cselect_b32 s37, s37, s38
  s_lshl_b32 s37, s37, 7
  s_add_u32 s37, s37, 0x4c00000
  v_mov_b32 v210, 2
  v_mov_b32 v211, 0
  s_mov_b64 exec, 1
  buffer_atomic_add v210, v211, s[8:11], s37 offen sc1
  s_mov_b64 exec, -1
po_110:
  s_lshl_b32 s36, s49, 2
  s_add_u32 s36, s36, s28
  s_cmp_lg_u32 s36, 3
  s_cbranch_scc1 po_111
  s_cmp_lt_u32 s32, 3
  s_cbranch_scc1 po_111
  s_cmp_ge_u32 s32, 61
  s_cbranch_scc1 po_111
  s_sub_u32 s36, s32, 3
  s_lshr_b32 s37, s36, 2
  s_add_u32 s37, s37, 156
  s_add_u32 s38, s36, 128
  s_cmp_lt_u32 s36, 40
  s_cselect_b32 s37, s37, s38
  s_lshl_b32 s37, s37, 7
  s_add_u32 s37, s37, 0x4c00000
  v_mov_b32 v210, 64
  v_mov_b32 v211, 0
  s_mov_b64 exec, 1
  buffer_atomic_add v210, v211, s[8:11], s37 offen sc1
  s_mov_b64 exec, -1
po_111:
  v_max3_u32 v0, v88, v89, v90
  v_max3_u32 v0, v0, v91, v92
  v_max3_u32 v0, v0, v93, v94
  v_max_u32 v0, v0, v95
  v_cmp_eq_u32 vcc, -1, v0
  v_mov_b32 v13, v13
  v_mov_b32 v13, v13
  v_mov_b32 v13, v13
  v_mov_b32 v13, v13
  s_cbranch_vccnz sp_112
sb_113:
  v_max3_f32 v210, v164, v165, v166
  v_max3_f32 v210, v210, v167, v168
  v_max3_f32 v210, v210, v169, v170
  v_max3_f32 v210, v210, v171, v160
  v_max3_f32 v210, v210, v161, v162
  v_max_f32 v210, v210, v163
  v_mov_b32 v211, v210
  s_nop 1
  v_permlane16_swap_b32 v210, v211
  v_max_f32 v210, v210, v211
  v_mov_b32 v211, v210
  s_nop 1
  v_permlane32_swap_b32 v210, v211
  v_max_f32 v210, v210, v211
  v_mul_f32 v212, s34, v210
  v_pk_fma_f32 v[160:161], v[160:161], s[34:35], v[212:213] op_sel_hi:[1,1,0] neg_lo:[0,0,1] neg_hi:[0,0,1]
  v_pk_fma_f32 v[162:163], v[162:163], s[34:35], v[212:213] op_sel_hi:[1,1,0] neg_lo:[0,0,1] neg_hi:[0,0,1]
  v_pk_fma_f32 v[164:165], v[164:165], s[34:35], v[212:213] op_sel_hi:[1,1,0] neg_lo:[0,0,1] neg_hi:[0,0,1]
  v_pk_fma_f32 v[166:167], v[166:167], s[34:35], v[212:213] op_sel_hi:[1,1,0] neg_lo:[0,0,1] neg_hi:[0,0,1]
  v_pk_fma_f32 v[168:169], v[168:169], s[34:35], v[212:213] op_sel_hi:[1,1,0] neg_lo:[0,0,1] neg_hi:[0,0,1]
  v_pk_fma_f32 v[170:171], v[170:171], s[34:35], v[212:213] op_sel_hi:[1,1,0] neg_lo:[0,0,1] neg_hi:[0,0,1]
  s_add_u32 s36, s32, 2
  s_cmp_ge_u32 s36, 64
  s_cbranch_scc1 wx_114
  s_cmp_lt_u32 s36, 8
  s_cselect_b32 s37, 3, 7
  s_and_b32 s37, s36, s37
  s_cmp_lg_u32 s37, 0
  s_cbranch_scc1 wx_114
  s_lshr_b32 s37, s36, 3
  s_add_u32 s37, s37, 1
  s_cmp_lt_u32 s36, 4
  s_cselect_b32 s37, 0, s37
  s_cmp_lt_u32 s36, 8
  s_cselect_b32 s38, 6, 3
  s_lshl_b32 s37, s37, 4
  s_lshr_b32 s39, s49, 1
  s_add_u32 s37, s37, s39
  s_lshl_b32 s37, s37, 7
  s_add_u32 s37, s37, 0x4c00000
wx_115:
  s_sub_u32 s48, s48, 1
  s_cbranch_scc1 L_fail
  v_mov_b32 v0, 0
  buffer_load_dword v0, v0, s[8:11], s37 offen sc1
  s_waitcnt vmcnt(0)
  v_readfirstlane_b32 s39, v0
  s_nop 3
  s_cmp_ge_u32 s39, s38
  s_cbranch_scc1 wx_114
  s_sleep 4
  s_branch wx_115
wx_114:
  s_sub_u32 s92, s32, 1
  s_cmp_ge_u32 s92, 58
  s_cselect_b32 s92, -1, s92
  s_cmp_ge_u32 s92, 48
  s_cbranch_scc1 ox_116
  s_lshr_b32 s38, s92, 2
  s_lshl_b32 s38, s38, 20
  s_and_b32 s37, s92, 3
  s_lshl_b32 s37, s37, 11
  s_add_u32 s38, s38, s37
  s_add_u32 s38, s38, 0x3000000
  s_add_u32 s37, s38, 0x2000
  buffer_store_dwordx4 v[240:243], v9, s[8:11], s38 offen sc1
  buffer_store_dwordx4 v[244:247], v9, s[8:11], s37 offen sc1
ox_117:
  s_add_u32 s36, s44, 0x10000
  s_bitset0_b32 s36, 19
  s_add_u32 s36, s36, s93
  buffer_load_dwordx4 v[112:115], v1, s[8:11], s36 offen sc1
  s_xor_b32 s36, s47, 0x100000
  buffer_store_dwordx4 v[232:235], v1, s[8:11], s36 offen sc1
  s_xor_b32 s38, s44, 0x40000
  s_lshl_b32 s39, s28, 9
  s_add_u32 s38, s38, s39
  s_add_u32 s36, s38, 0x4d00000
  s_add_u32 s37, s38, 0x4400000
  s_add_u32 s38, s38, 0x4800000
  s_xor_b32 s39, s42, 0x10000
  s_add_u32 s39, s39, s46
  s_cmp_eq_u32 s31, 1
  s_mov_b32 exec_hi, 0
  s_cbranch_scc0 ji_118
  buffer_store_dwordx4 v[232:235], v1, s[8:11], s36 offen
  buffer_store_dwordx4 v[232:235], v1, s[8:11], s37 offen
  buffer_store_dwordx4 v[232:235], v1, s[8:11], s38 offen
  buffer_store_dwordx4 v[232:235], v1, s[8:11], s39 offen
ji_119:
  s_mov_b64 exec, -1
  s_add_u32 s43, s32, 2
  s_lshl_b32 s36, s43, 18
  s_lshl_b32 s37, s49, 13
  s_add_u32 s36, s36, s37
  s_lshl_b32 s38, s28, 11
  s_add_u32 s36, s36, s38
  s_cmp_ge_u32 s43, 64
  s_cselect_b32 s36, 0x7f000000, s36
  s_and_b32 s37, s43, 3
  s_lshl_b32 s37, s37, 15
  s_add_u32 s37, s37, s38
  s_add_u32 m0, s37, 0x8000
  s_add_u32 s39, s36, 0x1000000
  buffer_load_dwordx4 v1, s[8:11], s39 offen offset:0 sc1 lds
  buffer_load_dwordx4 v1, s[8:11], s39 offen offset:1024 sc1 lds
  s_add_u32 m0, s37, 0xa000
  s_add_u32 s39, s36, 0x0
  buffer_load_dwordx4 v1, s[8:11], s39 offen offset:0 sc1 lds
  buffer_load_dwordx4 v1, s[8:11], s39 offen offset:1024 sc1 lds
  s_add_u32 m0, s37, 0xc000
  s_add_u32 s39, s36, 0x2000000
  buffer_load_dwordx4 v1, s[8:11], s39 offen offset:0 sc1 lds
  buffer_load_dwordx4 v1, s[8:11], s39 offen offset:1024 sc1 lds
  v_exp_f32 v164, v164
  v_exp_f32 v165, v165
  v_exp_f32 v166, v166
  v_exp_f32 v167, v167
  v_exp_f32 v168, v168
  v_exp_f32 v169, v169
  v_exp_f32 v170, v170
  v_exp_f32 v171, v171
  v_exp_f32 v160, v160
  v_exp_f32 v161, v161
  v_exp_f32 v162, v162
  v_exp_f32 v163, v163
  v_cvt_pk_bf16_f32 v96, v164, v165
  v_cvt_pk_bf16_f32 v97, v166, v167
  v_cvt_pk_bf16_f32 v98, v168, v169
  v_cvt_pk_bf16_f32 v99, v170, v171
  v_cvt_pk_bf16_f32 v100, v160, v161
  v_cvt_pk_bf16_f32 v101, v162, v163
  v_mfma_f32_16x16x32_bf16 v[200:203], v[204:207], v[96:99], 0
  v_mfma_f32_16x16x32_bf16 v[56:59], v[72:75], v[96:99], 0
  v_mfma_f32_16x16x32_bf16 v[60:63], v[76:79], v[96:99], 0
  v_mfma_f32_16x16x32_bf16 v[64:67], v[80:83], v[96:99], 0
  v_mfma_f32_16x16x32_bf16 v[68:71], v[84:87], v[96:99], 0
  v_mfma_f32_16x16x16_bf16 v[200:203], v[204:205], v[100:101], v[200:203]
  v_mfma_f32_16x16x16_bf16 v[56:59], v[88:89], v[100:101], v[56:59]
  v_mfma_f32_16x16x16_bf16 v[60:63], v[90:91], v[100:101], v[60:63]
  v_mfma_f32_16x16x16_bf16 v[64:67], v[92:93], v[100:101], v[64:67]
  v_mfma_f32_16x16x16_bf16 v[68:71], v[94:95], v[100:101], v[68:71]
  v_rcp_f32 v212, v200
  s_nop 0
  v_pk_mul_f32 v[56:57], v[56:57], v[212:213] op_sel_hi:[1,0]
  v_pk_mul_f32 v[58:59], v[58:59], v[212:213] op_sel_hi:[1,0]
  v_pk_mul_f32 v[60:61], v[60:61], v[212:213] op_sel_hi:[1,0]
  v_pk_mul_f32 v[62:63], v[62:63], v[212:213] op_sel_hi:[1,0]
  v_pk_mul_f32 v[64:65], v[64:65], v[212:213] op_sel_hi:[1,0]
  v_pk_mul_f32 v[66:67], v[66:67], v[212:213] op_sel_hi:[1,0]
  v_pk_mul_f32 v[68:69], v[68:69], v[212:213] op_sel_hi:[1,0]
  v_pk_mul_f32 v[70:71], v[70:71], v[212:213] op_sel_hi:[1,0]
  v_cvt_pk_bf16_f32 v240, v56, v57
  v_cvt_pk_bf16_f32 v241, v58, v59
  v_cvt_pk_bf16_f32 v242, v60, v61
  v_cvt_pk_bf16_f32 v243, v62, v63
  v_cvt_pk_bf16_f32 v244, v64, v65
  v_cvt_pk_bf16_f32 v245, v66, v67
  v_cvt_pk_bf16_f32 v246, v68, v69
  v_cvt_pk_bf16_f32 v247, v70, v71
  s_cmp_ge_u32 s32, 58
  s_cbranch_scc1 ie_120
ie_121:
  s_add_u32 s32, s32, 1
  s_cmp_eq_u32 s32, 64
  s_cbranch_scc1 S_exit
  s_add_u32 s42, s42, 0x4000
  s_bitset0_b32 s42, 17
  s_add_u32 s44, s44, 0x10000
  s_bitset0_b32 s44, 19
  s_add_u32 s47, s47, 0x40000
  s_bitset0_b32 s47, 21
  s_branch S_loop
rr_98:
  buffer_load_dwordx4 v[56:59], v2, s[8:11], s42 offen offset:0 sc1
  buffer_load_dwordx4 v[60:63], v2, s[8:11], s42 offen offset:1024 sc1
  buffer_load_dwordx4 v[64:67], v2, s[8:11], s42 offen offset:2048 sc1
  v_max3_u32 v0, v56, v57, v58
  v_max_u32 v0, v0, v59
  v_cmp_eq_u32 vcc, -1, v0
  v_mov_b32 v13, v13
  v_mov_b32 v13, v13
  v_mov_b32 v13, v13
  v_mov_b32 v13, v13
  v_mov_b32 v13, v13
  s_cbranch_vccz rb_99
  v_max3_u32 v0, v56, v57, v58
  v_max_u32 v0, v0, v59
  v_cmp_eq_u32 vcc, -1, v0
  v_mov_b32 v13, v13
  v_mov_b32 v13, v13
  v_mov_b32 v13, v13
  v_mov_b32 v13, v13
  v_mov_b32 v13, v13
  s_cbranch_vccz rb_99
  v_max3_u32 v0, v56, v57, v58
  v_max_u32 v0, v0, v59
  v_cmp_eq_u32 vcc, -1, v0
  v_mov_b32 v13, v13
  v_mov_b32 v13, v13
  v_mov_b32 v13, v13
  v_mov_b32 v13, v13
  v_mov_b32 v13, v13
  s_cbranch_vccz rb_99
  s_sub_u32 s48, s48, 1
  s_cbranch_scc1 L_fail
  s_waitcnt vmcnt(8)
  s_branch rr_98
rr_100:
  buffer_load_dwordx4 v[60:63], v2, s[8:11], s42 offen offset:1024 sc1
  buffer_load_dwordx4 v[64:67], v2, s[8:11], s42 offen offset:2048 sc1
  v_max3_u32 v0, v60, v61, v62
  v_max_u32 v0, v0, v63
  v_cmp_eq_u32 vcc, -1, v0
  v_mov_b32 v13, v13
  v_mov_b32 v13, v13
  v_mov_b32 v13, v13
  v_mov_b32 v13, v13
  v_mov_b32 v13, v13
  s_cbranch_vccz rb_101
  v_max3_u32 v0, v60, v61, v62
  v_max_u32 v0, v0, v63
  v_cmp_eq_u32 vcc, -1, v0
  v_mov_b32 v13, v13
  v_mov_b32 v13, v13
  v_mov_b32 v13, v13
  v_mov_b32 v13, v13
  v_mov_b32 v13, v13
  s_cbranch_vccz rb_101
  s_sub_u32 s48, s48, 1
  s_cbranch_scc1 L_fail
  s_waitcnt vmcnt(8)
  s_branch rr_100
rr_102:
  buffer_load_dwordx4 v[64:67], v2, s[8:11], s42 offen offset:2048 sc1
  v_max3_u32 v0, v64, v65, v66
  v_max_u32 v0, v0, v67
  v_cmp_eq_u32 vcc, -1, v0
  v_mov_b32 v13, v13
  v_mov_b32 v13, v13
  v_mov_b32 v13, v13
  v_mov_b32 v13, v13
  v_mov_b32 v13, v13
  s_cbranch_vccz rb_103
  s_sub_u32 s48, s48, 1
  s_cbranch_scc1 L_fail
  s_waitcnt vmcnt(8)
  s_branch rr_102
rc_94:
  ds_write_b128 v2, v[56:59] offset:0
  v_max3_u32 v0, v60, v61, v62
  v_max_u32 v0, v0, v63
  v_cmp_eq_u32 vcc, -1, v0
  v_smfmac_f32_16x16x64_bf16 v[120:123], v[56:59], a[0:7], v8
  s_cbranch_vccnz rr_122
rb_123:
  ds_write_b128 v2, v[60:63] offset:1024
  v_max3_u32 v0, v64, v65, v66
  v_max_u32 v0, v0, v67
  v_cmp_eq_u32 vcc, -1, v0
  v_smfmac_f32_16x16x64_bf16 v[120:123], v[60:63], a[16:23], v8
  s_cbranch_vccnz rr_124
rb_125:
  ds_write_b128 v2, v[64:67] offset:2048
  v_max3_u32 v0, v68, v69, v70
  v_max_u32 v0, v0, v71
  v_cmp_eq_u32 vcc, -1, v0
  v_smfmac_f32_16x16x64_bf16 v[120:123], v[64:67], a[32:39], v8
  s_cbranch_vccnz rr_126
rb_127:
  ds_write_b128 v2, v[68:71] offset:3072
  v_smfmac_f32_16x16x64_bf16 v[120:123], v[68:71], a[48:55], v8
  s_branch sj_89
rc_95:
  ds_write_b128 v2, v[60:63] offset:1024
  v_max3_u32 v0, v64, v65, v66
  v_max_u32 v0, v0, v67
  v_cmp_eq_u32 vcc, -1, v0
  v_smfmac_f32_16x16x64_bf16 v[120:123], v[60:63], a[16:23], v8
  s_cbranch_vccnz rr_128
rb_129:
  ds_write_b128 v2, v[64:67] offset:2048
  v_max3_u32 v0, v68, v69, v70
  v_max_u32 v0, v0, v71
  v_cmp_eq_u32 vcc, -1, v0
  v_smfmac_f32_16x16x64_bf16 v[120:123], v[64:67], a[32:39], v8
  s_cbranch_vccnz rr_130
rb_131:
  ds_write_b128 v2, v[68:71] offset:3072
  v_max3_u32 v0, v56, v57, v58
  v_max_u32 v0, v0, v59
  v_cmp_eq_u32 vcc, -1, v0
  v_smfmac_f32_16x16x64_bf16 v[120:123], v[68:71], a[48:55], v8
  s_cbranch_vccnz rr_132
rb_133:
  ds_write_b128 v2, v[56:59] offset:0
  v_smfmac_f32_16x16x64_bf16 v[120:123], v[56:59], a[0:7], v8
  s_branch sj_89
rc_96:
  ds_write_b128 v2, v[64:67] offset:2048
  v_max3_u32 v0, v68, v69, v70
  v_max_u32 v0, v0, v71
  v_cmp_eq_u32 vcc, -1, v0
  v_smfmac_f32_16x16x64_bf16 v[120:123], v[64:67], a[32:39], v8
  s_cbranch_vccnz rr_134
rb_135:
  ds_write_b128 v2, v[68:71] offset:3072
  v_max3_u32 v0, v56, v57, v58
  v_max_u32 v0, v0, v59
  v_cmp_eq_u32 vcc, -1, v0
  v_smfmac_f32_16x16x64_bf16 v[120:123], v[68:71], a[48:55], v8
  s_cbranch_vccnz rr_136
rb_137:
  ds_write_b128 v2, v[56:59] offset:0
  v_max3_u32 v0, v60, v61, v62
  v_max_u32 v0, v0, v63
  v_cmp_eq_u32 vcc, -1, v0
  v_smfmac_f32_16x16x64_bf16 v[120:123], v[56:59], a[0:7], v8
  s_cbranch_vccnz rr_138
rb_139:
  ds_write_b128 v2, v[60:63] offset:1024
  v_smfmac_f32_16x16x64_bf16 v[120:123], v[60:63], a[16:23], v8
  s_branch sj_89
sp_104:
sp_140:
  v_mov_b32 v13, v13
  buffer_load_dwordx4 v[144:147], v11, s[8:11], s45 offen offset:0 sc1
  buffer_load_dwordx4 v[148:151], v11, s[8:11], s45 offen offset:512 sc1
  buffer_load_dwordx4 v[152:155], v11, s[8:11], s45 offen offset:1024 sc1
  buffer_load_dwordx4 v[156:159], v11, s[8:11], s45 offen offset:1536 sc1
  v_mov_b32 v13, v13
  s_sub_u32 s48, s48, 1
  s_cbranch_scc1 L_fail
  s_waitcnt vmcnt(12)
  v_max3_u32 v0, v144, v145, v146
  v_max3_u32 v0, v0, v147, v148
  v_max3_u32 v0, v0, v149, v150
  v_max3_u32 v0, v0, v151, v152
  v_max3_u32 v0, v0, v153, v154
  v_max3_u32 v0, v0, v155, v156
  v_max3_u32 v0, v0, v157, v158
  v_max_u32 v0, v0, v159
  v_cmp_eq_u32 vcc, -1, v0
  v_mov_b32 v13, v13
  v_mov_b32 v13, v13
  v_mov_b32 v13, v13
  v_mov_b32 v13, v13
  v_mov_b32 v13, v13
  s_cbranch_vccnz sp_140
so_141:
  s_branch sb_105
vr_107:
  v_mov_b32 v13, v13
  buffer_load_dwordx4 v[172:175], v10, s[8:11], s41 offen sc1
  v_mov_b32 v13, v13
  s_sub_u32 s48, s48, 1
  s_cbranch_scc1 L_fail
  s_waitcnt vmcnt(3)
  v_max3_u32 v0, v172, v173, v174
  v_max_u32 v0, v0, v175
  v_cmp_eq_u32 vcc, -1, v0
  v_mov_b32 v13, v13
  v_mov_b32 v13, v13
  v_mov_b32 v13, v13
  v_mov_b32 v13, v13
  v_mov_b32 v13, v13
  s_cbranch_vccz so_142
  v_max3_u32 v0, v172, v173, v174
  v_max_u32 v0, v0, v175
  v_cmp_eq_u32 vcc, -1, v0
  v_mov_b32 v13, v13
  v_mov_b32 v13, v13
  v_mov_b32 v13, v13
  v_mov_b32 v13, v13
  v_mov_b32 v13, v13
  s_cbranch_vccnz vr_107
so_142:
  s_branch pv_106
sm_108:
  buffer_store_dwordx4 v[176:179], v1, s[8:11], s40 offen sc1
  s_branch sm_109
sp_112:
sp_143:
  v_mov_b32 v13, v13
  buffer_load_dwordx4 v[88:91], v228, s[8:11], s41 offen offset:0 sc1
  buffer_load_dwordx4 v[92:95], v228, s[8:11], s41 offen offset:512 sc1
  v_mov_b32 v13, v13
  s_sub_u32 s48, s48, 1
  s_cbranch_scc1 L_fail
  s_waitcnt vmcnt(0)
  v_max3_u32 v0, v88, v89, v90
  v_max3_u32 v0, v0, v91, v92
  v_max3_u32 v0, v0, v93, v94
  v_max_u32 v0, v0, v95
  v_cmp_eq_u32 vcc, -1, v0
  v_mov_b32 v13, v13
  v_mov_b32 v13, v13
  v_mov_b32 v13, v13
  v_mov_b32 v13, v13
  v_mov_b32 v13, v13
  s_cbranch_vccnz sp_143
so_144:
  s_branch sb_113
ox_116:
  s_lshl_b32 s38, s92, 18
  s_add_u32 s38, s38, s91
  s_cmp_ge_u32 s92, 64
  s_cselect_b32 s38, 0x7f000000, s38
  buffer_store_dwordx4 v[240:243], v1, s[8:11], s38 offen sc1
  buffer_store_dwordx4 v[244:247], v1, s[8:11], s38 offen offset:1024 sc1
  s_branch ox_117
ji_118:
  buffer_store_dwordx4 v[232:235], v1, s[8:11], s36 offen sc1
  buffer_store_dwordx4 v[232:235], v1, s[8:11], s37 offen sc1
  buffer_store_dwordx4 v[232:235], v1, s[8:11], s38 offen sc1
  buffer_store_dwordx4 v[232:235], v1, s[8:11], s39 offen sc1
  s_branch ji_119
ie_120:
  s_cmp_ge_u32 s32, 48
  s_cbranch_scc1 ox_145
  s_lshr_b32 s38, s32, 2
  s_lshl_b32 s38, s38, 20
  s_and_b32 s37, s32, 3
  s_lshl_b32 s37, s37, 11
  s_add_u32 s38, s38, s37
  s_add_u32 s38, s38, 0x3000000
  s_add_u32 s37, s38, 0x2000
  buffer_store_dwordx4 v[240:243], v9, s[8:11], s38 offen sc1
  buffer_store_dwordx4 v[244:247], v9, s[8:11], s37 offen sc1
ox_146:
  s_branch ie_121
rr_122:
  buffer_load_dwordx4 v[60:63], v2, s[8:11], s42 offen offset:1024 sc1
  buffer_load_dwordx4 v[64:67], v2, s[8:11], s42 offen offset:2048 sc1
  buffer_load_dwordx4 v[68:71], v2, s[8:11], s42 offen offset:3072 sc1
  v_max3_u32 v0, v60, v61, v62
  v_max_u32 v0, v0, v63
  v_cmp_eq_u32 vcc, -1, v0
  v_mov_b32 v13, v13
  v_mov_b32 v13, v13
  v_mov_b32 v13, v13
  v_mov_b32 v13, v13
  v_mov_b32 v13, v13
  s_cbranch_vccz rb_123
  v_max3_u32 v0, v60, v61, v62
  v_max_u32 v0, v0, v63
  v_cmp_eq_u32 vcc, -1, v0
  v_mov_b32 v13, v13
  v_mov_b32 v13, v13
  v_mov_b32 v13, v13
  v_mov_b32 v13, v13
  v_mov_b32 v13, v13
  s_cbranch_vccz rb_123
  v_max3_u32 v0, v60, v61, v62
  v_max_u32 v0, v0, v63
  v_cmp_eq_u32 vcc, -1, v0
  v_mov_b32 v13, v13
  v_mov_b32 v13, v13
  v_mov_b32 v13, v13
  v_mov_b32 v13, v13
  v_mov_b32 v13, v13
  s_cbranch_vccz rb_123
  s_sub_u32 s48, s48, 1
  s_cbranch_scc1 L_fail
  s_waitcnt vmcnt(8)
  s_branch rr_122
rr_124:
  buffer_load_dwordx4 v[64:67], v2, s[8:11], s42 offen offset:2048 sc1
  buffer_load_dwordx4 v[68:71], v2, s[8:11], s42 offen offset:3072 sc1
  v_max3_u32 v0, v64, v65, v66
  v_max_u32 v0, v0, v67
  v_cmp_eq_u32 vcc, -1, v0
  v_mov_b32 v13, v13
  v_mov_b32 v13, v13
  v_mov_b32 v13, v13
  v_mov_b32 v13, v13
  v_mov_b32 v13, v13
  s_cbranch_vccz rb_125
  v_max3_u32 v0, v64, v65, v66
  v_max_u32 v0, v0, v67
  v_cmp_eq_u32 vcc, -1, v0
  v_mov_b32 v13, v13
  v_mov_b32 v13, v13
  v_mov_b32 v13, v13
  v_mov_b32 v13, v13
  v_mov_b32 v13, v13
  s_cbranch_vccz rb_125
  s_sub_u32 s48, s48, 1
  s_cbranch_scc1 L_fail
  s_waitcnt vmcnt(8)
  s_branch rr_124
rr_126:
  buffer_load_dwordx4 v[68:71], v2, s[8:11], s42 offen offset:3072 sc1
  v_max3_u32 v0, v68, v69, v70
  v_max_u32 v0, v0, v71
  v_cmp_eq_u32 vcc, -1, v0
  v_mov_b32 v13, v13
  v_mov_b32 v13, v13
  v_mov_b32 v13, v13
  v_mov_b32 v13, v13
  v_mov_b32 v13, v13
  s_cbranch_vccz rb_127
  s_sub_u32 s48, s48, 1
  s_cbranch_scc1 L_fail
  s_waitcnt vmcnt(8)
  s_branch rr_126
rr_128:
  buffer_load_dwordx4 v[64:67], v2, s[8:11], s42 offen offset:2048 sc1
  buffer_load_dwordx4 v[68:71], v2, s[8:11], s42 offen offset:3072 sc1
  buffer_load_dwordx4 v[56:59], v2, s[8:11], s42 offen offset:0 sc1
  v_max3_u32 v0, v64, v65, v66
  v_max_u32 v0, v0, v67
  v_cmp_eq_u32 vcc, -1, v0
  v_mov_b32 v13, v13
  v_mov_b32 v13, v13
  v_mov_b32 v13, v13
  v_mov_b32 v13, v13
  v_mov_b32 v13, v13
  s_cbranch_vccz rb_129
  v_max3_u32 v0, v64, v65, v66
  v_max_u32 v0, v0, v67
  v_cmp_eq_u32 vcc, -1, v0
  v_mov_b32 v13, v13
  v_mov_b32 v13, v13
  v_mov_b32 v13, v13
  v_mov_b32 v13, v13
  v_mov_b32 v13, v13
  s_cbranch_vccz rb_129
  v_max3_u32 v0, v64, v65, v66
  v_max_u32 v0, v0, v67
  v_cmp_eq_u32 vcc, -1, v0
  v_mov_b32 v13, v13
  v_mov_b32 v13, v13
  v_mov_b32 v13, v13
  v_mov_b32 v13, v13
  v_mov_b32 v13, v13
  s_cbranch_vccz rb_129
  s_sub_u32 s48, s48, 1
  s_cbranch_scc1 L_fail
  s_waitcnt vmcnt(8)
  s_branch rr_128
rr_130:
  buffer_load_dwordx4 v[68:71], v2, s[8:11], s42 offen offset:3072 sc1
  buffer_load_dwordx4 v[56:59], v2, s[8:11], s42 offen offset:0 sc1
  v_max3_u32 v0, v68, v69, v70
  v_max_u32 v0, v0, v71
  v_cmp_eq_u32 vcc, -1, v0
  v_mov_b32 v13, v13
  v_mov_b32 v13, v13
  v_mov_b32 v13, v13
  v_mov_b32 v13, v13
  v_mov_b32 v13, v13
  s_cbranch_vccz rb_131
  v_max3_u32 v0, v68, v69, v70
  v_max_u32 v0, v0, v71
  v_cmp_eq_u32 vcc, -1, v0
  v_mov_b32 v13, v13
  v_mov_b32 v13, v13
  v_mov_b32 v13, v13
  v_mov_b32 v13, v13
  v_mov_b32 v13, v13
  s_cbranch_vccz rb_131
  s_sub_u32 s48, s48, 1
  s_cbranch_scc1 L_fail
  s_waitcnt vmcnt(8)
  s_branch rr_130
rr_132:
  buffer_load_dwordx4 v[56:59], v2, s[8:11], s42 offen offset:0 sc1
  v_max3_u32 v0, v56, v57, v58
  v_max_u32 v0, v0, v59
  v_cmp_eq_u32 vcc, -1, v0
  v_mov_b32 v13, v13
  v_mov_b32 v13, v13
  v_mov_b32 v13, v13
  v_mov_b32 v13, v13
  v_mov_b32 v13, v13
  s_cbranch_vccz rb_133
  s_sub_u32 s48, s48, 1
  s_cbranch_scc1 L_fail
  s_waitcnt vmcnt(8)
  s_branch rr_132
rr_134:
  buffer_load_dwordx4 v[68:71], v2, s[8:11], s42 offen offset:3072 sc1
  buffer_load_dwordx4 v[56:59], v2, s[8:11], s42 offen offset:0 sc1
  buffer_load_dwordx4 v[60:63], v2, s[8:11], s42 offen offset:1024 sc1
  v_max3_u32 v0, v68, v69, v70
  v_max_u32 v0, v0, v71
  v_cmp_eq_u32 vcc, -1, v0
  v_mov_b32 v13, v13
  v_mov_b32 v13, v13
  v_mov_b32 v13, v13
  v_mov_b32 v13, v13
  v_mov_b32 v13, v13
  s_cbranch_vccz rb_135
  v_max3_u32 v0, v68, v69, v70
  v_max_u32 v0, v0, v71
  v_cmp_eq_u32 vcc, -1, v0
  v_mov_b32 v13, v13
  v_mov_b32 v13, v13
  v_mov_b32 v13, v13
  v_mov_b32 v13, v13
  v_mov_b32 v13, v13
  s_cbranch_vccz rb_135
  v_max3_u32 v0, v68, v69, v70
  v_max_u32 v0, v0, v71
  v_cmp_eq_u32 vcc, -1, v0
  v_mov_b32 v13, v13
  v_mov_b32 v13, v13
  v_mov_b32 v13, v13
  v_mov_b32 v13, v13
  v_mov_b32 v13, v13
  s_cbranch_vccz rb_135
  s_sub_u32 s48, s48, 1
  s_cbranch_scc1 L_fail
  s_waitcnt vmcnt(8)
  s_branch rr_134
rr_136:
  buffer_load_dwordx4 v[56:59], v2, s[8:11], s42 offen offset:0 sc1
  buffer_load_dwordx4 v[60:63], v2, s[8:11], s42 offen offset:1024 sc1
  v_max3_u32 v0, v56, v57, v58
  v_max_u32 v0, v0, v59
  v_cmp_eq_u32 vcc, -1, v0
  v_mov_b32 v13, v13
  v_mov_b32 v13, v13
  v_mov_b32 v13, v13
  v_mov_b32 v13, v13
  v_mov_b32 v13, v13
  s_cbranch_vccz rb_137
  v_max3_u32 v0, v56, v57, v58
  v_max_u32 v0, v0, v59
  v_cmp_eq_u32 vcc, -1, v0
  v_mov_b32 v13, v13
  v_mov_b32 v13, v13
  v_mov_b32 v13, v13
  v_mov_b32 v13, v13
  v_mov_b32 v13, v13
  s_cbranch_vccz rb_137
  s_sub_u32 s48, s48, 1
  s_cbranch_scc1 L_fail
  s_waitcnt vmcnt(8)
  s_branch rr_136
rr_138:
  buffer_load_dwordx4 v[60:63], v2, s[8:11], s42 offen offset:1024 sc1
  v_max3_u32 v0, v60, v61, v62
  v_max_u32 v0, v0, v63
  v_cmp_eq_u32 vcc, -1, v0
  v_mov_b32 v13, v13
  v_mov_b32 v13, v13
  v_mov_b32 v13, v13
  v_mov_b32 v13, v13
  v_mov_b32 v13, v13
  s_cbranch_vccz rb_139
  s_sub_u32 s48, s48, 1
  s_cbranch_scc1 L_fail
  s_waitcnt vmcnt(8)
  s_branch rr_138
ox_145:
  s_lshl_b32 s38, s32, 18
  s_add_u32 s38, s38, s91
  s_cmp_ge_u32 s32, 64
  s_cselect_b32 s38, 0x7f000000, s38
  buffer_store_dwordx4 v[240:243], v1, s[8:11], s38 offen sc1
  buffer_store_dwordx4 v[244:247], v1, s[8:11], s38 offen offset:1024 sc1
  s_branch ox_146
S_exit:
  s_waitcnt vmcnt(0)
  s_barrier
  s_cmp_lg_u32 s28, 0
  s_cbranch_scc1 L_done
  s_mov_b32 s36, 63
  s_lshr_b32 s37, s36, 2
  s_add_u32 s37, s37, 156
  s_add_u32 s38, s36, 128
  s_cmp_lt_u32 s36, 40
  s_cselect_b32 s37, s37, s38
  s_lshl_b32 s37, s37, 7
  s_add_u32 s37, s37, 0x4c00000
  v_mov_b32 v60, 2
  v_mov_b32 v61, 0
  s_mov_b64 exec, 1
  buffer_atomic_add v60, v61, s[8:11], s37 offen sc1
  s_mov_b64 exec, -1
  s_endpgm
L_fail:
  v_mov_b32 v1, 0xdead
  v_mov_b32 v2, 0
  s_mov_b64 exec, 1
  buffer_store_dword v1, v2, s[12:15], 0 offen offset:8
  s_endpgm
L_W:
  v_and_b32 v0, 63, v0
  v_lshlrev_b32 v4, 4, v0
  s_load_dwordx2 s[60:61], s[0:1], 0
  s_load_dwordx2 s[62:63], s[0:1], 16
  s_load_dwordx4 s[64:67], s[0:1], 24
  s_load_dwordx2 s[68:69], s[0:1], 40
  s_load_dwordx2 s[70:71], s[0:1], 56
  s_load_dwordx4 s[72:75], s[0:1], 64
  s_getpc_b64 s[90:91]
W_pc:
  s_add_u32 s90, s90, W_table-W_pc
  s_addc_u32 s91, s91, 0
  s_waitcnt lgkmcnt(0)
  s_and_b32 s61, s61, 0xffff
  s_and_b32 s63, s63, 0xffff
  s_and_b32 s65, s65, 0xffff
  s_and_b32 s67, s67, 0xffff
  s_and_b32 s69, s69, 0xffff
  s_and_b32 s71, s71, 0xffff
  s_and_b32 s73, s73, 0xffff
  s_and_b32 s75, s75, 0xffff
  s_load_dwordx2 s[4:5], s[0:1], 80
  s_waitcnt lgkmcnt(0)
  s_mov_b32 s24, s4
  s_and_b32 s25, s5, 0xffff
  s_mov_b32 s26, 0x800000
  s_mov_b32 s27, 0x20000
  v_and_b32 v1, 15, v0
  v_lshlrev_b32 v37, 12, v1
  v_bfe_u32 v1, v0, 4, 1
  v_lshl_add_u32 v37, v1, 5, v37
  v_lshrrev_b32 v1, 5, v0
  v_lshl_add_u32 v37, v1, 4, v37
  s_mov_b32 s19, 0x20000
  s_mov_b32 s23, 0x20000
  s_mov_b32 s56, 0x7f000000
  s_mov_b32 s57, 0x7f000000
  v_mov_b32 v5, 0x27f00
  v_mov_b32 v6, 0
  s_mov_b32 s47, 0
  s_mov_b32 s32, 0
  s_mov_b32 s49, 255
  s_mov_b32 s29, 0
  s_sub_u32 s37, s30, 24
  s_cmp_lt_u32 s58, 4
  s_cselect_b32 s36, s37, s30
  s_cselect_b32 s30, 8, 32
  s_branch W_have
W_next:
  s_lshr_b32 s49, s85, 20
  s_mov_b32 s29, 0
  s_cmp_eq_u32 s87, 0
  s_cbranch_scc1 W_nu
  s_waitcnt vmcnt(0)
W_nu:
  s_cmp_lg_u32 s28, 0
  s_cbranch_scc1 W_tk
  s_mov_b64 exec, 1
  ds_write_b32 v5, v7
  s_mov_b64 exec, -1
W_tk:
  s_waitcnt lgkmcnt(0)
  s_barrier
  s_cmp_eq_u32 s87, 0
  s_cbranch_scc1 W_nu2
  s_cmp_lg_u32 s49, 255
  s_cbranch_scc1 sg_147
sb_148:
W_nu2:
  ds_read_b32 v1, v5
  s_waitcnt lgkmcnt(0)
  v_readfirstlane_b32 s36, v1
  s_nop 3
  s_add_u32 s36, s36, s30
W_have:
  s_min_u32 s36, s36, 258
  s_mul_i32 s37, s58, 259
  s_add_u32 s36, s36, s37
  s_lshl_b32 s36, s36, 4
  s_load_dwordx4 s[84:87], s[90:91], s36
  s_waitcnt lgkmcnt(0)
  s_and_b32 s89, s84, 15
  s_bfe_u32 s59, s84, 0x80004
  s_bfe_u32 s88, s84, 0x8000c
  s_cmp_lt_u32 s89, 3
  s_cbranch_scc1 W_go
  s_cmp_ge_u32 s89, 7
  s_cbranch_scc1 W_slow
  s_cmp_lg_u32 s28, 0
  s_cbranch_scc1 W_q2
  s_cmp_eq_u32 s47, 1
  s_cbranch_scc1 ic_149
  v_mov_b32 v44, 0
sb_150:
  s_sub_u32 s48, s48, 1
  s_cbranch_scc1 L_fail
  buffer_load_dwordx4 v[40:43], v44, s[12:15], 0 offen sc1
  s_waitcnt vmcnt(0)
  v_readfirstlane_b32 s37, v40
  s_nop 3
  s_cmp_ge_u32 s37, 96
  s_cbranch_scc1 sb_151
  s_sleep 8
  s_branch sb_150
sb_151:
  s_mov_b32 s47, 1
ic_149:
  s_and_b32 s39, s85, 0xff
  s_lshl_b32 s39, s39, 7
  s_add_u32 s39, s39, 0x4c00000
  buffer_load_dword v1, v6, s[8:11], s39 offen sc1
  s_waitcnt vmcnt(0)
  s_mov_b64 exec, 1
  ds_write_b32 v5, v1 offset:4
  s_mov_b64 exec, -1
  s_waitcnt lgkmcnt(0)
W_q2:
  s_barrier
  ds_read_b32 v1, v5 offset:4
  s_bfe_u32 s38, s85, 0xc0008
  s_waitcnt lgkmcnt(0)
  v_readfirstlane_b32 s36, v1
  s_nop 3
  s_cmp_ge_u32 s36, s38
  s_cbranch_scc1 W_go
W_slow:
  s_mov_b32 s3, 1
  s_cmp_lg_u32 s32, 0
  s_cbranch_scc1 W_epi
W_ret1:
  s_waitcnt vmcnt(0)
  s_barrier
  s_cmp_lg_u32 s49, 255
  s_cbranch_scc1 sg_152
sb_153:
  s_cmp_eq_u32 s89, 15
  s_cbranch_scc1 L_done
  s_cmp_eq_u32 s89, 7
  s_cbranch_scc1 W_pf
  s_cmp_eq_u32 s89, 8
  s_cbranch_scc1 W_tail
  s_cmp_lg_u32 s28, 0
  s_cbranch_scc1 W_go2
  s_cmp_eq_u32 s47, 1
  s_cbranch_scc1 ic_154
  v_mov_b32 v204, 0
sb_155:
  s_sub_u32 s48, s48, 1
  s_cbranch_scc1 L_fail
  buffer_load_dwordx4 v[200:203], v204, s[12:15], 0 offen sc1
  s_waitcnt vmcnt(0)
  v_readfirstlane_b32 s37, v200
  s_nop 3
  s_cmp_ge_u32 s37, 96
  s_cbranch_scc1 sb_156
  s_sleep 8
  s_branch sb_155
sb_156:
  s_mov_b32 s47, 1
ic_154:
  s_bfe_u32 s38, s85, 0xc0008
  s_and_b32 s39, s85, 0xff
  s_lshl_b32 s39, s39, 7
  s_add_u32 s39, s39, 0x4c00000
W_dep:
  s_sub_u32 s48, s48, 1
  s_cbranch_scc1 L_fail
  buffer_load_dword v1, v6, s[8:11], s39 offen sc1
  s_waitcnt vmcnt(0)
  v_readfirstlane_b32 s36, v1
  s_nop 3
  s_cmp_ge_u32 s36, s38
  s_cbranch_scc1 W_go2
  s_sleep 16
  s_branch W_dep
W_go2:
  s_barrier
W_go:
  s_cmp_eq_u32 s89, 3
  s_cbranch_scc1 W_att
  s_cmp_ge_u32 s89, 4
  s_cbranch_scc1 W_out
  s_mov_b32 s83, 16
  s_mov_b32 s78, 2048
  s_mov_b32 s33, 128
  s_mov_b32 s18, 0x400000
  s_cmp_eq_u32 s89, 2
  s_cbranch_scc1 W_bb
  s_cmp_eq_u32 s89, 1
  s_cbranch_scc1 W_abig
  s_lshr_b32 s93, s88, 5
  s_and_b32 s38, s88, 31
  s_lshl_b32 s52, s59, 18
  s_lshl_b32 s53, s38, 8
  s_lshl_b32 s36, s59, 1
  s_lshr_b32 s37, s28, 1
  s_add_u32 s36, s36, s37
  s_lshl_b32 s92, s36, 19
  s_lshl_b32 s36, s38, 13
  s_add_u32 s92, s92, s36
  s_and_b32 s37, s28, 1
  s_cmp_eq_u32 s93, 2
  s_cselect_b32 s36, 12, 11
  s_lshl_b32 s37, s37, s36
  s_add_u32 s92, s92, s37
  s_mov_b32 s16, s60
  s_mov_b32 s17, s61
  s_cmp_eq_u32 s93, 1
  s_cselect_b32 s20, s64, s62
  s_cselect_b32 s21, s65, s63
  s_cselect_b32 s36, 0x0, 0x1000000
  s_cmp_eq_u32 s93, 2
  s_cselect_b32 s20, s66, s20
  s_cselect_b32 s21, s67, s21
  s_cselect_b32 s36, 0x2000000, s36
  s_add_u32 s92, s92, s36
  s_mov_b32 s22, 0x800000
  s_mov_b32 s79, 8192
  v_lshrrev_b32 v1, 3, v0
  v_and_b32 v2, 7, v0
  v_xor_b32 v2, v2, v1
  v_lshlrev_b32 v2, 4, v2
  s_lshl_b32 s36, s28, 5
  v_add_u32 v1, s36, v1
  v_mul_lo_u32 v1, v1, s78
  v_add_u32 v8, v1, v2
  s_mul_i32 s36, s78, 8
  s_sub_u32 s36, s36, 1024
  v_add_u32 v9, s36, v8
  s_mul_i32 s36, s78, 16
  s_sub_u32 s36, s36, 2048
  v_add_u32 v10, s36, v8
  s_mul_i32 s36, s78, 24
  s_sub_u32 s36, s36, 3072
  v_add_u32 v11, s36, v8
  v_lshrrev_b32 v1, 4, v0
  s_lshl_b32 s36, s28, 4
  v_add_u32 v2, s36, v1
  v_mul_lo_u32 v2, v2, s79
  v_and_b32 v3, 15, v0
  v_lshlrev_b32 v3, 4, v3
  v_lshlrev_b32 v1, 5, v1
  v_xor_b32 v3, v3, v1
  v_xor_b32 v1, 0, v3
  s_mul_i32 s36, s79, 0
  s_sub_u32 s36, s36, 0
  v_add3_u32 v16, v2, v1, s36
  v_xor_b32 v1, 0, v3
  s_mul_i32 s36, s79, 4
  s_sub_u32 s36, s36, 1024
  v_add3_u32 v17, v2, v1, s36
  v_xor_b32 v1, 128, v3
  s_mul_i32 s36, s79, 8
  s_sub_u32 s36, s36, 2048
  v_add3_u32 v18, v2, v1, s36
  v_xor_b32 v1, 128, v3
  s_mul_i32 s36, s79, 12
  s_sub_u32 s36, s36, 3072
  v_add3_u32 v19, v2, v1, s36
  v_and_b32 v1, 15, v0
  v_lshlrev_b32 v2, 7, v1
  v_and_b32 v1, 7, v0
  v_lshrrev_b32 v3, 4, v0
  v_xor_b32 v1, v1, v3
  v_lshl_add_u32 v2, v1, 4, v2
  s_lshr_b32 s36, s28, 1
  s_lshl_b32 s36, s36, 13
  v_add_u32 v24, s36, v2
  v_xor_b32 v25, 64, v24
  v_lshrrev_b32 v1, 4, v0
  v_lshlrev_b32 v2, 11, v1
  v_bfe_u32 v3, v0, 2, 2
  v_lshl_add_u32 v2, v3, 8, v2
  v_bfe_u32 v3, v0, 2, 3
  v_lshl_add_u32 v2, v3, 5, v2
  v_and_b32 v3, 3, v0
  v_lshl_add_u32 v2, v3, 3, v2
  s_and_b32 s36, s28, 1
  s_lshl_b32 s36, s36, 7
  v_xor_b32 v2, s36, v2
  v_add_u32 v26, 0x4000, v2
  v_xor_b32 v27, 32, v26
  v_xor_b32 v28, 64, v26
  v_xor_b32 v29, 96, v26
  s_lshl_b32 s54, s79, 6
  s_mov_b32 s82, 0
  s_lshl_b32 s100, s28, 12
  s_lshl_b32 s101, s28, 12
  s_add_u32 s101, s101, 0x4000
  s_add_u32 m0, s82, s100
  s_nop 0
  buffer_load_dwordx4 v8, s[16:19], s52 offen offset:0  lds
  buffer_load_dwordx4 v9, s[16:19], s52 offen offset:1024  lds
  buffer_load_dwordx4 v10, s[16:19], s52 offen offset:2048  lds
  buffer_load_dwordx4 v11, s[16:19], s52 offen offset:3072  lds
  s_add_u32 m0, s82, s101
  s_nop 0
  buffer_load_dwordx4 v16, s[20:23], s53 offen offset:0  lds
  buffer_load_dwordx4 v17, s[20:23], s53 offen offset:1024  lds
  buffer_load_dwordx4 v18, s[20:23], s53 offen offset:2048  lds
  buffer_load_dwordx4 v19, s[20:23], s53 offen offset:3072  lds
  s_add_u32 s52, s52, s33
  s_add_u32 s53, s53, s54
  s_add_u32 s82, s82, 0x8000
  s_and_b32 s82, s82, 0x1ffff
  s_add_u32 m0, s82, s100
  s_nop 0
  buffer_load_dwordx4 v8, s[16:19], s52 offen offset:0  lds
  buffer_load_dwordx4 v9, s[16:19], s52 offen offset:1024  lds
  buffer_load_dwordx4 v10, s[16:19], s52 offen offset:2048  lds
  buffer_load_dwordx4 v11, s[16:19], s52 offen offset:3072  lds
  s_add_u32 m0, s82, s101
  s_nop 0
  buffer_load_dwordx4 v16, s[20:23], s53 offen offset:0  lds
  buffer_load_dwordx4 v17, s[20:23], s53 offen offset:1024  lds
  buffer_load_dwordx4 v18, s[20:23], s53 offen offset:2048  lds
  buffer_load_dwordx4 v19, s[20:23], s53 offen offset:3072  lds
  s_add_u32 s52, s52, s33
  s_add_u32 s53, s53, s54
  s_add_u32 s82, s82, 0x8000
  s_and_b32 s82, s82, 0x1ffff
  s_add_u32 m0, s82, s100
  s_nop 0
  buffer_load_dwordx4 v8, s[16:19], s52 offen offset:0  lds
  buffer_load_dwordx4 v9, s[16:19], s52 offen offset:1024  lds
  buffer_load_dwordx4 v10, s[16:19], s52 offen offset:2048  lds
  buffer_load_dwordx4 v11, s[16:19], s52 offen offset:3072  lds
  s_add_u32 m0, s82, s101
  s_nop 0
  buffer_load_dwordx4 v16, s[20:23], s53 offen offset:0  lds
  buffer_load_dwordx4 v17, s[20:23], s53 offen offset:1024  lds
  buffer_load_dwordx4 v18, s[20:23], s53 offen offset:2048  lds
  buffer_load_dwordx4 v19, s[20:23], s53 offen offset:3072  lds
  s_add_u32 s52, s52, s33
  s_add_u32 s53, s53, s54
  s_add_u32 s82, s82, 0x8000
  s_and_b32 s82, s82, 0x1ffff
  s_add_u32 m0, s82, s100
  s_nop 0
  buffer_load_dwordx4 v8, s[16:19], s52 offen offset:0  lds
  buffer_load_dwordx4 v9, s[16:19], s52 offen offset:1024  lds
  buffer_load_dwordx4 v10, s[16:19], s52 offen offset:2048  lds
  buffer_load_dwordx4 v11, s[16:19], s52 offen offset:3072  lds
  s_add_u32 m0, s82, s101
  s_nop 0
  buffer_load_dwordx4 v16, s[20:23], s53 offen offset:0  lds
  buffer_load_dwordx4 v17, s[20:23], s53 offen offset:1024  lds
  buffer_load_dwordx4 v18, s[20:23], s53 offen offset:2048  lds
  buffer_load_dwordx4 v19, s[20:23], s53 offen offset:3072  lds
  s_add_u32 s52, s52, s33
  s_add_u32 s53, s53, s54
  s_add_u32 s82, s82, 0x8000
  s_and_b32 s82, s82, 0x1ffff
  s_mov_b32 s3, 2
  s_cmp_lg_u32 s32, 0
  s_cbranch_scc1 W_epi
W_ret2:
  s_waitcnt vmcnt(24)
  s_barrier
  s_cmp_lg_u32 s49, 255
  s_cbranch_scc1 sg_157
sb_158:
  ds_read_b128 v[64:67], v24 offset:0
  ds_read_b64_tr_b16 v[128:129], v26 offset:0
  ds_read_b64_tr_b16 v[130:131], v26 offset:1024
  ds_read_b64_tr_b16 v[132:133], v27 offset:0
  ds_read_b64_tr_b16 v[134:135], v27 offset:1024
  ds_read_b64_tr_b16 v[136:137], v28 offset:0
  ds_read_b64_tr_b16 v[138:139], v28 offset:1024
  ds_read_b64_tr_b16 v[140:141], v29 offset:0
  ds_read_b64_tr_b16 v[142:143], v29 offset:1024
  ds_read_b128 v[68:71], v24 offset:2048
  ds_read_b128 v[72:75], v24 offset:4096
  ds_read_b128 v[76:79], v24 offset:6144
  s_cmp_eq_u32 s93, 2
  s_cbranch_scc1 W_mv
  s_mov_b32 s55, s83
  s_waitcnt lgkmcnt(0)
  v_mfma_f32_16x16x32_bf16 a[0:3], v[128:131], v[64:67], 0
  ds_read_b128 v[96:99], v25 offset:0
  v_mfma_f32_16x16x32_bf16 a[4:7], v[132:135], v[64:67], 0
  ds_read_b64_tr_b16 v[160:161], v26 offset:8192
  v_add_u32 v24, 0x8000, v24
  v_and_b32 v24, 0x1ffff, v24
  v_mfma_f32_16x16x32_bf16 a[8:11], v[136:139], v[64:67], 0
  ds_read_b64_tr_b16 v[162:163], v26 offset:9216
  v_mfma_f32_16x16x32_bf16 a[12:15], v[140:143], v[64:67], 0
  ds_read_b64_tr_b16 v[164:165], v27 offset:8192
  v_add_u32 v26, 0x8000, v26
  v_and_b32 v26, 0x1ffff, v26
  v_mfma_f32_16x16x32_bf16 a[16:19], v[128:131], v[68:71], 0
  ds_read_b64_tr_b16 v[166:167], v27 offset:9216
  v_mfma_f32_16x16x32_bf16 a[20:23], v[132:135], v[68:71], 0
  ds_read_b64_tr_b16 v[168:169], v28 offset:8192
  v_add_u32 v27, 0x8000, v27
  v_and_b32 v27, 0x1ffff, v27
  v_mfma_f32_16x16x32_bf16 a[24:27], v[136:139], v[68:71], 0
  ds_read_b64_tr_b16 v[170:171], v28 offset:9216
  v_mfma_f32_16x16x32_bf16 a[28:31], v[140:143], v[68:71], 0
  ds_read_b64_tr_b16 v[172:173], v29 offset:8192
  v_add_u32 v28, 0x8000, v28
  v_and_b32 v28, 0x1ffff, v28
  v_mfma_f32_16x16x32_bf16 a[32:35], v[128:131], v[72:75], 0
  ds_read_b64_tr_b16 v[174:175], v29 offset:9216
  v_mfma_f32_16x16x32_bf16 a[36:39], v[132:135], v[72:75], 0
  ds_read_b128 v[100:103], v25 offset:2048
  v_add_u32 v29, 0x8000, v29
  v_and_b32 v29, 0x1ffff, v29
  v_mfma_f32_16x16x32_bf16 a[40:43], v[136:139], v[72:75], 0
  ds_read_b128 v[104:107], v25 offset:4096
  v_mfma_f32_16x16x32_bf16 a[44:47], v[140:143], v[72:75], 0
  ds_read_b128 v[108:111], v25 offset:6144
  v_mfma_f32_16x16x32_bf16 a[48:51], v[128:131], v[76:79], 0
  v_add_u32 v25, 0x8000, v25
  v_and_b32 v25, 0x1ffff, v25
  s_cmp_eq_u32 s55, 4
  s_cselect_b32 s52, s56, s52
  s_cselect_b32 s53, s57, s53
  v_mfma_f32_16x16x32_bf16 a[52:55], v[132:135], v[76:79], 0
  s_cmp_eq_u32 s49, 255
  s_cbranch_scc1 pb_160
  s_waitcnt vmcnt(0)
pb_160:
  s_waitcnt vmcnt(16) lgkmcnt(0)
  s_barrier
  s_cmp_lg_u32 s49, 255
  s_cbranch_scc1 sg_161
sb_162:
  v_mfma_f32_16x16x32_bf16 a[56:59], v[136:139], v[76:79], 0
  s_add_u32 m0, s82, s100
  s_nop 0
  buffer_load_dwordx4 v8, s[16:19], s52 offen offset:0  lds
  v_mfma_f32_16x16x32_bf16 a[60:63], v[140:143], v[76:79], 0
  s_waitcnt lgkmcnt(0)
  v_mfma_f32_16x16x32_bf16 a[0:3], v[160:163], v[96:99], a[0:3]
  ds_read_b128 v[64:67], v24 offset:0
  buffer_load_dwordx4 v9, s[16:19], s52 offen offset:1024  lds
  v_mfma_f32_16x16x32_bf16 a[4:7], v[164:167], v[96:99], a[4:7]
  ds_read_b64_tr_b16 v[128:129], v26 offset:0
  v_mfma_f32_16x16x32_bf16 a[8:11], v[168:171], v[96:99], a[8:11]
  ds_read_b64_tr_b16 v[130:131], v26 offset:1024
  buffer_load_dwordx4 v10, s[16:19], s52 offen offset:2048  lds
  v_mfma_f32_16x16x32_bf16 a[12:15], v[172:175], v[96:99], a[12:15]
  ds_read_b64_tr_b16 v[132:133], v27 offset:0
  v_mfma_f32_16x16x32_bf16 a[16:19], v[160:163], v[100:103], a[16:19]
  ds_read_b64_tr_b16 v[134:135], v27 offset:1024
  buffer_load_dwordx4 v11, s[16:19], s52 offen offset:3072  lds
  v_mfma_f32_16x16x32_bf16 a[20:23], v[164:167], v[100:103], a[20:23]
  ds_read_b64_tr_b16 v[136:137], v28 offset:0
  v_mfma_f32_16x16x32_bf16 a[24:27], v[168:171], v[100:103], a[24:27]
  ds_read_b64_tr_b16 v[138:139], v28 offset:1024
  s_add_u32 m0, s82, s101
  s_nop 0
  buffer_load_dwordx4 v16, s[20:23], s53 offen offset:0  lds
  v_mfma_f32_16x16x32_bf16 a[28:31], v[172:175], v[100:103], a[28:31]
  ds_read_b64_tr_b16 v[140:141], v29 offset:0
  v_mfma_f32_16x16x32_bf16 a[32:35], v[160:163], v[104:107], a[32:35]
  ds_read_b64_tr_b16 v[142:143], v29 offset:1024
  buffer_load_dwordx4 v17, s[20:23], s53 offen offset:1024  lds
  v_mfma_f32_16x16x32_bf16 a[36:39], v[164:167], v[104:107], a[36:39]
  ds_read_b128 v[68:71], v24 offset:2048
  v_mfma_f32_16x16x32_bf16 a[40:43], v[168:171], v[104:107], a[40:43]
  ds_read_b128 v[72:75], v24 offset:4096
  buffer_load_dwordx4 v18, s[20:23], s53 offen offset:2048  lds
  v_mfma_f32_16x16x32_bf16 a[44:47], v[172:175], v[104:107], a[44:47]
  ds_read_b128 v[76:79], v24 offset:6144
  v_mfma_f32_16x16x32_bf16 a[48:51], v[160:163], v[108:111], a[48:51]
  buffer_load_dwordx4 v19, s[20:23], s53 offen offset:3072  lds
  v_mfma_f32_16x16x32_bf16 a[52:55], v[164:167], v[108:111], a[52:55]
  s_add_u32 s52, s52, s33
  s_add_u32 s53, s53, s54
  v_mfma_f32_16x16x32_bf16 a[56:59], v[168:171], v[108:111], a[56:59]
  s_add_u32 s82, s82, 0x8000
  s_and_b32 s82, s82, 0x1ffff
  v_mfma_f32_16x16x32_bf16 a[60:63], v[172:175], v[108:111], a[60:63]
  s_sub_u32 s55, s55, 1
gl_159:
  s_waitcnt lgkmcnt(0)
  v_mfma_f32_16x16x32_bf16 a[0:3], v[128:131], v[64:67], a[0:3]
  ds_read_b128 v[96:99], v25 offset:0
  v_mfma_f32_16x16x32_bf16 a[4:7], v[132:135], v[64:67], a[4:7]
  ds_read_b64_tr_b16 v[160:161], v26 offset:8192
  v_add_u32 v24, 0x8000, v24
  v_and_b32 v24, 0x1ffff, v24
  v_mfma_f32_16x16x32_bf16 a[8:11], v[136:139], v[64:67], a[8:11]
  ds_read_b64_tr_b16 v[162:163], v26 offset:9216
  v_mfma_f32_16x16x32_bf16 a[12:15], v[140:143], v[64:67], a[12:15]
  ds_read_b64_tr_b16 v[164:165], v27 offset:8192
  v_add_u32 v26, 0x8000, v26
  v_and_b32 v26, 0x1ffff, v26
  v_mfma_f32_16x16x32_bf16 a[16:19], v[128:131], v[68:71], a[16:19]
  ds_read_b64_tr_b16 v[166:167], v27 offset:9216
  v_mfma_f32_16x16x32_bf16 a[20:23], v[132:135], v[68:71], a[20:23]
  ds_read_b64_tr_b16 v[168:169], v28 offset:8192
  v_add_u32 v27, 0x8000, v27
  v_and_b32 v27, 0x1ffff, v27
  v_mfma_f32_16x16x32_bf16 a[24:27], v[136:139], v[68:71], a[24:27]
  ds_read_b64_tr_b16 v[170:171], v28 offset:9216
  v_mfma_f32_16x16x32_bf16 a[28:31], v[140:143], v[68:71], a[28:31]
  ds_read_b64_tr_b16 v[172:173], v29 offset:8192
  v_add_u32 v28, 0x8000, v28
  v_and_b32 v28, 0x1ffff, v28
  v_mfma_f32_16x16x32_bf16 a[32:35], v[128:131], v[72:75], a[32:35]
  ds_read_b64_tr_b16 v[174:175], v29 offset:9216
  v_mfma_f32_16x16x32_bf16 a[36:39], v[132:135], v[72:75], a[36:39]
  ds_read_b128 v[100:103], v25 offset:2048
  v_add_u32 v29, 0x8000, v29
  v_and_b32 v29, 0x1ffff, v29
  v_mfma_f32_16x16x32_bf16 a[40:43], v[136:139], v[72:75], a[40:43]
  ds_read_b128 v[104:107], v25 offset:4096
  s_cmp_eq_u32 s55, 5
  s_cbranch_scc1 tk_164
tb_163:
  v_mfma_f32_16x16x32_bf16 a[44:47], v[140:143], v[72:75], a[44:47]
  ds_read_b128 v[108:111], v25 offset:6144
  v_mfma_f32_16x16x32_bf16 a[48:51], v[128:131], v[76:79], a[48:51]
  v_add_u32 v25, 0x8000, v25
  v_and_b32 v25, 0x1ffff, v25
  s_cmp_eq_u32 s55, 4
  s_cselect_b32 s52, s56, s52
  s_cselect_b32 s53, s57, s53
  v_mfma_f32_16x16x32_bf16 a[52:55], v[132:135], v[76:79], a[52:55]
  s_waitcnt vmcnt(16) lgkmcnt(0)
  s_barrier
  v_mfma_f32_16x16x32_bf16 a[56:59], v[136:139], v[76:79], a[56:59]
  s_add_u32 m0, s82, s100
  s_nop 0
  buffer_load_dwordx4 v8, s[16:19], s52 offen offset:0  lds
  v_mfma_f32_16x16x32_bf16 a[60:63], v[140:143], v[76:79], a[60:63]
  s_waitcnt lgkmcnt(0)
  v_mfma_f32_16x16x32_bf16 a[0:3], v[160:163], v[96:99], a[0:3]
  ds_read_b128 v[64:67], v24 offset:0
  buffer_load_dwordx4 v9, s[16:19], s52 offen offset:1024  lds
  v_mfma_f32_16x16x32_bf16 a[4:7], v[164:167], v[96:99], a[4:7]
  ds_read_b64_tr_b16 v[128:129], v26 offset:0
  v_mfma_f32_16x16x32_bf16 a[8:11], v[168:171], v[96:99], a[8:11]
  ds_read_b64_tr_b16 v[130:131], v26 offset:1024
  buffer_load_dwordx4 v10, s[16:19], s52 offen offset:2048  lds
  v_mfma_f32_16x16x32_bf16 a[12:15], v[172:175], v[96:99], a[12:15]
  ds_read_b64_tr_b16 v[132:133], v27 offset:0
  v_mfma_f32_16x16x32_bf16 a[16:19], v[160:163], v[100:103], a[16:19]
  ds_read_b64_tr_b16 v[134:135], v27 offset:1024
  buffer_load_dwordx4 v11, s[16:19], s52 offen offset:3072  lds
  v_mfma_f32_16x16x32_bf16 a[20:23], v[164:167], v[100:103], a[20:23]
  ds_read_b64_tr_b16 v[136:137], v28 offset:0
  v_mfma_f32_16x16x32_bf16 a[24:27], v[168:171], v[100:103], a[24:27]
  ds_read_b64_tr_b16 v[138:139], v28 offset:1024
  s_add_u32 m0, s82, s101
  s_nop 0
  buffer_load_dwordx4 v16, s[20:23], s53 offen offset:0  lds
  v_mfma_f32_16x16x32_bf16 a[28:31], v[172:175], v[100:103], a[28:31]
  ds_read_b64_tr_b16 v[140:141], v29 offset:0
  v_mfma_f32_16x16x32_bf16 a[32:35], v[160:163], v[104:107], a[32:35]
  ds_read_b64_tr_b16 v[142:143], v29 offset:1024
  buffer_load_dwordx4 v17, s[20:23], s53 offen offset:1024  lds
  v_mfma_f32_16x16x32_bf16 a[36:39], v[164:167], v[104:107], a[36:39]
  ds_read_b128 v[68:71], v24 offset:2048
  v_mfma_f32_16x16x32_bf16 a[40:43], v[168:171], v[104:107], a[40:43]
  ds_read_b128 v[72:75], v24 offset:4096
  buffer_load_dwordx4 v18, s[20:23], s53 offen offset:2048  lds
  v_mfma_f32_16x16x32_bf16 a[44:47], v[172:175], v[104:107], a[44:47]
  ds_read_b128 v[76:79], v24 offset:6144
  v_mfma_f32_16x16x32_bf16 a[48:51], v[160:163], v[108:111], a[48:51]
  buffer_load_dwordx4 v19, s[20:23], s53 offen offset:3072  lds
  v_mfma_f32_16x16x32_bf16 a[52:55], v[164:167], v[108:111], a[52:55]
  s_add_u32 s52, s52, s33
  s_add_u32 s53, s53, s54
  v_mfma_f32_16x16x32_bf16 a[56:59], v[168:171], v[108:111], a[56:59]
  s_add_u32 s82, s82, 0x8000
  s_and_b32 s82, s82, 0x1ffff
  v_mfma_f32_16x16x32_bf16 a[60:63], v[172:175], v[108:111], a[60:63]
  s_sub_u32 s55, s55, 1
  s_cmp_lg_u32 s55, 0
  s_cbranch_scc1 gl_159
  s_mov_b32 s32, 1
  s_mov_b32 s31, s92
  s_mov_b32 s50, s34
  s_mov_b32 s51, s34
  s_waitcnt vmcnt(0)
  s_mov_b32 s3, 6
  s_branch W_epi
W_mv:
  s_mov_b32 s55, s83
  s_waitcnt lgkmcnt(0)
  v_mfma_f32_16x16x32_bf16 a[0:3], v[64:67], v[128:131], 0
  ds_read_b128 v[96:99], v25 offset:0
  v_mfma_f32_16x16x32_bf16 a[4:7], v[64:67], v[132:135], 0
  ds_read_b64_tr_b16 v[160:161], v26 offset:8192
  v_add_u32 v24, 0x8000, v24
  v_and_b32 v24, 0x1ffff, v24
  v_mfma_f32_16x16x32_bf16 a[8:11], v[64:67], v[136:139], 0
  ds_read_b64_tr_b16 v[162:163], v26 offset:9216
  v_mfma_f32_16x16x32_bf16 a[12:15], v[64:67], v[140:143], 0
  ds_read_b64_tr_b16 v[164:165], v27 offset:8192
  v_add_u32 v26, 0x8000, v26
  v_and_b32 v26, 0x1ffff, v26
  v_mfma_f32_16x16x32_bf16 a[16:19], v[68:71], v[128:131], 0
  ds_read_b64_tr_b16 v[166:167], v27 offset:9216
  v_mfma_f32_16x16x32_bf16 a[20:23], v[68:71], v[132:135], 0
  ds_read_b64_tr_b16 v[168:169], v28 offset:8192
  v_add_u32 v27, 0x8000, v27
  v_and_b32 v27, 0x1ffff, v27
  v_mfma_f32_16x16x32_bf16 a[24:27], v[68:71], v[136:139], 0
  ds_read_b64_tr_b16 v[170:171], v28 offset:9216
  v_mfma_f32_16x16x32_bf16 a[28:31], v[68:71], v[140:143], 0
  ds_read_b64_tr_b16 v[172:173], v29 offset:8192
  v_add_u32 v28, 0x8000, v28
  v_and_b32 v28, 0x1ffff, v28
  v_mfma_f32_16x16x32_bf16 a[32:35], v[72:75], v[128:131], 0
  ds_read_b64_tr_b16 v[174:175], v29 offset:9216
  v_mfma_f32_16x16x32_bf16 a[36:39], v[72:75], v[132:135], 0
  ds_read_b128 v[100:103], v25 offset:2048
  v_add_u32 v29, 0x8000, v29
  v_and_b32 v29, 0x1ffff, v29
  v_mfma_f32_16x16x32_bf16 a[40:43], v[72:75], v[136:139], 0
  ds_read_b128 v[104:107], v25 offset:4096
  v_mfma_f32_16x16x32_bf16 a[44:47], v[72:75], v[140:143], 0
  ds_read_b128 v[108:111], v25 offset:6144
  v_mfma_f32_16x16x32_bf16 a[48:51], v[76:79], v[128:131], 0
  v_add_u32 v25, 0x8000, v25
  v_and_b32 v25, 0x1ffff, v25
  s_cmp_eq_u32 s55, 4
  s_cselect_b32 s52, s56, s52
  s_cselect_b32 s53, s57, s53
  v_mfma_f32_16x16x32_bf16 a[52:55], v[76:79], v[132:135], 0
  s_cmp_eq_u32 s49, 255
  s_cbranch_scc1 pb_166
  s_waitcnt vmcnt(0)
pb_166:
  s_waitcnt vmcnt(16) lgkmcnt(0)
  s_barrier
  s_cmp_lg_u32 s49, 255
  s_cbranch_scc1 sg_167
sb_168:
  v_mfma_f32_16x16x32_bf16 a[56:59], v[76:79], v[136:139], 0
  s_add_u32 m0, s82, s100
  s_nop 0
  buffer_load_dwordx4 v8, s[16:19], s52 offen offset:0  lds
  v_mfma_f32_16x16x32_bf16 a[60:63], v[76:79], v[140:143], 0
  s_waitcnt lgkmcnt(0)
  v_mfma_f32_16x16x32_bf16 a[0:3], v[96:99], v[160:163], a[0:3]
  ds_read_b128 v[64:67], v24 offset:0
  buffer_load_dwordx4 v9, s[16:19], s52 offen offset:1024  lds
  v_mfma_f32_16x16x32_bf16 a[4:7], v[96:99], v[164:167], a[4:7]
  ds_read_b64_tr_b16 v[128:129], v26 offset:0
  v_mfma_f32_16x16x32_bf16 a[8:11], v[96:99], v[168:171], a[8:11]
  ds_read_b64_tr_b16 v[130:131], v26 offset:1024
  buffer_load_dwordx4 v10, s[16:19], s52 offen offset:2048  lds
  v_mfma_f32_16x16x32_bf16 a[12:15], v[96:99], v[172:175], a[12:15]
  ds_read_b64_tr_b16 v[132:133], v27 offset:0
  v_mfma_f32_16x16x32_bf16 a[16:19], v[100:103], v[160:163], a[16:19]
  ds_read_b64_tr_b16 v[134:135], v27 offset:1024
  buffer_load_dwordx4 v11, s[16:19], s52 offen offset:3072  lds
  v_mfma_f32_16x16x32_bf16 a[20:23], v[100:103], v[164:167], a[20:23]
  ds_read_b64_tr_b16 v[136:137], v28 offset:0
  v_mfma_f32_16x16x32_bf16 a[24:27], v[100:103], v[168:171], a[24:27]
  ds_read_b64_tr_b16 v[138:139], v28 offset:1024
  s_add_u32 m0, s82, s101
  s_nop 0
  buffer_load_dwordx4 v16, s[20:23], s53 offen offset:0  lds
  v_mfma_f32_16x16x32_bf16 a[28:31], v[100:103], v[172:175], a[28:31]
  ds_read_b64_tr_b16 v[140:141], v29 offset:0
  v_mfma_f32_16x16x32_bf16 a[32:35], v[104:107], v[160:163], a[32:35]
  ds_read_b64_tr_b16 v[142:143], v29 offset:1024
  buffer_load_dwordx4 v17, s[20:23], s53 offen offset:1024  lds
  v_mfma_f32_16x16x32_bf16 a[36:39], v[104:107], v[164:167], a[36:39]
  ds_read_b128 v[68:71], v24 offset:2048
  v_mfma_f32_16x16x32_bf16 a[40:43], v[104:107], v[168:171], a[40:43]
  ds_read_b128 v[72:75], v24 offset:4096
  buffer_load_dwordx4 v18, s[20:23], s53 offen offset:2048  lds
  v_mfma_f32_16x16x32_bf16 a[44:47], v[104:107], v[172:175], a[44:47]
  ds_read_b128 v[76:79], v24 offset:6144
  v_mfma_f32_16x16x32_bf16 a[48:51], v[108:111], v[160:163], a[48:51]
  buffer_load_dwordx4 v19, s[20:23], s53 offen offset:3072  lds
  v_mfma_f32_16x16x32_bf16 a[52:55], v[108:111], v[164:167], a[52:55]
  s_add_u32 s52, s52, s33
  s_add_u32 s53, s53, s54
  v_mfma_f32_16x16x32_bf16 a[56:59], v[108:111], v[168:171], a[56:59]
  s_add_u32 s82, s82, 0x8000
  s_and_b32 s82, s82, 0x1ffff
  v_mfma_f32_16x16x32_bf16 a[60:63], v[108:111], v[172:175], a[60:63]
  s_sub_u32 s55, s55, 1
gl_165:
  s_waitcnt lgkmcnt(0)
  v_mfma_f32_16x16x32_bf16 a[0:3], v[64:67], v[128:131], a[0:3]
  ds_read_b128 v[96:99], v25 offset:0
  v_mfma_f32_16x16x32_bf16 a[4:7], v[64:67], v[132:135], a[4:7]
  ds_read_b64_tr_b16 v[160:161], v26 offset:8192
  v_add_u32 v24, 0x8000, v24
  v_and_b32 v24, 0x1ffff, v24
  v_mfma_f32_16x16x32_bf16 a[8:11], v[64:67], v[136:139], a[8:11]
  ds_read_b64_tr_b16 v[162:163], v26 offset:9216
  v_mfma_f32_16x16x32_bf16 a[12:15], v[64:67], v[140:143], a[12:15]
  ds_read_b64_tr_b16 v[164:165], v27 offset:8192
  v_add_u32 v26, 0x8000, v26
  v_and_b32 v26, 0x1ffff, v26
  v_mfma_f32_16x16x32_bf16 a[16:19], v[68:71], v[128:131], a[16:19]
  ds_read_b64_tr_b16 v[166:167], v27 offset:9216
  v_mfma_f32_16x16x32_bf16 a[20:23], v[68:71], v[132:135], a[20:23]
  ds_read_b64_tr_b16 v[168:169], v28 offset:8192
  v_add_u32 v27, 0x8000, v27
  v_and_b32 v27, 0x1ffff, v27
  v_mfma_f32_16x16x32_bf16 a[24:27], v[68:71], v[136:139], a[24:27]
  ds_read_b64_tr_b16 v[170:171], v28 offset:9216
  v_mfma_f32_16x16x32_bf16 a[28:31], v[68:71], v[140:143], a[28:31]
  ds_read_b64_tr_b16 v[172:173], v29 offset:8192
  v_add_u32 v28, 0x8000, v28
  v_and_b32 v28, 0x1ffff, v28
  v_mfma_f32_16x16x32_bf16 a[32:35], v[72:75], v[128:131], a[32:35]
  ds_read_b64_tr_b16 v[174:175], v29 offset:9216
  v_mfma_f32_16x16x32_bf16 a[36:39], v[72:75], v[132:135], a[36:39]
  ds_read_b128 v[100:103], v25 offset:2048
  v_add_u32 v29, 0x8000, v29
  v_and_b32 v29, 0x1ffff, v29
  v_mfma_f32_16x16x32_bf16 a[40:43], v[72:75], v[136:139], a[40:43]
  ds_read_b128 v[104:107], v25 offset:4096
  s_cmp_eq_u32 s55, 5
  s_cbranch_scc1 tk_170
tb_169:
  v_mfma_f32_16x16x32_bf16 a[44:47], v[72:75], v[140:143], a[44:47]
  ds_read_b128 v[108:111], v25 offset:6144
  v_mfma_f32_16x16x32_bf16 a[48:51], v[76:79], v[128:131], a[48:51]
  v_add_u32 v25, 0x8000, v25
  v_and_b32 v25, 0x1ffff, v25
  s_cmp_eq_u32 s55, 4
  s_cselect_b32 s52, s56, s52
  s_cselect_b32 s53, s57, s53
  v_mfma_f32_16x16x32_bf16 a[52:55], v[76:79], v[132:135], a[52:55]
  s_waitcnt vmcnt(16) lgkmcnt(0)
  s_barrier
  v_mfma_f32_16x16x32_bf16 a[56:59], v[76:79], v[136:139], a[56:59]
  s_add_u32 m0, s82, s100
  s_nop 0
  buffer_load_dwordx4 v8, s[16:19], s52 offen offset:0  lds
  v_mfma_f32_16x16x32_bf16 a[60:63], v[76:79], v[140:143], a[60:63]
  s_waitcnt lgkmcnt(0)
  v_mfma_f32_16x16x32_bf16 a[0:3], v[96:99], v[160:163], a[0:3]
  ds_read_b128 v[64:67], v24 offset:0
  buffer_load_dwordx4 v9, s[16:19], s52 offen offset:1024  lds
  v_mfma_f32_16x16x32_bf16 a[4:7], v[96:99], v[164:167], a[4:7]
  ds_read_b64_tr_b16 v[128:129], v26 offset:0
  v_mfma_f32_16x16x32_bf16 a[8:11], v[96:99], v[168:171], a[8:11]
  ds_read_b64_tr_b16 v[130:131], v26 offset:1024
  buffer_load_dwordx4 v10, s[16:19], s52 offen offset:2048  lds
  v_mfma_f32_16x16x32_bf16 a[12:15], v[96:99], v[172:175], a[12:15]
  ds_read_b64_tr_b16 v[132:133], v27 offset:0
  v_mfma_f32_16x16x32_bf16 a[16:19], v[100:103], v[160:163], a[16:19]
  ds_read_b64_tr_b16 v[134:135], v27 offset:1024
  buffer_load_dwordx4 v11, s[16:19], s52 offen offset:3072  lds
  v_mfma_f32_16x16x32_bf16 a[20:23], v[100:103], v[164:167], a[20:23]
  ds_read_b64_tr_b16 v[136:137], v28 offset:0
  v_mfma_f32_16x16x32_bf16 a[24:27], v[100:103], v[168:171], a[24:27]
  ds_read_b64_tr_b16 v[138:139], v28 offset:1024
  s_add_u32 m0, s82, s101
  s_nop 0
  buffer_load_dwordx4 v16, s[20:23], s53 offen offset:0  lds
  v_mfma_f32_16x16x32_bf16 a[28:31], v[100:103], v[172:175], a[28:31]
  ds_read_b64_tr_b16 v[140:141], v29 offset:0
  v_mfma_f32_16x16x32_bf16 a[32:35], v[104:107], v[160:163], a[32:35]
  ds_read_b64_tr_b16 v[142:143], v29 offset:1024
  buffer_load_dwordx4 v17, s[20:23], s53 offen offset:1024  lds
  v_mfma_f32_16x16x32_bf16 a[36:39], v[104:107], v[164:167], a[36:39]
  ds_read_b128 v[68:71], v24 offset:2048
  v_mfma_f32_16x16x32_bf16 a[40:43], v[104:107], v[168:171], a[40:43]
  ds_read_b128 v[72:75], v24 offset:4096
  buffer_load_dwordx4 v18, s[20:23], s53 offen offset:2048  lds
  v_mfma_f32_16x16x32_bf16 a[44:47], v[104:107], v[172:175], a[44:47]
  ds_read_b128 v[76:79], v24 offset:6144
  v_mfma_f32_16x16x32_bf16 a[48:51], v[108:111], v[160:163], a[48:51]
  buffer_load_dwordx4 v19, s[20:23], s53 offen offset:3072  lds
  v_mfma_f32_16x16x32_bf16 a[52:55], v[108:111], v[164:167], a[52:55]
  s_add_u32 s52, s52, s33
  s_add_u32 s53, s53, s54
  v_mfma_f32_16x16x32_bf16 a[56:59], v[108:111], v[168:171], a[56:59]
  s_add_u32 s82, s82, 0x8000
  s_and_b32 s82, s82, 0x1ffff
  v_mfma_f32_16x16x32_bf16 a[60:63], v[108:111], v[172:175], a[60:63]
  s_sub_u32 s55, s55, 1
  s_cmp_lg_u32 s55, 0
  s_cbranch_scc1 gl_165
  s_mov_b32 s32, 2
  s_mov_b32 s31, s92
  s_mov_b32 s50, s34
  s_mov_b32 s51, s34
  s_waitcnt vmcnt(0)
  s_mov_b32 s3, 6
  s_branch W_epi
W_abig:
  s_lshr_b32 s93, s88, 4
  s_and_b32 s38, s88, 15
  s_lshl_b32 s52, s59, 19
  s_lshl_b32 s53, s38, 9
  s_lshl_b32 s36, s59, 1
  s_lshr_b32 s37, s28, 1
  s_add_u32 s36, s36, s37
  s_lshl_b32 s92, s36, 20
  s_lshl_b32 s36, s38, 1
  s_and_b32 s37, s28, 1
  s_add_u32 s36, s36, s37
  s_lshl_b32 s36, s36, 13
  s_add_u32 s92, s92, s36
  s_mov_b32 s16, s60
  s_mov_b32 s17, s61
  s_cmp_eq_u32 s93, 1
  s_cselect_b32 s20, s64, s62
  s_cselect_b32 s21, s65, s63
  s_cselect_b32 s36, 0x0, 0x1000000
  s_cmp_eq_u32 s93, 2
  s_cselect_b32 s20, s66, s20
  s_cselect_b32 s21, s67, s21
  s_cselect_b32 s36, 0x2000000, s36
  s_add_u32 s92, s92, s36
  s_mov_b32 s22, 0x800000
  s_mov_b32 s79, 8192
  s_branch W_biggo
W_bb:
  s_lshr_b32 s93, s88, 2
  s_lshl_b32 s52, s59, 19
  s_lshl_b32 s53, s88, 9
  s_and_b32 s36, s88, 3
  s_lshl_b32 s36, s36, 1
  s_and_b32 s37, s28, 1
  s_add_u32 s36, s36, s37
  s_lshl_b32 s92, s36, 19
  s_lshl_b32 s36, s59, 1
  s_lshr_b32 s37, s28, 1
  s_add_u32 s36, s36, s37
  s_lshl_b32 s36, s36, 13
  s_add_u32 s92, s92, s36
  s_lshl_b32 s36, s93, 22
  s_add_u32 s92, s92, s36
  s_add_u32 s92, s92, 0x7000000
  s_cmp_eq_u32 s93, 0
  s_cselect_b32 s34, 0x3e8293ee, 1.0
  s_mov_b32 s35, s34
  s_mov_b32 s16, s70
  s_mov_b32 s17, s71
  s_mov_b32 s20, s72
  s_mov_b32 s21, s73
  s_mov_b32 s22, 0x600000
  s_mov_b32 s79, 6144
W_biggo:
  v_lshrrev_b32 v1, 3, v0
  v_and_b32 v2, 7, v0
  v_xor_b32 v2, v2, v1
  v_lshlrev_b32 v2, 4, v2
  s_lshl_b32 s36, s28, 6
  v_add_u32 v1, s36, v1
  v_mul_lo_u32 v1, v1, s78
  v_add_u32 v8, v1, v2
  s_mul_i32 s36, s78, 8
  s_sub_u32 s36, s36, 1024
  v_add_u32 v9, s36, v8
  s_mul_i32 s36, s78, 16
  s_sub_u32 s36, s36, 2048
  v_add_u32 v10, s36, v8
  s_mul_i32 s36, s78, 24
  s_sub_u32 s36, s36, 3072
  v_add_u32 v11, s36, v8
  s_mul_i32 s36, s78, 32
  s_sub_u32 s36, s36, 0
  v_add_u32 v12, s36, v8
  s_mul_i32 s36, s78, 40
  s_sub_u32 s36, s36, 1024
  v_add_u32 v13, s36, v8
  s_mul_i32 s36, s78, 48
  s_sub_u32 s36, s36, 2048
  v_add_u32 v14, s36, v8
  s_mul_i32 s36, s78, 56
  s_sub_u32 s36, s36, 3072
  v_add_u32 v15, s36, v8
  v_lshrrev_b32 v1, 5, v0
  s_lshl_b32 s36, s28, 4
  v_add_u32 v2, s36, v1
  v_mul_lo_u32 v2, v2, s79
  v_and_b32 v3, 31, v0
  v_lshlrev_b32 v3, 4, v3
  v_lshlrev_b32 v1, 5, v1
  v_xor_b32 v3, v3, v1
  v_xor_b32 v1, 0, v3
  s_mul_i32 s36, s79, 0
  s_sub_u32 s36, s36, 0
  v_add3_u32 v16, v2, v1, s36
  v_xor_b32 v1, 64, v3
  s_mul_i32 s36, s79, 2
  s_sub_u32 s36, s36, 1024
  v_add3_u32 v17, v2, v1, s36
  v_xor_b32 v1, 0, v3
  s_mul_i32 s36, s79, 4
  s_sub_u32 s36, s36, 2048
  v_add3_u32 v18, v2, v1, s36
  v_xor_b32 v1, 64, v3
  s_mul_i32 s36, s79, 6
  s_sub_u32 s36, s36, 3072
  v_add3_u32 v19, v2, v1, s36
  v_xor_b32 v1, 128, v3
  s_mul_i32 s36, s79, 8
  s_sub_u32 s36, s36, 0
  v_add3_u32 v20, v2, v1, s36
  v_xor_b32 v1, 192, v3
  s_mul_i32 s36, s79, 10
  s_sub_u32 s36, s36, 1024
  v_add3_u32 v21, v2, v1, s36
  v_xor_b32 v1, 128, v3
  s_mul_i32 s36, s79, 12
  s_sub_u32 s36, s36, 2048
  v_add3_u32 v22, v2, v1, s36
  v_xor_b32 v1, 192, v3
  s_mul_i32 s36, s79, 14
  s_sub_u32 s36, s36, 3072
  v_add3_u32 v23, v2, v1, s36
  v_and_b32 v1, 15, v0
  v_lshlrev_b32 v2, 7, v1
  v_and_b32 v1, 7, v0
  v_lshrrev_b32 v3, 4, v0
  v_xor_b32 v1, v1, v3
  v_lshl_add_u32 v2, v1, 4, v2
  s_lshr_b32 s36, s28, 1
  s_lshl_b32 s36, s36, 14
  v_add_u32 v24, s36, v2
  v_xor_b32 v25, 64, v24
  v_lshrrev_b32 v1, 4, v0
  v_lshlrev_b32 v2, 12, v1
  v_bfe_u32 v3, v0, 2, 2
  v_lshl_add_u32 v2, v3, 9, v2
  v_bfe_u32 v3, v0, 2, 3
  v_lshl_add_u32 v2, v3, 5, v2
  v_and_b32 v3, 3, v0
  v_lshl_add_u32 v2, v3, 3, v2
  s_and_b32 s36, s28, 1
  s_lshl_b32 s36, s36, 8
  v_xor_b32 v2, s36, v2
  v_add_u32 v26, 0x8000, v2
  v_xor_b32 v27, 32, v26
  v_xor_b32 v28, 64, v26
  v_xor_b32 v29, 96, v26
  v_xor_b32 v30, 128, v26
  v_xor_b32 v31, 160, v26
  v_xor_b32 v32, 192, v26
  v_xor_b32 v33, 224, v26
  s_lshl_b32 s54, s79, 6
  s_mov_b32 s82, 0
  s_lshl_b32 s100, s28, 13
  s_lshl_b32 s101, s28, 13
  s_add_u32 s101, s101, 0x8000
  s_bfe_u32 s36, s86, 0x80008
  s_add_u32 s37, s36, 63
  s_lshr_b32 s37, s37, 6
  s_mov_b32 s99, 0x20000
  s_cmp_ge_u32 s28, s37
  s_cbranch_scc1 tw_171
  s_lshl_b32 s37, s28, 6
  v_add_u32 v1, s37, v0
  v_cmp_gt_u32 vcc, s36, v1
  s_and_b32 s36, s86, 0xff
  v_add_u32 v1, s36, v1
  v_mul_lo_u32 v34, v1, s78
  s_mov_b32 s96, s16
  s_mov_b32 s97, s17
  s_mov_b32 s98, s18
  s_mov_b32 s94, s52
  s_mov_b32 s95, s33
  s_branch tg_172
tw_171:
  s_sub_u32 s37, s28, s37
  s_lshl_b32 s37, s37, 6
  v_add_u32 v1, s37, v0
  s_lshr_b32 s36, s86, 24
  v_cmp_gt_u32 vcc, s36, v1
  s_bfe_u32 s36, s86, 0x80010
  v_add_u32 v1, s36, v1
  v_lshrrev_b32 v2, 2, v1
  v_mul_lo_u32 v34, v2, s79
  v_and_b32 v2, 3, v1
  v_lshl_add_u32 v34, v2, 7, v34
  s_mov_b32 s96, s20
  s_mov_b32 s97, s21
  s_mov_b32 s98, s22
  s_mov_b32 s94, s53
  s_mov_b32 s95, s54
tg_172:
  v_mov_b32 v2, 0x7f000000
  v_cndmask_b32 v34, v2, v34, vcc
  buffer_load_dword v36, v34, s[96:99], s94 offen
  s_add_u32 s94, s94, s95
  buffer_load_dword v36, v34, s[96:99], s94 offen
  s_add_u32 s94, s94, s95
  buffer_load_dword v36, v34, s[96:99], s94 offen
  s_add_u32 s94, s94, s95
  s_add_u32 m0, s82, s100
  s_nop 0
  buffer_load_dwordx4 v8, s[16:19], s52 offen offset:0  lds
  buffer_load_dwordx4 v9, s[16:19], s52 offen offset:1024  lds
  buffer_load_dwordx4 v10, s[16:19], s52 offen offset:2048  lds
  buffer_load_dwordx4 v11, s[16:19], s52 offen offset:3072  lds
  s_add_u32 m0, m0, 0x1000
  s_nop 0
  buffer_load_dwordx4 v12, s[16:19], s52 offen offset:0  lds
  buffer_load_dwordx4 v13, s[16:19], s52 offen offset:1024  lds
  buffer_load_dwordx4 v14, s[16:19], s52 offen offset:2048  lds
  buffer_load_dwordx4 v15, s[16:19], s52 offen offset:3072  lds
  s_add_u32 m0, s82, s101
  s_nop 0
  buffer_load_dwordx4 v16, s[20:23], s53 offen offset:0  lds
  buffer_load_dwordx4 v17, s[20:23], s53 offen offset:1024  lds
  buffer_load_dwordx4 v18, s[20:23], s53 offen offset:2048  lds
  buffer_load_dwordx4 v19, s[20:23], s53 offen offset:3072  lds
  s_add_u32 m0, m0, 0x1000
  s_nop 0
  buffer_load_dwordx4 v20, s[20:23], s53 offen offset:0  lds
  buffer_load_dwordx4 v21, s[20:23], s53 offen offset:1024  lds
  buffer_load_dwordx4 v22, s[20:23], s53 offen offset:2048  lds
  buffer_load_dwordx4 v23, s[20:23], s53 offen offset:3072  lds
  s_add_u32 s52, s52, s33
  s_add_u32 s53, s53, s54
  s_add_u32 s82, s82, 0x10000
  s_and_b32 s82, s82, 0x1ffff
  buffer_load_dword v36, v34, s[96:99], s94 offen
  s_add_u32 s94, s94, s95
  s_add_u32 m0, s82, s100
  s_nop 0
  buffer_load_dwordx4 v8, s[16:19], s52 offen offset:0  lds
  buffer_load_dwordx4 v9, s[16:19], s52 offen offset:1024  lds
  buffer_load_dwordx4 v10, s[16:19], s52 offen offset:2048  lds
  buffer_load_dwordx4 v11, s[16:19], s52 offen offset:3072  lds
  s_add_u32 m0, m0, 0x1000
  s_nop 0
  buffer_load_dwordx4 v12, s[16:19], s52 offen offset:0  lds
  buffer_load_dwordx4 v13, s[16:19], s52 offen offset:1024  lds
  buffer_load_dwordx4 v14, s[16:19], s52 offen offset:2048  lds
  buffer_load_dwordx4 v15, s[16:19], s52 offen offset:3072  lds
  s_add_u32 m0, s82, s101
  s_nop 0
  buffer_load_dwordx4 v16, s[20:23], s53 offen offset:0  lds
  buffer_load_dwordx4 v17, s[20:23], s53 offen offset:1024  lds
  buffer_load_dwordx4 v18, s[20:23], s53 offen offset:2048  lds
  buffer_load_dwordx4 v19, s[20:23], s53 offen offset:3072  lds
  s_add_u32 m0, m0, 0x1000
  s_nop 0
  buffer_load_dwordx4 v20, s[20:23], s53 offen offset:0  lds
  buffer_load_dwordx4 v21, s[20:23], s53 offen offset:1024  lds
  buffer_load_dwordx4 v22, s[20:23], s53 offen offset:2048  lds
  buffer_load_dwordx4 v23, s[20:23], s53 offen offset:3072  lds
  s_add_u32 s52, s52, s33
  s_add_u32 s53, s53, s54
  s_add_u32 s82, s82, 0x10000
  s_and_b32 s82, s82, 0x1ffff
  buffer_load_dword v36, v34, s[96:99], s94 offen
  s_add_u32 s94, s94, s95
  s_mov_b32 s3, 3
  s_cmp_lg_u32 s32, 0
  s_cbranch_scc1 W_epi
W_ret3:
  s_waitcnt vmcnt(18)
  s_barrier
  s_cmp_lg_u32 s49, 255
  s_cbranch_scc1 sg_173
sb_174:
  ds_read_b128 v[64:67], v24 offset:0
  ds_read_b64_tr_b16 v[128:129], v26 offset:0
  ds_read_b64_tr_b16 v[130:131], v26 offset:2048
  ds_read_b64_tr_b16 v[132:133], v27 offset:0
  ds_read_b64_tr_b16 v[134:135], v27 offset:2048
  ds_read_b64_tr_b16 v[136:137], v28 offset:0
  ds_read_b64_tr_b16 v[138:139], v28 offset:2048
  ds_read_b64_tr_b16 v[140:141], v29 offset:0
  ds_read_b64_tr_b16 v[142:143], v29 offset:2048
  ds_read_b64_tr_b16 v[144:145], v30 offset:0
  ds_read_b64_tr_b16 v[146:147], v30 offset:2048
  ds_read_b64_tr_b16 v[148:149], v31 offset:0
  ds_read_b64_tr_b16 v[150:151], v31 offset:2048
  ds_read_b64_tr_b16 v[152:153], v32 offset:0
  ds_read_b64_tr_b16 v[154:155], v32 offset:2048
  ds_read_b64_tr_b16 v[156:157], v33 offset:0
  ds_read_b64_tr_b16 v[158:159], v33 offset:2048
  ds_read_b128 v[68:71], v24 offset:2048
  ds_read_b128 v[72:75], v24 offset:4096
  ds_read_b128 v[76:79], v24 offset:6144
  ds_read_b128 v[80:83], v24 offset:8192
  ds_read_b128 v[84:87], v24 offset:10240
  ds_read_b128 v[88:91], v24 offset:12288
  ds_read_b128 v[92:95], v24 offset:14336
  s_cmp_eq_u32 s93, 2
  s_cbranch_scc1 W_bv
  s_mov_b32 s55, s83
  s_waitcnt lgkmcnt(0)
  v_mfma_f32_16x16x32_bf16 a[0:3], v[128:131], v[64:67], 0
  ds_read_b128 v[96:99], v25 offset:0
  v_mfma_f32_16x16x32_bf16 a[4:7], v[132:135], v[64:67], 0
  ds_read_b64_tr_b16 v[160:161], v26 offset:16384
  v_mfma_f32_16x16x32_bf16 a[8:11], v[136:139], v[64:67], 0
  ds_read_b64_tr_b16 v[162:163], v26 offset:18432
  v_mfma_f32_16x16x32_bf16 a[12:15], v[140:143], v[64:67], 0
  ds_read_b64_tr_b16 v[164:165], v27 offset:16384
  v_mfma_f32_16x16x32_bf16 a[16:19], v[144:147], v[64:67], 0
  ds_read_b64_tr_b16 v[166:167], v27 offset:18432
  v_mfma_f32_16x16x32_bf16 a[20:23], v[148:151], v[64:67], 0
  ds_read_b64_tr_b16 v[168:169], v28 offset:16384
  v_mfma_f32_16x16x32_bf16 a[24:27], v[152:155], v[64:67], 0
  ds_read_b64_tr_b16 v[170:171], v28 offset:18432
  v_mfma_f32_16x16x32_bf16 a[28:31], v[156:159], v[64:67], 0
  ds_read_b64_tr_b16 v[172:173], v29 offset:16384
  v_mfma_f32_16x16x32_bf16 a[32:35], v[128:131], v[68:71], 0
  ds_read_b64_tr_b16 v[174:175], v29 offset:18432
  v_mfma_f32_16x16x32_bf16 a[36:39], v[132:135], v[68:71], 0
  ds_read_b64_tr_b16 v[176:177], v30 offset:16384
  v_mfma_f32_16x16x32_bf16 a[40:43], v[136:139], v[68:71], 0
  ds_read_b64_tr_b16 v[178:179], v30 offset:18432
  v_mfma_f32_16x16x32_bf16 a[44:47], v[140:143], v[68:71], 0
  ds_read_b64_tr_b16 v[180:181], v31 offset:16384
  v_mfma_f32_16x16x32_bf16 a[48:51], v[144:147], v[68:71], 0
  ds_read_b64_tr_b16 v[182:183], v31 offset:18432
  v_mfma_f32_16x16x32_bf16 a[52:55], v[148:151], v[68:71], 0
  ds_read_b64_tr_b16 v[184:185], v32 offset:16384
  v_mfma_f32_16x16x32_bf16 a[56:59], v[152:155], v[68:71], 0
  ds_read_b64_tr_b16 v[186:187], v32 offset:18432
  v_mfma_f32_16x16x32_bf16 a[60:63], v[156:159], v[68:71], 0
  ds_read_b64_tr_b16 v[188:189], v33 offset:16384
  v_mfma_f32_16x16x32_bf16 a[64:67], v[128:131], v[72:75], 0
  ds_read_b64_tr_b16 v[190:191], v33 offset:18432
  v_mfma_f32_16x16x32_bf16 a[68:71], v[132:135], v[72:75], 0
  ds_read_b128 v[100:103], v25 offset:2048
  v_mfma_f32_16x16x32_bf16 a[72:75], v[136:139], v[72:75], 0
  ds_read_b128 v[104:107], v25 offset:4096
  v_mfma_f32_16x16x32_bf16 a[76:79], v[140:143], v[72:75], 0
  ds_read_b128 v[108:111], v25 offset:6144
  v_mfma_f32_16x16x32_bf16 a[80:83], v[144:147], v[72:75], 0
  ds_read_b128 v[112:115], v25 offset:8192
  v_mfma_f32_16x16x32_bf16 a[84:87], v[148:151], v[72:75], 0
  ds_read_b128 v[116:119], v25 offset:10240
  v_mfma_f32_16x16x32_bf16 a[88:91], v[152:155], v[72:75], 0
  ds_read_b128 v[120:123], v25 offset:12288
  v_mfma_f32_16x16x32_bf16 a[92:95], v[156:159], v[72:75], 0
  ds_read_b128 v[124:127], v25 offset:14336
  v_mfma_f32_16x16x32_bf16 a[96:99], v[128:131], v[76:79], 0
  v_xor_b32 v24, 0x10000, v24
  v_mfma_f32_16x16x32_bf16 a[100:103], v[132:135], v[76:79], 0
  v_xor_b32 v25, 0x10000, v25
  v_mfma_f32_16x16x32_bf16 a[104:107], v[136:139], v[76:79], 0
  v_xor_b32 v26, 0x10000, v26
  v_mfma_f32_16x16x32_bf16 a[108:111], v[140:143], v[76:79], 0
  v_xor_b32 v27, 0x10000, v27
  v_mfma_f32_16x16x32_bf16 a[112:115], v[144:147], v[76:79], 0
  v_xor_b32 v28, 0x10000, v28
  v_mfma_f32_16x16x32_bf16 a[116:119], v[148:151], v[76:79], 0
  v_xor_b32 v29, 0x10000, v29
  s_cmp_eq_u32 s55, 2
  s_cselect_b32 s52, s56, s52
  s_cselect_b32 s53, s57, s53
  v_mfma_f32_16x16x32_bf16 a[120:123], v[152:155], v[76:79], 0
  v_xor_b32 v30, 0x10000, v30
  s_cmp_eq_u32 s49, 255
  s_cbranch_scc1 pb_176
  s_waitcnt vmcnt(0)
pb_176:
  s_waitcnt vmcnt(1) lgkmcnt(0)
  s_barrier
  s_cmp_lg_u32 s49, 255
  s_cbranch_scc1 sg_177
sb_178:
  v_mfma_f32_16x16x32_bf16 a[124:127], v[156:159], v[76:79], 0
  v_xor_b32 v31, 0x10000, v31
  s_add_u32 m0, s82, s100
  s_nop 0
  buffer_load_dwordx4 v8, s[16:19], s52 offen offset:0  lds
  v_mfma_f32_16x16x32_bf16 a[128:131], v[128:131], v[80:83], 0
  v_xor_b32 v32, 0x10000, v32
  v_mfma_f32_16x16x32_bf16 a[132:135], v[132:135], v[80:83], 0
  v_xor_b32 v33, 0x10000, v33
  v_mfma_f32_16x16x32_bf16 a[136:139], v[136:139], v[80:83], 0
  v_mfma_f32_16x16x32_bf16 a[140:143], v[140:143], v[80:83], 0
  buffer_load_dwordx4 v9, s[16:19], s52 offen offset:1024  lds
  v_mfma_f32_16x16x32_bf16 a[144:147], v[144:147], v[80:83], 0
  v_mfma_f32_16x16x32_bf16 a[148:151], v[148:151], v[80:83], 0
  v_mfma_f32_16x16x32_bf16 a[152:155], v[152:155], v[80:83], 0
  v_mfma_f32_16x16x32_bf16 a[156:159], v[156:159], v[80:83], 0
  buffer_load_dwordx4 v10, s[16:19], s52 offen offset:2048  lds
  v_mfma_f32_16x16x32_bf16 a[160:163], v[128:131], v[84:87], 0
  v_mfma_f32_16x16x32_bf16 a[164:167], v[132:135], v[84:87], 0
  v_mfma_f32_16x16x32_bf16 a[168:171], v[136:139], v[84:87], 0
  v_mfma_f32_16x16x32_bf16 a[172:175], v[140:143], v[84:87], 0
  buffer_load_dwordx4 v11, s[16:19], s52 offen offset:3072  lds
  v_mfma_f32_16x16x32_bf16 a[176:179], v[144:147], v[84:87], 0
  v_mfma_f32_16x16x32_bf16 a[180:183], v[148:151], v[84:87], 0
  v_mfma_f32_16x16x32_bf16 a[184:187], v[152:155], v[84:87], 0
  v_mfma_f32_16x16x32_bf16 a[188:191], v[156:159], v[84:87], 0
  s_add_u32 m0, m0, 0x1000
  s_nop 0
  buffer_load_dwordx4 v12, s[16:19], s52 offen offset:0  lds
  v_mfma_f32_16x16x32_bf16 a[192:195], v[128:131], v[88:91], 0
  v_mfma_f32_16x16x32_bf16 a[196:199], v[132:135], v[88:91], 0
  v_mfma_f32_16x16x32_bf16 a[200:203], v[136:139], v[88:91], 0
  v_mfma_f32_16x16x32_bf16 a[204:207], v[140:143], v[88:91], 0
  buffer_load_dwordx4 v13, s[16:19], s52 offen offset:1024  lds
  v_mfma_f32_16x16x32_bf16 a[208:211], v[144:147], v[88:91], 0
  v_mfma_f32_16x16x32_bf16 a[212:215], v[148:151], v[88:91], 0
  v_mfma_f32_16x16x32_bf16 a[216:219], v[152:155], v[88:91], 0
  v_mfma_f32_16x16x32_bf16 a[220:223], v[156:159], v[88:91], 0
  buffer_load_dwordx4 v14, s[16:19], s52 offen offset:2048  lds
  v_mfma_f32_16x16x32_bf16 a[224:227], v[128:131], v[92:95], 0
  v_mfma_f32_16x16x32_bf16 a[228:231], v[132:135], v[92:95], 0
  v_mfma_f32_16x16x32_bf16 a[232:235], v[136:139], v[92:95], 0
  v_mfma_f32_16x16x32_bf16 a[236:239], v[140:143], v[92:95], 0
  buffer_load_dwordx4 v15, s[16:19], s52 offen offset:3072  lds
  v_mfma_f32_16x16x32_bf16 a[240:243], v[144:147], v[92:95], 0
  v_mfma_f32_16x16x32_bf16 a[244:247], v[148:151], v[92:95], 0
  v_mfma_f32_16x16x32_bf16 a[248:251], v[152:155], v[92:95], 0
  v_mfma_f32_16x16x32_bf16 a[252:255], v[156:159], v[92:95], 0
  s_add_u32 m0, s82, s101
  s_nop 0
  buffer_load_dwordx4 v16, s[20:23], s53 offen offset:0  lds
  s_waitcnt lgkmcnt(0)
  v_mfma_f32_16x16x32_bf16 a[0:3], v[160:163], v[96:99], a[0:3]
  ds_read_b128 v[64:67], v24 offset:0
  v_mfma_f32_16x16x32_bf16 a[4:7], v[164:167], v[96:99], a[4:7]
  ds_read_b64_tr_b16 v[128:129], v26 offset:0
  v_mfma_f32_16x16x32_bf16 a[8:11], v[168:171], v[96:99], a[8:11]
  ds_read_b64_tr_b16 v[130:131], v26 offset:2048
  v_mfma_f32_16x16x32_bf16 a[12:15], v[172:175], v[96:99], a[12:15]
  ds_read_b64_tr_b16 v[132:133], v27 offset:0
  buffer_load_dwordx4 v17, s[20:23], s53 offen offset:1024  lds
  v_mfma_f32_16x16x32_bf16 a[16:19], v[176:179], v[96:99], a[16:19]
  ds_read_b64_tr_b16 v[134:135], v27 offset:2048
  v_mfma_f32_16x16x32_bf16 a[20:23], v[180:183], v[96:99], a[20:23]
  ds_read_b64_tr_b16 v[136:137], v28 offset:0
  v_mfma_f32_16x16x32_bf16 a[24:27], v[184:187], v[96:99], a[24:27]
  ds_read_b64_tr_b16 v[138:139], v28 offset:2048
  v_mfma_f32_16x16x32_bf16 a[28:31], v[188:191], v[96:99], a[28:31]
  ds_read_b64_tr_b16 v[140:141], v29 offset:0
  buffer_load_dwordx4 v18, s[20:23], s53 offen offset:2048  lds
  v_mfma_f32_16x16x32_bf16 a[32:35], v[160:163], v[100:103], a[32:35]
  ds_read_b64_tr_b16 v[142:143], v29 offset:2048
  v_mfma_f32_16x16x32_bf16 a[36:39], v[164:167], v[100:103], a[36:39]
  ds_read_b64_tr_b16 v[144:145], v30 offset:0
  v_mfma_f32_16x16x32_bf16 a[40:43], v[168:171], v[100:103], a[40:43]
  ds_read_b64_tr_b16 v[146:147], v30 offset:2048
  v_mfma_f32_16x16x32_bf16 a[44:47], v[172:175], v[100:103], a[44:47]
  ds_read_b64_tr_b16 v[148:149], v31 offset:0
  buffer_load_dwordx4 v19, s[20:23], s53 offen offset:3072  lds
  v_mfma_f32_16x16x32_bf16 a[48:51], v[176:179], v[100:103], a[48:51]
  ds_read_b64_tr_b16 v[150:151], v31 offset:2048
  v_mfma_f32_16x16x32_bf16 a[52:55], v[180:183], v[100:103], a[52:55]
  ds_read_b64_tr_b16 v[152:153], v32 offset:0
  v_mfma_f32_16x16x32_bf16 a[56:59], v[184:187], v[100:103], a[56:59]
  ds_read_b64_tr_b16 v[154:155], v32 offset:2048
  v_mfma_f32_16x16x32_bf16 a[60:63], v[188:191], v[100:103], a[60:63]
  ds_read_b64_tr_b16 v[156:157], v33 offset:0
  s_add_u32 m0, m0, 0x1000
  s_nop 0
  buffer_load_dwordx4 v20, s[20:23], s53 offen offset:0  lds
  v_mfma_f32_16x16x32_bf16 a[64:67], v[160:163], v[104:107], a[64:67]
  ds_read_b64_tr_b16 v[158:159], v33 offset:2048
  v_mfma_f32_16x16x32_bf16 a[68:71], v[164:167], v[104:107], a[68:71]
  ds_read_b128 v[68:71], v24 offset:2048
  v_mfma_f32_16x16x32_bf16 a[72:75], v[168:171], v[104:107], a[72:75]
  ds_read_b128 v[72:75], v24 offset:4096
  v_mfma_f32_16x16x32_bf16 a[76:79], v[172:175], v[104:107], a[76:79]
  ds_read_b128 v[76:79], v24 offset:6144
  buffer_load_dwordx4 v21, s[20:23], s53 offen offset:1024  lds
  v_mfma_f32_16x16x32_bf16 a[80:83], v[176:179], v[104:107], a[80:83]
  ds_read_b128 v[80:83], v24 offset:8192
  v_mfma_f32_16x16x32_bf16 a[84:87], v[180:183], v[104:107], a[84:87]
  ds_read_b128 v[84:87], v24 offset:10240
  v_mfma_f32_16x16x32_bf16 a[88:91], v[184:187], v[104:107], a[88:91]
  ds_read_b128 v[88:91], v24 offset:12288
  v_mfma_f32_16x16x32_bf16 a[92:95], v[188:191], v[104:107], a[92:95]
  ds_read_b128 v[92:95], v24 offset:14336
  buffer_load_dwordx4 v22, s[20:23], s53 offen offset:2048  lds
  v_mfma_f32_16x16x32_bf16 a[96:99], v[160:163], v[108:111], a[96:99]
  v_mfma_f32_16x16x32_bf16 a[100:103], v[164:167], v[108:111], a[100:103]
  v_mfma_f32_16x16x32_bf16 a[104:107], v[168:171], v[108:111], a[104:107]
  v_mfma_f32_16x16x32_bf16 a[108:111], v[172:175], v[108:111], a[108:111]
  buffer_load_dwordx4 v23, s[20:23], s53 offen offset:3072  lds
  v_mfma_f32_16x16x32_bf16 a[112:115], v[176:179], v[108:111], a[112:115]
  s_add_u32 s52, s52, s33
  s_add_u32 s53, s53, s54
  v_mfma_f32_16x16x32_bf16 a[116:119], v[180:183], v[108:111], a[116:119]
  s_add_u32 s82, s82, 0x10000
  s_and_b32 s82, s82, 0x1ffff
  v_mfma_f32_16x16x32_bf16 a[120:123], v[184:187], v[108:111], a[120:123]
  v_mfma_f32_16x16x32_bf16 a[124:127], v[188:191], v[108:111], a[124:127]
  s_cmp_eq_u32 s55, 5
  s_cselect_b32 s94, s56, s94
  v_mfma_f32_16x16x32_bf16 a[128:131], v[160:163], v[112:115], a[128:131]
  buffer_load_dword v36, v34, s[96:99], s94 offen
  s_add_u32 s94, s94, s95
  v_mfma_f32_16x16x32_bf16 a[132:135], v[164:167], v[112:115], a[132:135]
  v_mfma_f32_16x16x32_bf16 a[136:139], v[168:171], v[112:115], a[136:139]
  v_mfma_f32_16x16x32_bf16 a[140:143], v[172:175], v[112:115], a[140:143]
  v_mfma_f32_16x16x32_bf16 a[144:147], v[176:179], v[112:115], a[144:147]
  v_mfma_f32_16x16x32_bf16 a[148:151], v[180:183], v[112:115], a[148:151]
  v_mfma_f32_16x16x32_bf16 a[152:155], v[184:187], v[112:115], a[152:155]
  v_mfma_f32_16x16x32_bf16 a[156:159], v[188:191], v[112:115], a[156:159]
  v_mfma_f32_16x16x32_bf16 a[160:163], v[160:163], v[116:119], a[160:163]
  v_mfma_f32_16x16x32_bf16 a[164:167], v[164:167], v[116:119], a[164:167]
  v_mfma_f32_16x16x32_bf16 a[168:171], v[168:171], v[116:119], a[168:171]
  v_mfma_f32_16x16x32_bf16 a[172:175], v[172:175], v[116:119], a[172:175]
  v_mfma_f32_16x16x32_bf16 a[176:179], v[176:179], v[116:119], a[176:179]
  v_mfma_f32_16x16x32_bf16 a[180:183], v[180:183], v[116:119], a[180:183]
  v_mfma_f32_16x16x32_bf16 a[184:187], v[184:187], v[116:119], a[184:187]
  v_mfma_f32_16x16x32_bf16 a[188:191], v[188:191], v[116:119], a[188:191]
  v_mfma_f32_16x16x32_bf16 a[192:195], v[160:163], v[120:123], a[192:195]
  v_mfma_f32_16x16x32_bf16 a[196:199], v[164:167], v[120:123], a[196:199]
  v_mfma_f32_16x16x32_bf16 a[200:203], v[168:171], v[120:123], a[200:203]
  v_mfma_f32_16x16x32_bf16 a[204:207], v[172:175], v[120:123], a[204:207]
  v_mfma_f32_16x16x32_bf16 a[208:211], v[176:179], v[120:123], a[208:211]
  v_mfma_f32_16x16x32_bf16 a[212:215], v[180:183], v[120:123], a[212:215]
  v_mfma_f32_16x16x32_bf16 a[216:219], v[184:187], v[120:123], a[216:219]
  v_mfma_f32_16x16x32_bf16 a[220:223], v[188:191], v[120:123], a[220:223]
  v_mfma_f32_16x16x32_bf16 a[224:227], v[160:163], v[124:127], a[224:227]
  v_mfma_f32_16x16x32_bf16 a[228:231], v[164:167], v[124:127], a[228:231]
  v_mfma_f32_16x16x32_bf16 a[232:235], v[168:171], v[124:127], a[232:235]
  v_mfma_f32_16x16x32_bf16 a[236:239], v[172:175], v[124:127], a[236:239]
  v_mfma_f32_16x16x32_bf16 a[240:243], v[176:179], v[124:127], a[240:243]
  v_mfma_f32_16x16x32_bf16 a[244:247], v[180:183], v[124:127], a[244:247]
  v_mfma_f32_16x16x32_bf16 a[248:251], v[184:187], v[124:127], a[248:251]
  v_mfma_f32_16x16x32_bf16 a[252:255], v[188:191], v[124:127], a[252:255]
  s_sub_u32 s55, s55, 1
gl_175:
  s_waitcnt lgkmcnt(0)
  v_mfma_f32_16x16x32_bf16 a[0:3], v[128:131], v[64:67], a[0:3]
  ds_read_b128 v[96:99], v25 offset:0
  v_mfma_f32_16x16x32_bf16 a[4:7], v[132:135], v[64:67], a[4:7]
  ds_read_b64_tr_b16 v[160:161], v26 offset:16384
  v_mfma_f32_16x16x32_bf16 a[8:11], v[136:139], v[64:67], a[8:11]
  ds_read_b64_tr_b16 v[162:163], v26 offset:18432
  v_mfma_f32_16x16x32_bf16 a[12:15], v[140:143], v[64:67], a[12:15]
  ds_read_b64_tr_b16 v[164:165], v27 offset:16384
  v_mfma_f32_16x16x32_bf16 a[16:19], v[144:147], v[64:67], a[16:19]
  ds_read_b64_tr_b16 v[166:167], v27 offset:18432
  v_mfma_f32_16x16x32_bf16 a[20:23], v[148:151], v[64:67], a[20:23]
  ds_read_b64_tr_b16 v[168:169], v28 offset:16384
  v_mfma_f32_16x16x32_bf16 a[24:27], v[152:155], v[64:67], a[24:27]
  ds_read_b64_tr_b16 v[170:171], v28 offset:18432
  v_mfma_f32_16x16x32_bf16 a[28:31], v[156:159], v[64:67], a[28:31]
  ds_read_b64_tr_b16 v[172:173], v29 offset:16384
  v_mfma_f32_16x16x32_bf16 a[32:35], v[128:131], v[68:71], a[32:35]
  ds_read_b64_tr_b16 v[174:175], v29 offset:18432
  v_mfma_f32_16x16x32_bf16 a[36:39], v[132:135], v[68:71], a[36:39]
  ds_read_b64_tr_b16 v[176:177], v30 offset:16384
  v_mfma_f32_16x16x32_bf16 a[40:43], v[136:139], v[68:71], a[40:43]
  ds_read_b64_tr_b16 v[178:179], v30 offset:18432
  v_mfma_f32_16x16x32_bf16 a[44:47], v[140:143], v[68:71], a[44:47]
  ds_read_b64_tr_b16 v[180:181], v31 offset:16384
  v_mfma_f32_16x16x32_bf16 a[48:51], v[144:147], v[68:71], a[48:51]
  ds_read_b64_tr_b16 v[182:183], v31 offset:18432
  v_mfma_f32_16x16x32_bf16 a[52:55], v[148:151], v[68:71], a[52:55]
  ds_read_b64_tr_b16 v[184:185], v32 offset:16384
  v_mfma_f32_16x16x32_bf16 a[56:59], v[152:155], v[68:71], a[56:59]
  ds_read_b64_tr_b16 v[186:187], v32 offset:18432
  v_mfma_f32_16x16x32_bf16 a[60:63], v[156:159], v[68:71], a[60:63]
  ds_read_b64_tr_b16 v[188:189], v33 offset:16384
  v_mfma_f32_16x16x32_bf16 a[64:67], v[128:131], v[72:75], a[64:67]
  ds_read_b64_tr_b16 v[190:191], v33 offset:18432
  v_mfma_f32_16x16x32_bf16 a[68:71], v[132:135], v[72:75], a[68:71]
  ds_read_b128 v[100:103], v25 offset:2048
  v_mfma_f32_16x16x32_bf16 a[72:75], v[136:139], v[72:75], a[72:75]
  ds_read_b128 v[104:107], v25 offset:4096
  v_mfma_f32_16x16x32_bf16 a[76:79], v[140:143], v[72:75], a[76:79]
  ds_read_b128 v[108:111], v25 offset:6144
  v_mfma_f32_16x16x32_bf16 a[80:83], v[144:147], v[72:75], a[80:83]
  ds_read_b128 v[112:115], v25 offset:8192
  v_mfma_f32_16x16x32_bf16 a[84:87], v[148:151], v[72:75], a[84:87]
  ds_read_b128 v[116:119], v25 offset:10240
  v_mfma_f32_16x16x32_bf16 a[88:91], v[152:155], v[72:75], a[88:91]
  ds_read_b128 v[120:123], v25 offset:12288
  v_mfma_f32_16x16x32_bf16 a[92:95], v[156:159], v[72:75], a[92:95]
  ds_read_b128 v[124:127], v25 offset:14336
  v_mfma_f32_16x16x32_bf16 a[96:99], v[128:131], v[76:79], a[96:99]
  v_xor_b32 v24, 0x10000, v24
  v_mfma_f32_16x16x32_bf16 a[100:103], v[132:135], v[76:79], a[100:103]
  v_xor_b32 v25, 0x10000, v25
  v_mfma_f32_16x16x32_bf16 a[104:107], v[136:139], v[76:79], a[104:107]
  v_xor_b32 v26, 0x10000, v26
  v_mfma_f32_16x16x32_bf16 a[108:111], v[140:143], v[76:79], a[108:111]
  v_xor_b32 v27, 0x10000, v27
  s_cmp_eq_u32 s55, 2
  s_cbranch_scc1 tk_180
tb_179:
  v_mfma_f32_16x16x32_bf16 a[112:115], v[144:147], v[76:79], a[112:115]
  v_xor_b32 v28, 0x10000, v28
  v_mfma_f32_16x16x32_bf16 a[116:119], v[148:151], v[76:79], a[116:119]
  v_xor_b32 v29, 0x10000, v29
  s_cmp_eq_u32 s55, 2
  s_cselect_b32 s52, s56, s52
  s_cselect_b32 s53, s57, s53
  v_mfma_f32_16x16x32_bf16 a[120:123], v[152:155], v[76:79], a[120:123]
  v_xor_b32 v30, 0x10000, v30
  s_waitcnt vmcnt(1) lgkmcnt(0)
  s_barrier
  v_mfma_f32_16x16x32_bf16 a[124:127], v[156:159], v[76:79], a[124:127]
  v_xor_b32 v31, 0x10000, v31
  s_add_u32 m0, s82, s100
  s_nop 0
  buffer_load_dwordx4 v8, s[16:19], s52 offen offset:0  lds
  v_mfma_f32_16x16x32_bf16 a[128:131], v[128:131], v[80:83], a[128:131]
  v_xor_b32 v32, 0x10000, v32
  v_mfma_f32_16x16x32_bf16 a[132:135], v[132:135], v[80:83], a[132:135]
  v_xor_b32 v33, 0x10000, v33
  v_mfma_f32_16x16x32_bf16 a[136:139], v[136:139], v[80:83], a[136:139]
  v_mfma_f32_16x16x32_bf16 a[140:143], v[140:143], v[80:83], a[140:143]
  buffer_load_dwordx4 v9, s[16:19], s52 offen offset:1024  lds
  v_mfma_f32_16x16x32_bf16 a[144:147], v[144:147], v[80:83], a[144:147]
  v_mfma_f32_16x16x32_bf16 a[148:151], v[148:151], v[80:83], a[148:151]
  v_mfma_f32_16x16x32_bf16 a[152:155], v[152:155], v[80:83], a[152:155]
  v_mfma_f32_16x16x32_bf16 a[156:159], v[156:159], v[80:83], a[156:159]
  buffer_load_dwordx4 v10, s[16:19], s52 offen offset:2048  lds
  v_mfma_f32_16x16x32_bf16 a[160:163], v[128:131], v[84:87], a[160:163]
  v_mfma_f32_16x16x32_bf16 a[164:167], v[132:135], v[84:87], a[164:167]
  v_mfma_f32_16x16x32_bf16 a[168:171], v[136:139], v[84:87], a[168:171]
  v_mfma_f32_16x16x32_bf16 a[172:175], v[140:143], v[84:87], a[172:175]
  buffer_load_dwordx4 v11, s[16:19], s52 offen offset:3072  lds
  v_mfma_f32_16x16x32_bf16 a[176:179], v[144:147], v[84:87], a[176:179]
  v_mfma_f32_16x16x32_bf16 a[180:183], v[148:151], v[84:87], a[180:183]
  v_mfma_f32_16x16x32_bf16 a[184:187], v[152:155], v[84:87], a[184:187]
  v_mfma_f32_16x16x32_bf16 a[188:191], v[156:159], v[84:87], a[188:191]
  s_add_u32 m0, m0, 0x1000
  s_nop 0
  buffer_load_dwordx4 v12, s[16:19], s52 offen offset:0  lds
  v_mfma_f32_16x16x32_bf16 a[192:195], v[128:131], v[88:91], a[192:195]
  v_mfma_f32_16x16x32_bf16 a[196:199], v[132:135], v[88:91], a[196:199]
  v_mfma_f32_16x16x32_bf16 a[200:203], v[136:139], v[88:91], a[200:203]
  v_mfma_f32_16x16x32_bf16 a[204:207], v[140:143], v[88:91], a[204:207]
  buffer_load_dwordx4 v13, s[16:19], s52 offen offset:1024  lds
  v_mfma_f32_16x16x32_bf16 a[208:211], v[144:147], v[88:91], a[208:211]
  v_mfma_f32_16x16x32_bf16 a[212:215], v[148:151], v[88:91], a[212:215]
  v_mfma_f32_16x16x32_bf16 a[216:219], v[152:155], v[88:91], a[216:219]
  v_mfma_f32_16x16x32_bf16 a[220:223], v[156:159], v[88:91], a[220:223]
  buffer_load_dwordx4 v14, s[16:19], s52 offen offset:2048  lds
  v_mfma_f32_16x16x32_bf16 a[224:227], v[128:131], v[92:95], a[224:227]
  v_mfma_f32_16x16x32_bf16 a[228:231], v[132:135], v[92:95], a[228:231]
  v_mfma_f32_16x16x32_bf16 a[232:235], v[136:139], v[92:95], a[232:235]
  v_mfma_f32_16x16x32_bf16 a[236:239], v[140:143], v[92:95], a[236:239]
  buffer_load_dwordx4 v15, s[16:19], s52 offen offset:3072  lds
  v_mfma_f32_16x16x32_bf16 a[240:243], v[144:147], v[92:95], a[240:243]
  v_mfma_f32_16x16x32_bf16 a[244:247], v[148:151], v[92:95], a[244:247]
  v_mfma_f32_16x16x32_bf16 a[248:251], v[152:155], v[92:95], a[248:251]
  v_mfma_f32_16x16x32_bf16 a[252:255], v[156:159], v[92:95], a[252:255]
  s_add_u32 m0, s82, s101
  s_nop 0
  buffer_load_dwordx4 v16, s[20:23], s53 offen offset:0  lds
  s_waitcnt lgkmcnt(0)
  v_mfma_f32_16x16x32_bf16 a[0:3], v[160:163], v[96:99], a[0:3]
  ds_read_b128 v[64:67], v24 offset:0
  v_mfma_f32_16x16x32_bf16 a[4:7], v[164:167], v[96:99], a[4:7]
  ds_read_b64_tr_b16 v[128:129], v26 offset:0
  v_mfma_f32_16x16x32_bf16 a[8:11], v[168:171], v[96:99], a[8:11]
  ds_read_b64_tr_b16 v[130:131], v26 offset:2048
  v_mfma_f32_16x16x32_bf16 a[12:15], v[172:175], v[96:99], a[12:15]
  ds_read_b64_tr_b16 v[132:133], v27 offset:0
  buffer_load_dwordx4 v17, s[20:23], s53 offen offset:1024  lds
  v_mfma_f32_16x16x32_bf16 a[16:19], v[176:179], v[96:99], a[16:19]
  ds_read_b64_tr_b16 v[134:135], v27 offset:2048
  v_mfma_f32_16x16x32_bf16 a[20:23], v[180:183], v[96:99], a[20:23]
  ds_read_b64_tr_b16 v[136:137], v28 offset:0
  v_mfma_f32_16x16x32_bf16 a[24:27], v[184:187], v[96:99], a[24:27]
  ds_read_b64_tr_b16 v[138:139], v28 offset:2048
  v_mfma_f32_16x16x32_bf16 a[28:31], v[188:191], v[96:99], a[28:31]
  ds_read_b64_tr_b16 v[140:141], v29 offset:0
  buffer_load_dwordx4 v18, s[20:23], s53 offen offset:2048  lds
  v_mfma_f32_16x16x32_bf16 a[32:35], v[160:163], v[100:103], a[32:35]
  ds_read_b64_tr_b16 v[142:143], v29 offset:2048
  v_mfma_f32_16x16x32_bf16 a[36:39], v[164:167], v[100:103], a[36:39]
  ds_read_b64_tr_b16 v[144:145], v30 offset:0
  v_mfma_f32_16x16x32_bf16 a[40:43], v[168:171], v[100:103], a[40:43]
  ds_read_b64_tr_b16 v[146:147], v30 offset:2048
  v_mfma_f32_16x16x32_bf16 a[44:47], v[172:175], v[100:103], a[44:47]
  ds_read_b64_tr_b16 v[148:149], v31 offset:0
  buffer_load_dwordx4 v19, s[20:23], s53 offen offset:3072  lds
  v_mfma_f32_16x16x32_bf16 a[48:51], v[176:179], v[100:103], a[48:51]
  ds_read_b64_tr_b16 v[150:151], v31 offset:2048
  v_mfma_f32_16x16x32_bf16 a[52:55], v[180:183], v[100:103], a[52:55]
  ds_read_b64_tr_b16 v[152:153], v32 offset:0
  v_mfma_f32_16x16x32_bf16 a[56:59], v[184:187], v[100:103], a[56:59]
  ds_read_b64_tr_b16 v[154:155], v32 offset:2048
  v_mfma_f32_16x16x32_bf16 a[60:63], v[188:191], v[100:103], a[60:63]
  ds_read_b64_tr_b16 v[156:157], v33 offset:0
  s_add_u32 m0, m0, 0x1000
  s_nop 0
  buffer_load_dwordx4 v20, s[20:23], s53 offen offset:0  lds
  v_mfma_f32_16x16x32_bf16 a[64:67], v[160:163], v[104:107], a[64:67]
  ds_read_b64_tr_b16 v[158:159], v33 offset:2048
  v_mfma_f32_16x16x32_bf16 a[68:71], v[164:167], v[104:107], a[68:71]
  ds_read_b128 v[68:71], v24 offset:2048
  v_mfma_f32_16x16x32_bf16 a[72:75], v[168:171], v[104:107], a[72:75]
  ds_read_b128 v[72:75], v24 offset:4096
  v_mfma_f32_16x16x32_bf16 a[76:79], v[172:175], v[104:107], a[76:79]
  ds_read_b128 v[76:79], v24 offset:6144
  buffer_load_dwordx4 v21, s[20:23], s53 offen offset:1024  lds
  v_mfma_f32_16x16x32_bf16 a[80:83], v[176:179], v[104:107], a[80:83]
  ds_read_b128 v[80:83], v24 offset:8192
  v_mfma_f32_16x16x32_bf16 a[84:87], v[180:183], v[104:107], a[84:87]
  ds_read_b128 v[84:87], v24 offset:10240
  v_mfma_f32_16x16x32_bf16 a[88:91], v[184:187], v[104:107], a[88:91]
  ds_read_b128 v[88:91], v24 offset:12288
  v_mfma_f32_16x16x32_bf16 a[92:95], v[188:191], v[104:107], a[92:95]
  ds_read_b128 v[92:95], v24 offset:14336
  buffer_load_dwordx4 v22, s[20:23], s53 offen offset:2048  lds
  v_mfma_f32_16x16x32_bf16 a[96:99], v[160:163], v[108:111], a[96:99]
  v_mfma_f32_16x16x32_bf16 a[100:103], v[164:167], v[108:111], a[100:103]
  v_mfma_f32_16x16x32_bf16 a[104:107], v[168:171], v[108:111], a[104:107]
  v_mfma_f32_16x16x32_bf16 a[108:111], v[172:175], v[108:111], a[108:111]
  buffer_load_dwordx4 v23, s[20:23], s53 offen offset:3072  lds
  v_mfma_f32_16x16x32_bf16 a[112:115], v[176:179], v[108:111], a[112:115]
  s_add_u32 s52, s52, s33
  s_add_u32 s53, s53, s54
  v_mfma_f32_16x16x32_bf16 a[116:119], v[180:183], v[108:111], a[116:119]
  s_add_u32 s82, s82, 0x10000
  s_and_b32 s82, s82, 0x1ffff
  v_mfma_f32_16x16x32_bf16 a[120:123], v[184:187], v[108:111], a[120:123]
  v_mfma_f32_16x16x32_bf16 a[124:127], v[188:191], v[108:111], a[124:127]
  s_cmp_eq_u32 s55, 5
  s_cselect_b32 s94, s56, s94
  v_mfma_f32_16x16x32_bf16 a[128:131], v[160:163], v[112:115], a[128:131]
  buffer_load_dword v36, v34, s[96:99], s94 offen
  s_add_u32 s94, s94, s95
  v_mfma_f32_16x16x32_bf16 a[132:135], v[164:167], v[112:115], a[132:135]
  v_mfma_f32_16x16x32_bf16 a[136:139], v[168:171], v[112:115], a[136:139]
  v_mfma_f32_16x16x32_bf16 a[140:143], v[172:175], v[112:115], a[140:143]
  v_mfma_f32_16x16x32_bf16 a[144:147], v[176:179], v[112:115], a[144:147]
  v_mfma_f32_16x16x32_bf16 a[148:151], v[180:183], v[112:115], a[148:151]
  v_mfma_f32_16x16x32_bf16 a[152:155], v[184:187], v[112:115], a[152:155]
  v_mfma_f32_16x16x32_bf16 a[156:159], v[188:191], v[112:115], a[156:159]
  v_mfma_f32_16x16x32_bf16 a[160:163], v[160:163], v[116:119], a[160:163]
  v_mfma_f32_16x16x32_bf16 a[164:167], v[164:167], v[116:119], a[164:167]
  v_mfma_f32_16x16x32_bf16 a[168:171], v[168:171], v[116:119], a[168:171]
  v_mfma_f32_16x16x32_bf16 a[172:175], v[172:175], v[116:119], a[172:175]
  v_mfma_f32_16x16x32_bf16 a[176:179], v[176:179], v[116:119], a[176:179]
  v_mfma_f32_16x16x32_bf16 a[180:183], v[180:183], v[116:119], a[180:183]
  v_mfma_f32_16x16x32_bf16 a[184:187], v[184:187], v[116:119], a[184:187]
  v_mfma_f32_16x16x32_bf16 a[188:191], v[188:191], v[116:119], a[188:191]
  v_mfma_f32_16x16x32_bf16 a[192:195], v[160:163], v[120:123], a[192:195]
  v_mfma_f32_16x16x32_bf16 a[196:199], v[164:167], v[120:123], a[196:199]
  v_mfma_f32_16x16x32_bf16 a[200:203], v[168:171], v[120:123], a[200:203]
  v_mfma_f32_16x16x32_bf16 a[204:207], v[172:175], v[120:123], a[204:207]
  v_mfma_f32_16x16x32_bf16 a[208:211], v[176:179], v[120:123], a[208:211]
  v_mfma_f32_16x16x32_bf16 a[212:215], v[180:183], v[120:123], a[212:215]
  v_mfma_f32_16x16x32_bf16 a[216:219], v[184:187], v[120:123], a[216:219]
  v_mfma_f32_16x16x32_bf16 a[220:223], v[188:191], v[120:123], a[220:223]
  v_mfma_f32_16x16x32_bf16 a[224:227], v[160:163], v[124:127], a[224:227]
  v_mfma_f32_16x16x32_bf16 a[228:231], v[164:167], v[124:127], a[228:231]
  v_mfma_f32_16x16x32_bf16 a[232:235], v[168:171], v[124:127], a[232:235]
  v_mfma_f32_16x16x32_bf16 a[236:239], v[172:175], v[124:127], a[236:239]
  v_mfma_f32_16x16x32_bf16 a[240:243], v[176:179], v[124:127], a[240:243]
  v_mfma_f32_16x16x32_bf16 a[244:247], v[180:183], v[124:127], a[244:247]
  v_mfma_f32_16x16x32_bf16 a[248:251], v[184:187], v[124:127], a[248:251]
  v_mfma_f32_16x16x32_bf16 a[252:255], v[188:191], v[124:127], a[252:255]
  s_sub_u32 s55, s55, 1
  s_cmp_lg_u32 s55, 0
  s_cbranch_scc1 gl_175
  s_add_u32 s36, s89, 2
  s_mov_b32 s32, s36
  s_mov_b32 s31, s92
  s_mov_b32 s50, s34
  s_mov_b32 s51, s34
  s_waitcnt vmcnt(0)
  s_mov_b32 s3, 6
  s_branch W_epi
W_bv:
  s_mov_b32 s55, s83
  s_waitcnt lgkmcnt(0)
  v_mfma_f32_16x16x32_bf16 a[0:3], v[64:67], v[128:131], 0
  ds_read_b128 v[96:99], v25 offset:0
  v_mfma_f32_16x16x32_bf16 a[4:7], v[64:67], v[132:135], 0
  ds_read_b64_tr_b16 v[160:161], v26 offset:16384
  v_mfma_f32_16x16x32_bf16 a[8:11], v[64:67], v[136:139], 0
  ds_read_b64_tr_b16 v[162:163], v26 offset:18432
  v_mfma_f32_16x16x32_bf16 a[12:15], v[64:67], v[140:143], 0
  ds_read_b64_tr_b16 v[164:165], v27 offset:16384
  v_mfma_f32_16x16x32_bf16 a[16:19], v[64:67], v[144:147], 0
  ds_read_b64_tr_b16 v[166:167], v27 offset:18432
  v_mfma_f32_16x16x32_bf16 a[20:23], v[64:67], v[148:151], 0
  ds_read_b64_tr_b16 v[168:169], v28 offset:16384
  v_mfma_f32_16x16x32_bf16 a[24:27], v[64:67], v[152:155], 0
  ds_read_b64_tr_b16 v[170:171], v28 offset:18432
  v_mfma_f32_16x16x32_bf16 a[28:31], v[64:67], v[156:159], 0
  ds_read_b64_tr_b16 v[172:173], v29 offset:16384
  v_mfma_f32_16x16x32_bf16 a[32:35], v[68:71], v[128:131], 0
  ds_read_b64_tr_b16 v[174:175], v29 offset:18432
  v_mfma_f32_16x16x32_bf16 a[36:39], v[68:71], v[132:135], 0
  ds_read_b64_tr_b16 v[176:177], v30 offset:16384
  v_mfma_f32_16x16x32_bf16 a[40:43], v[68:71], v[136:139], 0
  ds_read_b64_tr_b16 v[178:179], v30 offset:18432
  v_mfma_f32_16x16x32_bf16 a[44:47], v[68:71], v[140:143], 0
  ds_read_b64_tr_b16 v[180:181], v31 offset:16384
  v_mfma_f32_16x16x32_bf16 a[48:51], v[68:71], v[144:147], 0
  ds_read_b64_tr_b16 v[182:183], v31 offset:18432
  v_mfma_f32_16x16x32_bf16 a[52:55], v[68:71], v[148:151], 0
  ds_read_b64_tr_b16 v[184:185], v32 offset:16384
  v_mfma_f32_16x16x32_bf16 a[56:59], v[68:71], v[152:155], 0
  ds_read_b64_tr_b16 v[186:187], v32 offset:18432
  v_mfma_f32_16x16x32_bf16 a[60:63], v[68:71], v[156:159], 0
  ds_read_b64_tr_b16 v[188:189], v33 offset:16384
  v_mfma_f32_16x16x32_bf16 a[64:67], v[72:75], v[128:131], 0
  ds_read_b64_tr_b16 v[190:191], v33 offset:18432
  v_mfma_f32_16x16x32_bf16 a[68:71], v[72:75], v[132:135], 0
  ds_read_b128 v[100:103], v25 offset:2048
  v_mfma_f32_16x16x32_bf16 a[72:75], v[72:75], v[136:139], 0
  ds_read_b128 v[104:107], v25 offset:4096
  v_mfma_f32_16x16x32_bf16 a[76:79], v[72:75], v[140:143], 0
  ds_read_b128 v[108:111], v25 offset:6144
  v_mfma_f32_16x16x32_bf16 a[80:83], v[72:75], v[144:147], 0
  ds_read_b128 v[112:115], v25 offset:8192
  v_mfma_f32_16x16x32_bf16 a[84:87], v[72:75], v[148:151], 0
  ds_read_b128 v[116:119], v25 offset:10240
  v_mfma_f32_16x16x32_bf16 a[88:91], v[72:75], v[152:155], 0
  ds_read_b128 v[120:123], v25 offset:12288
  v_mfma_f32_16x16x32_bf16 a[92:95], v[72:75], v[156:159], 0
  ds_read_b128 v[124:127], v25 offset:14336
  v_mfma_f32_16x16x32_bf16 a[96:99], v[76:79], v[128:131], 0
  v_xor_b32 v24, 0x10000, v24
  v_mfma_f32_16x16x32_bf16 a[100:103], v[76:79], v[132:135], 0
  v_xor_b32 v25, 0x10000, v25
  v_mfma_f32_16x16x32_bf16 a[104:107], v[76:79], v[136:139], 0
  v_xor_b32 v26, 0x10000, v26
  v_mfma_f32_16x16x32_bf16 a[108:111], v[76:79], v[140:143], 0
  v_xor_b32 v27, 0x10000, v27
  v_mfma_f32_16x16x32_bf16 a[112:115], v[76:79], v[144:147], 0
  v_xor_b32 v28, 0x10000, v28
  v_mfma_f32_16x16x32_bf16 a[116:119], v[76:79], v[148:151], 0
  v_xor_b32 v29, 0x10000, v29
  s_cmp_eq_u32 s55, 2
  s_cselect_b32 s52, s56, s52
  s_cselect_b32 s53, s57, s53
  v_mfma_f32_16x16x32_bf16 a[120:123], v[76:79], v[152:155], 0
  v_xor_b32 v30, 0x10000, v30
  s_cmp_eq_u32 s49, 255
  s_cbranch_scc1 pb_182
  s_waitcnt vmcnt(0)
pb_182:
  s_waitcnt vmcnt(1) lgkmcnt(0)
  s_barrier
  s_cmp_lg_u32 s49, 255
  s_cbranch_scc1 sg_183
sb_184:
  v_mfma_f32_16x16x32_bf16 a[124:127], v[76:79], v[156:159], 0
  v_xor_b32 v31, 0x10000, v31
  s_add_u32 m0, s82, s100
  s_nop 0
  buffer_load_dwordx4 v8, s[16:19], s52 offen offset:0  lds
  v_mfma_f32_16x16x32_bf16 a[128:131], v[80:83], v[128:131], 0
  v_xor_b32 v32, 0x10000, v32
  v_mfma_f32_16x16x32_bf16 a[132:135], v[80:83], v[132:135], 0
  v_xor_b32 v33, 0x10000, v33
  v_mfma_f32_16x16x32_bf16 a[136:139], v[80:83], v[136:139], 0
  v_mfma_f32_16x16x32_bf16 a[140:143], v[80:83], v[140:143], 0
  buffer_load_dwordx4 v9, s[16:19], s52 offen offset:1024  lds
  v_mfma_f32_16x16x32_bf16 a[144:147], v[80:83], v[144:147], 0
  v_mfma_f32_16x16x32_bf16 a[148:151], v[80:83], v[148:151], 0
  v_mfma_f32_16x16x32_bf16 a[152:155], v[80:83], v[152:155], 0
  v_mfma_f32_16x16x32_bf16 a[156:159], v[80:83], v[156:159], 0
  buffer_load_dwordx4 v10, s[16:19], s52 offen offset:2048  lds
  v_mfma_f32_16x16x32_bf16 a[160:163], v[84:87], v[128:131], 0
  v_mfma_f32_16x16x32_bf16 a[164:167], v[84:87], v[132:135], 0
  v_mfma_f32_16x16x32_bf16 a[168:171], v[84:87], v[136:139], 0
  v_mfma_f32_16x16x32_bf16 a[172:175], v[84:87], v[140:143], 0
  buffer_load_dwordx4 v11, s[16:19], s52 offen offset:3072  lds
  v_mfma_f32_16x16x32_bf16 a[176:179], v[84:87], v[144:147], 0
  v_mfma_f32_16x16x32_bf16 a[180:183], v[84:87], v[148:151], 0
  v_mfma_f32_16x16x32_bf16 a[184:187], v[84:87], v[152:155], 0
  v_mfma_f32_16x16x32_bf16 a[188:191], v[84:87], v[156:159], 0
  s_add_u32 m0, m0, 0x1000
  s_nop 0
  buffer_load_dwordx4 v12, s[16:19], s52 offen offset:0  lds
  v_mfma_f32_16x16x32_bf16 a[192:195], v[88:91], v[128:131], 0
  v_mfma_f32_16x16x32_bf16 a[196:199], v[88:91], v[132:135], 0
  v_mfma_f32_16x16x32_bf16 a[200:203], v[88:91], v[136:139], 0
  v_mfma_f32_16x16x32_bf16 a[204:207], v[88:91], v[140:143], 0
  buffer_load_dwordx4 v13, s[16:19], s52 offen offset:1024  lds
  v_mfma_f32_16x16x32_bf16 a[208:211], v[88:91], v[144:147], 0
  v_mfma_f32_16x16x32_bf16 a[212:215], v[88:91], v[148:151], 0
  v_mfma_f32_16x16x32_bf16 a[216:219], v[88:91], v[152:155], 0
  v_mfma_f32_16x16x32_bf16 a[220:223], v[88:91], v[156:159], 0
  buffer_load_dwordx4 v14, s[16:19], s52 offen offset:2048  lds
  v_mfma_f32_16x16x32_bf16 a[224:227], v[92:95], v[128:131], 0
  v_mfma_f32_16x16x32_bf16 a[228:231], v[92:95], v[132:135], 0
  v_mfma_f32_16x16x32_bf16 a[232:235], v[92:95], v[136:139], 0
  v_mfma_f32_16x16x32_bf16 a[236:239], v[92:95], v[140:143], 0
  buffer_load_dwordx4 v15, s[16:19], s52 offen offset:3072  lds
  v_mfma_f32_16x16x32_bf16 a[240:243], v[92:95], v[144:147], 0
  v_mfma_f32_16x16x32_bf16 a[244:247], v[92:95], v[148:151], 0
  v_mfma_f32_16x16x32_bf16 a[248:251], v[92:95], v[152:155], 0
  v_mfma_f32_16x16x32_bf16 a[252:255], v[92:95], v[156:159], 0
  s_add_u32 m0, s82, s101
  s_nop 0
  buffer_load_dwordx4 v16, s[20:23], s53 offen offset:0  lds
  s_waitcnt lgkmcnt(0)
  v_mfma_f32_16x16x32_bf16 a[0:3], v[96:99], v[160:163], a[0:3]
  ds_read_b128 v[64:67], v24 offset:0
  v_mfma_f32_16x16x32_bf16 a[4:7], v[96:99], v[164:167], a[4:7]
  ds_read_b64_tr_b16 v[128:129], v26 offset:0
  v_mfma_f32_16x16x32_bf16 a[8:11], v[96:99], v[168:171], a[8:11]
  ds_read_b64_tr_b16 v[130:131], v26 offset:2048
  v_mfma_f32_16x16x32_bf16 a[12:15], v[96:99], v[172:175], a[12:15]
  ds_read_b64_tr_b16 v[132:133], v27 offset:0
  buffer_load_dwordx4 v17, s[20:23], s53 offen offset:1024  lds
  v_mfma_f32_16x16x32_bf16 a[16:19], v[96:99], v[176:179], a[16:19]
  ds_read_b64_tr_b16 v[134:135], v27 offset:2048
  v_mfma_f32_16x16x32_bf16 a[20:23], v[96:99], v[180:183], a[20:23]
  ds_read_b64_tr_b16 v[136:137], v28 offset:0
  v_mfma_f32_16x16x32_bf16 a[24:27], v[96:99], v[184:187], a[24:27]
  ds_read_b64_tr_b16 v[138:139], v28 offset:2048
  v_mfma_f32_16x16x32_bf16 a[28:31], v[96:99], v[188:191], a[28:31]
  ds_read_b64_tr_b16 v[140:141], v29 offset:0
  buffer_load_dwordx4 v18, s[20:23], s53 offen offset:2048  lds
  v_mfma_f32_16x16x32_bf16 a[32:35], v[100:103], v[160:163], a[32:35]
  ds_read_b64_tr_b16 v[142:143], v29 offset:2048
  v_mfma_f32_16x16x32_bf16 a[36:39], v[100:103], v[164:167], a[36:39]
  ds_read_b64_tr_b16 v[144:145], v30 offset:0
  v_mfma_f32_16x16x32_bf16 a[40:43], v[100:103], v[168:171], a[40:43]
  ds_read_b64_tr_b16 v[146:147], v30 offset:2048
  v_mfma_f32_16x16x32_bf16 a[44:47], v[100:103], v[172:175], a[44:47]
  ds_read_b64_tr_b16 v[148:149], v31 offset:0
  buffer_load_dwordx4 v19, s[20:23], s53 offen offset:3072  lds
  v_mfma_f32_16x16x32_bf16 a[48:51], v[100:103], v[176:179], a[48:51]
  ds_read_b64_tr_b16 v[150:151], v31 offset:2048
  v_mfma_f32_16x16x32_bf16 a[52:55], v[100:103], v[180:183], a[52:55]
  ds_read_b64_tr_b16 v[152:153], v32 offset:0
  v_mfma_f32_16x16x32_bf16 a[56:59], v[100:103], v[184:187], a[56:59]
  ds_read_b64_tr_b16 v[154:155], v32 offset:2048
  v_mfma_f32_16x16x32_bf16 a[60:63], v[100:103], v[188:191], a[60:63]
  ds_read_b64_tr_b16 v[156:157], v33 offset:0
  s_add_u32 m0, m0, 0x1000
  s_nop 0
  buffer_load_dwordx4 v20, s[20:23], s53 offen offset:0  lds
  v_mfma_f32_16x16x32_bf16 a[64:67], v[104:107], v[160:163], a[64:67]
  ds_read_b64_tr_b16 v[158:159], v33 offset:2048
  v_mfma_f32_16x16x32_bf16 a[68:71], v[104:107], v[164:167], a[68:71]
  ds_read_b128 v[68:71], v24 offset:2048
  v_mfma_f32_16x16x32_bf16 a[72:75], v[104:107], v[168:171], a[72:75]
  ds_read_b128 v[72:75], v24 offset:4096
  v_mfma_f32_16x16x32_bf16 a[76:79], v[104:107], v[172:175], a[76:79]
  ds_read_b128 v[76:79], v24 offset:6144
  buffer_load_dwordx4 v21, s[20:23], s53 offen offset:1024  lds
  v_mfma_f32_16x16x32_bf16 a[80:83], v[104:107], v[176:179], a[80:83]
  ds_read_b128 v[80:83], v24 offset:8192
  v_mfma_f32_16x16x32_bf16 a[84:87], v[104:107], v[180:183], a[84:87]
  ds_read_b128 v[84:87], v24 offset:10240
  v_mfma_f32_16x16x32_bf16 a[88:91], v[104:107], v[184:187], a[88:91]
  ds_read_b128 v[88:91], v24 offset:12288
  v_mfma_f32_16x16x32_bf16 a[92:95], v[104:107], v[188:191], a[92:95]
  ds_read_b128 v[92:95], v24 offset:14336
  buffer_load_dwordx4 v22, s[20:23], s53 offen offset:2048  lds
  v_mfma_f32_16x16x32_bf16 a[96:99], v[108:111], v[160:163], a[96:99]
  v_mfma_f32_16x16x32_bf16 a[100:103], v[108:111], v[164:167], a[100:103]
  v_mfma_f32_16x16x32_bf16 a[104:107], v[108:111], v[168:171], a[104:107]
  v_mfma_f32_16x16x32_bf16 a[108:111], v[108:111], v[172:175], a[108:111]
  buffer_load_dwordx4 v23, s[20:23], s53 offen offset:3072  lds
  v_mfma_f32_16x16x32_bf16 a[112:115], v[108:111], v[176:179], a[112:115]
  s_add_u32 s52, s52, s33
  s_add_u32 s53, s53, s54
  v_mfma_f32_16x16x32_bf16 a[116:119], v[108:111], v[180:183], a[116:119]
  s_add_u32 s82, s82, 0x10000
  s_and_b32 s82, s82, 0x1ffff
  v_mfma_f32_16x16x32_bf16 a[120:123], v[108:111], v[184:187], a[120:123]
  v_mfma_f32_16x16x32_bf16 a[124:127], v[108:111], v[188:191], a[124:127]
  s_cmp_eq_u32 s55, 5
  s_cselect_b32 s94, s56, s94
  v_mfma_f32_16x16x32_bf16 a[128:131], v[112:115], v[160:163], a[128:131]
  buffer_load_dword v36, v34, s[96:99], s94 offen
  s_add_u32 s94, s94, s95
  v_mfma_f32_16x16x32_bf16 a[132:135], v[112:115], v[164:167], a[132:135]
  v_mfma_f32_16x16x32_bf16 a[136:139], v[112:115], v[168:171], a[136:139]
  v_mfma_f32_16x16x32_bf16 a[140:143], v[112:115], v[172:175], a[140:143]
  v_mfma_f32_16x16x32_bf16 a[144:147], v[112:115], v[176:179], a[144:147]
  v_mfma_f32_16x16x32_bf16 a[148:151], v[112:115], v[180:183], a[148:151]
  v_mfma_f32_16x16x32_bf16 a[152:155], v[112:115], v[184:187], a[152:155]
  v_mfma_f32_16x16x32_bf16 a[156:159], v[112:115], v[188:191], a[156:159]
  v_mfma_f32_16x16x32_bf16 a[160:163], v[116:119], v[160:163], a[160:163]
  v_mfma_f32_16x16x32_bf16 a[164:167], v[116:119], v[164:167], a[164:167]
  v_mfma_f32_16x16x32_bf16 a[168:171], v[116:119], v[168:171], a[168:171]
  v_mfma_f32_16x16x32_bf16 a[172:175], v[116:119], v[172:175], a[172:175]
  v_mfma_f32_16x16x32_bf16 a[176:179], v[116:119], v[176:179], a[176:179]
  v_mfma_f32_16x16x32_bf16 a[180:183], v[116:119], v[180:183], a[180:183]
  v_mfma_f32_16x16x32_bf16 a[184:187], v[116:119], v[184:187], a[184:187]
  v_mfma_f32_16x16x32_bf16 a[188:191], v[116:119], v[188:191], a[188:191]
  v_mfma_f32_16x16x32_bf16 a[192:195], v[120:123], v[160:163], a[192:195]
  v_mfma_f32_16x16x32_bf16 a[196:199], v[120:123], v[164:167], a[196:199]
  v_mfma_f32_16x16x32_bf16 a[200:203], v[120:123], v[168:171], a[200:203]
  v_mfma_f32_16x16x32_bf16 a[204:207], v[120:123], v[172:175], a[204:207]
  v_mfma_f32_16x16x32_bf16 a[208:211], v[120:123], v[176:179], a[208:211]
  v_mfma_f32_16x16x32_bf16 a[212:215], v[120:123], v[180:183], a[212:215]
  v_mfma_f32_16x16x32_bf16 a[216:219], v[120:123], v[184:187], a[216:219]
  v_mfma_f32_16x16x32_bf16 a[220:223], v[120:123], v[188:191], a[220:223]
  v_mfma_f32_16x16x32_bf16 a[224:227], v[124:127], v[160:163], a[224:227]
  v_mfma_f32_16x16x32_bf16 a[228:231], v[124:127], v[164:167], a[228:231]
  v_mfma_f32_16x16x32_bf16 a[232:235], v[124:127], v[168:171], a[232:235]
  v_mfma_f32_16x16x32_bf16 a[236:239], v[124:127], v[172:175], a[236:239]
  v_mfma_f32_16x16x32_bf16 a[240:243], v[124:127], v[176:179], a[240:243]
  v_mfma_f32_16x16x32_bf16 a[244:247], v[124:127], v[180:183], a[244:247]
  v_mfma_f32_16x16x32_bf16 a[248:251], v[124:127], v[184:187], a[248:251]
  v_mfma_f32_16x16x32_bf16 a[252:255], v[124:127], v[188:191], a[252:255]
  s_sub_u32 s55, s55, 1
gl_181:
  s_waitcnt lgkmcnt(0)
  v_mfma_f32_16x16x32_bf16 a[0:3], v[64:67], v[128:131], a[0:3]
  ds_read_b128 v[96:99], v25 offset:0
  v_mfma_f32_16x16x32_bf16 a[4:7], v[64:67], v[132:135], a[4:7]
  ds_read_b64_tr_b16 v[160:161], v26 offset:16384
  v_mfma_f32_16x16x32_bf16 a[8:11], v[64:67], v[136:139], a[8:11]
  ds_read_b64_tr_b16 v[162:163], v26 offset:18432
  v_mfma_f32_16x16x32_bf16 a[12:15], v[64:67], v[140:143], a[12:15]
  ds_read_b64_tr_b16 v[164:165], v27 offset:16384
  v_mfma_f32_16x16x32_bf16 a[16:19], v[64:67], v[144:147], a[16:19]
  ds_read_b64_tr_b16 v[166:167], v27 offset:18432
  v_mfma_f32_16x16x32_bf16 a[20:23], v[64:67], v[148:151], a[20:23]
  ds_read_b64_tr_b16 v[168:169], v28 offset:16384
  v_mfma_f32_16x16x32_bf16 a[24:27], v[64:67], v[152:155], a[24:27]
  ds_read_b64_tr_b16 v[170:171], v28 offset:18432
  v_mfma_f32_16x16x32_bf16 a[28:31], v[64:67], v[156:159], a[28:31]
  ds_read_b64_tr_b16 v[172:173], v29 offset:16384
  v_mfma_f32_16x16x32_bf16 a[32:35], v[68:71], v[128:131], a[32:35]
  ds_read_b64_tr_b16 v[174:175], v29 offset:18432
  v_mfma_f32_16x16x32_bf16 a[36:39], v[68:71], v[132:135], a[36:39]
  ds_read_b64_tr_b16 v[176:177], v30 offset:16384
  v_mfma_f32_16x16x32_bf16 a[40:43], v[68:71], v[136:139], a[40:43]
  ds_read_b64_tr_b16 v[178:179], v30 offset:18432
  v_mfma_f32_16x16x32_bf16 a[44:47], v[68:71], v[140:143], a[44:47]
  ds_read_b64_tr_b16 v[180:181], v31 offset:16384
  v_mfma_f32_16x16x32_bf16 a[48:51], v[68:71], v[144:147], a[48:51]
  ds_read_b64_tr_b16 v[182:183], v31 offset:18432
  v_mfma_f32_16x16x32_bf16 a[52:55], v[68:71], v[148:151], a[52:55]
  ds_read_b64_tr_b16 v[184:185], v32 offset:16384
  v_mfma_f32_16x16x32_bf16 a[56:59], v[68:71], v[152:155], a[56:59]
  ds_read_b64_tr_b16 v[186:187], v32 offset:18432
  v_mfma_f32_16x16x32_bf16 a[60:63], v[68:71], v[156:159], a[60:63]
  ds_read_b64_tr_b16 v[188:189], v33 offset:16384
  v_mfma_f32_16x16x32_bf16 a[64:67], v[72:75], v[128:131], a[64:67]
  ds_read_b64_tr_b16 v[190:191], v33 offset:18432
  v_mfma_f32_16x16x32_bf16 a[68:71], v[72:75], v[132:135], a[68:71]
  ds_read_b128 v[100:103], v25 offset:2048
  v_mfma_f32_16x16x32_bf16 a[72:75], v[72:75], v[136:139], a[72:75]
  ds_read_b128 v[104:107], v25 offset:4096
  v_mfma_f32_16x16x32_bf16 a[76:79], v[72:75], v[140:143], a[76:79]
  ds_read_b128 v[108:111], v25 offset:6144
  v_mfma_f32_16x16x32_bf16 a[80:83], v[72:75], v[144:147], a[80:83]
  ds_read_b128 v[112:115], v25 offset:8192
  v_mfma_f32_16x16x32_bf16 a[84:87], v[72:75], v[148:151], a[84:87]
  ds_read_b128 v[116:119], v25 offset:10240
  v_mfma_f32_16x16x32_bf16 a[88:91], v[72:75], v[152:155], a[88:91]
  ds_read_b128 v[120:123], v25 offset:12288
  v_mfma_f32_16x16x32_bf16 a[92:95], v[72:75], v[156:159], a[92:95]
  ds_read_b128 v[124:127], v25 offset:14336
  v_mfma_f32_16x16x32_bf16 a[96:99], v[76:79], v[128:131], a[96:99]
  v_xor_b32 v24, 0x10000, v24
  v_mfma_f32_16x16x32_bf16 a[100:103], v[76:79], v[132:135], a[100:103]
  v_xor_b32 v25, 0x10000, v25
  v_mfma_f32_16x16x32_bf16 a[104:107], v[76:79], v[136:139], a[104:107]
  v_xor_b32 v26, 0x10000, v26
  v_mfma_f32_16x16x32_bf16 a[108:111], v[76:79], v[140:143], a[108:111]
  v_xor_b32 v27, 0x10000, v27
  s_cmp_eq_u32 s55, 2
  s_cbranch_scc1 tk_186
tb_185:
  v_mfma_f32_16x16x32_bf16 a[112:115], v[76:79], v[144:147], a[112:115]
  v_xor_b32 v28, 0x10000, v28
  v_mfma_f32_16x16x32_bf16 a[116:119], v[76:79], v[148:151], a[116:119]
  v_xor_b32 v29, 0x10000, v29
  s_cmp_eq_u32 s55, 2
  s_cselect_b32 s52, s56, s52
  s_cselect_b32 s53, s57, s53
  v_mfma_f32_16x16x32_bf16 a[120:123], v[76:79], v[152:155], a[120:123]
  v_xor_b32 v30, 0x10000, v30
  s_waitcnt vmcnt(1) lgkmcnt(0)
  s_barrier
  v_mfma_f32_16x16x32_bf16 a[124:127], v[76:79], v[156:159], a[124:127]
  v_xor_b32 v31, 0x10000, v31
  s_add_u32 m0, s82, s100
  s_nop 0
  buffer_load_dwordx4 v8, s[16:19], s52 offen offset:0  lds
  v_mfma_f32_16x16x32_bf16 a[128:131], v[80:83], v[128:131], a[128:131]
  v_xor_b32 v32, 0x10000, v32
  v_mfma_f32_16x16x32_bf16 a[132:135], v[80:83], v[132:135], a[132:135]
  v_xor_b32 v33, 0x10000, v33
  v_mfma_f32_16x16x32_bf16 a[136:139], v[80:83], v[136:139], a[136:139]
  v_mfma_f32_16x16x32_bf16 a[140:143], v[80:83], v[140:143], a[140:143]
  buffer_load_dwordx4 v9, s[16:19], s52 offen offset:1024  lds
  v_mfma_f32_16x16x32_bf16 a[144:147], v[80:83], v[144:147], a[144:147]
  v_mfma_f32_16x16x32_bf16 a[148:151], v[80:83], v[148:151], a[148:151]
  v_mfma_f32_16x16x32_bf16 a[152:155], v[80:83], v[152:155], a[152:155]
  v_mfma_f32_16x16x32_bf16 a[156:159], v[80:83], v[156:159], a[156:159]
  buffer_load_dwordx4 v10, s[16:19], s52 offen offset:2048  lds
  v_mfma_f32_16x16x32_bf16 a[160:163], v[84:87], v[128:131], a[160:163]
  v_mfma_f32_16x16x32_bf16 a[164:167], v[84:87], v[132:135], a[164:167]
  v_mfma_f32_16x16x32_bf16 a[168:171], v[84:87], v[136:139], a[168:171]
  v_mfma_f32_16x16x32_bf16 a[172:175], v[84:87], v[140:143], a[172:175]
  buffer_load_dwordx4 v11, s[16:19], s52 offen offset:3072  lds
  v_mfma_f32_16x16x32_bf16 a[176:179], v[84:87], v[144:147], a[176:179]
  v_mfma_f32_16x16x32_bf16 a[180:183], v[84:87], v[148:151], a[180:183]
  v_mfma_f32_16x16x32_bf16 a[184:187], v[84:87], v[152:155], a[184:187]
  v_mfma_f32_16x16x32_bf16 a[188:191], v[84:87], v[156:159], a[188:191]
  s_add_u32 m0, m0, 0x1000
  s_nop 0
  buffer_load_dwordx4 v12, s[16:19], s52 offen offset:0  lds
  v_mfma_f32_16x16x32_bf16 a[192:195], v[88:91], v[128:131], a[192:195]
  v_mfma_f32_16x16x32_bf16 a[196:199], v[88:91], v[132:135], a[196:199]
  v_mfma_f32_16x16x32_bf16 a[200:203], v[88:91], v[136:139], a[200:203]
  v_mfma_f32_16x16x32_bf16 a[204:207], v[88:91], v[140:143], a[204:207]
  buffer_load_dwordx4 v13, s[16:19], s52 offen offset:1024  lds
  v_mfma_f32_16x16x32_bf16 a[208:211], v[88:91], v[144:147], a[208:211]
  v_mfma_f32_16x16x32_bf16 a[212:215], v[88:91], v[148:151], a[212:215]
  v_mfma_f32_16x16x32_bf16 a[216:219], v[88:91], v[152:155], a[216:219]
  v_mfma_f32_16x16x32_bf16 a[220:223], v[88:91], v[156:159], a[220:223]
  buffer_load_dwordx4 v14, s[16:19], s52 offen offset:2048  lds
  v_mfma_f32_16x16x32_bf16 a[224:227], v[92:95], v[128:131], a[224:227]
  v_mfma_f32_16x16x32_bf16 a[228:231], v[92:95], v[132:135], a[228:231]
  v_mfma_f32_16x16x32_bf16 a[232:235], v[92:95], v[136:139], a[232:235]
  v_mfma_f32_16x16x32_bf16 a[236:239], v[92:95], v[140:143], a[236:239]
  buffer_load_dwordx4 v15, s[16:19], s52 offen offset:3072  lds
  v_mfma_f32_16x16x32_bf16 a[240:243], v[92:95], v[144:147], a[240:243]
  v_mfma_f32_16x16x32_bf16 a[244:247], v[92:95], v[148:151], a[244:247]
  v_mfma_f32_16x16x32_bf16 a[248:251], v[92:95], v[152:155], a[248:251]
  v_mfma_f32_16x16x32_bf16 a[252:255], v[92:95], v[156:159], a[252:255]
  s_add_u32 m0, s82, s101
  s_nop 0
  buffer_load_dwordx4 v16, s[20:23], s53 offen offset:0  lds
  s_waitcnt lgkmcnt(0)
  v_mfma_f32_16x16x32_bf16 a[0:3], v[96:99], v[160:163], a[0:3]
  ds_read_b128 v[64:67], v24 offset:0
  v_mfma_f32_16x16x32_bf16 a[4:7], v[96:99], v[164:167], a[4:7]
  ds_read_b64_tr_b16 v[128:129], v26 offset:0
  v_mfma_f32_16x16x32_bf16 a[8:11], v[96:99], v[168:171], a[8:11]
  ds_read_b64_tr_b16 v[130:131], v26 offset:2048
  v_mfma_f32_16x16x32_bf16 a[12:15], v[96:99], v[172:175], a[12:15]
  ds_read_b64_tr_b16 v[132:133], v27 offset:0
  buffer_load_dwordx4 v17, s[20:23], s53 offen offset:1024  lds
  v_mfma_f32_16x16x32_bf16 a[16:19], v[96:99], v[176:179], a[16:19]
  ds_read_b64_tr_b16 v[134:135], v27 offset:2048
  v_mfma_f32_16x16x32_bf16 a[20:23], v[96:99], v[180:183], a[20:23]
  ds_read_b64_tr_b16 v[136:137], v28 offset:0
  v_mfma_f32_16x16x32_bf16 a[24:27], v[96:99], v[184:187], a[24:27]
  ds_read_b64_tr_b16 v[138:139], v28 offset:2048
  v_mfma_f32_16x16x32_bf16 a[28:31], v[96:99], v[188:191], a[28:31]
  ds_read_b64_tr_b16 v[140:141], v29 offset:0
  buffer_load_dwordx4 v18, s[20:23], s53 offen offset:2048  lds
  v_mfma_f32_16x16x32_bf16 a[32:35], v[100:103], v[160:163], a[32:35]
  ds_read_b64_tr_b16 v[142:143], v29 offset:2048
  v_mfma_f32_16x16x32_bf16 a[36:39], v[100:103], v[164:167], a[36:39]
  ds_read_b64_tr_b16 v[144:145], v30 offset:0
  v_mfma_f32_16x16x32_bf16 a[40:43], v[100:103], v[168:171], a[40:43]
  ds_read_b64_tr_b16 v[146:147], v30 offset:2048
  v_mfma_f32_16x16x32_bf16 a[44:47], v[100:103], v[172:175], a[44:47]
  ds_read_b64_tr_b16 v[148:149], v31 offset:0
  buffer_load_dwordx4 v19, s[20:23], s53 offen offset:3072  lds
  v_mfma_f32_16x16x32_bf16 a[48:51], v[100:103], v[176:179], a[48:51]
  ds_read_b64_tr_b16 v[150:151], v31 offset:2048
  v_mfma_f32_16x16x32_bf16 a[52:55], v[100:103], v[180:183], a[52:55]
  ds_read_b64_tr_b16 v[152:153], v32 offset:0
  v_mfma_f32_16x16x32_bf16 a[56:59], v[100:103], v[184:187], a[56:59]
  ds_read_b64_tr_b16 v[154:155], v32 offset:2048
  v_mfma_f32_16x16x32_bf16 a[60:63], v[100:103], v[188:191], a[60:63]
  ds_read_b64_tr_b16 v[156:157], v33 offset:0
  s_add_u32 m0, m0, 0x1000
  s_nop 0
  buffer_load_dwordx4 v20, s[20:23], s53 offen offset:0  lds
  v_mfma_f32_16x16x32_bf16 a[64:67], v[104:107], v[160:163], a[64:67]
  ds_read_b64_tr_b16 v[158:159], v33 offset:2048
  v_mfma_f32_16x16x32_bf16 a[68:71], v[104:107], v[164:167], a[68:71]
  ds_read_b128 v[68:71], v24 offset:2048
  v_mfma_f32_16x16x32_bf16 a[72:75], v[104:107], v[168:171], a[72:75]
  ds_read_b128 v[72:75], v24 offset:4096
  v_mfma_f32_16x16x32_bf16 a[76:79], v[104:107], v[172:175], a[76:79]
  ds_read_b128 v[76:79], v24 offset:6144
  buffer_load_dwordx4 v21, s[20:23], s53 offen offset:1024  lds
  v_mfma_f32_16x16x32_bf16 a[80:83], v[104:107], v[176:179], a[80:83]
  ds_read_b128 v[80:83], v24 offset:8192
  v_mfma_f32_16x16x32_bf16 a[84:87], v[104:107], v[180:183], a[84:87]
  ds_read_b128 v[84:87], v24 offset:10240
  v_mfma_f32_16x16x32_bf16 a[88:91], v[104:107], v[184:187], a[88:91]
  ds_read_b128 v[88:91], v24 offset:12288
  v_mfma_f32_16x16x32_bf16 a[92:95], v[104:107], v[188:191], a[92:95]
  ds_read_b128 v[92:95], v24 offset:14336
  buffer_load_dwordx4 v22, s[20:23], s53 offen offset:2048  lds
  v_mfma_f32_16x16x32_bf16 a[96:99], v[108:111], v[160:163], a[96:99]
  v_mfma_f32_16x16x32_bf16 a[100:103], v[108:111], v[164:167], a[100:103]
  v_mfma_f32_16x16x32_bf16 a[104:107], v[108:111], v[168:171], a[104:107]
  v_mfma_f32_16x16x32_bf16 a[108:111], v[108:111], v[172:175], a[108:111]
  buffer_load_dwordx4 v23, s[20:23], s53 offen offset:3072  lds
  v_mfma_f32_16x16x32_bf16 a[112:115], v[108:111], v[176:179], a[112:115]
  s_add_u32 s52, s52, s33
  s_add_u32 s53, s53, s54
  v_mfma_f32_16x16x32_bf16 a[116:119], v[108:111], v[180:183], a[116:119]
  s_add_u32 s82, s82, 0x10000
  s_and_b32 s82, s82, 0x1ffff
  v_mfma_f32_16x16x32_bf16 a[120:123], v[108:111], v[184:187], a[120:123]
  v_mfma_f32_16x16x32_bf16 a[124:127], v[108:111], v[188:191], a[124:127]
  s_cmp_eq_u32 s55, 5
  s_cselect_b32 s94, s56, s94
  v_mfma_f32_16x16x32_bf16 a[128:131], v[112:115], v[160:163], a[128:131]
  buffer_load_dword v36, v34, s[96:99], s94 offen
  s_add_u32 s94, s94, s95
  v_mfma_f32_16x16x32_bf16 a[132:135], v[112:115], v[164:167], a[132:135]
  v_mfma_f32_16x16x32_bf16 a[136:139], v[112:115], v[168:171], a[136:139]
  v_mfma_f32_16x16x32_bf16 a[140:143], v[112:115], v[172:175], a[140:143]
  v_mfma_f32_16x16x32_bf16 a[144:147], v[112:115], v[176:179], a[144:147]
  v_mfma_f32_16x16x32_bf16 a[148:151], v[112:115], v[180:183], a[148:151]
  v_mfma_f32_16x16x32_bf16 a[152:155], v[112:115], v[184:187], a[152:155]
  v_mfma_f32_16x16x32_bf16 a[156:159], v[112:115], v[188:191], a[156:159]
  v_mfma_f32_16x16x32_bf16 a[160:163], v[116:119], v[160:163], a[160:163]
  v_mfma_f32_16x16x32_bf16 a[164:167], v[116:119], v[164:167], a[164:167]
  v_mfma_f32_16x16x32_bf16 a[168:171], v[116:119], v[168:171], a[168:171]
  v_mfma_f32_16x16x32_bf16 a[172:175], v[116:119], v[172:175], a[172:175]
  v_mfma_f32_16x16x32_bf16 a[176:179], v[116:119], v[176:179], a[176:179]
  v_mfma_f32_16x16x32_bf16 a[180:183], v[116:119], v[180:183], a[180:183]
  v_mfma_f32_16x16x32_bf16 a[184:187], v[116:119], v[184:187], a[184:187]
  v_mfma_f32_16x16x32_bf16 a[188:191], v[116:119], v[188:191], a[188:191]
  v_mfma_f32_16x16x32_bf16 a[192:195], v[120:123], v[160:163], a[192:195]
  v_mfma_f32_16x16x32_bf16 a[196:199], v[120:123], v[164:167], a[196:199]
  v_mfma_f32_16x16x32_bf16 a[200:203], v[120:123], v[168:171], a[200:203]
  v_mfma_f32_16x16x32_bf16 a[204:207], v[120:123], v[172:175], a[204:207]
  v_mfma_f32_16x16x32_bf16 a[208:211], v[120:123], v[176:179], a[208:211]
  v_mfma_f32_16x16x32_bf16 a[212:215], v[120:123], v[180:183], a[212:215]
  v_mfma_f32_16x16x32_bf16 a[216:219], v[120:123], v[184:187], a[216:219]
  v_mfma_f32_16x16x32_bf16 a[220:223], v[120:123], v[188:191], a[220:223]
  v_mfma_f32_16x16x32_bf16 a[224:227], v[124:127], v[160:163], a[224:227]
  v_mfma_f32_16x16x32_bf16 a[228:231], v[124:127], v[164:167], a[228:231]
  v_mfma_f32_16x16x32_bf16 a[232:235], v[124:127], v[168:171], a[232:235]
  v_mfma_f32_16x16x32_bf16 a[236:239], v[124:127], v[172:175], a[236:239]
  v_mfma_f32_16x16x32_bf16 a[240:243], v[124:127], v[176:179], a[240:243]
  v_mfma_f32_16x16x32_bf16 a[244:247], v[124:127], v[180:183], a[244:247]
  v_mfma_f32_16x16x32_bf16 a[248:251], v[124:127], v[184:187], a[248:251]
  v_mfma_f32_16x16x32_bf16 a[252:255], v[124:127], v[188:191], a[252:255]
  s_sub_u32 s55, s55, 1
  s_cmp_lg_u32 s55, 0
  s_cbranch_scc1 gl_181
  s_add_u32 s36, s89, 4
  s_mov_b32 s32, s36
  s_mov_b32 s31, s92
  s_mov_b32 s50, s34
  s_mov_b32 s51, s34
  s_waitcnt vmcnt(0)
  s_mov_b32 s3, 6
  s_branch W_epi
W_out:
  s_mov_b32 s16, s8
  s_mov_b32 s17, s9
  s_mov_b32 s18, s10
  s_mov_b32 s78, 64
  s_mov_b32 s79, 2048
  s_mov_b32 s33, 0x4000
  s_lshl_b32 s53, s88, 8
  s_lshl_b32 s92, s59, 19
  s_lshr_b32 s37, s28, 1
  s_cmp_eq_u32 s89, 6
  s_cselect_b32 s36, 18, 19
  s_lshl_b32 s37, s37, s36
  s_add_u32 s92, s92, s37
  s_lshl_b32 s36, s88, 1
  s_and_b32 s37, s28, 1
  s_add_u32 s36, s36, s37
  s_lshl_b32 s36, s36, 7
  s_add_u32 s92, s92, s36
  s_cmp_lg_u32 s89, 4
  s_cselect_b32 s20, s68, s74
  s_cselect_b32 s21, s69, s75
  s_mov_b32 s36, 0x200000
  s_cselect_b32 s22, 0x800000, s36
  s_cselect_b32 s83, 64, 16
  s_cselect_b32 s36, 20, 18
  s_mov_b32 s37, 0x7bff000
  s_cselect_b32 s37, 0x2fff000, s37
  s_cselect_b32 s38, 0, 2048
  s_lshl_b32 s52, s59, s36
  s_lshl_b32 s81, 1, s36
  s_add_u32 s52, s52, s37
  s_add_u32 s92, s92, s38
  s_cmp_eq_u32 s89, 6
  s_cbranch_scc1 W_oam
  v_lshrrev_b32 v1, 3, v0
  v_and_b32 v2, 7, v0
  v_xor_b32 v2, v2, v1
  v_lshrrev_b32 v3, 2, v2
  v_and_b32 v2, 3, v2
  v_lshlrev_b32 v2, 4, v2
  v_lshl_add_u32 v2, v3, 13, v2
  v_add_u32 v2, 0x1000, v2
  s_lshr_b32 s36, s28, 1
  s_mul_i32 s36, s36, s81
  v_add_u32 v2, s36, v2
  s_and_b32 s36, s28, 1
  s_lshl_b32 s36, s36, 6
  v_add_u32 v1, s36, v1
  v_mul_lo_u32 v1, v1, s78
  v_add_u32 v8, v1, v2
  s_mul_i32 s36, s78, 8
  s_sub_u32 s36, s36, 1024
  v_add_u32 v9, s36, v8
  s_mul_i32 s36, s78, 16
  s_sub_u32 s36, s36, 2048
  v_add_u32 v10, s36, v8
  s_mul_i32 s36, s78, 24
  s_sub_u32 s36, s36, 3072
  v_add_u32 v11, s36, v8
  s_mul_i32 s36, s78, 32
  s_sub_u32 s36, s36, 0
  v_add_u32 v12, s36, v8
  s_mul_i32 s36, s78, 40
  s_sub_u32 s36, s36, 1024
  v_add_u32 v13, s36, v8
  s_mul_i32 s36, s78, 48
  s_sub_u32 s36, s36, 2048
  v_add_u32 v14, s36, v8
  s_mul_i32 s36, s78, 56
  s_sub_u32 s36, s36, 3072
  v_add_u32 v15, s36, v8
  v_lshrrev_b32 v1, 4, v0
  s_lshl_b32 s36, s28, 4
  v_add_u32 v2, s36, v1
  v_mul_lo_u32 v2, v2, s79
  v_and_b32 v3, 15, v0
  v_lshlrev_b32 v3, 4, v3
  v_lshlrev_b32 v1, 5, v1
  v_xor_b32 v3, v3, v1
  v_xor_b32 v1, 0, v3
  s_mul_i32 s36, s79, 0
  s_sub_u32 s36, s36, 0
  v_add3_u32 v16, v2, v1, s36
  v_xor_b32 v1, 128, v3
  s_mul_i32 s36, s79, 4
  s_sub_u32 s36, s36, 1024
  v_add3_u32 v17, v2, v1, s36
  v_xor_b32 v1, 0, v3
  s_mul_i32 s36, s79, 8
  s_sub_u32 s36, s36, 2048
  v_add3_u32 v18, v2, v1, s36
  v_xor_b32 v1, 128, v3
  s_mul_i32 s36, s79, 12
  s_sub_u32 s36, s36, 3072
  v_add3_u32 v19, v2, v1, s36
  v_and_b32 v1, 15, v0
  v_lshlrev_b32 v2, 7, v1
  v_and_b32 v1, 7, v0
  v_lshrrev_b32 v3, 4, v0
  v_xor_b32 v1, v1, v3
  v_lshl_add_u32 v2, v1, 4, v2
  s_lshr_b32 s36, s28, 1
  s_lshl_b32 s36, s36, 14
  v_add_u32 v24, s36, v2
  v_xor_b32 v25, 64, v24
  v_lshrrev_b32 v1, 4, v0
  v_lshlrev_b32 v2, 10, v1
  v_bfe_u32 v3, v0, 2, 2
  v_lshl_add_u32 v2, v3, 8, v2
  v_bfe_u32 v3, v0, 2, 3
  v_lshl_add_u32 v2, v3, 5, v2
  v_and_b32 v3, 3, v0
  v_lshl_add_u32 v2, v3, 3, v2
  s_and_b32 s36, s28, 1
  s_lshl_b32 s36, s36, 7
  v_xor_b32 v2, s36, v2
  v_add_u32 v26, 0x8000, v2
  v_xor_b32 v27, 32, v26
  v_xor_b32 v28, 64, v26
  v_xor_b32 v29, 96, v26
  v_mov_b32 v40, v24
  v_mov_b32 v41, v25
  v_mov_b32 v42, v26
  v_mov_b32 v43, v27
  v_mov_b32 v44, v28
  v_mov_b32 v45, v29
  s_lshl_b32 s54, s79, 6
  s_mov_b32 s82, 0
  s_lshl_b32 s100, s28, 13
  s_lshl_b32 s101, s28, 12
  s_add_u32 s101, s101, 0x8000
  s_add_u32 m0, s82, s100
  s_nop 0
  buffer_load_dwordx4 v8, s[16:19], s52 offen offset:0 sc1 lds
  buffer_load_dwordx4 v9, s[16:19], s52 offen offset:1024 sc1 lds
  buffer_load_dwordx4 v10, s[16:19], s52 offen offset:2048 sc1 lds
  buffer_load_dwordx4 v11, s[16:19], s52 offen offset:3072 sc1 lds
  s_add_u32 m0, m0, 0x1000
  s_nop 0
  buffer_load_dwordx4 v12, s[16:19], s52 offen offset:0 sc1 lds
  buffer_load_dwordx4 v13, s[16:19], s52 offen offset:1024 sc1 lds
  buffer_load_dwordx4 v14, s[16:19], s52 offen offset:2048 sc1 lds
  buffer_load_dwordx4 v15, s[16:19], s52 offen offset:3072 sc1 lds
  s_add_u32 m0, s82, s101
  s_nop 0
  buffer_load_dwordx4 v16, s[20:23], s53 offen offset:0  lds
  buffer_load_dwordx4 v17, s[20:23], s53 offen offset:1024  lds
  buffer_load_dwordx4 v18, s[20:23], s53 offen offset:2048  lds
  buffer_load_dwordx4 v19, s[20:23], s53 offen offset:3072  lds
  s_add_u32 s52, s52, s33
  s_add_u32 s53, s53, s54
  s_add_u32 s82, s82, 0xc000
  s_cmp_eq_u32 s82, 0x24000
  s_cselect_b32 s82, 0, s82
  s_add_u32 m0, s82, s100
  s_nop 0
  buffer_load_dwordx4 v8, s[16:19], s52 offen offset:0 sc1 lds
  buffer_load_dwordx4 v9, s[16:19], s52 offen offset:1024 sc1 lds
  buffer_load_dwordx4 v10, s[16:19], s52 offen offset:2048 sc1 lds
  buffer_load_dwordx4 v11, s[16:19], s52 offen offset:3072 sc1 lds
  s_add_u32 m0, m0, 0x1000
  s_nop 0
  buffer_load_dwordx4 v12, s[16:19], s52 offen offset:0 sc1 lds
  buffer_load_dwordx4 v13, s[16:19], s52 offen offset:1024 sc1 lds
  buffer_load_dwordx4 v14, s[16:19], s52 offen offset:2048 sc1 lds
  buffer_load_dwordx4 v15, s[16:19], s52 offen offset:3072 sc1 lds
  s_add_u32 m0, s82, s101
  s_nop 0
  buffer_load_dwordx4 v16, s[20:23], s53 offen offset:0  lds
  buffer_load_dwordx4 v17, s[20:23], s53 offen offset:1024  lds
  buffer_load_dwordx4 v18, s[20:23], s53 offen offset:2048  lds
  buffer_load_dwordx4 v19, s[20:23], s53 offen offset:3072  lds
  s_add_u32 s52, s52, s33
  s_add_u32 s53, s53, s54
  s_add_u32 s82, s82, 0xc000
  s_cmp_eq_u32 s82, 0x24000
  s_cselect_b32 s82, 0, s82
  s_add_u32 m0, s82, s100
  s_nop 0
  buffer_load_dwordx4 v8, s[16:19], s52 offen offset:0 sc1 lds
  buffer_load_dwordx4 v9, s[16:19], s52 offen offset:1024 sc1 lds
  buffer_load_dwordx4 v10, s[16:19], s52 offen offset:2048 sc1 lds
  buffer_load_dwordx4 v11, s[16:19], s52 offen offset:3072 sc1 lds
  s_add_u32 m0, m0, 0x1000
  s_nop 0
  buffer_load_dwordx4 v12, s[16:19], s52 offen offset:0 sc1 lds
  buffer_load_dwordx4 v13, s[16:19], s52 offen offset:1024 sc1 lds
  buffer_load_dwordx4 v14, s[16:19], s52 offen offset:2048 sc1 lds
  buffer_load_dwordx4 v15, s[16:19], s52 offen offset:3072 sc1 lds
  s_add_u32 m0, s82, s101
  s_nop 0
  buffer_load_dwordx4 v16, s[20:23], s53 offen offset:0  lds
  buffer_load_dwordx4 v17, s[20:23], s53 offen offset:1024  lds
  buffer_load_dwordx4 v18, s[20:23], s53 offen offset:2048  lds
  buffer_load_dwordx4 v19, s[20:23], s53 offen offset:3072  lds
  s_add_u32 s52, s52, s33
  s_add_u32 s53, s53, s54
  s_add_u32 s82, s82, 0xc000
  s_cmp_eq_u32 s82, 0x24000
  s_cselect_b32 s82, 0, s82
  s_mov_b32 s3, 4
  s_cmp_lg_u32 s32, 0
  s_cbranch_scc1 W_epi
W_ret4:
  s_waitcnt vmcnt(24)
  s_barrier
  s_cmp_lg_u32 s49, 255
  s_cbranch_scc1 sg_187
sb_188:
  ds_read_b128 v[64:67], v24 offset:0
  ds_read_b64_tr_b16 v[128:129], v26 offset:0
  ds_read_b64_tr_b16 v[130:131], v26 offset:4096
  ds_read_b64_tr_b16 v[132:133], v27 offset:0
  ds_read_b64_tr_b16 v[134:135], v27 offset:4096
  ds_read_b64_tr_b16 v[136:137], v28 offset:0
  ds_read_b64_tr_b16 v[138:139], v28 offset:4096
  ds_read_b64_tr_b16 v[140:141], v29 offset:0
  ds_read_b64_tr_b16 v[142:143], v29 offset:4096
  ds_read_b128 v[68:71], v24 offset:2048
  ds_read_b128 v[72:75], v24 offset:4096
  ds_read_b128 v[76:79], v24 offset:6144
  ds_read_b128 v[80:83], v24 offset:8192
  ds_read_b128 v[84:87], v24 offset:10240
  ds_read_b128 v[88:91], v24 offset:12288
  ds_read_b128 v[92:95], v24 offset:14336
  s_mov_b32 s55, s83
  s_waitcnt lgkmcnt(0)
  v_mfma_f32_16x16x32_bf16 a[0:3], v[128:131], v[64:67], 0
  ds_read_b128 v[96:99], v25 offset:0
  v_mfma_f32_16x16x32_bf16 a[4:7], v[132:135], v[64:67], 0
  ds_read_b64_tr_b16 v[160:161], v26 offset:8192
  v_mfma_f32_16x16x32_bf16 a[8:11], v[136:139], v[64:67], 0
  ds_read_b64_tr_b16 v[162:163], v26 offset:12288
  v_mfma_f32_16x16x32_bf16 a[12:15], v[140:143], v[64:67], 0
  ds_read_b64_tr_b16 v[164:165], v27 offset:8192
  v_mfma_f32_16x16x32_bf16 a[16:19], v[128:131], v[68:71], 0
  ds_read_b64_tr_b16 v[166:167], v27 offset:12288
  v_mfma_f32_16x16x32_bf16 a[20:23], v[132:135], v[68:71], 0
  ds_read_b64_tr_b16 v[168:169], v28 offset:8192
  v_mfma_f32_16x16x32_bf16 a[24:27], v[136:139], v[68:71], 0
  ds_read_b64_tr_b16 v[170:171], v28 offset:12288
  v_mfma_f32_16x16x32_bf16 a[28:31], v[140:143], v[68:71], 0
  ds_read_b64_tr_b16 v[172:173], v29 offset:8192
  v_mfma_f32_16x16x32_bf16 a[32:35], v[128:131], v[72:75], 0
  ds_read_b64_tr_b16 v[174:175], v29 offset:12288
  v_mfma_f32_16x16x32_bf16 a[36:39], v[132:135], v[72:75], 0
  ds_read_b128 v[100:103], v25 offset:2048
  v_mfma_f32_16x16x32_bf16 a[40:43], v[136:139], v[72:75], 0
  ds_read_b128 v[104:107], v25 offset:4096
  v_mfma_f32_16x16x32_bf16 a[44:47], v[140:143], v[72:75], 0
  ds_read_b128 v[108:111], v25 offset:6144
  v_mfma_f32_16x16x32_bf16 a[48:51], v[128:131], v[76:79], 0
  ds_read_b128 v[112:115], v25 offset:8192
  v_mfma_f32_16x16x32_bf16 a[52:55], v[132:135], v[76:79], 0
  ds_read_b128 v[116:119], v25 offset:10240
  v_mfma_f32_16x16x32_bf16 a[56:59], v[136:139], v[76:79], 0
  ds_read_b128 v[120:123], v25 offset:12288
  v_mfma_f32_16x16x32_bf16 a[60:63], v[140:143], v[76:79], 0
  ds_read_b128 v[124:127], v25 offset:14336
  v_mfma_f32_16x16x32_bf16 a[64:67], v[128:131], v[80:83], 0
  s_add_u32 s2, s82, 0xc000
  s_cmp_eq_u32 s2, 0x24000
  s_cselect_b32 s2, 0, s2
  v_add_u32 v24, s2, v40
  v_mfma_f32_16x16x32_bf16 a[68:71], v[132:135], v[80:83], 0
  v_add_u32 v25, s2, v41
  v_mfma_f32_16x16x32_bf16 a[72:75], v[136:139], v[80:83], 0
  v_add_u32 v26, s2, v42
  v_mfma_f32_16x16x32_bf16 a[76:79], v[140:143], v[80:83], 0
  v_add_u32 v27, s2, v43
  v_mfma_f32_16x16x32_bf16 a[80:83], v[128:131], v[84:87], 0
  v_add_u32 v28, s2, v44
  v_mfma_f32_16x16x32_bf16 a[84:87], v[132:135], v[84:87], 0
  v_add_u32 v29, s2, v45
  s_cmp_eq_u32 s55, 3
  s_cselect_b32 s52, s56, s52
  s_cselect_b32 s53, s57, s53
  v_mfma_f32_16x16x32_bf16 a[88:91], v[136:139], v[84:87], 0
  s_cmp_eq_u32 s49, 255
  s_cbranch_scc1 pb_190
  s_waitcnt vmcnt(0)
pb_190:
  s_waitcnt vmcnt(12) lgkmcnt(0)
  s_barrier
  s_cmp_lg_u32 s49, 255
  s_cbranch_scc1 sg_191
sb_192:
  v_mfma_f32_16x16x32_bf16 a[92:95], v[140:143], v[84:87], 0
  s_add_u32 m0, s82, s100
  s_nop 0
  buffer_load_dwordx4 v8, s[16:19], s52 offen offset:0 sc1 lds
  v_mfma_f32_16x16x32_bf16 a[96:99], v[128:131], v[88:91], 0
  v_mfma_f32_16x16x32_bf16 a[100:103], v[132:135], v[88:91], 0
  v_mfma_f32_16x16x32_bf16 a[104:107], v[136:139], v[88:91], 0
  buffer_load_dwordx4 v9, s[16:19], s52 offen offset:1024 sc1 lds
  v_mfma_f32_16x16x32_bf16 a[108:111], v[140:143], v[88:91], 0
  v_mfma_f32_16x16x32_bf16 a[112:115], v[128:131], v[92:95], 0
  v_mfma_f32_16x16x32_bf16 a[116:119], v[132:135], v[92:95], 0
  buffer_load_dwordx4 v10, s[16:19], s52 offen offset:2048 sc1 lds
  v_mfma_f32_16x16x32_bf16 a[120:123], v[136:139], v[92:95], 0
  v_mfma_f32_16x16x32_bf16 a[124:127], v[140:143], v[92:95], 0
  s_waitcnt lgkmcnt(0)
  v_mfma_f32_16x16x32_bf16 a[0:3], v[160:163], v[96:99], a[0:3]
  ds_read_b128 v[64:67], v24 offset:0
  buffer_load_dwordx4 v11, s[16:19], s52 offen offset:3072 sc1 lds
  v_mfma_f32_16x16x32_bf16 a[4:7], v[164:167], v[96:99], a[4:7]
  ds_read_b64_tr_b16 v[128:129], v26 offset:0
  v_mfma_f32_16x16x32_bf16 a[8:11], v[168:171], v[96:99], a[8:11]
  ds_read_b64_tr_b16 v[130:131], v26 offset:4096
  v_mfma_f32_16x16x32_bf16 a[12:15], v[172:175], v[96:99], a[12:15]
  ds_read_b64_tr_b16 v[132:133], v27 offset:0
  s_add_u32 m0, m0, 0x1000
  s_nop 0
  buffer_load_dwordx4 v12, s[16:19], s52 offen offset:0 sc1 lds
  v_mfma_f32_16x16x32_bf16 a[16:19], v[160:163], v[100:103], a[16:19]
  ds_read_b64_tr_b16 v[134:135], v27 offset:4096
  v_mfma_f32_16x16x32_bf16 a[20:23], v[164:167], v[100:103], a[20:23]
  ds_read_b64_tr_b16 v[136:137], v28 offset:0
  v_mfma_f32_16x16x32_bf16 a[24:27], v[168:171], v[100:103], a[24:27]
  ds_read_b64_tr_b16 v[138:139], v28 offset:4096
  buffer_load_dwordx4 v13, s[16:19], s52 offen offset:1024 sc1 lds
  v_mfma_f32_16x16x32_bf16 a[28:31], v[172:175], v[100:103], a[28:31]
  ds_read_b64_tr_b16 v[140:141], v29 offset:0
  v_mfma_f32_16x16x32_bf16 a[32:35], v[160:163], v[104:107], a[32:35]
  ds_read_b64_tr_b16 v[142:143], v29 offset:4096
  v_mfma_f32_16x16x32_bf16 a[36:39], v[164:167], v[104:107], a[36:39]
  ds_read_b128 v[68:71], v24 offset:2048
  buffer_load_dwordx4 v14, s[16:19], s52 offen offset:2048 sc1 lds
  v_mfma_f32_16x16x32_bf16 a[40:43], v[168:171], v[104:107], a[40:43]
  ds_read_b128 v[72:75], v24 offset:4096
  v_mfma_f32_16x16x32_bf16 a[44:47], v[172:175], v[104:107], a[44:47]
  ds_read_b128 v[76:79], v24 offset:6144
  v_mfma_f32_16x16x32_bf16 a[48:51], v[160:163], v[108:111], a[48:51]
  ds_read_b128 v[80:83], v24 offset:8192
  buffer_load_dwordx4 v15, s[16:19], s52 offen offset:3072 sc1 lds
  v_mfma_f32_16x16x32_bf16 a[52:55], v[164:167], v[108:111], a[52:55]
  ds_read_b128 v[84:87], v24 offset:10240
  v_mfma_f32_16x16x32_bf16 a[56:59], v[168:171], v[108:111], a[56:59]
  ds_read_b128 v[88:91], v24 offset:12288
  v_mfma_f32_16x16x32_bf16 a[60:63], v[172:175], v[108:111], a[60:63]
  ds_read_b128 v[92:95], v24 offset:14336
  s_add_u32 m0, s82, s101
  s_nop 0
  buffer_load_dwordx4 v16, s[20:23], s53 offen offset:0  lds
  v_mfma_f32_16x16x32_bf16 a[64:67], v[160:163], v[112:115], a[64:67]
  v_mfma_f32_16x16x32_bf16 a[68:71], v[164:167], v[112:115], a[68:71]
  v_mfma_f32_16x16x32_bf16 a[72:75], v[168:171], v[112:115], a[72:75]
  buffer_load_dwordx4 v17, s[20:23], s53 offen offset:1024  lds
  v_mfma_f32_16x16x32_bf16 a[76:79], v[172:175], v[112:115], a[76:79]
  v_mfma_f32_16x16x32_bf16 a[80:83], v[160:163], v[116:119], a[80:83]
  v_mfma_f32_16x16x32_bf16 a[84:87], v[164:167], v[116:119], a[84:87]
  buffer_load_dwordx4 v18, s[20:23], s53 offen offset:2048  lds
  v_mfma_f32_16x16x32_bf16 a[88:91], v[168:171], v[116:119], a[88:91]
  v_mfma_f32_16x16x32_bf16 a[92:95], v[172:175], v[116:119], a[92:95]
  v_mfma_f32_16x16x32_bf16 a[96:99], v[160:163], v[120:123], a[96:99]
  buffer_load_dwordx4 v19, s[20:23], s53 offen offset:3072  lds
  v_mfma_f32_16x16x32_bf16 a[100:103], v[164:167], v[120:123], a[100:103]
  s_add_u32 s52, s52, s33
  s_add_u32 s53, s53, s54
  v_mfma_f32_16x16x32_bf16 a[104:107], v[168:171], v[120:123], a[104:107]
  s_add_u32 s82, s82, 0xc000
  s_cmp_eq_u32 s82, 0x24000
  s_cselect_b32 s82, 0, s82
  v_mfma_f32_16x16x32_bf16 a[108:111], v[172:175], v[120:123], a[108:111]
  v_mfma_f32_16x16x32_bf16 a[112:115], v[160:163], v[124:127], a[112:115]
  v_mfma_f32_16x16x32_bf16 a[116:119], v[164:167], v[124:127], a[116:119]
  v_mfma_f32_16x16x32_bf16 a[120:123], v[168:171], v[124:127], a[120:123]
  v_mfma_f32_16x16x32_bf16 a[124:127], v[172:175], v[124:127], a[124:127]
  s_sub_u32 s55, s55, 1
gl_189:
  s_waitcnt lgkmcnt(0)
  v_mfma_f32_16x16x32_bf16 a[0:3], v[128:131], v[64:67], a[0:3]
  ds_read_b128 v[96:99], v25 offset:0
  v_mfma_f32_16x16x32_bf16 a[4:7], v[132:135], v[64:67], a[4:7]
  ds_read_b64_tr_b16 v[160:161], v26 offset:8192
  v_mfma_f32_16x16x32_bf16 a[8:11], v[136:139], v[64:67], a[8:11]
  ds_read_b64_tr_b16 v[162:163], v26 offset:12288
  v_mfma_f32_16x16x32_bf16 a[12:15], v[140:143], v[64:67], a[12:15]
  ds_read_b64_tr_b16 v[164:165], v27 offset:8192
  v_mfma_f32_16x16x32_bf16 a[16:19], v[128:131], v[68:71], a[16:19]
  ds_read_b64_tr_b16 v[166:167], v27 offset:12288
  v_mfma_f32_16x16x32_bf16 a[20:23], v[132:135], v[68:71], a[20:23]
  ds_read_b64_tr_b16 v[168:169], v28 offset:8192
  v_mfma_f32_16x16x32_bf16 a[24:27], v[136:139], v[68:71], a[24:27]
  ds_read_b64_tr_b16 v[170:171], v28 offset:12288
  v_mfma_f32_16x16x32_bf16 a[28:31], v[140:143], v[68:71], a[28:31]
  ds_read_b64_tr_b16 v[172:173], v29 offset:8192
  v_mfma_f32_16x16x32_bf16 a[32:35], v[128:131], v[72:75], a[32:35]
  ds_read_b64_tr_b16 v[174:175], v29 offset:12288
  v_mfma_f32_16x16x32_bf16 a[36:39], v[132:135], v[72:75], a[36:39]
  ds_read_b128 v[100:103], v25 offset:2048
  v_mfma_f32_16x16x32_bf16 a[40:43], v[136:139], v[72:75], a[40:43]
  ds_read_b128 v[104:107], v25 offset:4096
  v_mfma_f32_16x16x32_bf16 a[44:47], v[140:143], v[72:75], a[44:47]
  ds_read_b128 v[108:111], v25 offset:6144
  v_mfma_f32_16x16x32_bf16 a[48:51], v[128:131], v[76:79], a[48:51]
  ds_read_b128 v[112:115], v25 offset:8192
  v_mfma_f32_16x16x32_bf16 a[52:55], v[132:135], v[76:79], a[52:55]
  ds_read_b128 v[116:119], v25 offset:10240
  v_mfma_f32_16x16x32_bf16 a[56:59], v[136:139], v[76:79], a[56:59]
  ds_read_b128 v[120:123], v25 offset:12288
  v_mfma_f32_16x16x32_bf16 a[60:63], v[140:143], v[76:79], a[60:63]
  ds_read_b128 v[124:127], v25 offset:14336
  v_mfma_f32_16x16x32_bf16 a[64:67], v[128:131], v[80:83], a[64:67]
  s_add_u32 s2, s82, 0xc000
  s_cmp_eq_u32 s2, 0x24000
  s_cselect_b32 s2, 0, s2
  v_add_u32 v24, s2, v40
  v_mfma_f32_16x16x32_bf16 a[68:71], v[132:135], v[80:83], a[68:71]
  v_add_u32 v25, s2, v41
  v_mfma_f32_16x16x32_bf16 a[72:75], v[136:139], v[80:83], a[72:75]
  v_add_u32 v26, s2, v42
  v_mfma_f32_16x16x32_bf16 a[76:79], v[140:143], v[80:83], a[76:79]
  v_add_u32 v27, s2, v43
  s_cmp_eq_u32 s55, 3
  s_cbranch_scc1 tk_194
tb_193:
  v_mfma_f32_16x16x32_bf16 a[80:83], v[128:131], v[84:87], a[80:83]
  v_add_u32 v28, s2, v44
  v_mfma_f32_16x16x32_bf16 a[84:87], v[132:135], v[84:87], a[84:87]
  v_add_u32 v29, s2, v45
  s_cmp_eq_u32 s55, 3
  s_cselect_b32 s52, s56, s52
  s_cselect_b32 s53, s57, s53
  v_mfma_f32_16x16x32_bf16 a[88:91], v[136:139], v[84:87], a[88:91]
  s_waitcnt vmcnt(12) lgkmcnt(0)
  s_barrier
  v_mfma_f32_16x16x32_bf16 a[92:95], v[140:143], v[84:87], a[92:95]
  s_add_u32 m0, s82, s100
  s_nop 0
  buffer_load_dwordx4 v8, s[16:19], s52 offen offset:0 sc1 lds
  v_mfma_f32_16x16x32_bf16 a[96:99], v[128:131], v[88:91], a[96:99]
  v_mfma_f32_16x16x32_bf16 a[100:103], v[132:135], v[88:91], a[100:103]
  v_mfma_f32_16x16x32_bf16 a[104:107], v[136:139], v[88:91], a[104:107]
  buffer_load_dwordx4 v9, s[16:19], s52 offen offset:1024 sc1 lds
  v_mfma_f32_16x16x32_bf16 a[108:111], v[140:143], v[88:91], a[108:111]
  v_mfma_f32_16x16x32_bf16 a[112:115], v[128:131], v[92:95], a[112:115]
  v_mfma_f32_16x16x32_bf16 a[116:119], v[132:135], v[92:95], a[116:119]
  buffer_load_dwordx4 v10, s[16:19], s52 offen offset:2048 sc1 lds
  v_mfma_f32_16x16x32_bf16 a[120:123], v[136:139], v[92:95], a[120:123]
  v_mfma_f32_16x16x32_bf16 a[124:127], v[140:143], v[92:95], a[124:127]
  s_waitcnt lgkmcnt(0)
  v_mfma_f32_16x16x32_bf16 a[0:3], v[160:163], v[96:99], a[0:3]
  ds_read_b128 v[64:67], v24 offset:0
  buffer_load_dwordx4 v11, s[16:19], s52 offen offset:3072 sc1 lds
  v_mfma_f32_16x16x32_bf16 a[4:7], v[164:167], v[96:99], a[4:7]
  ds_read_b64_tr_b16 v[128:129], v26 offset:0
  v_mfma_f32_16x16x32_bf16 a[8:11], v[168:171], v[96:99], a[8:11]
  ds_read_b64_tr_b16 v[130:131], v26 offset:4096
  v_mfma_f32_16x16x32_bf16 a[12:15], v[172:175], v[96:99], a[12:15]
  ds_read_b64_tr_b16 v[132:133], v27 offset:0
  s_add_u32 m0, m0, 0x1000
  s_nop 0
  buffer_load_dwordx4 v12, s[16:19], s52 offen offset:0 sc1 lds
  v_mfma_f32_16x16x32_bf16 a[16:19], v[160:163], v[100:103], a[16:19]
  ds_read_b64_tr_b16 v[134:135], v27 offset:4096
  v_mfma_f32_16x16x32_bf16 a[20:23], v[164:167], v[100:103], a[20:23]
  ds_read_b64_tr_b16 v[136:137], v28 offset:0
  v_mfma_f32_16x16x32_bf16 a[24:27], v[168:171], v[100:103], a[24:27]
  ds_read_b64_tr_b16 v[138:139], v28 offset:4096
  buffer_load_dwordx4 v13, s[16:19], s52 offen offset:1024 sc1 lds
  v_mfma_f32_16x16x32_bf16 a[28:31], v[172:175], v[100:103], a[28:31]
  ds_read_b64_tr_b16 v[140:141], v29 offset:0
  v_mfma_f32_16x16x32_bf16 a[32:35], v[160:163], v[104:107], a[32:35]
  ds_read_b64_tr_b16 v[142:143], v29 offset:4096
  v_mfma_f32_16x16x32_bf16 a[36:39], v[164:167], v[104:107], a[36:39]
  ds_read_b128 v[68:71], v24 offset:2048
  buffer_load_dwordx4 v14, s[16:19], s52 offen offset:2048 sc1 lds
  v_mfma_f32_16x16x32_bf16 a[40:43], v[168:171], v[104:107], a[40:43]
  ds_read_b128 v[72:75], v24 offset:4096
  v_mfma_f32_16x16x32_bf16 a[44:47], v[172:175], v[104:107], a[44:47]
  ds_read_b128 v[76:79], v24 offset:6144
  v_mfma_f32_16x16x32_bf16 a[48:51], v[160:163], v[108:111], a[48:51]
  ds_read_b128 v[80:83], v24 offset:8192
  buffer_load_dwordx4 v15, s[16:19], s52 offen offset:3072 sc1 lds
  v_mfma_f32_16x16x32_bf16 a[52:55], v[164:167], v[108:111], a[52:55]
  ds_read_b128 v[84:87], v24 offset:10240
  v_mfma_f32_16x16x32_bf16 a[56:59], v[168:171], v[108:111], a[56:59]
  ds_read_b128 v[88:91], v24 offset:12288
  v_mfma_f32_16x16x32_bf16 a[60:63], v[172:175], v[108:111], a[60:63]
  ds_read_b128 v[92:95], v24 offset:14336
  s_add_u32 m0, s82, s101
  s_nop 0
  buffer_load_dwordx4 v16, s[20:23], s53 offen offset:0  lds
  v_mfma_f32_16x16x32_bf16 a[64:67], v[160:163], v[112:115], a[64:67]
  v_mfma_f32_16x16x32_bf16 a[68:71], v[164:167], v[112:115], a[68:71]
  v_mfma_f32_16x16x32_bf16 a[72:75], v[168:171], v[112:115], a[72:75]
  buffer_load_dwordx4 v17, s[20:23], s53 offen offset:1024  lds
  v_mfma_f32_16x16x32_bf16 a[76:79], v[172:175], v[112:115], a[76:79]
  v_mfma_f32_16x16x32_bf16 a[80:83], v[160:163], v[116:119], a[80:83]
  v_mfma_f32_16x16x32_bf16 a[84:87], v[164:167], v[116:119], a[84:87]
  buffer_load_dwordx4 v18, s[20:23], s53 offen offset:2048  lds
  v_mfma_f32_16x16x32_bf16 a[88:91], v[168:171], v[116:119], a[88:91]
  v_mfma_f32_16x16x32_bf16 a[92:95], v[172:175], v[116:119], a[92:95]
  v_mfma_f32_16x16x32_bf16 a[96:99], v[160:163], v[120:123], a[96:99]
  buffer_load_dwordx4 v19, s[20:23], s53 offen offset:3072  lds
  v_mfma_f32_16x16x32_bf16 a[100:103], v[164:167], v[120:123], a[100:103]
  s_add_u32 s52, s52, s33
  s_add_u32 s53, s53, s54
  v_mfma_f32_16x16x32_bf16 a[104:107], v[168:171], v[120:123], a[104:107]
  s_add_u32 s82, s82, 0xc000
  s_cmp_eq_u32 s82, 0x24000
  s_cselect_b32 s82, 0, s82
  v_mfma_f32_16x16x32_bf16 a[108:111], v[172:175], v[120:123], a[108:111]
  v_mfma_f32_16x16x32_bf16 a[112:115], v[160:163], v[124:127], a[112:115]
  v_mfma_f32_16x16x32_bf16 a[116:119], v[164:167], v[124:127], a[116:119]
  v_mfma_f32_16x16x32_bf16 a[120:123], v[168:171], v[124:127], a[120:123]
  v_mfma_f32_16x16x32_bf16 a[124:127], v[172:175], v[124:127], a[124:127]
  s_sub_u32 s55, s55, 1
  s_cmp_lg_u32 s55, 0
  s_cbranch_scc1 gl_189
  s_mov_b32 s32, 8
  s_mov_b32 s31, s92
  s_mov_b32 s50, s34
  s_mov_b32 s51, s34
  s_waitcnt vmcnt(0)
  s_mov_b32 s3, 6
  s_branch W_epi
W_oam:
  v_lshrrev_b32 v1, 3, v0
  v_and_b32 v2, 7, v0
  v_xor_b32 v2, v2, v1
  v_lshrrev_b32 v3, 2, v2
  v_and_b32 v2, 3, v2
  v_lshlrev_b32 v2, 4, v2
  v_lshl_add_u32 v2, v3, 13, v2
  v_add_u32 v2, 0x1000, v2
  s_lshl_b32 s36, s28, 5
  v_add_u32 v1, s36, v1
  v_mul_lo_u32 v1, v1, s78
  v_add_u32 v8, v1, v2
  s_mul_i32 s36, s78, 8
  s_sub_u32 s36, s36, 1024
  v_add_u32 v9, s36, v8
  s_mul_i32 s36, s78, 16
  s_sub_u32 s36, s36, 2048
  v_add_u32 v10, s36, v8
  s_mul_i32 s36, s78, 24
  s_sub_u32 s36, s36, 3072
  v_add_u32 v11, s36, v8
  v_lshrrev_b32 v1, 4, v0
  s_lshl_b32 s36, s28, 4
  v_add_u32 v2, s36, v1
  v_mul_lo_u32 v2, v2, s79
  v_and_b32 v3, 15, v0
  v_lshlrev_b32 v3, 4, v3
  v_lshlrev_b32 v1, 5, v1
  v_xor_b32 v3, v3, v1
  v_xor_b32 v1, 0, v3
  s_mul_i32 s36, s79, 0
  s_sub_u32 s36, s36, 0
  v_add3_u32 v16, v2, v1, s36
  v_xor_b32 v1, 128, v3
  s_mul_i32 s36, s79, 4
  s_sub_u32 s36, s36, 1024
  v_add3_u32 v17, v2, v1, s36
  v_xor_b32 v1, 0, v3
  s_mul_i32 s36, s79, 8
  s_sub_u32 s36, s36, 2048
  v_add3_u32 v18, v2, v1, s36
  v_xor_b32 v1, 128, v3
  s_mul_i32 s36, s79, 12
  s_sub_u32 s36, s36, 3072
  v_add3_u32 v19, v2, v1, s36
  v_and_b32 v1, 15, v0
  v_lshlrev_b32 v2, 7, v1
  v_and_b32 v1, 7, v0
  v_lshrrev_b32 v3, 4, v0
  v_xor_b32 v1, v1, v3
  v_lshl_add_u32 v2, v1, 4, v2
  s_lshr_b32 s36, s28, 1
  s_lshl_b32 s36, s36, 13
  v_add_u32 v24, s36, v2
  v_xor_b32 v25, 64, v24
  v_lshrrev_b32 v1, 4, v0
  v_lshlrev_b32 v2, 10, v1
  v_bfe_u32 v3, v0, 2, 2
  v_lshl_add_u32 v2, v3, 8, v2
  v_bfe_u32 v3, v0, 2, 3
  v_lshl_add_u32 v2, v3, 5, v2
  v_and_b32 v3, 3, v0
  v_lshl_add_u32 v2, v3, 3, v2
  s_and_b32 s36, s28, 1
  s_lshl_b32 s36, s36, 7
  v_xor_b32 v2, s36, v2
  v_add_u32 v26, 0x4000, v2
  v_xor_b32 v27, 32, v26
  v_xor_b32 v28, 64, v26
  v_xor_b32 v29, 96, v26
  s_lshl_b32 s54, s79, 6
  s_mov_b32 s82, 0
  s_lshl_b32 s100, s28, 12
  s_lshl_b32 s101, s28, 12
  s_add_u32 s101, s101, 0x4000
  s_add_u32 m0, s82, s100
  s_nop 0
  buffer_load_dwordx4 v8, s[16:19], s52 offen offset:0 sc1 lds
  buffer_load_dwordx4 v9, s[16:19], s52 offen offset:1024 sc1 lds
  buffer_load_dwordx4 v10, s[16:19], s52 offen offset:2048 sc1 lds
  buffer_load_dwordx4 v11, s[16:19], s52 offen offset:3072 sc1 lds
  s_add_u32 m0, s82, s101
  s_nop 0
  buffer_load_dwordx4 v16, s[20:23], s53 offen offset:0  lds
  buffer_load_dwordx4 v17, s[20:23], s53 offen offset:1024  lds
  buffer_load_dwordx4 v18, s[20:23], s53 offen offset:2048  lds
  buffer_load_dwordx4 v19, s[20:23], s53 offen offset:3072  lds
  s_add_u32 s52, s52, s33
  s_add_u32 s53, s53, s54
  s_add_u32 s82, s82, 0x8000
  s_and_b32 s82, s82, 0x1ffff
  s_add_u32 m0, s82, s100
  s_nop 0
  buffer_load_dwordx4 v8, s[16:19], s52 offen offset:0 sc1 lds
  buffer_load_dwordx4 v9, s[16:19], s52 offen offset:1024 sc1 lds
  buffer_load_dwordx4 v10, s[16:19], s52 offen offset:2048 sc1 lds
  buffer_load_dwordx4 v11, s[16:19], s52 offen offset:3072 sc1 lds
  s_add_u32 m0, s82, s101
  s_nop 0
  buffer_load_dwordx4 v16, s[20:23], s53 offen offset:0  lds
  buffer_load_dwordx4 v17, s[20:23], s53 offen offset:1024  lds
  buffer_load_dwordx4 v18, s[20:23], s53 offen offset:2048  lds
  buffer_load_dwordx4 v19, s[20:23], s53 offen offset:3072  lds
  s_add_u32 s52, s52, s33
  s_add_u32 s53, s53, s54
  s_add_u32 s82, s82, 0x8000
  s_and_b32 s82, s82, 0x1ffff
  s_add_u32 m0, s82, s100
  s_nop 0
  buffer_load_dwordx4 v8, s[16:19], s52 offen offset:0 sc1 lds
  buffer_load_dwordx4 v9, s[16:19], s52 offen offset:1024 sc1 lds
  buffer_load_dwordx4 v10, s[16:19], s52 offen offset:2048 sc1 lds
  buffer_load_dwordx4 v11, s[16:19], s52 offen offset:3072 sc1 lds
  s_add_u32 m0, s82, s101
  s_nop 0
  buffer_load_dwordx4 v16, s[20:23], s53 offen offset:0  lds
  buffer_load_dwordx4 v17, s[20:23], s53 offen offset:1024  lds
  buffer_load_dwordx4 v18, s[20:23], s53 offen offset:2048  lds
  buffer_load_dwordx4 v19, s[20:23], s53 offen offset:3072  lds
  s_add_u32 s52, s52, s33
  s_add_u32 s53, s53, s54
  s_add_u32 s82, s82, 0x8000
  s_and_b32 s82, s82, 0x1ffff
  s_add_u32 m0, s82, s100
  s_nop 0
  buffer_load_dwordx4 v8, s[16:19], s52 offen offset:0 sc1 lds
  buffer_load_dwordx4 v9, s[16:19], s52 offen offset:1024 sc1 lds
  buffer_load_dwordx4 v10, s[16:19], s52 offen offset:2048 sc1 lds
  buffer_load_dwordx4 v11, s[16:19], s52 offen offset:3072 sc1 lds
  s_add_u32 m0, s82, s101
  s_nop 0
  buffer_load_dwordx4 v16, s[20:23], s53 offen offset:0  lds
  buffer_load_dwordx4 v17, s[20:23], s53 offen offset:1024  lds
  buffer_load_dwordx4 v18, s[20:23], s53 offen offset:2048  lds
  buffer_load_dwordx4 v19, s[20:23], s53 offen offset:3072  lds
  s_add_u32 s52, s52, s33
  s_add_u32 s53, s53, s54
  s_add_u32 s82, s82, 0x8000
  s_and_b32 s82, s82, 0x1ffff
  s_waitcnt vmcnt(24)
  s_barrier
  s_cmp_lg_u32 s49, 255
  s_cbranch_scc1 sg_195
sb_196:
  ds_read_b128 v[64:67], v24 offset:0
  ds_read_b64_tr_b16 v[128:129], v26 offset:0
  ds_read_b64_tr_b16 v[130:131], v26 offset:4096
  ds_read_b64_tr_b16 v[132:133], v27 offset:0
  ds_read_b64_tr_b16 v[134:135], v27 offset:4096
  ds_read_b64_tr_b16 v[136:137], v28 offset:0
  ds_read_b64_tr_b16 v[138:139], v28 offset:4096
  ds_read_b64_tr_b16 v[140:141], v29 offset:0
  ds_read_b64_tr_b16 v[142:143], v29 offset:4096
  ds_read_b128 v[68:71], v24 offset:2048
  ds_read_b128 v[72:75], v24 offset:4096
  ds_read_b128 v[76:79], v24 offset:6144
  s_mov_b32 s55, s83
  s_waitcnt lgkmcnt(0)
  v_mfma_f32_16x16x32_bf16 a[0:3], v[128:131], v[64:67], 0
  ds_read_b128 v[96:99], v25 offset:0
  v_mfma_f32_16x16x32_bf16 a[4:7], v[132:135], v[64:67], 0
  ds_read_b64_tr_b16 v[160:161], v26 offset:8192
  v_add_u32 v24, 0x8000, v24
  v_and_b32 v24, 0x1ffff, v24
  v_mfma_f32_16x16x32_bf16 a[8:11], v[136:139], v[64:67], 0
  ds_read_b64_tr_b16 v[162:163], v26 offset:12288
  v_mfma_f32_16x16x32_bf16 a[12:15], v[140:143], v[64:67], 0
  ds_read_b64_tr_b16 v[164:165], v27 offset:8192
  v_add_u32 v26, 0x8000, v26
  v_and_b32 v26, 0x1ffff, v26
  v_mfma_f32_16x16x32_bf16 a[16:19], v[128:131], v[68:71], 0
  ds_read_b64_tr_b16 v[166:167], v27 offset:12288
  v_mfma_f32_16x16x32_bf16 a[20:23], v[132:135], v[68:71], 0
  ds_read_b64_tr_b16 v[168:169], v28 offset:8192
  v_add_u32 v27, 0x8000, v27
  v_and_b32 v27, 0x1ffff, v27
  v_mfma_f32_16x16x32_bf16 a[24:27], v[136:139], v[68:71], 0
  ds_read_b64_tr_b16 v[170:171], v28 offset:12288
  v_mfma_f32_16x16x32_bf16 a[28:31], v[140:143], v[68:71], 0
  ds_read_b64_tr_b16 v[172:173], v29 offset:8192
  v_add_u32 v28, 0x8000, v28
  v_and_b32 v28, 0x1ffff, v28
  v_mfma_f32_16x16x32_bf16 a[32:35], v[128:131], v[72:75], 0
  ds_read_b64_tr_b16 v[174:175], v29 offset:12288
  v_mfma_f32_16x16x32_bf16 a[36:39], v[132:135], v[72:75], 0
  ds_read_b128 v[100:103], v25 offset:2048
  v_add_u32 v29, 0x8000, v29
  v_and_b32 v29, 0x1ffff, v29
  v_mfma_f32_16x16x32_bf16 a[40:43], v[136:139], v[72:75], 0
  ds_read_b128 v[104:107], v25 offset:4096
  v_mfma_f32_16x16x32_bf16 a[44:47], v[140:143], v[72:75], 0
  ds_read_b128 v[108:111], v25 offset:6144
  v_mfma_f32_16x16x32_bf16 a[48:51], v[128:131], v[76:79], 0
  v_add_u32 v25, 0x8000, v25
  v_and_b32 v25, 0x1ffff, v25
  s_cmp_eq_u32 s55, 4
  s_cselect_b32 s52, s56, s52
  s_cselect_b32 s53, s57, s53
  v_mfma_f32_16x16x32_bf16 a[52:55], v[132:135], v[76:79], 0
  s_cmp_eq_u32 s49, 255
  s_cbranch_scc1 pb_198
  s_waitcnt vmcnt(0)
pb_198:
  s_waitcnt vmcnt(16) lgkmcnt(0)
  s_barrier
  s_cmp_lg_u32 s49, 255
  s_cbranch_scc1 sg_199
sb_200:
  v_mfma_f32_16x16x32_bf16 a[56:59], v[136:139], v[76:79], 0
  s_add_u32 m0, s82, s100
  s_nop 0
  buffer_load_dwordx4 v8, s[16:19], s52 offen offset:0 sc1 lds
  v_mfma_f32_16x16x32_bf16 a[60:63], v[140:143], v[76:79], 0
  s_waitcnt lgkmcnt(0)
  v_mfma_f32_16x16x32_bf16 a[0:3], v[160:163], v[96:99], a[0:3]
  ds_read_b128 v[64:67], v24 offset:0
  buffer_load_dwordx4 v9, s[16:19], s52 offen offset:1024 sc1 lds
  v_mfma_f32_16x16x32_bf16 a[4:7], v[164:167], v[96:99], a[4:7]
  ds_read_b64_tr_b16 v[128:129], v26 offset:0
  v_mfma_f32_16x16x32_bf16 a[8:11], v[168:171], v[96:99], a[8:11]
  ds_read_b64_tr_b16 v[130:131], v26 offset:4096
  buffer_load_dwordx4 v10, s[16:19], s52 offen offset:2048 sc1 lds
  v_mfma_f32_16x16x32_bf16 a[12:15], v[172:175], v[96:99], a[12:15]
  ds_read_b64_tr_b16 v[132:133], v27 offset:0
  v_mfma_f32_16x16x32_bf16 a[16:19], v[160:163], v[100:103], a[16:19]
  ds_read_b64_tr_b16 v[134:135], v27 offset:4096
  buffer_load_dwordx4 v11, s[16:19], s52 offen offset:3072 sc1 lds
  v_mfma_f32_16x16x32_bf16 a[20:23], v[164:167], v[100:103], a[20:23]
  ds_read_b64_tr_b16 v[136:137], v28 offset:0
  v_mfma_f32_16x16x32_bf16 a[24:27], v[168:171], v[100:103], a[24:27]
  ds_read_b64_tr_b16 v[138:139], v28 offset:4096
  s_add_u32 m0, s82, s101
  s_nop 0
  buffer_load_dwordx4 v16, s[20:23], s53 offen offset:0  lds
  v_mfma_f32_16x16x32_bf16 a[28:31], v[172:175], v[100:103], a[28:31]
  ds_read_b64_tr_b16 v[140:141], v29 offset:0
  v_mfma_f32_16x16x32_bf16 a[32:35], v[160:163], v[104:107], a[32:35]
  ds_read_b64_tr_b16 v[142:143], v29 offset:4096
  buffer_load_dwordx4 v17, s[20:23], s53 offen offset:1024  lds
  v_mfma_f32_16x16x32_bf16 a[36:39], v[164:167], v[104:107], a[36:39]
  ds_read_b128 v[68:71], v24 offset:2048
  v_mfma_f32_16x16x32_bf16 a[40:43], v[168:171], v[104:107], a[40:43]
  ds_read_b128 v[72:75], v24 offset:4096
  buffer_load_dwordx4 v18, s[20:23], s53 offen offset:2048  lds
  v_mfma_f32_16x16x32_bf16 a[44:47], v[172:175], v[104:107], a[44:47]
  ds_read_b128 v[76:79], v24 offset:6144
  v_mfma_f32_16x16x32_bf16 a[48:51], v[160:163], v[108:111], a[48:51]
  buffer_load_dwordx4 v19, s[20:23], s53 offen offset:3072  lds
  v_mfma_f32_16x16x32_bf16 a[52:55], v[164:167], v[108:111], a[52:55]
  s_add_u32 s52, s52, s33
  s_add_u32 s53, s53, s54
  v_mfma_f32_16x16x32_bf16 a[56:59], v[168:171], v[108:111], a[56:59]
  s_add_u32 s82, s82, 0x8000
  s_and_b32 s82, s82, 0x1ffff
  v_mfma_f32_16x16x32_bf16 a[60:63], v[172:175], v[108:111], a[60:63]
  s_sub_u32 s55, s55, 1
gl_197:
  s_waitcnt lgkmcnt(0)
  v_mfma_f32_16x16x32_bf16 a[0:3], v[128:131], v[64:67], a[0:3]
  ds_read_b128 v[96:99], v25 offset:0
  v_mfma_f32_16x16x32_bf16 a[4:7], v[132:135], v[64:67], a[4:7]
  ds_read_b64_tr_b16 v[160:161], v26 offset:8192
  v_add_u32 v24, 0x8000, v24
  v_and_b32 v24, 0x1ffff, v24
  v_mfma_f32_16x16x32_bf16 a[8:11], v[136:139], v[64:67], a[8:11]
  ds_read_b64_tr_b16 v[162:163], v26 offset:12288
  v_mfma_f32_16x16x32_bf16 a[12:15], v[140:143], v[64:67], a[12:15]
  ds_read_b64_tr_b16 v[164:165], v27 offset:8192
  v_add_u32 v26, 0x8000, v26
  v_and_b32 v26, 0x1ffff, v26
  v_mfma_f32_16x16x32_bf16 a[16:19], v[128:131], v[68:71], a[16:19]
  ds_read_b64_tr_b16 v[166:167], v27 offset:12288
  v_mfma_f32_16x16x32_bf16 a[20:23], v[132:135], v[68:71], a[20:23]
  ds_read_b64_tr_b16 v[168:169], v28 offset:8192
  v_add_u32 v27, 0x8000, v27
  v_and_b32 v27, 0x1ffff, v27
  v_mfma_f32_16x16x32_bf16 a[24:27], v[136:139], v[68:71], a[24:27]
  ds_read_b64_tr_b16 v[170:171], v28 offset:12288
  v_mfma_f32_16x16x32_bf16 a[28:31], v[140:143], v[68:71], a[28:31]
  ds_read_b64_tr_b16 v[172:173], v29 offset:8192
  v_add_u32 v28, 0x8000, v28
  v_and_b32 v28, 0x1ffff, v28
  v_mfma_f32_16x16x32_bf16 a[32:35], v[128:131], v[72:75], a[32:35]
  ds_read_b64_tr_b16 v[174:175], v29 offset:12288
  v_mfma_f32_16x16x32_bf16 a[36:39], v[132:135], v[72:75], a[36:39]
  ds_read_b128 v[100:103], v25 offset:2048
  v_add_u32 v29, 0x8000, v29
  v_and_b32 v29, 0x1ffff, v29
  v_mfma_f32_16x16x32_bf16 a[40:43], v[136:139], v[72:75], a[40:43]
  ds_read_b128 v[104:107], v25 offset:4096
  s_cmp_eq_u32 s55, 5
  s_cbranch_scc1 tk_202
tb_201:
  v_mfma_f32_16x16x32_bf16 a[44:47], v[140:143], v[72:75], a[44:47]
  ds_read_b128 v[108:111], v25 offset:6144
  v_mfma_f32_16x16x32_bf16 a[48:51], v[128:131], v[76:79], a[48:51]
  v_add_u32 v25, 0x8000, v25
  v_and_b32 v25, 0x1ffff, v25
  s_cmp_eq_u32 s55, 4
  s_cselect_b32 s52, s56, s52
  s_cselect_b32 s53, s57, s53
  v_mfma_f32_16x16x32_bf16 a[52:55], v[132:135], v[76:79], a[52:55]
  s_waitcnt vmcnt(16) lgkmcnt(0)
  s_barrier
  v_mfma_f32_16x16x32_bf16 a[56:59], v[136:139], v[76:79], a[56:59]
  s_add_u32 m0, s82, s100
  s_nop 0
  buffer_load_dwordx4 v8, s[16:19], s52 offen offset:0 sc1 lds
  v_mfma_f32_16x16x32_bf16 a[60:63], v[140:143], v[76:79], a[60:63]
  s_waitcnt lgkmcnt(0)
  v_mfma_f32_16x16x32_bf16 a[0:3], v[160:163], v[96:99], a[0:3]
  ds_read_b128 v[64:67], v24 offset:0
  buffer_load_dwordx4 v9, s[16:19], s52 offen offset:1024 sc1 lds
  v_mfma_f32_16x16x32_bf16 a[4:7], v[164:167], v[96:99], a[4:7]
  ds_read_b64_tr_b16 v[128:129], v26 offset:0
  v_mfma_f32_16x16x32_bf16 a[8:11], v[168:171], v[96:99], a[8:11]
  ds_read_b64_tr_b16 v[130:131], v26 offset:4096
  buffer_load_dwordx4 v10, s[16:19], s52 offen offset:2048 sc1 lds
  v_mfma_f32_16x16x32_bf16 a[12:15], v[172:175], v[96:99], a[12:15]
  ds_read_b64_tr_b16 v[132:133], v27 offset:0
  v_mfma_f32_16x16x32_bf16 a[16:19], v[160:163], v[100:103], a[16:19]
  ds_read_b64_tr_b16 v[134:135], v27 offset:4096
  buffer_load_dwordx4 v11, s[16:19], s52 offen offset:3072 sc1 lds
  v_mfma_f32_16x16x32_bf16 a[20:23], v[164:167], v[100:103], a[20:23]
  ds_read_b64_tr_b16 v[136:137], v28 offset:0
  v_mfma_f32_16x16x32_bf16 a[24:27], v[168:171], v[100:103], a[24:27]
  ds_read_b64_tr_b16 v[138:139], v28 offset:4096
  s_add_u32 m0, s82, s101
  s_nop 0
  buffer_load_dwordx4 v16, s[20:23], s53 offen offset:0  lds
  v_mfma_f32_16x16x32_bf16 a[28:31], v[172:175], v[100:103], a[28:31]
  ds_read_b64_tr_b16 v[140:141], v29 offset:0
  v_mfma_f32_16x16x32_bf16 a[32:35], v[160:163], v[104:107], a[32:35]
  ds_read_b64_tr_b16 v[142:143], v29 offset:4096
  buffer_load_dwordx4 v17, s[20:23], s53 offen offset:1024  lds
  v_mfma_f32_16x16x32_bf16 a[36:39], v[164:167], v[104:107], a[36:39]
  ds_read_b128 v[68:71], v24 offset:2048
  v_mfma_f32_16x16x32_bf16 a[40:43], v[168:171], v[104:107], a[40:43]
  ds_read_b128 v[72:75], v24 offset:4096
  buffer_load_dwordx4 v18, s[20:23], s53 offen offset:2048  lds
  v_mfma_f32_16x16x32_bf16 a[44:47], v[172:175], v[104:107], a[44:47]
  ds_read_b128 v[76:79], v24 offset:6144
  v_mfma_f32_16x16x32_bf16 a[48:51], v[160:163], v[108:111], a[48:51]
  buffer_load_dwordx4 v19, s[20:23], s53 offen offset:3072  lds
  v_mfma_f32_16x16x32_bf16 a[52:55], v[164:167], v[108:111], a[52:55]
  s_add_u32 s52, s52, s33
  s_add_u32 s53, s53, s54
  v_mfma_f32_16x16x32_bf16 a[56:59], v[168:171], v[108:111], a[56:59]
  s_add_u32 s82, s82, 0x8000
  s_and_b32 s82, s82, 0x1ffff
  v_mfma_f32_16x16x32_bf16 a[60:63], v[172:175], v[108:111], a[60:63]
  s_sub_u32 s55, s55, 1
  s_cmp_lg_u32 s55, 0
  s_cbranch_scc1 gl_197
  s_mov_b32 s32, 7
  s_mov_b32 s31, s92
  s_mov_b32 s50, s34
  s_mov_b32 s51, s34
  s_waitcnt vmcnt(0)
  s_mov_b32 s3, 6
  s_branch W_epi
W_epi:
  s_cmp_eq_u32 s32, 1
  s_cbranch_scc1 W_epi1
  s_cmp_eq_u32 s32, 2
  s_cbranch_scc1 W_epi2
  s_cmp_eq_u32 s32, 3
  s_cbranch_scc1 W_epi3
  s_cmp_eq_u32 s32, 4
  s_cbranch_scc1 W_epi4
  s_cmp_eq_u32 s32, 5
  s_cbranch_scc1 W_epi5
  s_cmp_eq_u32 s32, 6
  s_cbranch_scc1 W_epi6
  v_and_b32 v1, 15, v0
  v_lshlrev_b32 v37, 12, v1
  v_bfe_u32 v1, v0, 4, 1
  v_lshl_add_u32 v37, v1, 5, v37
  v_lshrrev_b32 v1, 5, v0
  v_lshl_add_u32 v37, v1, 4, v37
  s_cmp_eq_u32 s32, 8
  s_cbranch_scc1 W_epi8
  s_add_u32 s36, s31, 0x0
  v_accvgpr_read_b32 v192, a0
  v_accvgpr_read_b32 v193, a1
  v_accvgpr_read_b32 v194, a2
  v_accvgpr_read_b32 v195, a3
  v_accvgpr_read_b32 v196, a4
  v_accvgpr_read_b32 v197, a5
  v_accvgpr_read_b32 v198, a6
  v_accvgpr_read_b32 v199, a7
  v_cvt_pk_bf16_f32 v208, v192, v193
  v_cvt_pk_bf16_f32 v209, v194, v195
  v_cvt_pk_bf16_f32 v210, v196, v197
  v_cvt_pk_bf16_f32 v211, v198, v199
  s_nop 0
  v_permlane16_swap_b32 v208, v210
  v_permlane16_swap_b32 v209, v211
  buffer_store_dwordx4 v[208:211], v37, s[24:27], s36 offen offset:0
  v_accvgpr_read_b32 v200, a8
  v_accvgpr_read_b32 v201, a9
  v_accvgpr_read_b32 v202, a10
  v_accvgpr_read_b32 v203, a11
  v_accvgpr_read_b32 v204, a12
  v_accvgpr_read_b32 v205, a13
  v_accvgpr_read_b32 v206, a14
  v_accvgpr_read_b32 v207, a15
  v_cvt_pk_bf16_f32 v212, v200, v201
  v_cvt_pk_bf16_f32 v213, v202, v203
  v_cvt_pk_bf16_f32 v214, v204, v205
  v_cvt_pk_bf16_f32 v215, v206, v207
  s_nop 0
  v_permlane16_swap_b32 v212, v214
  v_permlane16_swap_b32 v213, v215
  buffer_store_dwordx4 v[212:215], v37, s[24:27], s36 offen offset:64
  s_add_u32 s36, s31, 0x10000
  v_accvgpr_read_b32 v192, a16
  v_accvgpr_read_b32 v193, a17
  v_accvgpr_read_b32 v194, a18
  v_accvgpr_read_b32 v195, a19
  v_accvgpr_read_b32 v196, a20
  v_accvgpr_read_b32 v197, a21
  v_accvgpr_read_b32 v198, a22
  v_accvgpr_read_b32 v199, a23
  v_cvt_pk_bf16_f32 v216, v192, v193
  v_cvt_pk_bf16_f32 v217, v194, v195
  v_cvt_pk_bf16_f32 v218, v196, v197
  v_cvt_pk_bf16_f32 v219, v198, v199
  s_nop 0
  v_permlane16_swap_b32 v216, v218
  v_permlane16_swap_b32 v217, v219
  buffer_store_dwordx4 v[216:219], v37, s[24:27], s36 offen offset:0
  v_accvgpr_read_b32 v200, a24
  v_accvgpr_read_b32 v201, a25
  v_accvgpr_read_b32 v202, a26
  v_accvgpr_read_b32 v203, a27
  v_accvgpr_read_b32 v204, a28
  v_accvgpr_read_b32 v205, a29
  v_accvgpr_read_b32 v206, a30
  v_accvgpr_read_b32 v207, a31
  v_cvt_pk_bf16_f32 v220, v200, v201
  v_cvt_pk_bf16_f32 v221, v202, v203
  v_cvt_pk_bf16_f32 v222, v204, v205
  v_cvt_pk_bf16_f32 v223, v206, v207
  s_nop 0
  v_permlane16_swap_b32 v220, v222
  v_permlane16_swap_b32 v221, v223
  buffer_store_dwordx4 v[220:223], v37, s[24:27], s36 offen offset:64
  s_add_u32 s36, s31, 0x20000
  v_accvgpr_read_b32 v192, a32
  v_accvgpr_read_b32 v193, a33
  v_accvgpr_read_b32 v194, a34
  v_accvgpr_read_b32 v195, a35
  v_accvgpr_read_b32 v196, a36
  v_accvgpr_read_b32 v197, a37
  v_accvgpr_read_b32 v198, a38
  v_accvgpr_read_b32 v199, a39
  v_cvt_pk_bf16_f32 v224, v192, v193
  v_cvt_pk_bf16_f32 v225, v194, v195
  v_cvt_pk_bf16_f32 v226, v196, v197
  v_cvt_pk_bf16_f32 v227, v198, v199
  s_nop 0
  v_permlane16_swap_b32 v224, v226
  v_permlane16_swap_b32 v225, v227
  buffer_store_dwordx4 v[224:227], v37, s[24:27], s36 offen offset:0
  v_accvgpr_read_b32 v200, a40
  v_accvgpr_read_b32 v201, a41
  v_accvgpr_read_b32 v202, a42
  v_accvgpr_read_b32 v203, a43
  v_accvgpr_read_b32 v204, a44
  v_accvgpr_read_b32 v205, a45
  v_accvgpr_read_b32 v206, a46
  v_accvgpr_read_b32 v207, a47
  v_cvt_pk_bf16_f32 v228, v200, v201
  v_cvt_pk_bf16_f32 v229, v202, v203
  v_cvt_pk_bf16_f32 v230, v204, v205
  v_cvt_pk_bf16_f32 v231, v206, v207
  s_nop 0
  v_permlane16_swap_b32 v228, v230
  v_permlane16_swap_b32 v229, v231
  buffer_store_dwordx4 v[228:231], v37, s[24:27], s36 offen offset:64
  s_add_u32 s36, s31, 0x30000
  v_accvgpr_read_b32 v192, a48
  v_accvgpr_read_b32 v193, a49
  v_accvgpr_read_b32 v194, a50
  v_accvgpr_read_b32 v195, a51
  v_accvgpr_read_b32 v196, a52
  v_accvgpr_read_b32 v197, a53
  v_accvgpr_read_b32 v198, a54
  v_accvgpr_read_b32 v199, a55
  v_cvt_pk_bf16_f32 v232, v192, v193
  v_cvt_pk_bf16_f32 v233, v194, v195
  v_cvt_pk_bf16_f32 v234, v196, v197
  v_cvt_pk_bf16_f32 v235, v198, v199
  s_nop 0
  v_permlane16_swap_b32 v232, v234
  v_permlane16_swap_b32 v233, v235
  buffer_store_dwordx4 v[232:235], v37, s[24:27], s36 offen offset:0
  v_accvgpr_read_b32 v200, a56
  v_accvgpr_read_b32 v201, a57
  v_accvgpr_read_b32 v202, a58
  v_accvgpr_read_b32 v203, a59
  v_accvgpr_read_b32 v204, a60
  v_accvgpr_read_b32 v205, a61
  v_accvgpr_read_b32 v206, a62
  v_accvgpr_read_b32 v207, a63
  v_cvt_pk_bf16_f32 v236, v200, v201
  v_cvt_pk_bf16_f32 v237, v202, v203
  v_cvt_pk_bf16_f32 v238, v204, v205
  v_cvt_pk_bf16_f32 v239, v206, v207
  s_nop 0
  v_permlane16_swap_b32 v236, v238
  v_permlane16_swap_b32 v237, v239
  buffer_store_dwordx4 v[236:239], v37, s[24:27], s36 offen offset:64
  s_branch W_epiend
W_epi8:
  s_add_u32 s36, s31, 0x0
  v_accvgpr_read_b32 v192, a0
  v_accvgpr_read_b32 v193, a1
  v_accvgpr_read_b32 v194, a2
  v_accvgpr_read_b32 v195, a3
  v_accvgpr_read_b32 v196, a4
  v_accvgpr_read_b32 v197, a5
  v_accvgpr_read_b32 v198, a6
  v_accvgpr_read_b32 v199, a7
  v_cvt_pk_bf16_f32 v208, v192, v193
  v_cvt_pk_bf16_f32 v209, v194, v195
  v_cvt_pk_bf16_f32 v210, v196, v197
  v_cvt_pk_bf16_f32 v211, v198, v199
  s_nop 0
  v_permlane16_swap_b32 v208, v210
  v_permlane16_swap_b32 v209, v211
  buffer_store_dwordx4 v[208:211], v37, s[24:27], s36 offen offset:0
  v_accvgpr_read_b32 v200, a8
  v_accvgpr_read_b32 v201, a9
  v_accvgpr_read_b32 v202, a10
  v_accvgpr_read_b32 v203, a11
  v_accvgpr_read_b32 v204, a12
  v_accvgpr_read_b32 v205, a13
  v_accvgpr_read_b32 v206, a14
  v_accvgpr_read_b32 v207, a15
  v_cvt_pk_bf16_f32 v212, v200, v201
  v_cvt_pk_bf16_f32 v213, v202, v203
  v_cvt_pk_bf16_f32 v214, v204, v205
  v_cvt_pk_bf16_f32 v215, v206, v207
  s_nop 0
  v_permlane16_swap_b32 v212, v214
  v_permlane16_swap_b32 v213, v215
  buffer_store_dwordx4 v[212:215], v37, s[24:27], s36 offen offset:64
  s_add_u32 s36, s31, 0x10000
  v_accvgpr_read_b32 v192, a16
  v_accvgpr_read_b32 v193, a17
  v_accvgpr_read_b32 v194, a18
  v_accvgpr_read_b32 v195, a19
  v_accvgpr_read_b32 v196, a20
  v_accvgpr_read_b32 v197, a21
  v_accvgpr_read_b32 v198, a22
  v_accvgpr_read_b32 v199, a23
  v_cvt_pk_bf16_f32 v216, v192, v193
  v_cvt_pk_bf16_f32 v217, v194, v195
  v_cvt_pk_bf16_f32 v218, v196, v197
  v_cvt_pk_bf16_f32 v219, v198, v199
  s_nop 0
  v_permlane16_swap_b32 v216, v218
  v_permlane16_swap_b32 v217, v219
  buffer_store_dwordx4 v[216:219], v37, s[24:27], s36 offen offset:0
  v_accvgpr_read_b32 v200, a24
  v_accvgpr_read_b32 v201, a25
  v_accvgpr_read_b32 v202, a26
  v_accvgpr_read_b32 v203, a27
  v_accvgpr_read_b32 v204, a28
  v_accvgpr_read_b32 v205, a29
  v_accvgpr_read_b32 v206, a30
  v_accvgpr_read_b32 v207, a31
  v_cvt_pk_bf16_f32 v220, v200, v201
  v_cvt_pk_bf16_f32 v221, v202, v203
  v_cvt_pk_bf16_f32 v222, v204, v205
  v_cvt_pk_bf16_f32 v223, v206, v207
  s_nop 0
  v_permlane16_swap_b32 v220, v222
  v_permlane16_swap_b32 v221, v223
  buffer_store_dwordx4 v[220:223], v37, s[24:27], s36 offen offset:64
  s_add_u32 s36, s31, 0x20000
  v_accvgpr_read_b32 v192, a32
  v_accvgpr_read_b32 v193, a33
  v_accvgpr_read_b32 v194, a34
  v_accvgpr_read_b32 v195, a35
  v_accvgpr_read_b32 v196, a36
  v_accvgpr_read_b32 v197, a37
  v_accvgpr_read_b32 v198, a38
  v_accvgpr_read_b32 v199, a39
  v_cvt_pk_bf16_f32 v224, v192, v193
  v_cvt_pk_bf16_f32 v225, v194, v195
  v_cvt_pk_bf16_f32 v226, v196, v197
  v_cvt_pk_bf16_f32 v227, v198, v199
  s_nop 0
  v_permlane16_swap_b32 v224, v226
  v_permlane16_swap_b32 v225, v227
  buffer_store_dwordx4 v[224:227], v37, s[24:27], s36 offen offset:0
  v_accvgpr_read_b32 v200, a40
  v_accvgpr_read_b32 v201, a41
  v_accvgpr_read_b32 v202, a42
  v_accvgpr_read_b32 v203, a43
  v_accvgpr_read_b32 v204, a44
  v_accvgpr_read_b32 v205, a45
  v_accvgpr_read_b32 v206, a46
  v_accvgpr_read_b32 v207, a47
  v_cvt_pk_bf16_f32 v228, v200, v201
  v_cvt_pk_bf16_f32 v229, v202, v203
  v_cvt_pk_bf16_f32 v230, v204, v205
  v_cvt_pk_bf16_f32 v231, v206, v207
  s_nop 0
  v_permlane16_swap_b32 v228, v230
  v_permlane16_swap_b32 v229, v231
  buffer_store_dwordx4 v[228:231], v37, s[24:27], s36 offen offset:64
  s_add_u32 s36, s31, 0x30000
  v_accvgpr_read_b32 v192, a48
  v_accvgpr_read_b32 v193, a49
  v_accvgpr_read_b32 v194, a50
  v_accvgpr_read_b32 v195, a51
  v_accvgpr_read_b32 v196, a52
  v_accvgpr_read_b32 v197, a53
  v_accvgpr_read_b32 v198, a54
  v_accvgpr_read_b32 v199, a55
  v_cvt_pk_bf16_f32 v232, v192, v193
  v_cvt_pk_bf16_f32 v233, v194, v195
  v_cvt_pk_bf16_f32 v234, v196, v197
  v_cvt_pk_bf16_f32 v235, v198, v199
  s_nop 0
  v_permlane16_swap_b32 v232, v234
  v_permlane16_swap_b32 v233, v235
  buffer_store_dwordx4 v[232:235], v37, s[24:27], s36 offen offset:0
  v_accvgpr_read_b32 v200, a56
  v_accvgpr_read_b32 v201, a57
  v_accvgpr_read_b32 v202, a58
  v_accvgpr_read_b32 v203, a59
  v_accvgpr_read_b32 v204, a60
  v_accvgpr_read_b32 v205, a61
  v_accvgpr_read_b32 v206, a62
  v_accvgpr_read_b32 v207, a63
  v_cvt_pk_bf16_f32 v236, v200, v201
  v_cvt_pk_bf16_f32 v237, v202, v203
  v_cvt_pk_bf16_f32 v238, v204, v205
  v_cvt_pk_bf16_f32 v239, v206, v207
  s_nop 0
  v_permlane16_swap_b32 v236, v238
  v_permlane16_swap_b32 v237, v239
  buffer_store_dwordx4 v[236:239], v37, s[24:27], s36 offen offset:64
  s_add_u32 s36, s31, 0x40000
  v_accvgpr_read_b32 v192, a64
  v_accvgpr_read_b32 v193, a65
  v_accvgpr_read_b32 v194, a66
  v_accvgpr_read_b32 v195, a67
  v_accvgpr_read_b32 v196, a68
  v_accvgpr_read_b32 v197, a69
  v_accvgpr_read_b32 v198, a70
  v_accvgpr_read_b32 v199, a71
  v_cvt_pk_bf16_f32 v208, v192, v193
  v_cvt_pk_bf16_f32 v209, v194, v195
  v_cvt_pk_bf16_f32 v210, v196, v197
  v_cvt_pk_bf16_f32 v211, v198, v199
  s_nop 0
  v_permlane16_swap_b32 v208, v210
  v_permlane16_swap_b32 v209, v211
  buffer_store_dwordx4 v[208:211], v37, s[24:27], s36 offen offset:0
  v_accvgpr_read_b32 v200, a72
  v_accvgpr_read_b32 v201, a73
  v_accvgpr_read_b32 v202, a74
  v_accvgpr_read_b32 v203, a75
  v_accvgpr_read_b32 v204, a76
  v_accvgpr_read_b32 v205, a77
  v_accvgpr_read_b32 v206, a78
  v_accvgpr_read_b32 v207, a79
  v_cvt_pk_bf16_f32 v212, v200, v201
  v_cvt_pk_bf16_f32 v213, v202, v203
  v_cvt_pk_bf16_f32 v214, v204, v205
  v_cvt_pk_bf16_f32 v215, v206, v207
  s_nop 0
  v_permlane16_swap_b32 v212, v214
  v_permlane16_swap_b32 v213, v215
  buffer_store_dwordx4 v[212:215], v37, s[24:27], s36 offen offset:64
  s_add_u32 s36, s31, 0x50000
  v_accvgpr_read_b32 v192, a80
  v_accvgpr_read_b32 v193, a81
  v_accvgpr_read_b32 v194, a82
  v_accvgpr_read_b32 v195, a83
  v_accvgpr_read_b32 v196, a84
  v_accvgpr_read_b32 v197, a85
  v_accvgpr_read_b32 v198, a86
  v_accvgpr_read_b32 v199, a87
  v_cvt_pk_bf16_f32 v216, v192, v193
  v_cvt_pk_bf16_f32 v217, v194, v195
  v_cvt_pk_bf16_f32 v218, v196, v197
  v_cvt_pk_bf16_f32 v219, v198, v199
  s_nop 0
  v_permlane16_swap_b32 v216, v218
  v_permlane16_swap_b32 v217, v219
  buffer_store_dwordx4 v[216:219], v37, s[24:27], s36 offen offset:0
  v_accvgpr_read_b32 v200, a88
  v_accvgpr_read_b32 v201, a89
  v_accvgpr_read_b32 v202, a90
  v_accvgpr_read_b32 v203, a91
  v_accvgpr_read_b32 v204, a92
  v_accvgpr_read_b32 v205, a93
  v_accvgpr_read_b32 v206, a94
  v_accvgpr_read_b32 v207, a95
  v_cvt_pk_bf16_f32 v220, v200, v201
  v_cvt_pk_bf16_f32 v221, v202, v203
  v_cvt_pk_bf16_f32 v222, v204, v205
  v_cvt_pk_bf16_f32 v223, v206, v207
  s_nop 0
  v_permlane16_swap_b32 v220, v222
  v_permlane16_swap_b32 v221, v223
  buffer_store_dwordx4 v[220:223], v37, s[24:27], s36 offen offset:64
  s_add_u32 s36, s31, 0x60000
  v_accvgpr_read_b32 v192, a96
  v_accvgpr_read_b32 v193, a97
  v_accvgpr_read_b32 v194, a98
  v_accvgpr_read_b32 v195, a99
  v_accvgpr_read_b32 v196, a100
  v_accvgpr_read_b32 v197, a101
  v_accvgpr_read_b32 v198, a102
  v_accvgpr_read_b32 v199, a103
  v_cvt_pk_bf16_f32 v224, v192, v193
  v_cvt_pk_bf16_f32 v225, v194, v195
  v_cvt_pk_bf16_f32 v226, v196, v197
  v_cvt_pk_bf16_f32 v227, v198, v199
  s_nop 0
  v_permlane16_swap_b32 v224, v226
  v_permlane16_swap_b32 v225, v227
  buffer_store_dwordx4 v[224:227], v37, s[24:27], s36 offen offset:0
  v_accvgpr_read_b32 v200, a104
  v_accvgpr_read_b32 v201, a105
  v_accvgpr_read_b32 v202, a106
  v_accvgpr_read_b32 v203, a107
  v_accvgpr_read_b32 v204, a108
  v_accvgpr_read_b32 v205, a109
  v_accvgpr_read_b32 v206, a110
  v_accvgpr_read_b32 v207, a111
  v_cvt_pk_bf16_f32 v228, v200, v201
  v_cvt_pk_bf16_f32 v229, v202, v203
  v_cvt_pk_bf16_f32 v230, v204, v205
  v_cvt_pk_bf16_f32 v231, v206, v207
  s_nop 0
  v_permlane16_swap_b32 v228, v230
  v_permlane16_swap_b32 v229, v231
  buffer_store_dwordx4 v[228:231], v37, s[24:27], s36 offen offset:64
  s_add_u32 s36, s31, 0x70000
  v_accvgpr_read_b32 v192, a112
  v_accvgpr_read_b32 v193, a113
  v_accvgpr_read_b32 v194, a114
  v_accvgpr_read_b32 v195, a115
  v_accvgpr_read_b32 v196, a116
  v_accvgpr_read_b32 v197, a117
  v_accvgpr_read_b32 v198, a118
  v_accvgpr_read_b32 v199, a119
  v_cvt_pk_bf16_f32 v232, v192, v193
  v_cvt_pk_bf16_f32 v233, v194, v195
  v_cvt_pk_bf16_f32 v234, v196, v197
  v_cvt_pk_bf16_f32 v235, v198, v199
  s_nop 0
  v_permlane16_swap_b32 v232, v234
  v_permlane16_swap_b32 v233, v235
  buffer_store_dwordx4 v[232:235], v37, s[24:27], s36 offen offset:0
  v_accvgpr_read_b32 v200, a120
  v_accvgpr_read_b32 v201, a121
  v_accvgpr_read_b32 v202, a122
  v_accvgpr_read_b32 v203, a123
  v_accvgpr_read_b32 v204, a124
  v_accvgpr_read_b32 v205, a125
  v_accvgpr_read_b32 v206, a126
  v_accvgpr_read_b32 v207, a127
  v_cvt_pk_bf16_f32 v236, v200, v201
  v_cvt_pk_bf16_f32 v237, v202, v203
  v_cvt_pk_bf16_f32 v238, v204, v205
  v_cvt_pk_bf16_f32 v239, v206, v207
  s_nop 0
  v_permlane16_swap_b32 v236, v238
  v_permlane16_swap_b32 v237, v239
  buffer_store_dwordx4 v[236:239], v37, s[24:27], s36 offen offset:64
W_epiend:
  s_mov_b32 s32, 0
  s_cmp_eq_u32 s3, 6
  s_cbranch_scc1 W_next
  s_cmp_eq_u32 s3, 1
  s_cbranch_scc1 W_ret1
  s_cmp_eq_u32 s3, 2
  s_cbranch_scc1 W_ret2
  s_cmp_eq_u32 s3, 4
  s_cbranch_scc1 W_ret4
  s_cmp_eq_u32 s3, 5
  s_cbranch_scc1 W_ret5
  s_branch W_ret3
W_epi1:
  s_add_u32 s36, s31, 0x0
  v_accvgpr_read_b32 v192, a0
  v_accvgpr_read_b32 v193, a1
  v_accvgpr_read_b32 v194, a2
  v_accvgpr_read_b32 v195, a3
  v_accvgpr_read_b32 v196, a4
  v_accvgpr_read_b32 v197, a5
  v_accvgpr_read_b32 v198, a6
  v_accvgpr_read_b32 v199, a7
  v_cvt_pk_bf16_f32 v208, v192, v193
  v_cvt_pk_bf16_f32 v209, v194, v195
  v_cvt_pk_bf16_f32 v210, v196, v197
  v_cvt_pk_bf16_f32 v211, v198, v199
  buffer_store_dwordx4 v[208:211], v4, s[8:11], s36 offen offset:0 sc1
  v_accvgpr_read_b32 v200, a8
  v_accvgpr_read_b32 v201, a9
  v_accvgpr_read_b32 v202, a10
  v_accvgpr_read_b32 v203, a11
  v_accvgpr_read_b32 v204, a12
  v_accvgpr_read_b32 v205, a13
  v_accvgpr_read_b32 v206, a14
  v_accvgpr_read_b32 v207, a15
  v_cvt_pk_bf16_f32 v212, v200, v201
  v_cvt_pk_bf16_f32 v213, v202, v203
  v_cvt_pk_bf16_f32 v214, v204, v205
  v_cvt_pk_bf16_f32 v215, v206, v207
  buffer_store_dwordx4 v[212:215], v4, s[8:11], s36 offen offset:1024 sc1
  s_add_u32 s36, s31, 0x1000
  v_accvgpr_read_b32 v192, a16
  v_accvgpr_read_b32 v193, a17
  v_accvgpr_read_b32 v194, a18
  v_accvgpr_read_b32 v195, a19
  v_accvgpr_read_b32 v196, a20
  v_accvgpr_read_b32 v197, a21
  v_accvgpr_read_b32 v198, a22
  v_accvgpr_read_b32 v199, a23
  v_cvt_pk_bf16_f32 v216, v192, v193
  v_cvt_pk_bf16_f32 v217, v194, v195
  v_cvt_pk_bf16_f32 v218, v196, v197
  v_cvt_pk_bf16_f32 v219, v198, v199
  buffer_store_dwordx4 v[216:219], v4, s[8:11], s36 offen offset:0 sc1
  v_accvgpr_read_b32 v200, a24
  v_accvgpr_read_b32 v201, a25
  v_accvgpr_read_b32 v202, a26
  v_accvgpr_read_b32 v203, a27
  v_accvgpr_read_b32 v204, a28
  v_accvgpr_read_b32 v205, a29
  v_accvgpr_read_b32 v206, a30
  v_accvgpr_read_b32 v207, a31
  v_cvt_pk_bf16_f32 v220, v200, v201
  v_cvt_pk_bf16_f32 v221, v202, v203
  v_cvt_pk_bf16_f32 v222, v204, v205
  v_cvt_pk_bf16_f32 v223, v206, v207
  buffer_store_dwordx4 v[220:223], v4, s[8:11], s36 offen offset:1024 sc1
  s_add_u32 s36, s31, 0x40000
  v_accvgpr_read_b32 v192, a32
  v_accvgpr_read_b32 v193, a33
  v_accvgpr_read_b32 v194, a34
  v_accvgpr_read_b32 v195, a35
  v_accvgpr_read_b32 v196, a36
  v_accvgpr_read_b32 v197, a37
  v_accvgpr_read_b32 v198, a38
  v_accvgpr_read_b32 v199, a39
  v_cvt_pk_bf16_f32 v224, v192, v193
  v_cvt_pk_bf16_f32 v225, v194, v195
  v_cvt_pk_bf16_f32 v226, v196, v197
  v_cvt_pk_bf16_f32 v227, v198, v199
  buffer_store_dwordx4 v[224:227], v4, s[8:11], s36 offen offset:0 sc1
  v_accvgpr_read_b32 v200, a40
  v_accvgpr_read_b32 v201, a41
  v_accvgpr_read_b32 v202, a42
  v_accvgpr_read_b32 v203, a43
  v_accvgpr_read_b32 v204, a44
  v_accvgpr_read_b32 v205, a45
  v_accvgpr_read_b32 v206, a46
  v_accvgpr_read_b32 v207, a47
  v_cvt_pk_bf16_f32 v228, v200, v201
  v_cvt_pk_bf16_f32 v229, v202, v203
  v_cvt_pk_bf16_f32 v230, v204, v205
  v_cvt_pk_bf16_f32 v231, v206, v207
  buffer_store_dwordx4 v[228:231], v4, s[8:11], s36 offen offset:1024 sc1
  s_add_u32 s36, s31, 0x41000
  v_accvgpr_read_b32 v192, a48
  v_accvgpr_read_b32 v193, a49
  v_accvgpr_read_b32 v194, a50
  v_accvgpr_read_b32 v195, a51
  v_accvgpr_read_b32 v196, a52
  v_accvgpr_read_b32 v197, a53
  v_accvgpr_read_b32 v198, a54
  v_accvgpr_read_b32 v199, a55
  v_cvt_pk_bf16_f32 v232, v192, v193
  v_cvt_pk_bf16_f32 v233, v194, v195
  v_cvt_pk_bf16_f32 v234, v196, v197
  v_cvt_pk_bf16_f32 v235, v198, v199
  buffer_store_dwordx4 v[232:235], v4, s[8:11], s36 offen offset:0 sc1
  v_accvgpr_read_b32 v200, a56
  v_accvgpr_read_b32 v201, a57
  v_accvgpr_read_b32 v202, a58
  v_accvgpr_read_b32 v203, a59
  v_accvgpr_read_b32 v204, a60
  v_accvgpr_read_b32 v205, a61
  v_accvgpr_read_b32 v206, a62
  v_accvgpr_read_b32 v207, a63
  v_cvt_pk_bf16_f32 v236, v200, v201
  v_cvt_pk_bf16_f32 v237, v202, v203
  v_cvt_pk_bf16_f32 v238, v204, v205
  v_cvt_pk_bf16_f32 v239, v206, v207
  buffer_store_dwordx4 v[236:239], v4, s[8:11], s36 offen offset:1024 sc1
  s_branch W_epiend
W_epi2:
  s_add_u32 s36, s31, 0x0
  v_accvgpr_read_b32 v192, a0
  v_accvgpr_read_b32 v193, a1
  v_accvgpr_read_b32 v194, a2
  v_accvgpr_read_b32 v195, a3
  v_accvgpr_read_b32 v196, a16
  v_accvgpr_read_b32 v197, a17
  v_accvgpr_read_b32 v198, a18
  v_accvgpr_read_b32 v199, a19
  v_cvt_pk_bf16_f32 v208, v192, v193
  v_cvt_pk_bf16_f32 v209, v194, v195
  v_cvt_pk_bf16_f32 v210, v196, v197
  v_cvt_pk_bf16_f32 v211, v198, v199
  buffer_store_dwordx4 v[208:211], v4, s[8:11], s36 offen offset:0 sc1
  v_accvgpr_read_b32 v200, a4
  v_accvgpr_read_b32 v201, a5
  v_accvgpr_read_b32 v202, a6
  v_accvgpr_read_b32 v203, a7
  v_accvgpr_read_b32 v204, a20
  v_accvgpr_read_b32 v205, a21
  v_accvgpr_read_b32 v206, a22
  v_accvgpr_read_b32 v207, a23
  v_cvt_pk_bf16_f32 v212, v200, v201
  v_cvt_pk_bf16_f32 v213, v202, v203
  v_cvt_pk_bf16_f32 v214, v204, v205
  v_cvt_pk_bf16_f32 v215, v206, v207
  buffer_store_dwordx4 v[212:215], v4, s[8:11], s36 offen offset:1024 sc1
  v_accvgpr_read_b32 v192, a8
  v_accvgpr_read_b32 v193, a9
  v_accvgpr_read_b32 v194, a10
  v_accvgpr_read_b32 v195, a11
  v_accvgpr_read_b32 v196, a24
  v_accvgpr_read_b32 v197, a25
  v_accvgpr_read_b32 v198, a26
  v_accvgpr_read_b32 v199, a27
  v_cvt_pk_bf16_f32 v216, v192, v193
  v_cvt_pk_bf16_f32 v217, v194, v195
  v_cvt_pk_bf16_f32 v218, v196, v197
  v_cvt_pk_bf16_f32 v219, v198, v199
  buffer_store_dwordx4 v[216:219], v4, s[8:11], s36 offen offset:2048 sc1
  v_accvgpr_read_b32 v200, a12
  v_accvgpr_read_b32 v201, a13
  v_accvgpr_read_b32 v202, a14
  v_accvgpr_read_b32 v203, a15
  v_accvgpr_read_b32 v204, a28
  v_accvgpr_read_b32 v205, a29
  v_accvgpr_read_b32 v206, a30
  v_accvgpr_read_b32 v207, a31
  v_cvt_pk_bf16_f32 v220, v200, v201
  v_cvt_pk_bf16_f32 v221, v202, v203
  v_cvt_pk_bf16_f32 v222, v204, v205
  v_cvt_pk_bf16_f32 v223, v206, v207
  buffer_store_dwordx4 v[220:223], v4, s[8:11], s36 offen offset:3072 sc1
  s_add_u32 s36, s31, 0x40000
  v_accvgpr_read_b32 v192, a32
  v_accvgpr_read_b32 v193, a33
  v_accvgpr_read_b32 v194, a34
  v_accvgpr_read_b32 v195, a35
  v_accvgpr_read_b32 v196, a48
  v_accvgpr_read_b32 v197, a49
  v_accvgpr_read_b32 v198, a50
  v_accvgpr_read_b32 v199, a51
  v_cvt_pk_bf16_f32 v224, v192, v193
  v_cvt_pk_bf16_f32 v225, v194, v195
  v_cvt_pk_bf16_f32 v226, v196, v197
  v_cvt_pk_bf16_f32 v227, v198, v199
  buffer_store_dwordx4 v[224:227], v4, s[8:11], s36 offen offset:0 sc1
  v_accvgpr_read_b32 v200, a36
  v_accvgpr_read_b32 v201, a37
  v_accvgpr_read_b32 v202, a38
  v_accvgpr_read_b32 v203, a39
  v_accvgpr_read_b32 v204, a52
  v_accvgpr_read_b32 v205, a53
  v_accvgpr_read_b32 v206, a54
  v_accvgpr_read_b32 v207, a55
  v_cvt_pk_bf16_f32 v228, v200, v201
  v_cvt_pk_bf16_f32 v229, v202, v203
  v_cvt_pk_bf16_f32 v230, v204, v205
  v_cvt_pk_bf16_f32 v231, v206, v207
  buffer_store_dwordx4 v[228:231], v4, s[8:11], s36 offen offset:1024 sc1
  v_accvgpr_read_b32 v192, a40
  v_accvgpr_read_b32 v193, a41
  v_accvgpr_read_b32 v194, a42
  v_accvgpr_read_b32 v195, a43
  v_accvgpr_read_b32 v196, a56
  v_accvgpr_read_b32 v197, a57
  v_accvgpr_read_b32 v198, a58
  v_accvgpr_read_b32 v199, a59
  v_cvt_pk_bf16_f32 v232, v192, v193
  v_cvt_pk_bf16_f32 v233, v194, v195
  v_cvt_pk_bf16_f32 v234, v196, v197
  v_cvt_pk_bf16_f32 v235, v198, v199
  buffer_store_dwordx4 v[232:235], v4, s[8:11], s36 offen offset:2048 sc1
  v_accvgpr_read_b32 v200, a44
  v_accvgpr_read_b32 v201, a45
  v_accvgpr_read_b32 v202, a46
  v_accvgpr_read_b32 v203, a47
  v_accvgpr_read_b32 v204, a60
  v_accvgpr_read_b32 v205, a61
  v_accvgpr_read_b32 v206, a62
  v_accvgpr_read_b32 v207, a63
  v_cvt_pk_bf16_f32 v236, v200, v201
  v_cvt_pk_bf16_f32 v237, v202, v203
  v_cvt_pk_bf16_f32 v238, v204, v205
  v_cvt_pk_bf16_f32 v239, v206, v207
  buffer_store_dwordx4 v[236:239], v4, s[8:11], s36 offen offset:3072 sc1
  s_branch W_epiend
W_epi3:
  s_add_u32 s36, s31, 0x0
  v_accvgpr_read_b32 v192, a0
  v_accvgpr_read_b32 v193, a1
  v_accvgpr_read_b32 v194, a2
  v_accvgpr_read_b32 v195, a3
  v_accvgpr_read_b32 v196, a4
  v_accvgpr_read_b32 v197, a5
  v_accvgpr_read_b32 v198, a6
  v_accvgpr_read_b32 v199, a7
  v_cvt_pk_bf16_f32 v208, v192, v193
  v_cvt_pk_bf16_f32 v209, v194, v195
  v_cvt_pk_bf16_f32 v210, v196, v197
  v_cvt_pk_bf16_f32 v211, v198, v199
  buffer_store_dwordx4 v[208:211], v4, s[8:11], s36 offen offset:0 sc1
  v_accvgpr_read_b32 v200, a8
  v_accvgpr_read_b32 v201, a9
  v_accvgpr_read_b32 v202, a10
  v_accvgpr_read_b32 v203, a11
  v_accvgpr_read_b32 v204, a12
  v_accvgpr_read_b32 v205, a13
  v_accvgpr_read_b32 v206, a14
  v_accvgpr_read_b32 v207, a15
  v_cvt_pk_bf16_f32 v212, v200, v201
  v_cvt_pk_bf16_f32 v213, v202, v203
  v_cvt_pk_bf16_f32 v214, v204, v205
  v_cvt_pk_bf16_f32 v215, v206, v207
  buffer_store_dwordx4 v[212:215], v4, s[8:11], s36 offen offset:1024 sc1
  v_accvgpr_read_b32 v192, a16
  v_accvgpr_read_b32 v193, a17
  v_accvgpr_read_b32 v194, a18
  v_accvgpr_read_b32 v195, a19
  v_accvgpr_read_b32 v196, a20
  v_accvgpr_read_b32 v197, a21
  v_accvgpr_read_b32 v198, a22
  v_accvgpr_read_b32 v199, a23
  v_cvt_pk_bf16_f32 v216, v192, v193
  v_cvt_pk_bf16_f32 v217, v194, v195
  v_cvt_pk_bf16_f32 v218, v196, v197
  v_cvt_pk_bf16_f32 v219, v198, v199
  buffer_store_dwordx4 v[216:219], v4, s[8:11], s36 offen offset:2048 sc1
  v_accvgpr_read_b32 v200, a24
  v_accvgpr_read_b32 v201, a25
  v_accvgpr_read_b32 v202, a26
  v_accvgpr_read_b32 v203, a27
  v_accvgpr_read_b32 v204, a28
  v_accvgpr_read_b32 v205, a29
  v_accvgpr_read_b32 v206, a30
  v_accvgpr_read_b32 v207, a31
  v_cvt_pk_bf16_f32 v220, v200, v201
  v_cvt_pk_bf16_f32 v221, v202, v203
  v_cvt_pk_bf16_f32 v222, v204, v205
  v_cvt_pk_bf16_f32 v223, v206, v207
  buffer_store_dwordx4 v[220:223], v4, s[8:11], s36 offen offset:3072 sc1
  s_add_u32 s36, s31, 0x1000
  v_accvgpr_read_b32 v192, a32
  v_accvgpr_read_b32 v193, a33
  v_accvgpr_read_b32 v194, a34
  v_accvgpr_read_b32 v195, a35
  v_accvgpr_read_b32 v196, a36
  v_accvgpr_read_b32 v197, a37
  v_accvgpr_read_b32 v198, a38
  v_accvgpr_read_b32 v199, a39
  v_cvt_pk_bf16_f32 v224, v192, v193
  v_cvt_pk_bf16_f32 v225, v194, v195
  v_cvt_pk_bf16_f32 v226, v196, v197
  v_cvt_pk_bf16_f32 v227, v198, v199
  buffer_store_dwordx4 v[224:227], v4, s[8:11], s36 offen offset:0 sc1
  v_accvgpr_read_b32 v200, a40
  v_accvgpr_read_b32 v201, a41
  v_accvgpr_read_b32 v202, a42
  v_accvgpr_read_b32 v203, a43
  v_accvgpr_read_b32 v204, a44
  v_accvgpr_read_b32 v205, a45
  v_accvgpr_read_b32 v206, a46
  v_accvgpr_read_b32 v207, a47
  v_cvt_pk_bf16_f32 v228, v200, v201
  v_cvt_pk_bf16_f32 v229, v202, v203
  v_cvt_pk_bf16_f32 v230, v204, v205
  v_cvt_pk_bf16_f32 v231, v206, v207
  buffer_store_dwordx4 v[228:231], v4, s[8:11], s36 offen offset:1024 sc1
  v_accvgpr_read_b32 v192, a48
  v_accvgpr_read_b32 v193, a49
  v_accvgpr_read_b32 v194, a50
  v_accvgpr_read_b32 v195, a51
  v_accvgpr_read_b32 v196, a52
  v_accvgpr_read_b32 v197, a53
  v_accvgpr_read_b32 v198, a54
  v_accvgpr_read_b32 v199, a55
  v_cvt_pk_bf16_f32 v232, v192, v193
  v_cvt_pk_bf16_f32 v233, v194, v195
  v_cvt_pk_bf16_f32 v234, v196, v197
  v_cvt_pk_bf16_f32 v235, v198, v199
  buffer_store_dwordx4 v[232:235], v4, s[8:11], s36 offen offset:2048 sc1
  v_accvgpr_read_b32 v200, a56
  v_accvgpr_read_b32 v201, a57
  v_accvgpr_read_b32 v202, a58
  v_accvgpr_read_b32 v203, a59
  v_accvgpr_read_b32 v204, a60
  v_accvgpr_read_b32 v205, a61
  v_accvgpr_read_b32 v206, a62
  v_accvgpr_read_b32 v207, a63
  v_cvt_pk_bf16_f32 v236, v200, v201
  v_cvt_pk_bf16_f32 v237, v202, v203
  v_cvt_pk_bf16_f32 v238, v204, v205
  v_cvt_pk_bf16_f32 v239, v206, v207
  buffer_store_dwordx4 v[236:239], v4, s[8:11], s36 offen offset:3072 sc1
  s_add_u32 s36, s31, 0x40000
  v_accvgpr_read_b32 v192, a64
  v_accvgpr_read_b32 v193, a65
  v_accvgpr_read_b32 v194, a66
  v_accvgpr_read_b32 v195, a67
  v_accvgpr_read_b32 v196, a68
  v_accvgpr_read_b32 v197, a69
  v_accvgpr_read_b32 v198, a70
  v_accvgpr_read_b32 v199, a71
  v_cvt_pk_bf16_f32 v208, v192, v193
  v_cvt_pk_bf16_f32 v209, v194, v195
  v_cvt_pk_bf16_f32 v210, v196, v197
  v_cvt_pk_bf16_f32 v211, v198, v199
  buffer_store_dwordx4 v[208:211], v4, s[8:11], s36 offen offset:0 sc1
  v_accvgpr_read_b32 v200, a72
  v_accvgpr_read_b32 v201, a73
  v_accvgpr_read_b32 v202, a74
  v_accvgpr_read_b32 v203, a75
  v_accvgpr_read_b32 v204, a76
  v_accvgpr_read_b32 v205, a77
  v_accvgpr_read_b32 v206, a78
  v_accvgpr_read_b32 v207, a79
  v_cvt_pk_bf16_f32 v212, v200, v201
  v_cvt_pk_bf16_f32 v213, v202, v203
  v_cvt_pk_bf16_f32 v214, v204, v205
  v_cvt_pk_bf16_f32 v215, v206, v207
  buffer_store_dwordx4 v[212:215], v4, s[8:11], s36 offen offset:1024 sc1
  v_accvgpr_read_b32 v192, a80
  v_accvgpr_read_b32 v193, a81
  v_accvgpr_read_b32 v194, a82
  v_accvgpr_read_b32 v195, a83
  v_accvgpr_read_b32 v196, a84
  v_accvgpr_read_b32 v197, a85
  v_accvgpr_read_b32 v198, a86
  v_accvgpr_read_b32 v199, a87
  v_cvt_pk_bf16_f32 v216, v192, v193
  v_cvt_pk_bf16_f32 v217, v194, v195
  v_cvt_pk_bf16_f32 v218, v196, v197
  v_cvt_pk_bf16_f32 v219, v198, v199
  buffer_store_dwordx4 v[216:219], v4, s[8:11], s36 offen offset:2048 sc1
  v_accvgpr_read_b32 v200, a88
  v_accvgpr_read_b32 v201, a89
  v_accvgpr_read_b32 v202, a90
  v_accvgpr_read_b32 v203, a91
  v_accvgpr_read_b32 v204, a92
  v_accvgpr_read_b32 v205, a93
  v_accvgpr_read_b32 v206, a94
  v_accvgpr_read_b32 v207, a95
  v_cvt_pk_bf16_f32 v220, v200, v201
  v_cvt_pk_bf16_f32 v221, v202, v203
  v_cvt_pk_bf16_f32 v222, v204, v205
  v_cvt_pk_bf16_f32 v223, v206, v207
  buffer_store_dwordx4 v[220:223], v4, s[8:11], s36 offen offset:3072 sc1
  s_add_u32 s36, s31, 0x41000
  v_accvgpr_read_b32 v192, a96
  v_accvgpr_read_b32 v193, a97
  v_accvgpr_read_b32 v194, a98
  v_accvgpr_read_b32 v195, a99
  v_accvgpr_read_b32 v196, a100
  v_accvgpr_read_b32 v197, a101
  v_accvgpr_read_b32 v198, a102
  v_accvgpr_read_b32 v199, a103
  v_cvt_pk_bf16_f32 v224, v192, v193
  v_cvt_pk_bf16_f32 v225, v194, v195
  v_cvt_pk_bf16_f32 v226, v196, v197
  v_cvt_pk_bf16_f32 v227, v198, v199
  buffer_store_dwordx4 v[224:227], v4, s[8:11], s36 offen offset:0 sc1
  v_accvgpr_read_b32 v200, a104
  v_accvgpr_read_b32 v201, a105
  v_accvgpr_read_b32 v202, a106
  v_accvgpr_read_b32 v203, a107
  v_accvgpr_read_b32 v204, a108
  v_accvgpr_read_b32 v205, a109
  v_accvgpr_read_b32 v206, a110
  v_accvgpr_read_b32 v207, a111
  v_cvt_pk_bf16_f32 v228, v200, v201
  v_cvt_pk_bf16_f32 v229, v202, v203
  v_cvt_pk_bf16_f32 v230, v204, v205
  v_cvt_pk_bf16_f32 v231, v206, v207
  buffer_store_dwordx4 v[228:231], v4, s[8:11], s36 offen offset:1024 sc1
  v_accvgpr_read_b32 v192, a112
  v_accvgpr_read_b32 v193, a113
  v_accvgpr_read_b32 v194, a114
  v_accvgpr_read_b32 v195, a115
  v_accvgpr_read_b32 v196, a116
  v_accvgpr_read_b32 v197, a117
  v_accvgpr_read_b32 v198, a118
  v_accvgpr_read_b32 v199, a119
  v_cvt_pk_bf16_f32 v232, v192, v193
  v_cvt_pk_bf16_f32 v233, v194, v195
  v_cvt_pk_bf16_f32 v234, v196, v197
  v_cvt_pk_bf16_f32 v235, v198, v199
  buffer_store_dwordx4 v[232:235], v4, s[8:11], s36 offen offset:2048 sc1
  v_accvgpr_read_b32 v200, a120
  v_accvgpr_read_b32 v201, a121
  v_accvgpr_read_b32 v202, a122
  v_accvgpr_read_b32 v203, a123
  v_accvgpr_read_b32 v204, a124
  v_accvgpr_read_b32 v205, a125
  v_accvgpr_read_b32 v206, a126
  v_accvgpr_read_b32 v207, a127
  v_cvt_pk_bf16_f32 v236, v200, v201
  v_cvt_pk_bf16_f32 v237, v202, v203
  v_cvt_pk_bf16_f32 v238, v204, v205
  v_cvt_pk_bf16_f32 v239, v206, v207
  buffer_store_dwordx4 v[236:239], v4, s[8:11], s36 offen offset:3072 sc1
  s_add_u32 s36, s31, 0x80000
  v_accvgpr_read_b32 v192, a128
  v_accvgpr_read_b32 v193, a129
  v_accvgpr_read_b32 v194, a130
  v_accvgpr_read_b32 v195, a131
  v_accvgpr_read_b32 v196, a132
  v_accvgpr_read_b32 v197, a133
  v_accvgpr_read_b32 v198, a134
  v_accvgpr_read_b32 v199, a135
  v_cvt_pk_bf16_f32 v208, v192, v193
  v_cvt_pk_bf16_f32 v209, v194, v195
  v_cvt_pk_bf16_f32 v210, v196, v197
  v_cvt_pk_bf16_f32 v211, v198, v199
  buffer_store_dwordx4 v[208:211], v4, s[8:11], s36 offen offset:0 sc1
  v_accvgpr_read_b32 v200, a136
  v_accvgpr_read_b32 v201, a137
  v_accvgpr_read_b32 v202, a138
  v_accvgpr_read_b32 v203, a139
  v_accvgpr_read_b32 v204, a140
  v_accvgpr_read_b32 v205, a141
  v_accvgpr_read_b32 v206, a142
  v_accvgpr_read_b32 v207, a143
  v_cvt_pk_bf16_f32 v212, v200, v201
  v_cvt_pk_bf16_f32 v213, v202, v203
  v_cvt_pk_bf16_f32 v214, v204, v205
  v_cvt_pk_bf16_f32 v215, v206, v207
  buffer_store_dwordx4 v[212:215], v4, s[8:11], s36 offen offset:1024 sc1
  v_accvgpr_read_b32 v192, a144
  v_accvgpr_read_b32 v193, a145
  v_accvgpr_read_b32 v194, a146
  v_accvgpr_read_b32 v195, a147
  v_accvgpr_read_b32 v196, a148
  v_accvgpr_read_b32 v197, a149
  v_accvgpr_read_b32 v198, a150
  v_accvgpr_read_b32 v199, a151
  v_cvt_pk_bf16_f32 v216, v192, v193
  v_cvt_pk_bf16_f32 v217, v194, v195
  v_cvt_pk_bf16_f32 v218, v196, v197
  v_cvt_pk_bf16_f32 v219, v198, v199
  buffer_store_dwordx4 v[216:219], v4, s[8:11], s36 offen offset:2048 sc1
  v_accvgpr_read_b32 v200, a152
  v_accvgpr_read_b32 v201, a153
  v_accvgpr_read_b32 v202, a154
  v_accvgpr_read_b32 v203, a155
  v_accvgpr_read_b32 v204, a156
  v_accvgpr_read_b32 v205, a157
  v_accvgpr_read_b32 v206, a158
  v_accvgpr_read_b32 v207, a159
  v_cvt_pk_bf16_f32 v220, v200, v201
  v_cvt_pk_bf16_f32 v221, v202, v203
  v_cvt_pk_bf16_f32 v222, v204, v205
  v_cvt_pk_bf16_f32 v223, v206, v207
  buffer_store_dwordx4 v[220:223], v4, s[8:11], s36 offen offset:3072 sc1
  s_add_u32 s36, s31, 0x81000
  v_accvgpr_read_b32 v192, a160
  v_accvgpr_read_b32 v193, a161
  v_accvgpr_read_b32 v194, a162
  v_accvgpr_read_b32 v195, a163
  v_accvgpr_read_b32 v196, a164
  v_accvgpr_read_b32 v197, a165
  v_accvgpr_read_b32 v198, a166
  v_accvgpr_read_b32 v199, a167
  v_cvt_pk_bf16_f32 v224, v192, v193
  v_cvt_pk_bf16_f32 v225, v194, v195
  v_cvt_pk_bf16_f32 v226, v196, v197
  v_cvt_pk_bf16_f32 v227, v198, v199
  buffer_store_dwordx4 v[224:227], v4, s[8:11], s36 offen offset:0 sc1
  v_accvgpr_read_b32 v200, a168
  v_accvgpr_read_b32 v201, a169
  v_accvgpr_read_b32 v202, a170
  v_accvgpr_read_b32 v203, a171
  v_accvgpr_read_b32 v204, a172
  v_accvgpr_read_b32 v205, a173
  v_accvgpr_read_b32 v206, a174
  v_accvgpr_read_b32 v207, a175
  v_cvt_pk_bf16_f32 v228, v200, v201
  v_cvt_pk_bf16_f32 v229, v202, v203
  v_cvt_pk_bf16_f32 v230, v204, v205
  v_cvt_pk_bf16_f32 v231, v206, v207
  buffer_store_dwordx4 v[228:231], v4, s[8:11], s36 offen offset:1024 sc1
  v_accvgpr_read_b32 v192, a176
  v_accvgpr_read_b32 v193, a177
  v_accvgpr_read_b32 v194, a178
  v_accvgpr_read_b32 v195, a179
  v_accvgpr_read_b32 v196, a180
  v_accvgpr_read_b32 v197, a181
  v_accvgpr_read_b32 v198, a182
  v_accvgpr_read_b32 v199, a183
  v_cvt_pk_bf16_f32 v232, v192, v193
  v_cvt_pk_bf16_f32 v233, v194, v195
  v_cvt_pk_bf16_f32 v234, v196, v197
  v_cvt_pk_bf16_f32 v235, v198, v199
  buffer_store_dwordx4 v[232:235], v4, s[8:11], s36 offen offset:2048 sc1
  v_accvgpr_read_b32 v200, a184
  v_accvgpr_read_b32 v201, a185
  v_accvgpr_read_b32 v202, a186
  v_accvgpr_read_b32 v203, a187
  v_accvgpr_read_b32 v204, a188
  v_accvgpr_read_b32 v205, a189
  v_accvgpr_read_b32 v206, a190
  v_accvgpr_read_b32 v207, a191
  v_cvt_pk_bf16_f32 v236, v200, v201
  v_cvt_pk_bf16_f32 v237, v202, v203
  v_cvt_pk_bf16_f32 v238, v204, v205
  v_cvt_pk_bf16_f32 v239, v206, v207
  buffer_store_dwordx4 v[236:239], v4, s[8:11], s36 offen offset:3072 sc1
  s_add_u32 s36, s31, 0xc0000
  v_accvgpr_read_b32 v192, a192
  v_accvgpr_read_b32 v193, a193
  v_accvgpr_read_b32 v194, a194
  v_accvgpr_read_b32 v195, a195
  v_accvgpr_read_b32 v196, a196
  v_accvgpr_read_b32 v197, a197
  v_accvgpr_read_b32 v198, a198
  v_accvgpr_read_b32 v199, a199
  v_cvt_pk_bf16_f32 v208, v192, v193
  v_cvt_pk_bf16_f32 v209, v194, v195
  v_cvt_pk_bf16_f32 v210, v196, v197
  v_cvt_pk_bf16_f32 v211, v198, v199
  buffer_store_dwordx4 v[208:211], v4, s[8:11], s36 offen offset:0 sc1
  v_accvgpr_read_b32 v200, a200
  v_accvgpr_read_b32 v201, a201
  v_accvgpr_read_b32 v202, a202
  v_accvgpr_read_b32 v203, a203
  v_accvgpr_read_b32 v204, a204
  v_accvgpr_read_b32 v205, a205
  v_accvgpr_read_b32 v206, a206
  v_accvgpr_read_b32 v207, a207
  v_cvt_pk_bf16_f32 v212, v200, v201
  v_cvt_pk_bf16_f32 v213, v202, v203
  v_cvt_pk_bf16_f32 v214, v204, v205
  v_cvt_pk_bf16_f32 v215, v206, v207
  buffer_store_dwordx4 v[212:215], v4, s[8:11], s36 offen offset:1024 sc1
  v_accvgpr_read_b32 v192, a208
  v_accvgpr_read_b32 v193, a209
  v_accvgpr_read_b32 v194, a210
  v_accvgpr_read_b32 v195, a211
  v_accvgpr_read_b32 v196, a212
  v_accvgpr_read_b32 v197, a213
  v_accvgpr_read_b32 v198, a214
  v_accvgpr_read_b32 v199, a215
  v_cvt_pk_bf16_f32 v216, v192, v193
  v_cvt_pk_bf16_f32 v217, v194, v195
  v_cvt_pk_bf16_f32 v218, v196, v197
  v_cvt_pk_bf16_f32 v219, v198, v199
  buffer_store_dwordx4 v[216:219], v4, s[8:11], s36 offen offset:2048 sc1
  v_accvgpr_read_b32 v200, a216
  v_accvgpr_read_b32 v201, a217
  v_accvgpr_read_b32 v202, a218
  v_accvgpr_read_b32 v203, a219
  v_accvgpr_read_b32 v204, a220
  v_accvgpr_read_b32 v205, a221
  v_accvgpr_read_b32 v206, a222
  v_accvgpr_read_b32 v207, a223
  v_cvt_pk_bf16_f32 v220, v200, v201
  v_cvt_pk_bf16_f32 v221, v202, v203
  v_cvt_pk_bf16_f32 v222, v204, v205
  v_cvt_pk_bf16_f32 v223, v206, v207
  buffer_store_dwordx4 v[220:223], v4, s[8:11], s36 offen offset:3072 sc1
  s_add_u32 s36, s31, 0xc1000
  v_accvgpr_read_b32 v192, a224
  v_accvgpr_read_b32 v193, a225
  v_accvgpr_read_b32 v194, a226
  v_accvgpr_read_b32 v195, a227
  v_accvgpr_read_b32 v196, a228
  v_accvgpr_read_b32 v197, a229
  v_accvgpr_read_b32 v198, a230
  v_accvgpr_read_b32 v199, a231
  v_cvt_pk_bf16_f32 v224, v192, v193
  v_cvt_pk_bf16_f32 v225, v194, v195
  v_cvt_pk_bf16_f32 v226, v196, v197
  v_cvt_pk_bf16_f32 v227, v198, v199
  buffer_store_dwordx4 v[224:227], v4, s[8:11], s36 offen offset:0 sc1
  v_accvgpr_read_b32 v200, a232
  v_accvgpr_read_b32 v201, a233
  v_accvgpr_read_b32 v202, a234
  v_accvgpr_read_b32 v203, a235
  v_accvgpr_read_b32 v204, a236
  v_accvgpr_read_b32 v205, a237
  v_accvgpr_read_b32 v206, a238
  v_accvgpr_read_b32 v207, a239
  v_cvt_pk_bf16_f32 v228, v200, v201
  v_cvt_pk_bf16_f32 v229, v202, v203
  v_cvt_pk_bf16_f32 v230, v204, v205
  v_cvt_pk_bf16_f32 v231, v206, v207
  buffer_store_dwordx4 v[228:231], v4, s[8:11], s36 offen offset:1024 sc1
  v_accvgpr_read_b32 v192, a240
  v_accvgpr_read_b32 v193, a241
  v_accvgpr_read_b32 v194, a242
  v_accvgpr_read_b32 v195, a243
  v_accvgpr_read_b32 v196, a244
  v_accvgpr_read_b32 v197, a245
  v_accvgpr_read_b32 v198, a246
  v_accvgpr_read_b32 v199, a247
  v_cvt_pk_bf16_f32 v232, v192, v193
  v_cvt_pk_bf16_f32 v233, v194, v195
  v_cvt_pk_bf16_f32 v234, v196, v197
  v_cvt_pk_bf16_f32 v235, v198, v199
  buffer_store_dwordx4 v[232:235], v4, s[8:11], s36 offen offset:2048 sc1
  v_accvgpr_read_b32 v200, a248
  v_accvgpr_read_b32 v201, a249
  v_accvgpr_read_b32 v202, a250
  v_accvgpr_read_b32 v203, a251
  v_accvgpr_read_b32 v204, a252
  v_accvgpr_read_b32 v205, a253
  v_accvgpr_read_b32 v206, a254
  v_accvgpr_read_b32 v207, a255
  v_cvt_pk_bf16_f32 v236, v200, v201
  v_cvt_pk_bf16_f32 v237, v202, v203
  v_cvt_pk_bf16_f32 v238, v204, v205
  v_cvt_pk_bf16_f32 v239, v206, v207
  buffer_store_dwordx4 v[236:239], v4, s[8:11], s36 offen offset:3072 sc1
  s_branch W_epiend
W_epi4:
  v_lshrrev_b32 v1, 4, v0
  v_lshlrev_b32 v38, 9, v1
  v_bfe_u32 v1, v0, 3, 1
  v_lshl_add_u32 v38, v1, 8, v38
  v_and_b32 v1, 7, v0
  v_lshl_add_u32 v38, v1, 4, v38
  s_add_u32 s36, s31, 0x0
  v_accvgpr_read_b32 v192, a0
  v_accvgpr_read_b32 v193, a1
  v_accvgpr_read_b32 v194, a2
  v_accvgpr_read_b32 v195, a3
  v_accvgpr_read_b32 v196, a4
  v_accvgpr_read_b32 v197, a5
  v_accvgpr_read_b32 v198, a6
  v_accvgpr_read_b32 v199, a7
  v_pk_mul_f32 v[192:193], v[192:193], s[50:51]
  v_pk_mul_f32 v[194:195], v[194:195], s[50:51]
  v_pk_mul_f32 v[196:197], v[196:197], s[50:51]
  v_pk_mul_f32 v[198:199], v[198:199], s[50:51]
  v_cvt_pk_bf16_f32 v208, v192, v193
  v_cvt_pk_bf16_f32 v209, v194, v195
  v_cvt_pk_bf16_f32 v210, v196, v197
  v_cvt_pk_bf16_f32 v211, v198, v199
  buffer_store_dwordx4 v[208:211], v38, s[8:11], s36 offen offset:0 sc1
  v_accvgpr_read_b32 v200, a32
  v_accvgpr_read_b32 v201, a33
  v_accvgpr_read_b32 v202, a34
  v_accvgpr_read_b32 v203, a35
  v_accvgpr_read_b32 v204, a36
  v_accvgpr_read_b32 v205, a37
  v_accvgpr_read_b32 v206, a38
  v_accvgpr_read_b32 v207, a39
  v_pk_mul_f32 v[200:201], v[200:201], s[50:51]
  v_pk_mul_f32 v[202:203], v[202:203], s[50:51]
  v_pk_mul_f32 v[204:205], v[204:205], s[50:51]
  v_pk_mul_f32 v[206:207], v[206:207], s[50:51]
  v_cvt_pk_bf16_f32 v212, v200, v201
  v_cvt_pk_bf16_f32 v213, v202, v203
  v_cvt_pk_bf16_f32 v214, v204, v205
  v_cvt_pk_bf16_f32 v215, v206, v207
  buffer_store_dwordx4 v[212:215], v38, s[8:11], s36 offen offset:128 sc1
  v_accvgpr_read_b32 v192, a64
  v_accvgpr_read_b32 v193, a65
  v_accvgpr_read_b32 v194, a66
  v_accvgpr_read_b32 v195, a67
  v_accvgpr_read_b32 v196, a68
  v_accvgpr_read_b32 v197, a69
  v_accvgpr_read_b32 v198, a70
  v_accvgpr_read_b32 v199, a71
  v_pk_mul_f32 v[192:193], v[192:193], s[50:51]
  v_pk_mul_f32 v[194:195], v[194:195], s[50:51]
  v_pk_mul_f32 v[196:197], v[196:197], s[50:51]
  v_pk_mul_f32 v[198:199], v[198:199], s[50:51]
  v_cvt_pk_bf16_f32 v216, v192, v193
  v_cvt_pk_bf16_f32 v217, v194, v195
  v_cvt_pk_bf16_f32 v218, v196, v197
  v_cvt_pk_bf16_f32 v219, v198, v199
  buffer_store_dwordx4 v[216:219], v38, s[8:11], s36 offen offset:2048 sc1
  v_accvgpr_read_b32 v200, a96
  v_accvgpr_read_b32 v201, a97
  v_accvgpr_read_b32 v202, a98
  v_accvgpr_read_b32 v203, a99
  v_accvgpr_read_b32 v204, a100
  v_accvgpr_read_b32 v205, a101
  v_accvgpr_read_b32 v206, a102
  v_accvgpr_read_b32 v207, a103
  v_pk_mul_f32 v[200:201], v[200:201], s[50:51]
  v_pk_mul_f32 v[202:203], v[202:203], s[50:51]
  v_pk_mul_f32 v[204:205], v[204:205], s[50:51]
  v_pk_mul_f32 v[206:207], v[206:207], s[50:51]
  v_cvt_pk_bf16_f32 v220, v200, v201
  v_cvt_pk_bf16_f32 v221, v202, v203
  v_cvt_pk_bf16_f32 v222, v204, v205
  v_cvt_pk_bf16_f32 v223, v206, v207
  buffer_store_dwordx4 v[220:223], v38, s[8:11], s36 offen offset:2176 sc1
  s_add_u32 s36, s31, 0x1000
  v_accvgpr_read_b32 v192, a128
  v_accvgpr_read_b32 v193, a129
  v_accvgpr_read_b32 v194, a130
  v_accvgpr_read_b32 v195, a131
  v_accvgpr_read_b32 v196, a132
  v_accvgpr_read_b32 v197, a133
  v_accvgpr_read_b32 v198, a134
  v_accvgpr_read_b32 v199, a135
  v_pk_mul_f32 v[192:193], v[192:193], s[50:51]
  v_pk_mul_f32 v[194:195], v[194:195], s[50:51]
  v_pk_mul_f32 v[196:197], v[196:197], s[50:51]
  v_pk_mul_f32 v[198:199], v[198:199], s[50:51]
  v_cvt_pk_bf16_f32 v224, v192, v193
  v_cvt_pk_bf16_f32 v225, v194, v195
  v_cvt_pk_bf16_f32 v226, v196, v197
  v_cvt_pk_bf16_f32 v227, v198, v199
  buffer_store_dwordx4 v[224:227], v38, s[8:11], s36 offen offset:0 sc1
  v_accvgpr_read_b32 v200, a160
  v_accvgpr_read_b32 v201, a161
  v_accvgpr_read_b32 v202, a162
  v_accvgpr_read_b32 v203, a163
  v_accvgpr_read_b32 v204, a164
  v_accvgpr_read_b32 v205, a165
  v_accvgpr_read_b32 v206, a166
  v_accvgpr_read_b32 v207, a167
  v_pk_mul_f32 v[200:201], v[200:201], s[50:51]
  v_pk_mul_f32 v[202:203], v[202:203], s[50:51]
  v_pk_mul_f32 v[204:205], v[204:205], s[50:51]
  v_pk_mul_f32 v[206:207], v[206:207], s[50:51]
  v_cvt_pk_bf16_f32 v228, v200, v201
  v_cvt_pk_bf16_f32 v229, v202, v203
  v_cvt_pk_bf16_f32 v230, v204, v205
  v_cvt_pk_bf16_f32 v231, v206, v207
  buffer_store_dwordx4 v[228:231], v38, s[8:11], s36 offen offset:128 sc1
  v_accvgpr_read_b32 v192, a192
  v_accvgpr_read_b32 v193, a193
  v_accvgpr_read_b32 v194, a194
  v_accvgpr_read_b32 v195, a195
  v_accvgpr_read_b32 v196, a196
  v_accvgpr_read_b32 v197, a197
  v_accvgpr_read_b32 v198, a198
  v_accvgpr_read_b32 v199, a199
  v_pk_mul_f32 v[192:193], v[192:193], s[50:51]
  v_pk_mul_f32 v[194:195], v[194:195], s[50:51]
  v_pk_mul_f32 v[196:197], v[196:197], s[50:51]
  v_pk_mul_f32 v[198:199], v[198:199], s[50:51]
  v_cvt_pk_bf16_f32 v232, v192, v193
  v_cvt_pk_bf16_f32 v233, v194, v195
  v_cvt_pk_bf16_f32 v234, v196, v197
  v_cvt_pk_bf16_f32 v235, v198, v199
  buffer_store_dwordx4 v[232:235], v38, s[8:11], s36 offen offset:2048 sc1
  v_accvgpr_read_b32 v200, a224
  v_accvgpr_read_b32 v201, a225
  v_accvgpr_read_b32 v202, a226
  v_accvgpr_read_b32 v203, a227
  v_accvgpr_read_b32 v204, a228
  v_accvgpr_read_b32 v205, a229
  v_accvgpr_read_b32 v206, a230
  v_accvgpr_read_b32 v207, a231
  v_pk_mul_f32 v[200:201], v[200:201], s[50:51]
  v_pk_mul_f32 v[202:203], v[202:203], s[50:51]
  v_pk_mul_f32 v[204:205], v[204:205], s[50:51]
  v_pk_mul_f32 v[206:207], v[206:207], s[50:51]
  v_cvt_pk_bf16_f32 v236, v200, v201
  v_cvt_pk_bf16_f32 v237, v202, v203
  v_cvt_pk_bf16_f32 v238, v204, v205
  v_cvt_pk_bf16_f32 v239, v206, v207
  buffer_store_dwordx4 v[236:239], v38, s[8:11], s36 offen offset:2176 sc1
  s_add_u32 s36, s31, 0x20000
  v_accvgpr_read_b32 v192, a8
  v_accvgpr_read_b32 v193, a9
  v_accvgpr_read_b32 v194, a10
  v_accvgpr_read_b32 v195, a11
  v_accvgpr_read_b32 v196, a12
  v_accvgpr_read_b32 v197, a13
  v_accvgpr_read_b32 v198, a14
  v_accvgpr_read_b32 v199, a15
  v_pk_mul_f32 v[192:193], v[192:193], s[50:51]
  v_pk_mul_f32 v[194:195], v[194:195], s[50:51]
  v_pk_mul_f32 v[196:197], v[196:197], s[50:51]
  v_pk_mul_f32 v[198:199], v[198:199], s[50:51]
  v_cvt_pk_bf16_f32 v208, v192, v193
  v_cvt_pk_bf16_f32 v209, v194, v195
  v_cvt_pk_bf16_f32 v210, v196, v197
  v_cvt_pk_bf16_f32 v211, v198, v199
  buffer_store_dwordx4 v[208:211], v38, s[8:11], s36 offen offset:0 sc1
  v_accvgpr_read_b32 v200, a40
  v_accvgpr_read_b32 v201, a41
  v_accvgpr_read_b32 v202, a42
  v_accvgpr_read_b32 v203, a43
  v_accvgpr_read_b32 v204, a44
  v_accvgpr_read_b32 v205, a45
  v_accvgpr_read_b32 v206, a46
  v_accvgpr_read_b32 v207, a47
  v_pk_mul_f32 v[200:201], v[200:201], s[50:51]
  v_pk_mul_f32 v[202:203], v[202:203], s[50:51]
  v_pk_mul_f32 v[204:205], v[204:205], s[50:51]
  v_pk_mul_f32 v[206:207], v[206:207], s[50:51]
  v_cvt_pk_bf16_f32 v212, v200, v201
  v_cvt_pk_bf16_f32 v213, v202, v203
  v_cvt_pk_bf16_f32 v214, v204, v205
  v_cvt_pk_bf16_f32 v215, v206, v207
  buffer_store_dwordx4 v[212:215], v38, s[8:11], s36 offen offset:128 sc1
  v_accvgpr_read_b32 v192, a72
  v_accvgpr_read_b32 v193, a73
  v_accvgpr_read_b32 v194, a74
  v_accvgpr_read_b32 v195, a75
  v_accvgpr_read_b32 v196, a76
  v_accvgpr_read_b32 v197, a77
  v_accvgpr_read_b32 v198, a78
  v_accvgpr_read_b32 v199, a79
  v_pk_mul_f32 v[192:193], v[192:193], s[50:51]
  v_pk_mul_f32 v[194:195], v[194:195], s[50:51]
  v_pk_mul_f32 v[196:197], v[196:197], s[50:51]
  v_pk_mul_f32 v[198:199], v[198:199], s[50:51]
  v_cvt_pk_bf16_f32 v216, v192, v193
  v_cvt_pk_bf16_f32 v217, v194, v195
  v_cvt_pk_bf16_f32 v218, v196, v197
  v_cvt_pk_bf16_f32 v219, v198, v199
  buffer_store_dwordx4 v[216:219], v38, s[8:11], s36 offen offset:2048 sc1
  v_accvgpr_read_b32 v200, a104
  v_accvgpr_read_b32 v201, a105
  v_accvgpr_read_b32 v202, a106
  v_accvgpr_read_b32 v203, a107
  v_accvgpr_read_b32 v204, a108
  v_accvgpr_read_b32 v205, a109
  v_accvgpr_read_b32 v206, a110
  v_accvgpr_read_b32 v207, a111
  v_pk_mul_f32 v[200:201], v[200:201], s[50:51]
  v_pk_mul_f32 v[202:203], v[202:203], s[50:51]
  v_pk_mul_f32 v[204:205], v[204:205], s[50:51]
  v_pk_mul_f32 v[206:207], v[206:207], s[50:51]
  v_cvt_pk_bf16_f32 v220, v200, v201
  v_cvt_pk_bf16_f32 v221, v202, v203
  v_cvt_pk_bf16_f32 v222, v204, v205
  v_cvt_pk_bf16_f32 v223, v206, v207
  buffer_store_dwordx4 v[220:223], v38, s[8:11], s36 offen offset:2176 sc1
  s_add_u32 s36, s31, 0x21000
  v_accvgpr_read_b32 v192, a136
  v_accvgpr_read_b32 v193, a137
  v_accvgpr_read_b32 v194, a138
  v_accvgpr_read_b32 v195, a139
  v_accvgpr_read_b32 v196, a140
  v_accvgpr_read_b32 v197, a141
  v_accvgpr_read_b32 v198, a142
  v_accvgpr_read_b32 v199, a143
  v_pk_mul_f32 v[192:193], v[192:193], s[50:51]
  v_pk_mul_f32 v[194:195], v[194:195], s[50:51]
  v_pk_mul_f32 v[196:197], v[196:197], s[50:51]
  v_pk_mul_f32 v[198:199], v[198:199], s[50:51]
  v_cvt_pk_bf16_f32 v224, v192, v193
  v_cvt_pk_bf16_f32 v225, v194, v195
  v_cvt_pk_bf16_f32 v226, v196, v197
  v_cvt_pk_bf16_f32 v227, v198, v199
  buffer_store_dwordx4 v[224:227], v38, s[8:11], s36 offen offset:0 sc1
  v_accvgpr_read_b32 v200, a168
  v_accvgpr_read_b32 v201, a169
  v_accvgpr_read_b32 v202, a170
  v_accvgpr_read_b32 v203, a171
  v_accvgpr_read_b32 v204, a172
  v_accvgpr_read_b32 v205, a173
  v_accvgpr_read_b32 v206, a174
  v_accvgpr_read_b32 v207, a175
  v_pk_mul_f32 v[200:201], v[200:201], s[50:51]
  v_pk_mul_f32 v[202:203], v[202:203], s[50:51]
  v_pk_mul_f32 v[204:205], v[204:205], s[50:51]
  v_pk_mul_f32 v[206:207], v[206:207], s[50:51]
  v_cvt_pk_bf16_f32 v228, v200, v201
  v_cvt_pk_bf16_f32 v229, v202, v203
  v_cvt_pk_bf16_f32 v230, v204, v205
  v_cvt_pk_bf16_f32 v231, v206, v207
  buffer_store_dwordx4 v[228:231], v38, s[8:11], s36 offen offset:128 sc1
  v_accvgpr_read_b32 v192, a200
  v_accvgpr_read_b32 v193, a201
  v_accvgpr_read_b32 v194, a202
  v_accvgpr_read_b32 v195, a203
  v_accvgpr_read_b32 v196, a204
  v_accvgpr_read_b32 v197, a205
  v_accvgpr_read_b32 v198, a206
  v_accvgpr_read_b32 v199, a207
  v_pk_mul_f32 v[192:193], v[192:193], s[50:51]
  v_pk_mul_f32 v[194:195], v[194:195], s[50:51]
  v_pk_mul_f32 v[196:197], v[196:197], s[50:51]
  v_pk_mul_f32 v[198:199], v[198:199], s[50:51]
  v_cvt_pk_bf16_f32 v232, v192, v193
  v_cvt_pk_bf16_f32 v233, v194, v195
  v_cvt_pk_bf16_f32 v234, v196, v197
  v_cvt_pk_bf16_f32 v235, v198, v199
  buffer_store_dwordx4 v[232:235], v38, s[8:11], s36 offen offset:2048 sc1
  v_accvgpr_read_b32 v200, a232
  v_accvgpr_read_b32 v201, a233
  v_accvgpr_read_b32 v202, a234
  v_accvgpr_read_b32 v203, a235
  v_accvgpr_read_b32 v204, a236
  v_accvgpr_read_b32 v205, a237
  v_accvgpr_read_b32 v206, a238
  v_accvgpr_read_b32 v207, a239
  v_pk_mul_f32 v[200:201], v[200:201], s[50:51]
  v_pk_mul_f32 v[202:203], v[202:203], s[50:51]
  v_pk_mul_f32 v[204:205], v[204:205], s[50:51]
  v_pk_mul_f32 v[206:207], v[206:207], s[50:51]
  v_cvt_pk_bf16_f32 v236, v200, v201
  v_cvt_pk_bf16_f32 v237, v202, v203
  v_cvt_pk_bf16_f32 v238, v204, v205
  v_cvt_pk_bf16_f32 v239, v206, v207
  buffer_store_dwordx4 v[236:239], v38, s[8:11], s36 offen offset:2176 sc1
  s_add_u32 s36, s31, 0x40000
  v_accvgpr_read_b32 v192, a16
  v_accvgpr_read_b32 v193, a17
  v_accvgpr_read_b32 v194, a18
  v_accvgpr_read_b32 v195, a19
  v_accvgpr_read_b32 v196, a20
  v_accvgpr_read_b32 v197, a21
  v_accvgpr_read_b32 v198, a22
  v_accvgpr_read_b32 v199, a23
  v_pk_mul_f32 v[192:193], v[192:193], s[50:51]
  v_pk_mul_f32 v[194:195], v[194:195], s[50:51]
  v_pk_mul_f32 v[196:197], v[196:197], s[50:51]
  v_pk_mul_f32 v[198:199], v[198:199], s[50:51]
  v_cvt_pk_bf16_f32 v208, v192, v193
  v_cvt_pk_bf16_f32 v209, v194, v195
  v_cvt_pk_bf16_f32 v210, v196, v197
  v_cvt_pk_bf16_f32 v211, v198, v199
  buffer_store_dwordx4 v[208:211], v38, s[8:11], s36 offen offset:0 sc1
  v_accvgpr_read_b32 v200, a48
  v_accvgpr_read_b32 v201, a49
  v_accvgpr_read_b32 v202, a50
  v_accvgpr_read_b32 v203, a51
  v_accvgpr_read_b32 v204, a52
  v_accvgpr_read_b32 v205, a53
  v_accvgpr_read_b32 v206, a54
  v_accvgpr_read_b32 v207, a55
  v_pk_mul_f32 v[200:201], v[200:201], s[50:51]
  v_pk_mul_f32 v[202:203], v[202:203], s[50:51]
  v_pk_mul_f32 v[204:205], v[204:205], s[50:51]
  v_pk_mul_f32 v[206:207], v[206:207], s[50:51]
  v_cvt_pk_bf16_f32 v212, v200, v201
  v_cvt_pk_bf16_f32 v213, v202, v203
  v_cvt_pk_bf16_f32 v214, v204, v205
  v_cvt_pk_bf16_f32 v215, v206, v207
  buffer_store_dwordx4 v[212:215], v38, s[8:11], s36 offen offset:128 sc1
  v_accvgpr_read_b32 v192, a80
  v_accvgpr_read_b32 v193, a81
  v_accvgpr_read_b32 v194, a82
  v_accvgpr_read_b32 v195, a83
  v_accvgpr_read_b32 v196, a84
  v_accvgpr_read_b32 v197, a85
  v_accvgpr_read_b32 v198, a86
  v_accvgpr_read_b32 v199, a87
  v_pk_mul_f32 v[192:193], v[192:193], s[50:51]
  v_pk_mul_f32 v[194:195], v[194:195], s[50:51]
  v_pk_mul_f32 v[196:197], v[196:197], s[50:51]
  v_pk_mul_f32 v[198:199], v[198:199], s[50:51]
  v_cvt_pk_bf16_f32 v216, v192, v193
  v_cvt_pk_bf16_f32 v217, v194, v195
  v_cvt_pk_bf16_f32 v218, v196, v197
  v_cvt_pk_bf16_f32 v219, v198, v199
  buffer_store_dwordx4 v[216:219], v38, s[8:11], s36 offen offset:2048 sc1
  v_accvgpr_read_b32 v200, a112
  v_accvgpr_read_b32 v201, a113
  v_accvgpr_read_b32 v202, a114
  v_accvgpr_read_b32 v203, a115
  v_accvgpr_read_b32 v204, a116
  v_accvgpr_read_b32 v205, a117
  v_accvgpr_read_b32 v206, a118
  v_accvgpr_read_b32 v207, a119
  v_pk_mul_f32 v[200:201], v[200:201], s[50:51]
  v_pk_mul_f32 v[202:203], v[202:203], s[50:51]
  v_pk_mul_f32 v[204:205], v[204:205], s[50:51]
  v_pk_mul_f32 v[206:207], v[206:207], s[50:51]
  v_cvt_pk_bf16_f32 v220, v200, v201
  v_cvt_pk_bf16_f32 v221, v202, v203
  v_cvt_pk_bf16_f32 v222, v204, v205
  v_cvt_pk_bf16_f32 v223, v206, v207
  buffer_store_dwordx4 v[220:223], v38, s[8:11], s36 offen offset:2176 sc1
  s_add_u32 s36, s31, 0x41000
  v_accvgpr_read_b32 v192, a144
  v_accvgpr_read_b32 v193, a145
  v_accvgpr_read_b32 v194, a146
  v_accvgpr_read_b32 v195, a147
  v_accvgpr_read_b32 v196, a148
  v_accvgpr_read_b32 v197, a149
  v_accvgpr_read_b32 v198, a150
  v_accvgpr_read_b32 v199, a151
  v_pk_mul_f32 v[192:193], v[192:193], s[50:51]
  v_pk_mul_f32 v[194:195], v[194:195], s[50:51]
  v_pk_mul_f32 v[196:197], v[196:197], s[50:51]
  v_pk_mul_f32 v[198:199], v[198:199], s[50:51]
  v_cvt_pk_bf16_f32 v224, v192, v193
  v_cvt_pk_bf16_f32 v225, v194, v195
  v_cvt_pk_bf16_f32 v226, v196, v197
  v_cvt_pk_bf16_f32 v227, v198, v199
  buffer_store_dwordx4 v[224:227], v38, s[8:11], s36 offen offset:0 sc1
  v_accvgpr_read_b32 v200, a176
  v_accvgpr_read_b32 v201, a177
  v_accvgpr_read_b32 v202, a178
  v_accvgpr_read_b32 v203, a179
  v_accvgpr_read_b32 v204, a180
  v_accvgpr_read_b32 v205, a181
  v_accvgpr_read_b32 v206, a182
  v_accvgpr_read_b32 v207, a183
  v_pk_mul_f32 v[200:201], v[200:201], s[50:51]
  v_pk_mul_f32 v[202:203], v[202:203], s[50:51]
  v_pk_mul_f32 v[204:205], v[204:205], s[50:51]
  v_pk_mul_f32 v[206:207], v[206:207], s[50:51]
  v_cvt_pk_bf16_f32 v228, v200, v201
  v_cvt_pk_bf16_f32 v229, v202, v203
  v_cvt_pk_bf16_f32 v230, v204, v205
  v_cvt_pk_bf16_f32 v231, v206, v207
  buffer_store_dwordx4 v[228:231], v38, s[8:11], s36 offen offset:128 sc1
  v_accvgpr_read_b32 v192, a208
  v_accvgpr_read_b32 v193, a209
  v_accvgpr_read_b32 v194, a210
  v_accvgpr_read_b32 v195, a211
  v_accvgpr_read_b32 v196, a212
  v_accvgpr_read_b32 v197, a213
  v_accvgpr_read_b32 v198, a214
  v_accvgpr_read_b32 v199, a215
  v_pk_mul_f32 v[192:193], v[192:193], s[50:51]
  v_pk_mul_f32 v[194:195], v[194:195], s[50:51]
  v_pk_mul_f32 v[196:197], v[196:197], s[50:51]
  v_pk_mul_f32 v[198:199], v[198:199], s[50:51]
  v_cvt_pk_bf16_f32 v232, v192, v193
  v_cvt_pk_bf16_f32 v233, v194, v195
  v_cvt_pk_bf16_f32 v234, v196, v197
  v_cvt_pk_bf16_f32 v235, v198, v199
  buffer_store_dwordx4 v[232:235], v38, s[8:11], s36 offen offset:2048 sc1
  v_accvgpr_read_b32 v200, a240
  v_accvgpr_read_b32 v201, a241
  v_accvgpr_read_b32 v202, a242
  v_accvgpr_read_b32 v203, a243
  v_accvgpr_read_b32 v204, a244
  v_accvgpr_read_b32 v205, a245
  v_accvgpr_read_b32 v206, a246
  v_accvgpr_read_b32 v207, a247
  v_pk_mul_f32 v[200:201], v[200:201], s[50:51]
  v_pk_mul_f32 v[202:203], v[202:203], s[50:51]
  v_pk_mul_f32 v[204:205], v[204:205], s[50:51]
  v_pk_mul_f32 v[206:207], v[206:207], s[50:51]
  v_cvt_pk_bf16_f32 v236, v200, v201
  v_cvt_pk_bf16_f32 v237, v202, v203
  v_cvt_pk_bf16_f32 v238, v204, v205
  v_cvt_pk_bf16_f32 v239, v206, v207
  buffer_store_dwordx4 v[236:239], v38, s[8:11], s36 offen offset:2176 sc1
  s_add_u32 s36, s31, 0x60000
  v_accvgpr_read_b32 v192, a24
  v_accvgpr_read_b32 v193, a25
  v_accvgpr_read_b32 v194, a26
  v_accvgpr_read_b32 v195, a27
  v_accvgpr_read_b32 v196, a28
  v_accvgpr_read_b32 v197, a29
  v_accvgpr_read_b32 v198, a30
  v_accvgpr_read_b32 v199, a31
  v_pk_mul_f32 v[192:193], v[192:193], s[50:51]
  v_pk_mul_f32 v[194:195], v[194:195], s[50:51]
  v_pk_mul_f32 v[196:197], v[196:197], s[50:51]
  v_pk_mul_f32 v[198:199], v[198:199], s[50:51]
  v_cvt_pk_bf16_f32 v208, v192, v193
  v_cvt_pk_bf16_f32 v209, v194, v195
  v_cvt_pk_bf16_f32 v210, v196, v197
  v_cvt_pk_bf16_f32 v211, v198, v199
  buffer_store_dwordx4 v[208:211], v38, s[8:11], s36 offen offset:0 sc1
  v_accvgpr_read_b32 v200, a56
  v_accvgpr_read_b32 v201, a57
  v_accvgpr_read_b32 v202, a58
  v_accvgpr_read_b32 v203, a59
  v_accvgpr_read_b32 v204, a60
  v_accvgpr_read_b32 v205, a61
  v_accvgpr_read_b32 v206, a62
  v_accvgpr_read_b32 v207, a63
  v_pk_mul_f32 v[200:201], v[200:201], s[50:51]
  v_pk_mul_f32 v[202:203], v[202:203], s[50:51]
  v_pk_mul_f32 v[204:205], v[204:205], s[50:51]
  v_pk_mul_f32 v[206:207], v[206:207], s[50:51]
  v_cvt_pk_bf16_f32 v212, v200, v201
  v_cvt_pk_bf16_f32 v213, v202, v203
  v_cvt_pk_bf16_f32 v214, v204, v205
  v_cvt_pk_bf16_f32 v215, v206, v207
  buffer_store_dwordx4 v[212:215], v38, s[8:11], s36 offen offset:128 sc1
  v_accvgpr_read_b32 v192, a88
  v_accvgpr_read_b32 v193, a89
  v_accvgpr_read_b32 v194, a90
  v_accvgpr_read_b32 v195, a91
  v_accvgpr_read_b32 v196, a92
  v_accvgpr_read_b32 v197, a93
  v_accvgpr_read_b32 v198, a94
  v_accvgpr_read_b32 v199, a95
  v_pk_mul_f32 v[192:193], v[192:193], s[50:51]
  v_pk_mul_f32 v[194:195], v[194:195], s[50:51]
  v_pk_mul_f32 v[196:197], v[196:197], s[50:51]
  v_pk_mul_f32 v[198:199], v[198:199], s[50:51]
  v_cvt_pk_bf16_f32 v216, v192, v193
  v_cvt_pk_bf16_f32 v217, v194, v195
  v_cvt_pk_bf16_f32 v218, v196, v197
  v_cvt_pk_bf16_f32 v219, v198, v199
  buffer_store_dwordx4 v[216:219], v38, s[8:11], s36 offen offset:2048 sc1
  v_accvgpr_read_b32 v200, a120
  v_accvgpr_read_b32 v201, a121
  v_accvgpr_read_b32 v202, a122
  v_accvgpr_read_b32 v203, a123
  v_accvgpr_read_b32 v204, a124
  v_accvgpr_read_b32 v205, a125
  v_accvgpr_read_b32 v206, a126
  v_accvgpr_read_b32 v207, a127
  v_pk_mul_f32 v[200:201], v[200:201], s[50:51]
  v_pk_mul_f32 v[202:203], v[202:203], s[50:51]
  v_pk_mul_f32 v[204:205], v[204:205], s[50:51]
  v_pk_mul_f32 v[206:207], v[206:207], s[50:51]
  v_cvt_pk_bf16_f32 v220, v200, v201
  v_cvt_pk_bf16_f32 v221, v202, v203
  v_cvt_pk_bf16_f32 v222, v204, v205
  v_cvt_pk_bf16_f32 v223, v206, v207
  buffer_store_dwordx4 v[220:223], v38, s[8:11], s36 offen offset:2176 sc1
  s_add_u32 s36, s31, 0x61000
  v_accvgpr_read_b32 v192, a152
  v_accvgpr_read_b32 v193, a153
  v_accvgpr_read_b32 v194, a154
  v_accvgpr_read_b32 v195, a155
  v_accvgpr_read_b32 v196, a156
  v_accvgpr_read_b32 v197, a157
  v_accvgpr_read_b32 v198, a158
  v_accvgpr_read_b32 v199, a159
  v_pk_mul_f32 v[192:193], v[192:193], s[50:51]
  v_pk_mul_f32 v[194:195], v[194:195], s[50:51]
  v_pk_mul_f32 v[196:197], v[196:197], s[50:51]
  v_pk_mul_f32 v[198:199], v[198:199], s[50:51]
  v_cvt_pk_bf16_f32 v224, v192, v193
  v_cvt_pk_bf16_f32 v225, v194, v195
  v_cvt_pk_bf16_f32 v226, v196, v197
  v_cvt_pk_bf16_f32 v227, v198, v199
  buffer_store_dwordx4 v[224:227], v38, s[8:11], s36 offen offset:0 sc1
  v_accvgpr_read_b32 v200, a184
  v_accvgpr_read_b32 v201, a185
  v_accvgpr_read_b32 v202, a186
  v_accvgpr_read_b32 v203, a187
  v_accvgpr_read_b32 v204, a188
  v_accvgpr_read_b32 v205, a189
  v_accvgpr_read_b32 v206, a190
  v_accvgpr_read_b32 v207, a191
  v_pk_mul_f32 v[200:201], v[200:201], s[50:51]
  v_pk_mul_f32 v[202:203], v[202:203], s[50:51]
  v_pk_mul_f32 v[204:205], v[204:205], s[50:51]
  v_pk_mul_f32 v[206:207], v[206:207], s[50:51]
  v_cvt_pk_bf16_f32 v228, v200, v201
  v_cvt_pk_bf16_f32 v229, v202, v203
  v_cvt_pk_bf16_f32 v230, v204, v205
  v_cvt_pk_bf16_f32 v231, v206, v207
  buffer_store_dwordx4 v[228:231], v38, s[8:11], s36 offen offset:128 sc1
  v_accvgpr_read_b32 v192, a216
  v_accvgpr_read_b32 v193, a217
  v_accvgpr_read_b32 v194, a218
  v_accvgpr_read_b32 v195, a219
  v_accvgpr_read_b32 v196, a220
  v_accvgpr_read_b32 v197, a221
  v_accvgpr_read_b32 v198, a222
  v_accvgpr_read_b32 v199, a223
  v_pk_mul_f32 v[192:193], v[192:193], s[50:51]
  v_pk_mul_f32 v[194:195], v[194:195], s[50:51]
  v_pk_mul_f32 v[196:197], v[196:197], s[50:51]
  v_pk_mul_f32 v[198:199], v[198:199], s[50:51]
  v_cvt_pk_bf16_f32 v232, v192, v193
  v_cvt_pk_bf16_f32 v233, v194, v195
  v_cvt_pk_bf16_f32 v234, v196, v197
  v_cvt_pk_bf16_f32 v235, v198, v199
  buffer_store_dwordx4 v[232:235], v38, s[8:11], s36 offen offset:2048 sc1
  v_accvgpr_read_b32 v200, a248
  v_accvgpr_read_b32 v201, a249
  v_accvgpr_read_b32 v202, a250
  v_accvgpr_read_b32 v203, a251
  v_accvgpr_read_b32 v204, a252
  v_accvgpr_read_b32 v205, a253
  v_accvgpr_read_b32 v206, a254
  v_accvgpr_read_b32 v207, a255
  v_pk_mul_f32 v[200:201], v[200:201], s[50:51]
  v_pk_mul_f32 v[202:203], v[202:203], s[50:51]
  v_pk_mul_f32 v[204:205], v[204:205], s[50:51]
  v_pk_mul_f32 v[206:207], v[206:207], s[50:51]
  v_cvt_pk_bf16_f32 v236, v200, v201
  v_cvt_pk_bf16_f32 v237, v202, v203
  v_cvt_pk_bf16_f32 v238, v204, v205
  v_cvt_pk_bf16_f32 v239, v206, v207
  buffer_store_dwordx4 v[236:239], v38, s[8:11], s36 offen offset:2176 sc1
  s_branch W_epiend
W_epi5:
  s_add_u32 s36, s31, 0x0
  v_accvgpr_read_b32 v192, a0
  v_accvgpr_read_b32 v193, a1
  v_accvgpr_read_b32 v194, a2
  v_accvgpr_read_b32 v195, a3
  v_accvgpr_read_b32 v196, a32
  v_accvgpr_read_b32 v197, a33
  v_accvgpr_read_b32 v198, a34
  v_accvgpr_read_b32 v199, a35
  v_cvt_pk_bf16_f32 v208, v192, v193
  v_cvt_pk_bf16_f32 v209, v194, v195
  v_cvt_pk_bf16_f32 v210, v196, v197
  v_cvt_pk_bf16_f32 v211, v198, v199
  buffer_store_dwordx4 v[208:211], v4, s[8:11], s36 offen offset:0 sc1
  v_accvgpr_read_b32 v200, a4
  v_accvgpr_read_b32 v201, a5
  v_accvgpr_read_b32 v202, a6
  v_accvgpr_read_b32 v203, a7
  v_accvgpr_read_b32 v204, a36
  v_accvgpr_read_b32 v205, a37
  v_accvgpr_read_b32 v206, a38
  v_accvgpr_read_b32 v207, a39
  v_cvt_pk_bf16_f32 v212, v200, v201
  v_cvt_pk_bf16_f32 v213, v202, v203
  v_cvt_pk_bf16_f32 v214, v204, v205
  v_cvt_pk_bf16_f32 v215, v206, v207
  buffer_store_dwordx4 v[212:215], v4, s[8:11], s36 offen offset:1024 sc1
  v_accvgpr_read_b32 v192, a8
  v_accvgpr_read_b32 v193, a9
  v_accvgpr_read_b32 v194, a10
  v_accvgpr_read_b32 v195, a11
  v_accvgpr_read_b32 v196, a40
  v_accvgpr_read_b32 v197, a41
  v_accvgpr_read_b32 v198, a42
  v_accvgpr_read_b32 v199, a43
  v_cvt_pk_bf16_f32 v216, v192, v193
  v_cvt_pk_bf16_f32 v217, v194, v195
  v_cvt_pk_bf16_f32 v218, v196, v197
  v_cvt_pk_bf16_f32 v219, v198, v199
  buffer_store_dwordx4 v[216:219], v4, s[8:11], s36 offen offset:2048 sc1
  v_accvgpr_read_b32 v200, a12
  v_accvgpr_read_b32 v201, a13
  v_accvgpr_read_b32 v202, a14
  v_accvgpr_read_b32 v203, a15
  v_accvgpr_read_b32 v204, a44
  v_accvgpr_read_b32 v205, a45
  v_accvgpr_read_b32 v206, a46
  v_accvgpr_read_b32 v207, a47
  v_cvt_pk_bf16_f32 v220, v200, v201
  v_cvt_pk_bf16_f32 v221, v202, v203
  v_cvt_pk_bf16_f32 v222, v204, v205
  v_cvt_pk_bf16_f32 v223, v206, v207
  buffer_store_dwordx4 v[220:223], v4, s[8:11], s36 offen offset:3072 sc1
  s_add_u32 s36, s31, 0x1000
  v_accvgpr_read_b32 v192, a16
  v_accvgpr_read_b32 v193, a17
  v_accvgpr_read_b32 v194, a18
  v_accvgpr_read_b32 v195, a19
  v_accvgpr_read_b32 v196, a48
  v_accvgpr_read_b32 v197, a49
  v_accvgpr_read_b32 v198, a50
  v_accvgpr_read_b32 v199, a51
  v_cvt_pk_bf16_f32 v224, v192, v193
  v_cvt_pk_bf16_f32 v225, v194, v195
  v_cvt_pk_bf16_f32 v226, v196, v197
  v_cvt_pk_bf16_f32 v227, v198, v199
  buffer_store_dwordx4 v[224:227], v4, s[8:11], s36 offen offset:0 sc1
  v_accvgpr_read_b32 v200, a20
  v_accvgpr_read_b32 v201, a21
  v_accvgpr_read_b32 v202, a22
  v_accvgpr_read_b32 v203, a23
  v_accvgpr_read_b32 v204, a52
  v_accvgpr_read_b32 v205, a53
  v_accvgpr_read_b32 v206, a54
  v_accvgpr_read_b32 v207, a55
  v_cvt_pk_bf16_f32 v228, v200, v201
  v_cvt_pk_bf16_f32 v229, v202, v203
  v_cvt_pk_bf16_f32 v230, v204, v205
  v_cvt_pk_bf16_f32 v231, v206, v207
  buffer_store_dwordx4 v[228:231], v4, s[8:11], s36 offen offset:1024 sc1
  v_accvgpr_read_b32 v192, a24
  v_accvgpr_read_b32 v193, a25
  v_accvgpr_read_b32 v194, a26
  v_accvgpr_read_b32 v195, a27
  v_accvgpr_read_b32 v196, a56
  v_accvgpr_read_b32 v197, a57
  v_accvgpr_read_b32 v198, a58
  v_accvgpr_read_b32 v199, a59
  v_cvt_pk_bf16_f32 v232, v192, v193
  v_cvt_pk_bf16_f32 v233, v194, v195
  v_cvt_pk_bf16_f32 v234, v196, v197
  v_cvt_pk_bf16_f32 v235, v198, v199
  buffer_store_dwordx4 v[232:235], v4, s[8:11], s36 offen offset:2048 sc1
  v_accvgpr_read_b32 v200, a28
  v_accvgpr_read_b32 v201, a29
  v_accvgpr_read_b32 v202, a30
  v_accvgpr_read_b32 v203, a31
  v_accvgpr_read_b32 v204, a60
  v_accvgpr_read_b32 v205, a61
  v_accvgpr_read_b32 v206, a62
  v_accvgpr_read_b32 v207, a63
  v_cvt_pk_bf16_f32 v236, v200, v201
  v_cvt_pk_bf16_f32 v237, v202, v203
  v_cvt_pk_bf16_f32 v238, v204, v205
  v_cvt_pk_bf16_f32 v239, v206, v207
  buffer_store_dwordx4 v[236:239], v4, s[8:11], s36 offen offset:3072 sc1
  s_add_u32 s36, s31, 0x40000
  v_accvgpr_read_b32 v192, a64
  v_accvgpr_read_b32 v193, a65
  v_accvgpr_read_b32 v194, a66
  v_accvgpr_read_b32 v195, a67
  v_accvgpr_read_b32 v196, a96
  v_accvgpr_read_b32 v197, a97
  v_accvgpr_read_b32 v198, a98
  v_accvgpr_read_b32 v199, a99
  v_cvt_pk_bf16_f32 v208, v192, v193
  v_cvt_pk_bf16_f32 v209, v194, v195
  v_cvt_pk_bf16_f32 v210, v196, v197
  v_cvt_pk_bf16_f32 v211, v198, v199
  buffer_store_dwordx4 v[208:211], v4, s[8:11], s36 offen offset:0 sc1
  v_accvgpr_read_b32 v200, a68
  v_accvgpr_read_b32 v201, a69
  v_accvgpr_read_b32 v202, a70
  v_accvgpr_read_b32 v203, a71
  v_accvgpr_read_b32 v204, a100
  v_accvgpr_read_b32 v205, a101
  v_accvgpr_read_b32 v206, a102
  v_accvgpr_read_b32 v207, a103
  v_cvt_pk_bf16_f32 v212, v200, v201
  v_cvt_pk_bf16_f32 v213, v202, v203
  v_cvt_pk_bf16_f32 v214, v204, v205
  v_cvt_pk_bf16_f32 v215, v206, v207
  buffer_store_dwordx4 v[212:215], v4, s[8:11], s36 offen offset:1024 sc1
  v_accvgpr_read_b32 v192, a72
  v_accvgpr_read_b32 v193, a73
  v_accvgpr_read_b32 v194, a74
  v_accvgpr_read_b32 v195, a75
  v_accvgpr_read_b32 v196, a104
  v_accvgpr_read_b32 v197, a105
  v_accvgpr_read_b32 v198, a106
  v_accvgpr_read_b32 v199, a107
  v_cvt_pk_bf16_f32 v216, v192, v193
  v_cvt_pk_bf16_f32 v217, v194, v195
  v_cvt_pk_bf16_f32 v218, v196, v197
  v_cvt_pk_bf16_f32 v219, v198, v199
  buffer_store_dwordx4 v[216:219], v4, s[8:11], s36 offen offset:2048 sc1
  v_accvgpr_read_b32 v200, a76
  v_accvgpr_read_b32 v201, a77
  v_accvgpr_read_b32 v202, a78
  v_accvgpr_read_b32 v203, a79
  v_accvgpr_read_b32 v204, a108
  v_accvgpr_read_b32 v205, a109
  v_accvgpr_read_b32 v206, a110
  v_accvgpr_read_b32 v207, a111
  v_cvt_pk_bf16_f32 v220, v200, v201
  v_cvt_pk_bf16_f32 v221, v202, v203
  v_cvt_pk_bf16_f32 v222, v204, v205
  v_cvt_pk_bf16_f32 v223, v206, v207
  buffer_store_dwordx4 v[220:223], v4, s[8:11], s36 offen offset:3072 sc1
  s_add_u32 s36, s31, 0x41000
  v_accvgpr_read_b32 v192, a80
  v_accvgpr_read_b32 v193, a81
  v_accvgpr_read_b32 v194, a82
  v_accvgpr_read_b32 v195, a83
  v_accvgpr_read_b32 v196, a112
  v_accvgpr_read_b32 v197, a113
  v_accvgpr_read_b32 v198, a114
  v_accvgpr_read_b32 v199, a115
  v_cvt_pk_bf16_f32 v224, v192, v193
  v_cvt_pk_bf16_f32 v225, v194, v195
  v_cvt_pk_bf16_f32 v226, v196, v197
  v_cvt_pk_bf16_f32 v227, v198, v199
  buffer_store_dwordx4 v[224:227], v4, s[8:11], s36 offen offset:0 sc1
  v_accvgpr_read_b32 v200, a84
  v_accvgpr_read_b32 v201, a85
  v_accvgpr_read_b32 v202, a86
  v_accvgpr_read_b32 v203, a87
  v_accvgpr_read_b32 v204, a116
  v_accvgpr_read_b32 v205, a117
  v_accvgpr_read_b32 v206, a118
  v_accvgpr_read_b32 v207, a119
  v_cvt_pk_bf16_f32 v228, v200, v201
  v_cvt_pk_bf16_f32 v229, v202, v203
  v_cvt_pk_bf16_f32 v230, v204, v205
  v_cvt_pk_bf16_f32 v231, v206, v207
  buffer_store_dwordx4 v[228:231], v4, s[8:11], s36 offen offset:1024 sc1
  v_accvgpr_read_b32 v192, a88
  v_accvgpr_read_b32 v193, a89
  v_accvgpr_read_b32 v194, a90
  v_accvgpr_read_b32 v195, a91
  v_accvgpr_read_b32 v196, a120
  v_accvgpr_read_b32 v197, a121
  v_accvgpr_read_b32 v198, a122
  v_accvgpr_read_b32 v199, a123
  v_cvt_pk_bf16_f32 v232, v192, v193
  v_cvt_pk_bf16_f32 v233, v194, v195
  v_cvt_pk_bf16_f32 v234, v196, v197
  v_cvt_pk_bf16_f32 v235, v198, v199
  buffer_store_dwordx4 v[232:235], v4, s[8:11], s36 offen offset:2048 sc1
  v_accvgpr_read_b32 v200, a92
  v_accvgpr_read_b32 v201, a93
  v_accvgpr_read_b32 v202, a94
  v_accvgpr_read_b32 v203, a95
  v_accvgpr_read_b32 v204, a124
  v_accvgpr_read_b32 v205, a125
  v_accvgpr_read_b32 v206, a126
  v_accvgpr_read_b32 v207, a127
  v_cvt_pk_bf16_f32 v236, v200, v201
  v_cvt_pk_bf16_f32 v237, v202, v203
  v_cvt_pk_bf16_f32 v238, v204, v205
  v_cvt_pk_bf16_f32 v239, v206, v207
  buffer_store_dwordx4 v[236:239], v4, s[8:11], s36 offen offset:3072 sc1
  s_add_u32 s36, s31, 0x80000
  v_accvgpr_read_b32 v192, a128
  v_accvgpr_read_b32 v193, a129
  v_accvgpr_read_b32 v194, a130
  v_accvgpr_read_b32 v195, a131
  v_accvgpr_read_b32 v196, a160
  v_accvgpr_read_b32 v197, a161
  v_accvgpr_read_b32 v198, a162
  v_accvgpr_read_b32 v199, a163
  v_cvt_pk_bf16_f32 v208, v192, v193
  v_cvt_pk_bf16_f32 v209, v194, v195
  v_cvt_pk_bf16_f32 v210, v196, v197
  v_cvt_pk_bf16_f32 v211, v198, v199
  buffer_store_dwordx4 v[208:211], v4, s[8:11], s36 offen offset:0 sc1
  v_accvgpr_read_b32 v200, a132
  v_accvgpr_read_b32 v201, a133
  v_accvgpr_read_b32 v202, a134
  v_accvgpr_read_b32 v203, a135
  v_accvgpr_read_b32 v204, a164
  v_accvgpr_read_b32 v205, a165
  v_accvgpr_read_b32 v206, a166
  v_accvgpr_read_b32 v207, a167
  v_cvt_pk_bf16_f32 v212, v200, v201
  v_cvt_pk_bf16_f32 v213, v202, v203
  v_cvt_pk_bf16_f32 v214, v204, v205
  v_cvt_pk_bf16_f32 v215, v206, v207
  buffer_store_dwordx4 v[212:215], v4, s[8:11], s36 offen offset:1024 sc1
  v_accvgpr_read_b32 v192, a136
  v_accvgpr_read_b32 v193, a137
  v_accvgpr_read_b32 v194, a138
  v_accvgpr_read_b32 v195, a139
  v_accvgpr_read_b32 v196, a168
  v_accvgpr_read_b32 v197, a169
  v_accvgpr_read_b32 v198, a170
  v_accvgpr_read_b32 v199, a171
  v_cvt_pk_bf16_f32 v216, v192, v193
  v_cvt_pk_bf16_f32 v217, v194, v195
  v_cvt_pk_bf16_f32 v218, v196, v197
  v_cvt_pk_bf16_f32 v219, v198, v199
  buffer_store_dwordx4 v[216:219], v4, s[8:11], s36 offen offset:2048 sc1
  v_accvgpr_read_b32 v200, a140
  v_accvgpr_read_b32 v201, a141
  v_accvgpr_read_b32 v202, a142
  v_accvgpr_read_b32 v203, a143
  v_accvgpr_read_b32 v204, a172
  v_accvgpr_read_b32 v205, a173
  v_accvgpr_read_b32 v206, a174
  v_accvgpr_read_b32 v207, a175
  v_cvt_pk_bf16_f32 v220, v200, v201
  v_cvt_pk_bf16_f32 v221, v202, v203
  v_cvt_pk_bf16_f32 v222, v204, v205
  v_cvt_pk_bf16_f32 v223, v206, v207
  buffer_store_dwordx4 v[220:223], v4, s[8:11], s36 offen offset:3072 sc1
  s_add_u32 s36, s31, 0x81000
  v_accvgpr_read_b32 v192, a144
  v_accvgpr_read_b32 v193, a145
  v_accvgpr_read_b32 v194, a146
  v_accvgpr_read_b32 v195, a147
  v_accvgpr_read_b32 v196, a176
  v_accvgpr_read_b32 v197, a177
  v_accvgpr_read_b32 v198, a178
  v_accvgpr_read_b32 v199, a179
  v_cvt_pk_bf16_f32 v224, v192, v193
  v_cvt_pk_bf16_f32 v225, v194, v195
  v_cvt_pk_bf16_f32 v226, v196, v197
  v_cvt_pk_bf16_f32 v227, v198, v199
  buffer_store_dwordx4 v[224:227], v4, s[8:11], s36 offen offset:0 sc1
  v_accvgpr_read_b32 v200, a148
  v_accvgpr_read_b32 v201, a149
  v_accvgpr_read_b32 v202, a150
  v_accvgpr_read_b32 v203, a151
  v_accvgpr_read_b32 v204, a180
  v_accvgpr_read_b32 v205, a181
  v_accvgpr_read_b32 v206, a182
  v_accvgpr_read_b32 v207, a183
  v_cvt_pk_bf16_f32 v228, v200, v201
  v_cvt_pk_bf16_f32 v229, v202, v203
  v_cvt_pk_bf16_f32 v230, v204, v205
  v_cvt_pk_bf16_f32 v231, v206, v207
  buffer_store_dwordx4 v[228:231], v4, s[8:11], s36 offen offset:1024 sc1
  v_accvgpr_read_b32 v192, a152
  v_accvgpr_read_b32 v193, a153
  v_accvgpr_read_b32 v194, a154
  v_accvgpr_read_b32 v195, a155
  v_accvgpr_read_b32 v196, a184
  v_accvgpr_read_b32 v197, a185
  v_accvgpr_read_b32 v198, a186
  v_accvgpr_read_b32 v199, a187
  v_cvt_pk_bf16_f32 v232, v192, v193
  v_cvt_pk_bf16_f32 v233, v194, v195
  v_cvt_pk_bf16_f32 v234, v196, v197
  v_cvt_pk_bf16_f32 v235, v198, v199
  buffer_store_dwordx4 v[232:235], v4, s[8:11], s36 offen offset:2048 sc1
  v_accvgpr_read_b32 v200, a156
  v_accvgpr_read_b32 v201, a157
  v_accvgpr_read_b32 v202, a158
  v_accvgpr_read_b32 v203, a159
  v_accvgpr_read_b32 v204, a188
  v_accvgpr_read_b32 v205, a189
  v_accvgpr_read_b32 v206, a190
  v_accvgpr_read_b32 v207, a191
  v_cvt_pk_bf16_f32 v236, v200, v201
  v_cvt_pk_bf16_f32 v237, v202, v203
  v_cvt_pk_bf16_f32 v238, v204, v205
  v_cvt_pk_bf16_f32 v239, v206, v207
  buffer_store_dwordx4 v[236:239], v4, s[8:11], s36 offen offset:3072 sc1
  s_add_u32 s36, s31, 0xc0000
  v_accvgpr_read_b32 v192, a192
  v_accvgpr_read_b32 v193, a193
  v_accvgpr_read_b32 v194, a194
  v_accvgpr_read_b32 v195, a195
  v_accvgpr_read_b32 v196, a224
  v_accvgpr_read_b32 v197, a225
  v_accvgpr_read_b32 v198, a226
  v_accvgpr_read_b32 v199, a227
  v_cvt_pk_bf16_f32 v208, v192, v193
  v_cvt_pk_bf16_f32 v209, v194, v195
  v_cvt_pk_bf16_f32 v210, v196, v197
  v_cvt_pk_bf16_f32 v211, v198, v199
  buffer_store_dwordx4 v[208:211], v4, s[8:11], s36 offen offset:0 sc1
  v_accvgpr_read_b32 v200, a196
  v_accvgpr_read_b32 v201, a197
  v_accvgpr_read_b32 v202, a198
  v_accvgpr_read_b32 v203, a199
  v_accvgpr_read_b32 v204, a228
  v_accvgpr_read_b32 v205, a229
  v_accvgpr_read_b32 v206, a230
  v_accvgpr_read_b32 v207, a231
  v_cvt_pk_bf16_f32 v212, v200, v201
  v_cvt_pk_bf16_f32 v213, v202, v203
  v_cvt_pk_bf16_f32 v214, v204, v205
  v_cvt_pk_bf16_f32 v215, v206, v207
  buffer_store_dwordx4 v[212:215], v4, s[8:11], s36 offen offset:1024 sc1
  v_accvgpr_read_b32 v192, a200
  v_accvgpr_read_b32 v193, a201
  v_accvgpr_read_b32 v194, a202
  v_accvgpr_read_b32 v195, a203
  v_accvgpr_read_b32 v196, a232
  v_accvgpr_read_b32 v197, a233
  v_accvgpr_read_b32 v198, a234
  v_accvgpr_read_b32 v199, a235
  v_cvt_pk_bf16_f32 v216, v192, v193
  v_cvt_pk_bf16_f32 v217, v194, v195
  v_cvt_pk_bf16_f32 v218, v196, v197
  v_cvt_pk_bf16_f32 v219, v198, v199
  buffer_store_dwordx4 v[216:219], v4, s[8:11], s36 offen offset:2048 sc1
  v_accvgpr_read_b32 v200, a204
  v_accvgpr_read_b32 v201, a205
  v_accvgpr_read_b32 v202, a206
  v_accvgpr_read_b32 v203, a207
  v_accvgpr_read_b32 v204, a236
  v_accvgpr_read_b32 v205, a237
  v_accvgpr_read_b32 v206, a238
  v_accvgpr_read_b32 v207, a239
  v_cvt_pk_bf16_f32 v220, v200, v201
  v_cvt_pk_bf16_f32 v221, v202, v203
  v_cvt_pk_bf16_f32 v222, v204, v205
  v_cvt_pk_bf16_f32 v223, v206, v207
  buffer_store_dwordx4 v[220:223], v4, s[8:11], s36 offen offset:3072 sc1
  s_add_u32 s36, s31, 0xc1000
  v_accvgpr_read_b32 v192, a208
  v_accvgpr_read_b32 v193, a209
  v_accvgpr_read_b32 v194, a210
  v_accvgpr_read_b32 v195, a211
  v_accvgpr_read_b32 v196, a240
  v_accvgpr_read_b32 v197, a241
  v_accvgpr_read_b32 v198, a242
  v_accvgpr_read_b32 v199, a243
  v_cvt_pk_bf16_f32 v224, v192, v193
  v_cvt_pk_bf16_f32 v225, v194, v195
  v_cvt_pk_bf16_f32 v226, v196, v197
  v_cvt_pk_bf16_f32 v227, v198, v199
  buffer_store_dwordx4 v[224:227], v4, s[8:11], s36 offen offset:0 sc1
  v_accvgpr_read_b32 v200, a212
  v_accvgpr_read_b32 v201, a213
  v_accvgpr_read_b32 v202, a214
  v_accvgpr_read_b32 v203, a215
  v_accvgpr_read_b32 v204, a244
  v_accvgpr_read_b32 v205, a245
  v_accvgpr_read_b32 v206, a246
  v_accvgpr_read_b32 v207, a247
  v_cvt_pk_bf16_f32 v228, v200, v201
  v_cvt_pk_bf16_f32 v229, v202, v203
  v_cvt_pk_bf16_f32 v230, v204, v205
  v_cvt_pk_bf16_f32 v231, v206, v207
  buffer_store_dwordx4 v[228:231], v4, s[8:11], s36 offen offset:1024 sc1
  v_accvgpr_read_b32 v192, a216
  v_accvgpr_read_b32 v193, a217
  v_accvgpr_read_b32 v194, a218
  v_accvgpr_read_b32 v195, a219
  v_accvgpr_read_b32 v196, a248
  v_accvgpr_read_b32 v197, a249
  v_accvgpr_read_b32 v198, a250
  v_accvgpr_read_b32 v199, a251
  v_cvt_pk_bf16_f32 v232, v192, v193
  v_cvt_pk_bf16_f32 v233, v194, v195
  v_cvt_pk_bf16_f32 v234, v196, v197
  v_cvt_pk_bf16_f32 v235, v198, v199
  buffer_store_dwordx4 v[232:235], v4, s[8:11], s36 offen offset:2048 sc1
  v_accvgpr_read_b32 v200, a220
  v_accvgpr_read_b32 v201, a221
  v_accvgpr_read_b32 v202, a222
  v_accvgpr_read_b32 v203, a223
  v_accvgpr_read_b32 v204, a252
  v_accvgpr_read_b32 v205, a253
  v_accvgpr_read_b32 v206, a254
  v_accvgpr_read_b32 v207, a255
  v_cvt_pk_bf16_f32 v236, v200, v201
  v_cvt_pk_bf16_f32 v237, v202, v203
  v_cvt_pk_bf16_f32 v238, v204, v205
  v_cvt_pk_bf16_f32 v239, v206, v207
  buffer_store_dwordx4 v[236:239], v4, s[8:11], s36 offen offset:3072 sc1
  s_branch W_epiend
W_epi6:
  v_lshrrev_b32 v1, 4, v0
  v_lshlrev_b32 v38, 9, v1
  v_and_b32 v1, 15, v0
  v_lshl_add_u32 v38, v1, 4, v38
  s_add_u32 s36, s31, 0x0
  v_accvgpr_read_b32 v192, a0
  v_accvgpr_read_b32 v193, a1
  v_accvgpr_read_b32 v194, a2
  v_accvgpr_read_b32 v195, a3
  v_accvgpr_read_b32 v196, a32
  v_accvgpr_read_b32 v197, a33
  v_accvgpr_read_b32 v198, a34
  v_accvgpr_read_b32 v199, a35
  v_cvt_pk_bf16_f32 v208, v192, v193
  v_cvt_pk_bf16_f32 v209, v194, v195
  v_cvt_pk_bf16_f32 v210, v196, v197
  v_cvt_pk_bf16_f32 v211, v198, v199
  buffer_store_dwordx4 v[208:211], v38, s[8:11], s36 offen offset:0 sc1
  v_accvgpr_read_b32 v200, a4
  v_accvgpr_read_b32 v201, a5
  v_accvgpr_read_b32 v202, a6
  v_accvgpr_read_b32 v203, a7
  v_accvgpr_read_b32 v204, a36
  v_accvgpr_read_b32 v205, a37
  v_accvgpr_read_b32 v206, a38
  v_accvgpr_read_b32 v207, a39
  v_cvt_pk_bf16_f32 v212, v200, v201
  v_cvt_pk_bf16_f32 v213, v202, v203
  v_cvt_pk_bf16_f32 v214, v204, v205
  v_cvt_pk_bf16_f32 v215, v206, v207
  buffer_store_dwordx4 v[212:215], v38, s[8:11], s36 offen offset:256 sc1
  v_accvgpr_read_b32 v192, a64
  v_accvgpr_read_b32 v193, a65
  v_accvgpr_read_b32 v194, a66
  v_accvgpr_read_b32 v195, a67
  v_accvgpr_read_b32 v196, a96
  v_accvgpr_read_b32 v197, a97
  v_accvgpr_read_b32 v198, a98
  v_accvgpr_read_b32 v199, a99
  v_cvt_pk_bf16_f32 v216, v192, v193
  v_cvt_pk_bf16_f32 v217, v194, v195
  v_cvt_pk_bf16_f32 v218, v196, v197
  v_cvt_pk_bf16_f32 v219, v198, v199
  buffer_store_dwordx4 v[216:219], v38, s[8:11], s36 offen offset:2048 sc1
  v_accvgpr_read_b32 v200, a68
  v_accvgpr_read_b32 v201, a69
  v_accvgpr_read_b32 v202, a70
  v_accvgpr_read_b32 v203, a71
  v_accvgpr_read_b32 v204, a100
  v_accvgpr_read_b32 v205, a101
  v_accvgpr_read_b32 v206, a102
  v_accvgpr_read_b32 v207, a103
  v_cvt_pk_bf16_f32 v220, v200, v201
  v_cvt_pk_bf16_f32 v221, v202, v203
  v_cvt_pk_bf16_f32 v222, v204, v205
  v_cvt_pk_bf16_f32 v223, v206, v207
  buffer_store_dwordx4 v[220:223], v38, s[8:11], s36 offen offset:2304 sc1
  s_add_u32 s36, s31, 0x1000
  v_accvgpr_read_b32 v192, a128
  v_accvgpr_read_b32 v193, a129
  v_accvgpr_read_b32 v194, a130
  v_accvgpr_read_b32 v195, a131
  v_accvgpr_read_b32 v196, a160
  v_accvgpr_read_b32 v197, a161
  v_accvgpr_read_b32 v198, a162
  v_accvgpr_read_b32 v199, a163
  v_cvt_pk_bf16_f32 v224, v192, v193
  v_cvt_pk_bf16_f32 v225, v194, v195
  v_cvt_pk_bf16_f32 v226, v196, v197
  v_cvt_pk_bf16_f32 v227, v198, v199
  buffer_store_dwordx4 v[224:227], v38, s[8:11], s36 offen offset:0 sc1
  v_accvgpr_read_b32 v200, a132
  v_accvgpr_read_b32 v201, a133
  v_accvgpr_read_b32 v202, a134
  v_accvgpr_read_b32 v203, a135
  v_accvgpr_read_b32 v204, a164
  v_accvgpr_read_b32 v205, a165
  v_accvgpr_read_b32 v206, a166
  v_accvgpr_read_b32 v207, a167
  v_cvt_pk_bf16_f32 v228, v200, v201
  v_cvt_pk_bf16_f32 v229, v202, v203
  v_cvt_pk_bf16_f32 v230, v204, v205
  v_cvt_pk_bf16_f32 v231, v206, v207
  buffer_store_dwordx4 v[228:231], v38, s[8:11], s36 offen offset:256 sc1
  v_accvgpr_read_b32 v192, a192
  v_accvgpr_read_b32 v193, a193
  v_accvgpr_read_b32 v194, a194
  v_accvgpr_read_b32 v195, a195
  v_accvgpr_read_b32 v196, a224
  v_accvgpr_read_b32 v197, a225
  v_accvgpr_read_b32 v198, a226
  v_accvgpr_read_b32 v199, a227
  v_cvt_pk_bf16_f32 v232, v192, v193
  v_cvt_pk_bf16_f32 v233, v194, v195
  v_cvt_pk_bf16_f32 v234, v196, v197
  v_cvt_pk_bf16_f32 v235, v198, v199
  buffer_store_dwordx4 v[232:235], v38, s[8:11], s36 offen offset:2048 sc1
  v_accvgpr_read_b32 v200, a196
  v_accvgpr_read_b32 v201, a197
  v_accvgpr_read_b32 v202, a198
  v_accvgpr_read_b32 v203, a199
  v_accvgpr_read_b32 v204, a228
  v_accvgpr_read_b32 v205, a229
  v_accvgpr_read_b32 v206, a230
  v_accvgpr_read_b32 v207, a231
  v_cvt_pk_bf16_f32 v236, v200, v201
  v_cvt_pk_bf16_f32 v237, v202, v203
  v_cvt_pk_bf16_f32 v238, v204, v205
  v_cvt_pk_bf16_f32 v239, v206, v207
  buffer_store_dwordx4 v[236:239], v38, s[8:11], s36 offen offset:2304 sc1
  s_add_u32 s36, s31, 0x20000
  v_accvgpr_read_b32 v192, a8
  v_accvgpr_read_b32 v193, a9
  v_accvgpr_read_b32 v194, a10
  v_accvgpr_read_b32 v195, a11
  v_accvgpr_read_b32 v196, a40
  v_accvgpr_read_b32 v197, a41
  v_accvgpr_read_b32 v198, a42
  v_accvgpr_read_b32 v199, a43
  v_cvt_pk_bf16_f32 v208, v192, v193
  v_cvt_pk_bf16_f32 v209, v194, v195
  v_cvt_pk_bf16_f32 v210, v196, v197
  v_cvt_pk_bf16_f32 v211, v198, v199
  buffer_store_dwordx4 v[208:211], v38, s[8:11], s36 offen offset:0 sc1
  v_accvgpr_read_b32 v200, a12
  v_accvgpr_read_b32 v201, a13
  v_accvgpr_read_b32 v202, a14
  v_accvgpr_read_b32 v203, a15
  v_accvgpr_read_b32 v204, a44
  v_accvgpr_read_b32 v205, a45
  v_accvgpr_read_b32 v206, a46
  v_accvgpr_read_b32 v207, a47
  v_cvt_pk_bf16_f32 v212, v200, v201
  v_cvt_pk_bf16_f32 v213, v202, v203
  v_cvt_pk_bf16_f32 v214, v204, v205
  v_cvt_pk_bf16_f32 v215, v206, v207
  buffer_store_dwordx4 v[212:215], v38, s[8:11], s36 offen offset:256 sc1
  v_accvgpr_read_b32 v192, a72
  v_accvgpr_read_b32 v193, a73
  v_accvgpr_read_b32 v194, a74
  v_accvgpr_read_b32 v195, a75
  v_accvgpr_read_b32 v196, a104
  v_accvgpr_read_b32 v197, a105
  v_accvgpr_read_b32 v198, a106
  v_accvgpr_read_b32 v199, a107
  v_cvt_pk_bf16_f32 v216, v192, v193
  v_cvt_pk_bf16_f32 v217, v194, v195
  v_cvt_pk_bf16_f32 v218, v196, v197
  v_cvt_pk_bf16_f32 v219, v198, v199
  buffer_store_dwordx4 v[216:219], v38, s[8:11], s36 offen offset:2048 sc1
  v_accvgpr_read_b32 v200, a76
  v_accvgpr_read_b32 v201, a77
  v_accvgpr_read_b32 v202, a78
  v_accvgpr_read_b32 v203, a79
  v_accvgpr_read_b32 v204, a108
  v_accvgpr_read_b32 v205, a109
  v_accvgpr_read_b32 v206, a110
  v_accvgpr_read_b32 v207, a111
  v_cvt_pk_bf16_f32 v220, v200, v201
  v_cvt_pk_bf16_f32 v221, v202, v203
  v_cvt_pk_bf16_f32 v222, v204, v205
  v_cvt_pk_bf16_f32 v223, v206, v207
  buffer_store_dwordx4 v[220:223], v38, s[8:11], s36 offen offset:2304 sc1
  s_add_u32 s36, s31, 0x21000
  v_accvgpr_read_b32 v192, a136
  v_accvgpr_read_b32 v193, a137
  v_accvgpr_read_b32 v194, a138
  v_accvgpr_read_b32 v195, a139
  v_accvgpr_read_b32 v196, a168
  v_accvgpr_read_b32 v197, a169
  v_accvgpr_read_b32 v198, a170
  v_accvgpr_read_b32 v199, a171
  v_cvt_pk_bf16_f32 v224, v192, v193
  v_cvt_pk_bf16_f32 v225, v194, v195
  v_cvt_pk_bf16_f32 v226, v196, v197
  v_cvt_pk_bf16_f32 v227, v198, v199
  buffer_store_dwordx4 v[224:227], v38, s[8:11], s36 offen offset:0 sc1
  v_accvgpr_read_b32 v200, a140
  v_accvgpr_read_b32 v201, a141
  v_accvgpr_read_b32 v202, a142
  v_accvgpr_read_b32 v203, a143
  v_accvgpr_read_b32 v204, a172
  v_accvgpr_read_b32 v205, a173
  v_accvgpr_read_b32 v206, a174
  v_accvgpr_read_b32 v207, a175
  v_cvt_pk_bf16_f32 v228, v200, v201
  v_cvt_pk_bf16_f32 v229, v202, v203
  v_cvt_pk_bf16_f32 v230, v204, v205
  v_cvt_pk_bf16_f32 v231, v206, v207
  buffer_store_dwordx4 v[228:231], v38, s[8:11], s36 offen offset:256 sc1
  v_accvgpr_read_b32 v192, a200
  v_accvgpr_read_b32 v193, a201
  v_accvgpr_read_b32 v194, a202
  v_accvgpr_read_b32 v195, a203
  v_accvgpr_read_b32 v196, a232
  v_accvgpr_read_b32 v197, a233
  v_accvgpr_read_b32 v198, a234
  v_accvgpr_read_b32 v199, a235
  v_cvt_pk_bf16_f32 v232, v192, v193
  v_cvt_pk_bf16_f32 v233, v194, v195
  v_cvt_pk_bf16_f32 v234, v196, v197
  v_cvt_pk_bf16_f32 v235, v198, v199
  buffer_store_dwordx4 v[232:235], v38, s[8:11], s36 offen offset:2048 sc1
  v_accvgpr_read_b32 v200, a204
  v_accvgpr_read_b32 v201, a205
  v_accvgpr_read_b32 v202, a206
  v_accvgpr_read_b32 v203, a207
  v_accvgpr_read_b32 v204, a236
  v_accvgpr_read_b32 v205, a237
  v_accvgpr_read_b32 v206, a238
  v_accvgpr_read_b32 v207, a239
  v_cvt_pk_bf16_f32 v236, v200, v201
  v_cvt_pk_bf16_f32 v237, v202, v203
  v_cvt_pk_bf16_f32 v238, v204, v205
  v_cvt_pk_bf16_f32 v239, v206, v207
  buffer_store_dwordx4 v[236:239], v38, s[8:11], s36 offen offset:2304 sc1
  s_add_u32 s36, s31, 0x40000
  v_accvgpr_read_b32 v192, a16
  v_accvgpr_read_b32 v193, a17
  v_accvgpr_read_b32 v194, a18
  v_accvgpr_read_b32 v195, a19
  v_accvgpr_read_b32 v196, a48
  v_accvgpr_read_b32 v197, a49
  v_accvgpr_read_b32 v198, a50
  v_accvgpr_read_b32 v199, a51
  v_cvt_pk_bf16_f32 v208, v192, v193
  v_cvt_pk_bf16_f32 v209, v194, v195
  v_cvt_pk_bf16_f32 v210, v196, v197
  v_cvt_pk_bf16_f32 v211, v198, v199
  buffer_store_dwordx4 v[208:211], v38, s[8:11], s36 offen offset:0 sc1
  v_accvgpr_read_b32 v200, a20
  v_accvgpr_read_b32 v201, a21
  v_accvgpr_read_b32 v202, a22
  v_accvgpr_read_b32 v203, a23
  v_accvgpr_read_b32 v204, a52
  v_accvgpr_read_b32 v205, a53
  v_accvgpr_read_b32 v206, a54
  v_accvgpr_read_b32 v207, a55
  v_cvt_pk_bf16_f32 v212, v200, v201
  v_cvt_pk_bf16_f32 v213, v202, v203
  v_cvt_pk_bf16_f32 v214, v204, v205
  v_cvt_pk_bf16_f32 v215, v206, v207
  buffer_store_dwordx4 v[212:215], v38, s[8:11], s36 offen offset:256 sc1
  v_accvgpr_read_b32 v192, a80
  v_accvgpr_read_b32 v193, a81
  v_accvgpr_read_b32 v194, a82
  v_accvgpr_read_b32 v195, a83
  v_accvgpr_read_b32 v196, a112
  v_accvgpr_read_b32 v197, a113
  v_accvgpr_read_b32 v198, a114
  v_accvgpr_read_b32 v199, a115
  v_cvt_pk_bf16_f32 v216, v192, v193
  v_cvt_pk_bf16_f32 v217, v194, v195
  v_cvt_pk_bf16_f32 v218, v196, v197
  v_cvt_pk_bf16_f32 v219, v198, v199
  buffer_store_dwordx4 v[216:219], v38, s[8:11], s36 offen offset:2048 sc1
  v_accvgpr_read_b32 v200, a84
  v_accvgpr_read_b32 v201, a85
  v_accvgpr_read_b32 v202, a86
  v_accvgpr_read_b32 v203, a87
  v_accvgpr_read_b32 v204, a116
  v_accvgpr_read_b32 v205, a117
  v_accvgpr_read_b32 v206, a118
  v_accvgpr_read_b32 v207, a119
  v_cvt_pk_bf16_f32 v220, v200, v201
  v_cvt_pk_bf16_f32 v221, v202, v203
  v_cvt_pk_bf16_f32 v222, v204, v205
  v_cvt_pk_bf16_f32 v223, v206, v207
  buffer_store_dwordx4 v[220:223], v38, s[8:11], s36 offen offset:2304 sc1
  s_add_u32 s36, s31, 0x41000
  v_accvgpr_read_b32 v192, a144
  v_accvgpr_read_b32 v193, a145
  v_accvgpr_read_b32 v194, a146
  v_accvgpr_read_b32 v195, a147
  v_accvgpr_read_b32 v196, a176
  v_accvgpr_read_b32 v197, a177
  v_accvgpr_read_b32 v198, a178
  v_accvgpr_read_b32 v199, a179
  v_cvt_pk_bf16_f32 v224, v192, v193
  v_cvt_pk_bf16_f32 v225, v194, v195
  v_cvt_pk_bf16_f32 v226, v196, v197
  v_cvt_pk_bf16_f32 v227, v198, v199
  buffer_store_dwordx4 v[224:227], v38, s[8:11], s36 offen offset:0 sc1
  v_accvgpr_read_b32 v200, a148
  v_accvgpr_read_b32 v201, a149
  v_accvgpr_read_b32 v202, a150
  v_accvgpr_read_b32 v203, a151
  v_accvgpr_read_b32 v204, a180
  v_accvgpr_read_b32 v205, a181
  v_accvgpr_read_b32 v206, a182
  v_accvgpr_read_b32 v207, a183
  v_cvt_pk_bf16_f32 v228, v200, v201
  v_cvt_pk_bf16_f32 v229, v202, v203
  v_cvt_pk_bf16_f32 v230, v204, v205
  v_cvt_pk_bf16_f32 v231, v206, v207
  buffer_store_dwordx4 v[228:231], v38, s[8:11], s36 offen offset:256 sc1
  v_accvgpr_read_b32 v192, a208
  v_accvgpr_read_b32 v193, a209
  v_accvgpr_read_b32 v194, a210
  v_accvgpr_read_b32 v195, a211
  v_accvgpr_read_b32 v196, a240
  v_accvgpr_read_b32 v197, a241
  v_accvgpr_read_b32 v198, a242
  v_accvgpr_read_b32 v199, a243
  v_cvt_pk_bf16_f32 v232, v192, v193
  v_cvt_pk_bf16_f32 v233, v194, v195
  v_cvt_pk_bf16_f32 v234, v196, v197
  v_cvt_pk_bf16_f32 v235, v198, v199
  buffer_store_dwordx4 v[232:235], v38, s[8:11], s36 offen offset:2048 sc1
  v_accvgpr_read_b32 v200, a212
  v_accvgpr_read_b32 v201, a213
  v_accvgpr_read_b32 v202, a214
  v_accvgpr_read_b32 v203, a215
  v_accvgpr_read_b32 v204, a244
  v_accvgpr_read_b32 v205, a245
  v_accvgpr_read_b32 v206, a246
  v_accvgpr_read_b32 v207, a247
  v_cvt_pk_bf16_f32 v236, v200, v201
  v_cvt_pk_bf16_f32 v237, v202, v203
  v_cvt_pk_bf16_f32 v238, v204, v205
  v_cvt_pk_bf16_f32 v239, v206, v207
  buffer_store_dwordx4 v[236:239], v38, s[8:11], s36 offen offset:2304 sc1
  s_add_u32 s36, s31, 0x60000
  v_accvgpr_read_b32 v192, a24
  v_accvgpr_read_b32 v193, a25
  v_accvgpr_read_b32 v194, a26
  v_accvgpr_read_b32 v195, a27
  v_accvgpr_read_b32 v196, a56
  v_accvgpr_read_b32 v197, a57
  v_accvgpr_read_b32 v198, a58
  v_accvgpr_read_b32 v199, a59
  v_cvt_pk_bf16_f32 v208, v192, v193
  v_cvt_pk_bf16_f32 v209, v194, v195
  v_cvt_pk_bf16_f32 v210, v196, v197
  v_cvt_pk_bf16_f32 v211, v198, v199
  buffer_store_dwordx4 v[208:211], v38, s[8:11], s36 offen offset:0 sc1
  v_accvgpr_read_b32 v200, a28
  v_accvgpr_read_b32 v201, a29
  v_accvgpr_read_b32 v202, a30
  v_accvgpr_read_b32 v203, a31
  v_accvgpr_read_b32 v204, a60
  v_accvgpr_read_b32 v205, a61
  v_accvgpr_read_b32 v206, a62
  v_accvgpr_read_b32 v207, a63
  v_cvt_pk_bf16_f32 v212, v200, v201
  v_cvt_pk_bf16_f32 v213, v202, v203
  v_cvt_pk_bf16_f32 v214, v204, v205
  v_cvt_pk_bf16_f32 v215, v206, v207
  buffer_store_dwordx4 v[212:215], v38, s[8:11], s36 offen offset:256 sc1
  v_accvgpr_read_b32 v192, a88
  v_accvgpr_read_b32 v193, a89
  v_accvgpr_read_b32 v194, a90
  v_accvgpr_read_b32 v195, a91
  v_accvgpr_read_b32 v196, a120
  v_accvgpr_read_b32 v197, a121
  v_accvgpr_read_b32 v198, a122
  v_accvgpr_read_b32 v199, a123
  v_cvt_pk_bf16_f32 v216, v192, v193
  v_cvt_pk_bf16_f32 v217, v194, v195
  v_cvt_pk_bf16_f32 v218, v196, v197
  v_cvt_pk_bf16_f32 v219, v198, v199
  buffer_store_dwordx4 v[216:219], v38, s[8:11], s36 offen offset:2048 sc1
  v_accvgpr_read_b32 v200, a92
  v_accvgpr_read_b32 v201, a93
  v_accvgpr_read_b32 v202, a94
  v_accvgpr_read_b32 v203, a95
  v_accvgpr_read_b32 v204, a124
  v_accvgpr_read_b32 v205, a125
  v_accvgpr_read_b32 v206, a126
  v_accvgpr_read_b32 v207, a127
  v_cvt_pk_bf16_f32 v220, v200, v201
  v_cvt_pk_bf16_f32 v221, v202, v203
  v_cvt_pk_bf16_f32 v222, v204, v205
  v_cvt_pk_bf16_f32 v223, v206, v207
  buffer_store_dwordx4 v[220:223], v38, s[8:11], s36 offen offset:2304 sc1
  s_add_u32 s36, s31, 0x61000
  v_accvgpr_read_b32 v192, a152
  v_accvgpr_read_b32 v193, a153
  v_accvgpr_read_b32 v194, a154
  v_accvgpr_read_b32 v195, a155
  v_accvgpr_read_b32 v196, a184
  v_accvgpr_read_b32 v197, a185
  v_accvgpr_read_b32 v198, a186
  v_accvgpr_read_b32 v199, a187
  v_cvt_pk_bf16_f32 v224, v192, v193
  v_cvt_pk_bf16_f32 v225, v194, v195
  v_cvt_pk_bf16_f32 v226, v196, v197
  v_cvt_pk_bf16_f32 v227, v198, v199
  buffer_store_dwordx4 v[224:227], v38, s[8:11], s36 offen offset:0 sc1
  v_accvgpr_read_b32 v200, a156
  v_accvgpr_read_b32 v201, a157
  v_accvgpr_read_b32 v202, a158
  v_accvgpr_read_b32 v203, a159
  v_accvgpr_read_b32 v204, a188
  v_accvgpr_read_b32 v205, a189
  v_accvgpr_read_b32 v206, a190
  v_accvgpr_read_b32 v207, a191
  v_cvt_pk_bf16_f32 v228, v200, v201
  v_cvt_pk_bf16_f32 v229, v202, v203
  v_cvt_pk_bf16_f32 v230, v204, v205
  v_cvt_pk_bf16_f32 v231, v206, v207
  buffer_store_dwordx4 v[228:231], v38, s[8:11], s36 offen offset:256 sc1
  v_accvgpr_read_b32 v192, a216
  v_accvgpr_read_b32 v193, a217
  v_accvgpr_read_b32 v194, a218
  v_accvgpr_read_b32 v195, a219
  v_accvgpr_read_b32 v196, a248
  v_accvgpr_read_b32 v197, a249
  v_accvgpr_read_b32 v198, a250
  v_accvgpr_read_b32 v199, a251
  v_cvt_pk_bf16_f32 v232, v192, v193
  v_cvt_pk_bf16_f32 v233, v194, v195
  v_cvt_pk_bf16_f32 v234, v196, v197
  v_cvt_pk_bf16_f32 v235, v198, v199
  buffer_store_dwordx4 v[232:235], v38, s[8:11], s36 offen offset:2048 sc1
  v_accvgpr_read_b32 v200, a220
  v_accvgpr_read_b32 v201, a221
  v_accvgpr_read_b32 v202, a222
  v_accvgpr_read_b32 v203, a223
  v_accvgpr_read_b32 v204, a252
  v_accvgpr_read_b32 v205, a253
  v_accvgpr_read_b32 v206, a254
  v_accvgpr_read_b32 v207, a255
  v_cvt_pk_bf16_f32 v236, v200, v201
  v_cvt_pk_bf16_f32 v237, v202, v203
  v_cvt_pk_bf16_f32 v238, v204, v205
  v_cvt_pk_bf16_f32 v239, v206, v207
  buffer_store_dwordx4 v[236:239], v38, s[8:11], s36 offen offset:2304 sc1
  s_branch W_epiend
W_pf:
  s_cmp_eq_u32 s59, 1
  s_cselect_b32 s20, s64, s62
  s_cselect_b32 s21, s65, s63
  s_cmp_eq_u32 s59, 2
  s_cselect_b32 s20, s66, s20
  s_cselect_b32 s21, s67, s21
  s_cmp_eq_u32 s59, 3
  s_cselect_b32 s20, s68, s20
  s_cselect_b32 s21, s69, s21
  s_cselect_b32 s38, 11, 13
  s_mov_b32 s22, 0x800000
  s_cmp_eq_u32 s59, 4
  s_cselect_b32 s20, s60, s20
  s_cselect_b32 s21, s61, s21
  s_cselect_b32 s22, 0x400000, s22
  s_cmp_eq_u32 s59, 5
  s_cselect_b32 s20, s70, s20
  s_cselect_b32 s21, s71, s21
  s_cselect_b32 s22, 0x400000, s22
  s_cmp_eq_u32 s59, 6
  s_cselect_b32 s20, s72, s20
  s_cselect_b32 s21, s73, s21
  s_cselect_b32 s22, 0x600000, s22
  s_cmp_eq_u32 s59, 7
  s_cselect_b32 s20, s74, s20
  s_cselect_b32 s21, s75, s21
  s_cselect_b32 s22, 0x200000, s22
  s_cmp_ge_u32 s59, 3
  s_cselect_b32 s38, 11, s38
  s_cmp_eq_u32 s88, 1
  s_cbranch_scc1 W_pf1
  v_lshrrev_b32 v1, 3, v0
  s_lshl_b32 s36, s28, 3
  v_add_u32 v1, s36, v1
  v_lshlrev_b32 v1, s38, v1
  v_and_b32 v2, 7, v0
  v_lshl_add_u32 v1, v2, 4, v1
  s_lshl_b32 s37, 32, s38
  s_mov_b32 s39, 32
  s_branch W_pfgo
W_pf1:
  s_lshr_b32 s36, s28, 1
  s_lshl_b32 s36, s36, s38
  s_and_b32 s37, s28, 1
  s_lshl_b32 s37, s37, 10
  s_add_u32 s36, s36, s37
  v_add_u32 v1, s36, v4
  s_lshl_b32 s37, 2, s38
  s_mov_b32 s39, s86
W_pfgo:
  s_mov_b32 s36, s85
W_pfl:
  buffer_load_dwordx4 v[64:67], v1, s[20:23], s36 offen
  s_add_u32 s36, s36, s37
  s_waitcnt vmcnt(48)
  s_sub_u32 s39, s39, 1
  s_cmp_lg_u32 s39, 0
  s_cbranch_scc1 W_pfl
  s_mov_b32 s85, 0xff00000
  s_cmp_eq_u32 s29, 0
  s_cbranch_scc1 tk_204
tb_203:
  s_waitcnt vmcnt(0)
  s_branch W_next
W_tail:
  s_cmp_eq_u32 s47, 1
  s_cbranch_scc1 ic_205
  v_mov_b32 v204, 0
sb_206:
  s_sub_u32 s48, s48, 1
  s_cbranch_scc1 L_fail
  buffer_load_dwordx4 v[200:203], v204, s[12:15], 0 offen sc1
  s_waitcnt vmcnt(0)
  v_readfirstlane_b32 s37, v200
  s_nop 3
  s_cmp_ge_u32 s37, 96
  s_cbranch_scc1 sb_207
  s_sleep 8
  s_branch sb_206
sb_207:
  s_mov_b32 s47, 1
ic_205:
  s_mov_b32 s20, s68
  s_mov_b32 s21, s69
  s_mov_b32 s22, 0x800000
  v_lshrrev_b32 v9, 2, v0
  v_lshlrev_b32 v8, 11, v9
  v_and_b32 v9, 3, v0
  v_lshl_add_u32 v8, v9, 4, v8
  s_lshl_b32 s36, s28, 21
  s_lshl_b32 s37, s59, 6
  s_add_u32 s36, s36, s37
  s_lshl_b32 s38, s28, 15
  v_lshrrev_b32 v9, 2, v0
  v_lshlrev_b32 v10, 6, v9
  v_and_b32 v9, 3, v0
  v_lshl_add_u32 v10, v9, 3, v10
  v_add_u32 v10, s38, v10
  s_add_u32 m0, s38, 0
  s_add_u32 s37, s36, 0x0
  buffer_load_dwordx4 v8, s[20:23], s37 offen lds
  s_add_u32 m0, s38, 1024
  s_add_u32 s37, s36, 0x8000
  buffer_load_dwordx4 v8, s[20:23], s37 offen lds
  s_add_u32 m0, s38, 2048
  s_add_u32 s37, s36, 0x10000
  buffer_load_dwordx4 v8, s[20:23], s37 offen lds
  s_add_u32 m0, s38, 3072
  s_add_u32 s37, s36, 0x18000
  buffer_load_dwordx4 v8, s[20:23], s37 offen lds
  s_add_u32 m0, s38, 4096
  s_add_u32 s37, s36, 0x20000
  buffer_load_dwordx4 v8, s[20:23], s37 offen lds
  s_add_u32 m0, s38, 5120
  s_add_u32 s37, s36, 0x28000
  buffer_load_dwordx4 v8, s[20:23], s37 offen lds
  s_add_u32 m0, s38, 6144
  s_add_u32 s37, s36, 0x30000
  buffer_load_dwordx4 v8, s[20:23], s37 offen lds
  s_add_u32 m0, s38, 7168
  s_add_u32 s37, s36, 0x38000
  buffer_load_dwordx4 v8, s[20:23], s37 offen lds
  s_add_u32 m0, s38, 8192
  s_add_u32 s37, s36, 0x40000
  buffer_load_dwordx4 v8, s[20:23], s37 offen lds
  s_add_u32 m0, s38, 9216
  s_add_u32 s37, s36, 0x48000
  buffer_load_dwordx4 v8, s[20:23], s37 offen lds
  s_add_u32 m0, s38, 10240
  s_add_u32 s37, s36, 0x50000
  buffer_load_dwordx4 v8, s[20:23], s37 offen lds
  s_add_u32 m0, s38, 11264
  s_add_u32 s37, s36, 0x58000
  buffer_load_dwordx4 v8, s[20:23], s37 offen lds
  s_add_u32 m0, s38, 12288
  s_add_u32 s37, s36, 0x60000
  buffer_load_dwordx4 v8, s[20:23], s37 offen lds
  s_add_u32 m0, s38, 13312
  s_add_u32 s37, s36, 0x68000
  buffer_load_dwordx4 v8, s[20:23], s37 offen lds
  s_add_u32 m0, s38, 14336
  s_add_u32 s37, s36, 0x70000
  buffer_load_dwordx4 v8, s[20:23], s37 offen lds
  s_add_u32 m0, s38, 15360
  s_add_u32 s37, s36, 0x78000
  buffer_load_dwordx4 v8, s[20:23], s37 offen lds
  s_add_u32 m0, s38, 16384
  s_add_u32 s37, s36, 0x80000
  buffer_load_dwordx4 v8, s[20:23], s37 offen lds
  s_add_u32 m0, s38, 17408
  s_add_u32 s37, s36, 0x88000
  buffer_load_dwordx4 v8, s[20:23], s37 offen lds
  s_add_u32 m0, s38, 18432
  s_add_u32 s37, s36, 0x90000
  buffer_load_dwordx4 v8, s[20:23], s37 offen lds
  s_add_u32 m0, s38, 19456
  s_add_u32 s37, s36, 0x98000
  buffer_load_dwordx4 v8, s[20:23], s37 offen lds
  s_add_u32 m0, s38, 20480
  s_add_u32 s37, s36, 0xa0000
  buffer_load_dwordx4 v8, s[20:23], s37 offen lds
  s_add_u32 m0, s38, 21504
  s_add_u32 s37, s36, 0xa8000
  buffer_load_dwordx4 v8, s[20:23], s37 offen lds
  s_add_u32 m0, s38, 22528
  s_add_u32 s37, s36, 0xb0000
  buffer_load_dwordx4 v8, s[20:23], s37 offen lds
  s_add_u32 m0, s38, 23552
  s_add_u32 s37, s36, 0xb8000
  buffer_load_dwordx4 v8, s[20:23], s37 offen lds
  s_add_u32 m0, s38, 24576
  s_add_u32 s37, s36, 0xc0000
  buffer_load_dwordx4 v8, s[20:23], s37 offen lds
  s_add_u32 m0, s38, 25600
  s_add_u32 s37, s36, 0xc8000
  buffer_load_dwordx4 v8, s[20:23], s37 offen lds
  s_add_u32 m0, s38, 26624
  s_add_u32 s37, s36, 0xd0000
  buffer_load_dwordx4 v8, s[20:23], s37 offen lds
  s_add_u32 m0, s38, 27648
  s_add_u32 s37, s36, 0xd8000
  buffer_load_dwordx4 v8, s[20:23], s37 offen lds
  s_add_u32 m0, s38, 28672
  s_add_u32 s37, s36, 0xe0000
  buffer_load_dwordx4 v8, s[20:23], s37 offen lds
  s_add_u32 m0, s38, 29696
  s_add_u32 s37, s36, 0xe8000
  buffer_load_dwordx4 v8, s[20:23], s37 offen lds
  s_add_u32 m0, s38, 30720
  s_add_u32 s37, s36, 0xf0000
  buffer_load_dwordx4 v8, s[20:23], s37 offen lds
  s_add_u32 m0, s38, 31744
  s_add_u32 s37, s36, 0xf8000
  buffer_load_dwordx4 v8, s[20:23], s37 offen lds
  s_waitcnt vmcnt(30)
  ds_read_b64_tr_b16 a[0:1], v10 offset:0
  ds_read_b64_tr_b16 a[2:3], v10 offset:1024
  ds_read_b64_tr_b16 a[4:5], v10 offset:32
  ds_read_b64_tr_b16 a[6:7], v10 offset:1056
  s_waitcnt lgkmcnt(8)
  s_waitcnt vmcnt(28)
  ds_read_b64_tr_b16 a[8:9], v10 offset:2048
  ds_read_b64_tr_b16 a[10:11], v10 offset:3072
  ds_read_b64_tr_b16 a[12:13], v10 offset:2080
  ds_read_b64_tr_b16 a[14:15], v10 offset:3104
  s_waitcnt lgkmcnt(8)
  s_waitcnt vmcnt(26)
  ds_read_b64_tr_b16 a[16:17], v10 offset:4096
  ds_read_b64_tr_b16 a[18:19], v10 offset:5120
  ds_read_b64_tr_b16 a[20:21], v10 offset:4128
  ds_read_b64_tr_b16 a[22:23], v10 offset:5152
  s_waitcnt lgkmcnt(8)
  s_waitcnt vmcnt(24)
  ds_read_b64_tr_b16 a[24:25], v10 offset:6144
  ds_read_b64_tr_b16 a[26:27], v10 offset:7168
  ds_read_b64_tr_b16 a[28:29], v10 offset:6176
  ds_read_b64_tr_b16 a[30:31], v10 offset:7200
  s_waitcnt lgkmcnt(8)
  s_waitcnt vmcnt(22)
  ds_read_b64_tr_b16 a[32:33], v10 offset:8192
  ds_read_b64_tr_b16 a[34:35], v10 offset:9216
  ds_read_b64_tr_b16 a[36:37], v10 offset:8224
  ds_read_b64_tr_b16 a[38:39], v10 offset:9248
  s_waitcnt lgkmcnt(8)
  s_waitcnt vmcnt(20)
  ds_read_b64_tr_b16 a[40:41], v10 offset:10240
  ds_read_b64_tr_b16 a[42:43], v10 offset:11264
  ds_read_b64_tr_b16 a[44:45], v10 offset:10272
  ds_read_b64_tr_b16 a[46:47], v10 offset:11296
  s_waitcnt lgkmcnt(8)
  s_waitcnt vmcnt(18)
  ds_read_b64_tr_b16 a[48:49], v10 offset:12288
  ds_read_b64_tr_b16 a[50:51], v10 offset:13312
  ds_read_b64_tr_b16 a[52:53], v10 offset:12320
  ds_read_b64_tr_b16 a[54:55], v10 offset:13344
  s_waitcnt lgkmcnt(8)
  s_waitcnt vmcnt(16)
  ds_read_b64_tr_b16 a[56:57], v10 offset:14336
  ds_read_b64_tr_b16 a[58:59], v10 offset:15360
  ds_read_b64_tr_b16 a[60:61], v10 offset:14368
  ds_read_b64_tr_b16 a[62:63], v10 offset:15392
  s_waitcnt lgkmcnt(8)
  s_waitcnt vmcnt(14)
  ds_read_b64_tr_b16 a[64:65], v10 offset:16384
  ds_read_b64_tr_b16 a[66:67], v10 offset:17408
  ds_read_b64_tr_b16 a[68:69], v10 offset:16416
  ds_read_b64_tr_b16 a[70:71], v10 offset:17440
  s_waitcnt lgkmcnt(8)
  s_waitcnt vmcnt(12)
  ds_read_b64_tr_b16 a[72:73], v10 offset:18432
  ds_read_b64_tr_b16 a[74:75], v10 offset:19456
  ds_read_b64_tr_b16 a[76:77], v10 offset:18464
  ds_read_b64_tr_b16 a[78:79], v10 offset:19488
  s_waitcnt lgkmcnt(8)
  s_waitcnt vmcnt(10)
  ds_read_b64_tr_b16 a[80:81], v10 offset:20480
  ds_read_b64_tr_b16 a[82:83], v10 offset:21504
  ds_read_b64_tr_b16 a[84:85], v10 offset:20512
  ds_read_b64_tr_b16 a[86:87], v10 offset:21536
  s_waitcnt lgkmcnt(8)
  s_waitcnt vmcnt(8)
  ds_read_b64_tr_b16 a[88:89], v10 offset:22528
  ds_read_b64_tr_b16 a[90:91], v10 offset:23552
  ds_read_b64_tr_b16 a[92:93], v10 offset:22560
  ds_read_b64_tr_b16 a[94:95], v10 offset:23584
  s_waitcnt lgkmcnt(8)
  s_waitcnt vmcnt(6)
  ds_read_b64_tr_b16 a[96:97], v10 offset:24576
  ds_read_b64_tr_b16 a[98:99], v10 offset:25600
  ds_read_b64_tr_b16 a[100:101], v10 offset:24608
  ds_read_b64_tr_b16 a[102:103], v10 offset:25632
  s_waitcnt lgkmcnt(8)
  s_waitcnt vmcnt(4)
  ds_read_b64_tr_b16 a[104:105], v10 offset:26624
  ds_read_b64_tr_b16 a[106:107], v10 offset:27648
  ds_read_b64_tr_b16 a[108:109], v10 offset:26656
  ds_read_b64_tr_b16 a[110:111], v10 offset:27680
  s_waitcnt lgkmcnt(8)
  s_waitcnt vmcnt(2)
  ds_read_b64_tr_b16 a[112:113], v10 offset:28672
  ds_read_b64_tr_b16 a[114:115], v10 offset:29696
  ds_read_b64_tr_b16 a[116:117], v10 offset:28704
  ds_read_b64_tr_b16 a[118:119], v10 offset:29728
  s_waitcnt lgkmcnt(8)
  s_waitcnt vmcnt(0)
  ds_read_b64_tr_b16 a[120:121], v10 offset:30720
  ds_read_b64_tr_b16 a[122:123], v10 offset:31744
  ds_read_b64_tr_b16 a[124:125], v10 offset:30752
  ds_read_b64_tr_b16 a[126:127], v10 offset:31776
  s_waitcnt lgkmcnt(8)
  s_waitcnt lgkmcnt(0)
  s_add_u32 m0, s38, 0
  s_add_u32 s37, s36, 0x100000
  buffer_load_dwordx4 v8, s[20:23], s37 offen lds
  s_add_u32 m0, s38, 1024
  s_add_u32 s37, s36, 0x108000
  buffer_load_dwordx4 v8, s[20:23], s37 offen lds
  s_add_u32 m0, s38, 2048
  s_add_u32 s37, s36, 0x110000
  buffer_load_dwordx4 v8, s[20:23], s37 offen lds
  s_add_u32 m0, s38, 3072
  s_add_u32 s37, s36, 0x118000
  buffer_load_dwordx4 v8, s[20:23], s37 offen lds
  s_add_u32 m0, s38, 4096
  s_add_u32 s37, s36, 0x120000
  buffer_load_dwordx4 v8, s[20:23], s37 offen lds
  s_add_u32 m0, s38, 5120
  s_add_u32 s37, s36, 0x128000
  buffer_load_dwordx4 v8, s[20:23], s37 offen lds
  s_add_u32 m0, s38, 6144
  s_add_u32 s37, s36, 0x130000
  buffer_load_dwordx4 v8, s[20:23], s37 offen lds
  s_add_u32 m0, s38, 7168
  s_add_u32 s37, s36, 0x138000
  buffer_load_dwordx4 v8, s[20:23], s37 offen lds
  s_add_u32 m0, s38, 8192
  s_add_u32 s37, s36, 0x140000
  buffer_load_dwordx4 v8, s[20:23], s37 offen lds
  s_add_u32 m0, s38, 9216
  s_add_u32 s37, s36, 0x148000
  buffer_load_dwordx4 v8, s[20:23], s37 offen lds
  s_add_u32 m0, s38, 10240
  s_add_u32 s37, s36, 0x150000
  buffer_load_dwordx4 v8, s[20:23], s37 offen lds
  s_add_u32 m0, s38, 11264
  s_add_u32 s37, s36, 0x158000
  buffer_load_dwordx4 v8, s[20:23], s37 offen lds
  s_add_u32 m0, s38, 12288
  s_add_u32 s37, s36, 0x160000
  buffer_load_dwordx4 v8, s[20:23], s37 offen lds
  s_add_u32 m0, s38, 13312
  s_add_u32 s37, s36, 0x168000
  buffer_load_dwordx4 v8, s[20:23], s37 offen lds
  s_add_u32 m0, s38, 14336
  s_add_u32 s37, s36, 0x170000
  buffer_load_dwordx4 v8, s[20:23], s37 offen lds
  s_add_u32 m0, s38, 15360
  s_add_u32 s37, s36, 0x178000
  buffer_load_dwordx4 v8, s[20:23], s37 offen lds
  s_add_u32 m0, s38, 16384
  s_add_u32 s37, s36, 0x180000
  buffer_load_dwordx4 v8, s[20:23], s37 offen lds
  s_add_u32 m0, s38, 17408
  s_add_u32 s37, s36, 0x188000
  buffer_load_dwordx4 v8, s[20:23], s37 offen lds
  s_add_u32 m0, s38, 18432
  s_add_u32 s37, s36, 0x190000
  buffer_load_dwordx4 v8, s[20:23], s37 offen lds
  s_add_u32 m0, s38, 19456
  s_add_u32 s37, s36, 0x198000
  buffer_load_dwordx4 v8, s[20:23], s37 offen lds
  s_add_u32 m0, s38, 20480
  s_add_u32 s37, s36, 0x1a0000
  buffer_load_dwordx4 v8, s[20:23], s37 offen lds
  s_add_u32 m0, s38, 21504
  s_add_u32 s37, s36, 0x1a8000
  buffer_load_dwordx4 v8, s[20:23], s37 offen lds
  s_add_u32 m0, s38, 22528
  s_add_u32 s37, s36, 0x1b0000
  buffer_load_dwordx4 v8, s[20:23], s37 offen lds
  s_add_u32 m0, s38, 23552
  s_add_u32 s37, s36, 0x1b8000
  buffer_load_dwordx4 v8, s[20:23], s37 offen lds
  s_add_u32 m0, s38, 24576
  s_add_u32 s37, s36, 0x1c0000
  buffer_load_dwordx4 v8, s[20:23], s37 offen lds
  s_add_u32 m0, s38, 25600
  s_add_u32 s37, s36, 0x1c8000
  buffer_load_dwordx4 v8, s[20:23], s37 offen lds
  s_add_u32 m0, s38, 26624
  s_add_u32 s37, s36, 0x1d0000
  buffer_load_dwordx4 v8, s[20:23], s37 offen lds
  s_add_u32 m0, s38, 27648
  s_add_u32 s37, s36, 0x1d8000
  buffer_load_dwordx4 v8, s[20:23], s37 offen lds
  s_add_u32 m0, s38, 28672
  s_add_u32 s37, s36, 0x1e0000
  buffer_load_dwordx4 v8, s[20:23], s37 offen lds
  s_add_u32 m0, s38, 29696
  s_add_u32 s37, s36, 0x1e8000
  buffer_load_dwordx4 v8, s[20:23], s37 offen lds
  s_add_u32 m0, s38, 30720
  s_add_u32 s37, s36, 0x1f0000
  buffer_load_dwordx4 v8, s[20:23], s37 offen lds
  s_add_u32 m0, s38, 31744
  s_add_u32 s37, s36, 0x1f8000
  buffer_load_dwordx4 v8, s[20:23], s37 offen lds
  s_waitcnt vmcnt(30)
  ds_read_b64_tr_b16 a[128:129], v10 offset:0
  ds_read_b64_tr_b16 a[130:131], v10 offset:1024
  ds_read_b64_tr_b16 a[132:133], v10 offset:32
  ds_read_b64_tr_b16 a[134:135], v10 offset:1056
  s_waitcnt lgkmcnt(8)
  s_waitcnt vmcnt(28)
  ds_read_b64_tr_b16 a[136:137], v10 offset:2048
  ds_read_b64_tr_b16 a[138:139], v10 offset:3072
  ds_read_b64_tr_b16 a[140:141], v10 offset:2080
  ds_read_b64_tr_b16 a[142:143], v10 offset:3104
  s_waitcnt lgkmcnt(8)
  s_waitcnt vmcnt(26)
  ds_read_b64_tr_b16 a[144:145], v10 offset:4096
  ds_read_b64_tr_b16 a[146:147], v10 offset:5120
  ds_read_b64_tr_b16 a[148:149], v10 offset:4128
  ds_read_b64_tr_b16 a[150:151], v10 offset:5152
  s_waitcnt lgkmcnt(8)
  s_waitcnt vmcnt(24)
  ds_read_b64_tr_b16 a[152:153], v10 offset:6144
  ds_read_b64_tr_b16 a[154:155], v10 offset:7168
  ds_read_b64_tr_b16 a[156:157], v10 offset:6176
  ds_read_b64_tr_b16 a[158:159], v10 offset:7200
  s_waitcnt lgkmcnt(8)
  s_waitcnt vmcnt(22)
  ds_read_b64_tr_b16 a[160:161], v10 offset:8192
  ds_read_b64_tr_b16 a[162:163], v10 offset:9216
  ds_read_b64_tr_b16 a[164:165], v10 offset:8224
  ds_read_b64_tr_b16 a[166:167], v10 offset:9248
  s_waitcnt lgkmcnt(8)
  s_waitcnt vmcnt(20)
  ds_read_b64_tr_b16 a[168:169], v10 offset:10240
  ds_read_b64_tr_b16 a[170:171], v10 offset:11264
  ds_read_b64_tr_b16 a[172:173], v10 offset:10272
  ds_read_b64_tr_b16 a[174:175], v10 offset:11296
  s_waitcnt lgkmcnt(8)
  s_waitcnt vmcnt(18)
  ds_read_b64_tr_b16 a[176:177], v10 offset:12288
  ds_read_b64_tr_b16 a[178:179], v10 offset:13312
  ds_read_b64_tr_b16 a[180:181], v10 offset:12320
  ds_read_b64_tr_b16 a[182:183], v10 offset:13344
  s_waitcnt lgkmcnt(8)
  s_waitcnt vmcnt(16)
  ds_read_b64_tr_b16 a[184:185], v10 offset:14336
  ds_read_b64_tr_b16 a[186:187], v10 offset:15360
  ds_read_b64_tr_b16 a[188:189], v10 offset:14368
  ds_read_b64_tr_b16 a[190:191], v10 offset:15392
  s_waitcnt lgkmcnt(8)
  s_waitcnt vmcnt(14)
  ds_read_b64_tr_b16 a[192:193], v10 offset:16384
  ds_read_b64_tr_b16 a[194:195], v10 offset:17408
  ds_read_b64_tr_b16 a[196:197], v10 offset:16416
  ds_read_b64_tr_b16 a[198:199], v10 offset:17440
  s_waitcnt lgkmcnt(8)
  s_waitcnt vmcnt(12)
  ds_read_b64_tr_b16 a[200:201], v10 offset:18432
  ds_read_b64_tr_b16 a[202:203], v10 offset:19456
  ds_read_b64_tr_b16 a[204:205], v10 offset:18464
  ds_read_b64_tr_b16 a[206:207], v10 offset:19488
  s_waitcnt lgkmcnt(8)
  s_waitcnt vmcnt(10)
  ds_read_b64_tr_b16 a[208:209], v10 offset:20480
  ds_read_b64_tr_b16 a[210:211], v10 offset:21504
  ds_read_b64_tr_b16 a[212:213], v10 offset:20512
  ds_read_b64_tr_b16 a[214:215], v10 offset:21536
  s_waitcnt lgkmcnt(8)
  s_waitcnt vmcnt(8)
  ds_read_b64_tr_b16 a[216:217], v10 offset:22528
  ds_read_b64_tr_b16 a[218:219], v10 offset:23552
  ds_read_b64_tr_b16 a[220:221], v10 offset:22560
  ds_read_b64_tr_b16 a[222:223], v10 offset:23584
  s_waitcnt lgkmcnt(8)
  s_waitcnt vmcnt(6)
  ds_read_b64_tr_b16 a[224:225], v10 offset:24576
  ds_read_b64_tr_b16 a[226:227], v10 offset:25600
  ds_read_b64_tr_b16 a[228:229], v10 offset:24608
  ds_read_b64_tr_b16 a[230:231], v10 offset:25632
  s_waitcnt lgkmcnt(8)
  s_waitcnt vmcnt(4)
  ds_read_b64_tr_b16 a[232:233], v10 offset:26624
  ds_read_b64_tr_b16 a[234:235], v10 offset:27648
  ds_read_b64_tr_b16 a[236:237], v10 offset:26656
  ds_read_b64_tr_b16 a[238:239], v10 offset:27680
  s_waitcnt lgkmcnt(8)
  s_waitcnt vmcnt(2)
  ds_read_b64_tr_b16 a[240:241], v10 offset:28672
  ds_read_b64_tr_b16 a[242:243], v10 offset:29696
  ds_read_b64_tr_b16 a[244:245], v10 offset:28704
  ds_read_b64_tr_b16 a[246:247], v10 offset:29728
  s_waitcnt lgkmcnt(8)
  s_waitcnt vmcnt(0)
  ds_read_b64_tr_b16 a[248:249], v10 offset:30720
  ds_read_b64_tr_b16 a[250:251], v10 offset:31744
  ds_read_b64_tr_b16 a[252:253], v10 offset:30752
  ds_read_b64_tr_b16 a[254:255], v10 offset:31776
  s_waitcnt lgkmcnt(8)
  s_waitcnt lgkmcnt(0)
  s_lshl_b32 s36, s28, 11
  v_add_u32 v11, s36, v4
  s_and_b32 s37, s28, 1
  s_lshl_b32 s36, s37, 10
  v_add_u32 v12, s36, v4
  v_and_b32 v9, 15, v0
  v_lshlrev_b32 v13, 12, v9
  v_lshrrev_b32 v9, 4, v0
  v_lshl_add_u32 v13, v9, 3, v13
  s_lshl_b32 s36, s37, 5
  s_lshl_b32 s37, s59, 6
  s_add_u32 s36, s36, s37
  v_add_u32 v13, s36, v13
  v_and_b32 v9, 15, v0
  v_lshlrev_b32 v14, 11, v9
  s_and_b32 s36, s59, 15
  s_lshl_b32 s36, s36, 7
  v_add_u32 v14, s36, v14
  s_barrier
tl_208:
  s_add_u32 s39, s88, 0
  s_lshr_b32 s39, s39, 1
  s_lshl_b32 s39, s39, 7
  s_add_u32 s39, s39, 0x4c04000
tl_209:
  s_sub_u32 s48, s48, 1
  s_cbranch_scc1 L_fail
  buffer_load_dword v9, v6, s[8:11], s39 offen sc1
  s_waitcnt vmcnt(0)
  v_readfirstlane_b32 s36, v9
  s_nop 3
  s_cmp_ge_u32 s36, 64
  s_cbranch_scc1 tl_210
  s_sleep 6
  s_branch tl_209
tl_210:
  s_add_u32 s38, s88, 0
  s_lshl_b32 s38, s38, 17
  s_lshl_b32 s36, s28, 15
  s_add_u32 s38, s38, s36
  s_add_u32 s38, s38, 0x9000000
  s_add_u32 s39, s88, 2
  s_lshr_b32 s39, s39, 1
  s_lshl_b32 s39, s39, 7
  s_add_u32 s39, s39, 0x4c04000
  buffer_load_dword v9, v14, s[8:11], s38 offen sc1
  buffer_load_dword v15, v6, s[8:11], s39 offen sc1
  s_add_u32 s37, s38, 0x0
  buffer_load_dwordx4 v[64:67], v4, s[8:11], s37 offen offset:0 sc1
  buffer_load_dwordx4 v[68:71], v4, s[8:11], s37 offen offset:1024 sc1
  buffer_load_dwordx4 v[72:75], v4, s[8:11], s37 offen offset:2048 sc1
  buffer_load_dwordx4 v[76:79], v4, s[8:11], s37 offen offset:3072 sc1
  s_add_u32 s37, s38, 0x1000
  buffer_load_dwordx4 v[80:83], v4, s[8:11], s37 offen offset:0 sc1
  buffer_load_dwordx4 v[84:87], v4, s[8:11], s37 offen offset:1024 sc1
  buffer_load_dwordx4 v[88:91], v4, s[8:11], s37 offen offset:2048 sc1
  buffer_load_dwordx4 v[92:95], v4, s[8:11], s37 offen offset:3072 sc1
  s_add_u32 s37, s38, 0x2000
  buffer_load_dwordx4 v[96:99], v4, s[8:11], s37 offen offset:0 sc1
  buffer_load_dwordx4 v[100:103], v4, s[8:11], s37 offen offset:1024 sc1
  buffer_load_dwordx4 v[104:107], v4, s[8:11], s37 offen offset:2048 sc1
  buffer_load_dwordx4 v[108:111], v4, s[8:11], s37 offen offset:3072 sc1
  s_add_u32 s37, s38, 0x3000
  buffer_load_dwordx4 v[112:115], v4, s[8:11], s37 offen offset:0 sc1
  buffer_load_dwordx4 v[116:119], v4, s[8:11], s37 offen offset:1024 sc1
  buffer_load_dwordx4 v[120:123], v4, s[8:11], s37 offen offset:2048 sc1
  buffer_load_dwordx4 v[124:127], v4, s[8:11], s37 offen offset:3072 sc1
  s_add_u32 s37, s38, 0x4000
  buffer_load_dwordx4 v[128:131], v4, s[8:11], s37 offen offset:0 sc1
  buffer_load_dwordx4 v[132:135], v4, s[8:11], s37 offen offset:1024 sc1
  buffer_load_dwordx4 v[136:139], v4, s[8:11], s37 offen offset:2048 sc1
  buffer_load_dwordx4 v[140:143], v4, s[8:11], s37 offen offset:3072 sc1
  s_add_u32 s37, s38, 0x5000
  buffer_load_dwordx4 v[144:147], v4, s[8:11], s37 offen offset:0 sc1
  buffer_load_dwordx4 v[148:151], v4, s[8:11], s37 offen offset:1024 sc1
  buffer_load_dwordx4 v[152:155], v4, s[8:11], s37 offen offset:2048 sc1
  buffer_load_dwordx4 v[156:159], v4, s[8:11], s37 offen offset:3072 sc1
  s_add_u32 s37, s38, 0x6000
  buffer_load_dwordx4 v[160:163], v4, s[8:11], s37 offen offset:0 sc1
  buffer_load_dwordx4 v[164:167], v4, s[8:11], s37 offen offset:1024 sc1
  buffer_load_dwordx4 v[168:171], v4, s[8:11], s37 offen offset:2048 sc1
  buffer_load_dwordx4 v[172:175], v4, s[8:11], s37 offen offset:3072 sc1
  s_add_u32 s37, s38, 0x7000
  buffer_load_dwordx4 v[176:179], v4, s[8:11], s37 offen offset:0 sc1
  buffer_load_dwordx4 v[180:183], v4, s[8:11], s37 offen offset:1024 sc1
  buffer_load_dwordx4 v[184:187], v4, s[8:11], s37 offen offset:2048 sc1
  buffer_load_dwordx4 v[188:191], v4, s[8:11], s37 offen offset:3072 sc1
tl_214:
  s_add_u32 s38, s88, 2
  s_lshl_b32 s38, s38, 17
  s_lshl_b32 s36, s28, 15
  s_add_u32 s38, s38, s36
  s_add_u32 s38, s38, 0x9000000
  s_add_u32 s39, s88, 4
  s_lshr_b32 s39, s39, 1
  s_lshl_b32 s39, s39, 7
  s_add_u32 s39, s39, 0x4c04000
  s_waitcnt vmcnt(32)
  v_readfirstlane_b32 s52, v15
  s_add_u32 s36, s88, 2
  s_cmp_ge_u32 s36, 128
  s_cselect_b32 s52, 0, s52
  s_cmp_ge_u32 s52, 64
  s_cbranch_scc1 tl_212
  s_waitcnt vmcnt(31)
  v_mfma_f32_16x16x32_bf16 v[16:19], a[0:3], v[64:67], 0
  v_mfma_f32_16x16x32_bf16 v[20:23], a[4:7], v[64:67], 0
  s_waitcnt vmcnt(30)
  v_mfma_f32_16x16x32_bf16 v[16:19], a[8:11], v[68:71], v[16:19]
  v_mfma_f32_16x16x32_bf16 v[20:23], a[12:15], v[68:71], v[20:23]
  s_waitcnt vmcnt(29)
  v_mfma_f32_16x16x32_bf16 v[16:19], a[16:19], v[72:75], v[16:19]
  v_mfma_f32_16x16x32_bf16 v[20:23], a[20:23], v[72:75], v[20:23]
  s_waitcnt vmcnt(28)
  v_mfma_f32_16x16x32_bf16 v[16:19], a[24:27], v[76:79], v[16:19]
  v_mfma_f32_16x16x32_bf16 v[20:23], a[28:31], v[76:79], v[20:23]
  s_waitcnt vmcnt(27)
  v_mfma_f32_16x16x32_bf16 v[16:19], a[32:35], v[80:83], v[16:19]
  v_mfma_f32_16x16x32_bf16 v[20:23], a[36:39], v[80:83], v[20:23]
  s_waitcnt vmcnt(26)
  v_mfma_f32_16x16x32_bf16 v[16:19], a[40:43], v[84:87], v[16:19]
  v_mfma_f32_16x16x32_bf16 v[20:23], a[44:47], v[84:87], v[20:23]
  s_waitcnt vmcnt(25)
  v_mfma_f32_16x16x32_bf16 v[16:19], a[48:51], v[88:91], v[16:19]
  v_mfma_f32_16x16x32_bf16 v[20:23], a[52:55], v[88:91], v[20:23]
  s_waitcnt vmcnt(24)
  v_mfma_f32_16x16x32_bf16 v[16:19], a[56:59], v[92:95], v[16:19]
  v_mfma_f32_16x16x32_bf16 v[20:23], a[60:63], v[92:95], v[20:23]
  s_waitcnt vmcnt(23)
  v_mfma_f32_16x16x32_bf16 v[16:19], a[64:67], v[96:99], v[16:19]
  v_mfma_f32_16x16x32_bf16 v[20:23], a[68:71], v[96:99], v[20:23]
  s_waitcnt vmcnt(22)
  v_mfma_f32_16x16x32_bf16 v[16:19], a[72:75], v[100:103], v[16:19]
  v_mfma_f32_16x16x32_bf16 v[20:23], a[76:79], v[100:103], v[20:23]
  s_waitcnt vmcnt(21)
  v_mfma_f32_16x16x32_bf16 v[16:19], a[80:83], v[104:107], v[16:19]
  v_mfma_f32_16x16x32_bf16 v[20:23], a[84:87], v[104:107], v[20:23]
  s_waitcnt vmcnt(20)
  v_mfma_f32_16x16x32_bf16 v[16:19], a[88:91], v[108:111], v[16:19]
  v_mfma_f32_16x16x32_bf16 v[20:23], a[92:95], v[108:111], v[20:23]
  s_waitcnt vmcnt(19)
  v_mfma_f32_16x16x32_bf16 v[16:19], a[96:99], v[112:115], v[16:19]
  v_mfma_f32_16x16x32_bf16 v[20:23], a[100:103], v[112:115], v[20:23]
  s_waitcnt vmcnt(18)
  v_mfma_f32_16x16x32_bf16 v[16:19], a[104:107], v[116:119], v[16:19]
  v_mfma_f32_16x16x32_bf16 v[20:23], a[108:111], v[116:119], v[20:23]
  s_waitcnt vmcnt(17)
  v_mfma_f32_16x16x32_bf16 v[16:19], a[112:115], v[120:123], v[16:19]
  v_mfma_f32_16x16x32_bf16 v[20:23], a[116:119], v[120:123], v[20:23]
  s_waitcnt vmcnt(16)
  v_mfma_f32_16x16x32_bf16 v[16:19], a[120:123], v[124:127], v[16:19]
  v_mfma_f32_16x16x32_bf16 v[20:23], a[124:127], v[124:127], v[20:23]
  s_waitcnt vmcnt(15)
  v_mfma_f32_16x16x32_bf16 v[16:19], a[128:131], v[128:131], v[16:19]
  v_mfma_f32_16x16x32_bf16 v[20:23], a[132:135], v[128:131], v[20:23]
  s_waitcnt vmcnt(14)
  v_mfma_f32_16x16x32_bf16 v[16:19], a[136:139], v[132:135], v[16:19]
  v_mfma_f32_16x16x32_bf16 v[20:23], a[140:143], v[132:135], v[20:23]
  s_waitcnt vmcnt(13)
  v_mfma_f32_16x16x32_bf16 v[16:19], a[144:147], v[136:139], v[16:19]
  v_mfma_f32_16x16x32_bf16 v[20:23], a[148:151], v[136:139], v[20:23]
  s_waitcnt vmcnt(12)
  v_mfma_f32_16x16x32_bf16 v[16:19], a[152:155], v[140:143], v[16:19]
  v_mfma_f32_16x16x32_bf16 v[20:23], a[156:159], v[140:143], v[20:23]
  s_waitcnt vmcnt(11)
  v_mfma_f32_16x16x32_bf16 v[16:19], a[160:163], v[144:147], v[16:19]
  v_mfma_f32_16x16x32_bf16 v[20:23], a[164:167], v[144:147], v[20:23]
  s_waitcnt vmcnt(10)
  v_mfma_f32_16x16x32_bf16 v[16:19], a[168:171], v[148:151], v[16:19]
  v_mfma_f32_16x16x32_bf16 v[20:23], a[172:175], v[148:151], v[20:23]
  s_waitcnt vmcnt(9)
  v_mfma_f32_16x16x32_bf16 v[16:19], a[176:179], v[152:155], v[16:19]
  v_mfma_f32_16x16x32_bf16 v[20:23], a[180:183], v[152:155], v[20:23]
  s_waitcnt vmcnt(8)
  v_mfma_f32_16x16x32_bf16 v[16:19], a[184:187], v[156:159], v[16:19]
  v_mfma_f32_16x16x32_bf16 v[20:23], a[188:191], v[156:159], v[20:23]
  s_waitcnt vmcnt(7)
  v_mfma_f32_16x16x32_bf16 v[16:19], a[192:195], v[160:163], v[16:19]
  v_mfma_f32_16x16x32_bf16 v[20:23], a[196:199], v[160:163], v[20:23]
  s_waitcnt vmcnt(6)
  v_mfma_f32_16x16x32_bf16 v[16:19], a[200:203], v[164:167], v[16:19]
  v_mfma_f32_16x16x32_bf16 v[20:23], a[204:207], v[164:167], v[20:23]
  s_waitcnt vmcnt(5)
  v_mfma_f32_16x16x32_bf16 v[16:19], a[208:211], v[168:171], v[16:19]
  v_mfma_f32_16x16x32_bf16 v[20:23], a[212:215], v[168:171], v[20:23]
  s_waitcnt vmcnt(4)
  v_mfma_f32_16x16x32_bf16 v[16:19], a[216:219], v[172:175], v[16:19]
  v_mfma_f32_16x16x32_bf16 v[20:23], a[220:223], v[172:175], v[20:23]
  s_waitcnt vmcnt(3)
  v_mfma_f32_16x16x32_bf16 v[16:19], a[224:227], v[176:179], v[16:19]
  v_mfma_f32_16x16x32_bf16 v[20:23], a[228:231], v[176:179], v[20:23]
  s_waitcnt vmcnt(2)
  v_mfma_f32_16x16x32_bf16 v[16:19], a[232:235], v[180:183], v[16:19]
  v_mfma_f32_16x16x32_bf16 v[20:23], a[236:239], v[180:183], v[20:23]
  s_waitcnt vmcnt(1)
  v_mfma_f32_16x16x32_bf16 v[16:19], a[240:243], v[184:187], v[16:19]
  v_mfma_f32_16x16x32_bf16 v[20:23], a[244:247], v[184:187], v[20:23]
  s_waitcnt vmcnt(0)
  v_mfma_f32_16x16x32_bf16 v[16:19], a[248:251], v[188:191], v[16:19]
  v_mfma_f32_16x16x32_bf16 v[20:23], a[252:255], v[188:191], v[20:23]
  s_branch tl_213
tl_212:
  buffer_load_dword v15, v6, s[8:11], s39 offen sc1
  s_waitcnt vmcnt(32)
  v_mfma_f32_16x16x32_bf16 v[16:19], a[0:3], v[64:67], 0
  v_mfma_f32_16x16x32_bf16 v[20:23], a[4:7], v[64:67], 0
  s_add_u32 s37, s38, 0x0
  buffer_load_dwordx4 v[64:67], v4, s[8:11], s37 offen offset:0 sc1
  s_waitcnt vmcnt(32)
  v_mfma_f32_16x16x32_bf16 v[16:19], a[8:11], v[68:71], v[16:19]
  v_mfma_f32_16x16x32_bf16 v[20:23], a[12:15], v[68:71], v[20:23]
  buffer_load_dwordx4 v[68:71], v4, s[8:11], s37 offen offset:1024 sc1
  s_waitcnt vmcnt(32)
  v_mfma_f32_16x16x32_bf16 v[16:19], a[16:19], v[72:75], v[16:19]
  v_mfma_f32_16x16x32_bf16 v[20:23], a[20:23], v[72:75], v[20:23]
  buffer_load_dwordx4 v[72:75], v4, s[8:11], s37 offen offset:2048 sc1
  s_waitcnt vmcnt(32)
  v_mfma_f32_16x16x32_bf16 v[16:19], a[24:27], v[76:79], v[16:19]
  v_mfma_f32_16x16x32_bf16 v[20:23], a[28:31], v[76:79], v[20:23]
  buffer_load_dwordx4 v[76:79], v4, s[8:11], s37 offen offset:3072 sc1
  s_waitcnt vmcnt(32)
  v_mfma_f32_16x16x32_bf16 v[16:19], a[32:35], v[80:83], v[16:19]
  v_mfma_f32_16x16x32_bf16 v[20:23], a[36:39], v[80:83], v[20:23]
  s_add_u32 s37, s38, 0x1000
  buffer_load_dwordx4 v[80:83], v4, s[8:11], s37 offen offset:0 sc1
  s_waitcnt vmcnt(32)
  v_mfma_f32_16x16x32_bf16 v[16:19], a[40:43], v[84:87], v[16:19]
  v_mfma_f32_16x16x32_bf16 v[20:23], a[44:47], v[84:87], v[20:23]
  buffer_load_dwordx4 v[84:87], v4, s[8:11], s37 offen offset:1024 sc1
  s_waitcnt vmcnt(32)
  v_mfma_f32_16x16x32_bf16 v[16:19], a[48:51], v[88:91], v[16:19]
  v_mfma_f32_16x16x32_bf16 v[20:23], a[52:55], v[88:91], v[20:23]
  buffer_load_dwordx4 v[88:91], v4, s[8:11], s37 offen offset:2048 sc1
  s_waitcnt vmcnt(32)
  v_mfma_f32_16x16x32_bf16 v[16:19], a[56:59], v[92:95], v[16:19]
  v_mfma_f32_16x16x32_bf16 v[20:23], a[60:63], v[92:95], v[20:23]
  buffer_load_dwordx4 v[92:95], v4, s[8:11], s37 offen offset:3072 sc1
  s_waitcnt vmcnt(32)
  v_mfma_f32_16x16x32_bf16 v[16:19], a[64:67], v[96:99], v[16:19]
  v_mfma_f32_16x16x32_bf16 v[20:23], a[68:71], v[96:99], v[20:23]
  s_add_u32 s37, s38, 0x2000
  buffer_load_dwordx4 v[96:99], v4, s[8:11], s37 offen offset:0 sc1
  s_waitcnt vmcnt(32)
  v_mfma_f32_16x16x32_bf16 v[16:19], a[72:75], v[100:103], v[16:19]
  v_mfma_f32_16x16x32_bf16 v[20:23], a[76:79], v[100:103], v[20:23]
  buffer_load_dwordx4 v[100:103], v4, s[8:11], s37 offen offset:1024 sc1
  s_waitcnt vmcnt(32)
  v_mfma_f32_16x16x32_bf16 v[16:19], a[80:83], v[104:107], v[16:19]
  v_mfma_f32_16x16x32_bf16 v[20:23], a[84:87], v[104:107], v[20:23]
  buffer_load_dwordx4 v[104:107], v4, s[8:11], s37 offen offset:2048 sc1
  s_waitcnt vmcnt(32)
  v_mfma_f32_16x16x32_bf16 v[16:19], a[88:91], v[108:111], v[16:19]
  v_mfma_f32_16x16x32_bf16 v[20:23], a[92:95], v[108:111], v[20:23]
  buffer_load_dwordx4 v[108:111], v4, s[8:11], s37 offen offset:3072 sc1
  s_waitcnt vmcnt(32)
  v_mfma_f32_16x16x32_bf16 v[16:19], a[96:99], v[112:115], v[16:19]
  v_mfma_f32_16x16x32_bf16 v[20:23], a[100:103], v[112:115], v[20:23]
  s_add_u32 s37, s38, 0x3000
  buffer_load_dwordx4 v[112:115], v4, s[8:11], s37 offen offset:0 sc1
  s_waitcnt vmcnt(32)
  v_mfma_f32_16x16x32_bf16 v[16:19], a[104:107], v[116:119], v[16:19]
  v_mfma_f32_16x16x32_bf16 v[20:23], a[108:111], v[116:119], v[20:23]
  buffer_load_dwordx4 v[116:119], v4, s[8:11], s37 offen offset:1024 sc1
  s_waitcnt vmcnt(32)
  v_mfma_f32_16x16x32_bf16 v[16:19], a[112:115], v[120:123], v[16:19]
  v_mfma_f32_16x16x32_bf16 v[20:23], a[116:119], v[120:123], v[20:23]
  buffer_load_dwordx4 v[120:123], v4, s[8:11], s37 offen offset:2048 sc1
  s_waitcnt vmcnt(32)
  v_mfma_f32_16x16x32_bf16 v[16:19], a[120:123], v[124:127], v[16:19]
  v_mfma_f32_16x16x32_bf16 v[20:23], a[124:127], v[124:127], v[20:23]
  buffer_load_dwordx4 v[124:127], v4, s[8:11], s37 offen offset:3072 sc1
  s_waitcnt vmcnt(32)
  v_mfma_f32_16x16x32_bf16 v[16:19], a[128:131], v[128:131], v[16:19]
  v_mfma_f32_16x16x32_bf16 v[20:23], a[132:135], v[128:131], v[20:23]
  s_add_u32 s37, s38, 0x4000
  buffer_load_dwordx4 v[128:131], v4, s[8:11], s37 offen offset:0 sc1
  s_waitcnt vmcnt(32)
  v_mfma_f32_16x16x32_bf16 v[16:19], a[136:139], v[132:135], v[16:19]
  v_mfma_f32_16x16x32_bf16 v[20:23], a[140:143], v[132:135], v[20:23]
  buffer_load_dwordx4 v[132:135], v4, s[8:11], s37 offen offset:1024 sc1
  s_waitcnt vmcnt(32)
  v_mfma_f32_16x16x32_bf16 v[16:19], a[144:147], v[136:139], v[16:19]
  v_mfma_f32_16x16x32_bf16 v[20:23], a[148:151], v[136:139], v[20:23]
  buffer_load_dwordx4 v[136:139], v4, s[8:11], s37 offen offset:2048 sc1
  s_waitcnt vmcnt(32)
  v_mfma_f32_16x16x32_bf16 v[16:19], a[152:155], v[140:143], v[16:19]
  v_mfma_f32_16x16x32_bf16 v[20:23], a[156:159], v[140:143], v[20:23]
  buffer_load_dwordx4 v[140:143], v4, s[8:11], s37 offen offset:3072 sc1
  s_waitcnt vmcnt(32)
  v_mfma_f32_16x16x32_bf16 v[16:19], a[160:163], v[144:147], v[16:19]
  v_mfma_f32_16x16x32_bf16 v[20:23], a[164:167], v[144:147], v[20:23]
  s_add_u32 s37, s38, 0x5000
  buffer_load_dwordx4 v[144:147], v4, s[8:11], s37 offen offset:0 sc1
  s_waitcnt vmcnt(32)
  v_mfma_f32_16x16x32_bf16 v[16:19], a[168:171], v[148:151], v[16:19]
  v_mfma_f32_16x16x32_bf16 v[20:23], a[172:175], v[148:151], v[20:23]
  buffer_load_dwordx4 v[148:151], v4, s[8:11], s37 offen offset:1024 sc1
  s_waitcnt vmcnt(32)
  v_mfma_f32_16x16x32_bf16 v[16:19], a[176:179], v[152:155], v[16:19]
  v_mfma_f32_16x16x32_bf16 v[20:23], a[180:183], v[152:155], v[20:23]
  buffer_load_dwordx4 v[152:155], v4, s[8:11], s37 offen offset:2048 sc1
  s_waitcnt vmcnt(32)
  v_mfma_f32_16x16x32_bf16 v[16:19], a[184:187], v[156:159], v[16:19]
  v_mfma_f32_16x16x32_bf16 v[20:23], a[188:191], v[156:159], v[20:23]
  buffer_load_dwordx4 v[156:159], v4, s[8:11], s37 offen offset:3072 sc1
  s_waitcnt vmcnt(32)
  v_mfma_f32_16x16x32_bf16 v[16:19], a[192:195], v[160:163], v[16:19]
  v_mfma_f32_16x16x32_bf16 v[20:23], a[196:199], v[160:163], v[20:23]
  s_add_u32 s37, s38, 0x6000
  buffer_load_dwordx4 v[160:163], v4, s[8:11], s37 offen offset:0 sc1
  s_waitcnt vmcnt(32)
  v_mfma_f32_16x16x32_bf16 v[16:19], a[200:203], v[164:167], v[16:19]
  v_mfma_f32_16x16x32_bf16 v[20:23], a[204:207], v[164:167], v[20:23]
  buffer_load_dwordx4 v[164:167], v4, s[8:11], s37 offen offset:1024 sc1
  s_waitcnt vmcnt(32)
  v_mfma_f32_16x16x32_bf16 v[16:19], a[208:211], v[168:171], v[16:19]
  v_mfma_f32_16x16x32_bf16 v[20:23], a[212:215], v[168:171], v[20:23]
  buffer_load_dwordx4 v[168:171], v4, s[8:11], s37 offen offset:2048 sc1
  s_waitcnt vmcnt(32)
  v_mfma_f32_16x16x32_bf16 v[16:19], a[216:219], v[172:175], v[16:19]
  v_mfma_f32_16x16x32_bf16 v[20:23], a[220:223], v[172:175], v[20:23]
  buffer_load_dwordx4 v[172:175], v4, s[8:11], s37 offen offset:3072 sc1
  s_waitcnt vmcnt(32)
  v_mfma_f32_16x16x32_bf16 v[16:19], a[224:227], v[176:179], v[16:19]
  v_mfma_f32_16x16x32_bf16 v[20:23], a[228:231], v[176:179], v[20:23]
  s_add_u32 s37, s38, 0x7000
  buffer_load_dwordx4 v[176:179], v4, s[8:11], s37 offen offset:0 sc1
  s_waitcnt vmcnt(32)
  v_mfma_f32_16x16x32_bf16 v[16:19], a[232:235], v[180:183], v[16:19]
  v_mfma_f32_16x16x32_bf16 v[20:23], a[236:239], v[180:183], v[20:23]
  buffer_load_dwordx4 v[180:183], v4, s[8:11], s37 offen offset:1024 sc1
  s_waitcnt vmcnt(32)
  v_mfma_f32_16x16x32_bf16 v[16:19], a[240:243], v[184:187], v[16:19]
  v_mfma_f32_16x16x32_bf16 v[20:23], a[244:247], v[184:187], v[20:23]
  buffer_load_dwordx4 v[184:187], v4, s[8:11], s37 offen offset:2048 sc1
  s_waitcnt vmcnt(32)
  v_mfma_f32_16x16x32_bf16 v[16:19], a[248:251], v[188:191], v[16:19]
  v_mfma_f32_16x16x32_bf16 v[20:23], a[252:255], v[188:191], v[20:23]
  buffer_load_dwordx4 v[188:191], v4, s[8:11], s37 offen offset:3072 sc1
tl_213:
  s_barrier
  s_nop 1
  ds_write_b128 v11, v[16:19] offset:0
  s_nop 2
  ds_write_b128 v11, v[20:23] offset:1024
  s_waitcnt lgkmcnt(0)
  s_barrier
  s_cmp_ge_u32 s28, 2
  s_cbranch_scc1 tl_211
  ds_read_b128 v[32:35], v12 offset:0
  ds_read_b128 v[36:39], v12 offset:2048
  ds_read_b128 v[40:43], v12 offset:4096
  ds_read_b128 v[44:47], v12 offset:6144
  s_waitcnt lgkmcnt(0)
  v_pk_add_f32 v[32:33], v[32:33], v[36:37]
  v_pk_add_f32 v[40:41], v[40:41], v[44:45]
  v_pk_add_f32 v[32:33], v[32:33], v[40:41]
  v_pk_add_f32 v[34:35], v[34:35], v[38:39]
  v_pk_add_f32 v[42:43], v[42:43], v[46:47]
  v_pk_add_f32 v[34:35], v[34:35], v[42:43]
  v_cvt_pk_bf16_f32 v36, v32, v33
  v_cvt_pk_bf16_f32 v37, v34, v35
  s_lshl_b32 s36, s88, 16
  buffer_store_dwordx2 v[36:37], v13, s[24:27], s36 offen
tl_211:
  s_add_u32 s88, s88, 2
  s_cmp_ge_u32 s52, 64
  s_cbranch_scc1 tl_214
  s_cmp_lt_u32 s88, 128
  s_cbranch_scc1 tl_208
  s_endpgm
  s_cmp_eq_u32 s29, 0
  s_cbranch_scc1 tk_216
tb_215:
  s_waitcnt vmcnt(0)
  s_branch W_next
W_att:
  s_mov_b32 s3, 5
  s_cmp_lg_u32 s32, 0
  s_cbranch_scc1 W_epi
W_ret5:
  s_cmp_lg_u32 s28, 0
  s_cbranch_scc1 W_p2
  s_lshl_b32 s38, s59, 7
  s_add_u32 s38, s38, 0x4c06400
  v_mov_b32 v1, 1
  s_mov_b64 exec, 1
  buffer_atomic_add v1, v6, s[8:11], s38 offen sc0 sc1
  s_waitcnt vmcnt(0)
  ds_write_b32 v5, v1 offset:8
  s_mov_b64 exec, -1
  s_waitcnt lgkmcnt(0)
W_p2:
  s_barrier
  ds_read_b32 v1, v5 offset:8
  s_waitcnt lgkmcnt(0)
  v_readfirstlane_b32 s36, v1
  s_nop 3
  s_cmp_lt_u32 s36, 64
  s_cbranch_scc1 W_p3
  s_waitcnt vmcnt(0)
  s_barrier
  s_cmp_lg_u32 s49, 255
  s_cbranch_scc1 sg_217
sb_218:
  s_cmp_lt_u32 s58, 4
  s_cbranch_scc1 L_done
  s_cmp_eq_u32 s29, 0
  s_cbranch_scc1 tk_220
tb_219:
  s_mov_b32 s85, 0xff00000
  s_waitcnt vmcnt(0)
  s_branch W_next
W_p3:
  s_lshr_b32 s88, s36, 3
  s_and_b32 s36, s36, 7
  s_lshl_b32 s59, s59, 3
  s_add_u32 s59, s59, s36
  s_add_u32 s36, s88, 148
  s_lshl_b32 s85, s36, 20
  s_mov_b32 s54, 0
br_221:
  s_lshl_b32 s36, s59, 17
  s_lshl_b32 s37, s28, 10
  s_add_u32 s36, s36, s37
  s_add_u32 s52, s36, 0x7400000
  s_add_u32 s53, s36, 0x7800000
  s_mov_b32 s82, s37
  s_lshl_b32 s37, s28, 12
  s_lshl_b32 s36, s59, 17
  s_lshl_b32 s38, s88, 14
  s_add_u32 s36, s36, s38
  s_add_u32 s36, s36, s37
  s_add_u32 s36, s36, 0x7000000
  buffer_load_dwordx4 v[20:23], v4, s[8:11], s36 offen offset:0 sc1
  buffer_load_dwordx4 v[24:27], v4, s[8:11], s36 offen offset:1024 sc1
  buffer_load_dwordx4 v[28:31], v4, s[8:11], s36 offen offset:2048 sc1
  buffer_load_dwordx4 v[32:35], v4, s[8:11], s36 offen offset:3072 sc1
  s_add_u32 m0, s82, 0x0
  s_nop 0
  buffer_load_dwordx4 v4, s[8:11], s52 offen sc1 lds
  s_add_u32 s52, s52, 0x1000
  s_add_u32 m0, s82, 0x10000
  s_nop 0
  buffer_load_dwordx4 v4, s[8:11], s53 offen sc1 lds
  s_add_u32 s53, s53, 0x1000
  s_add_u32 s82, s82, 0x1000
  s_and_b32 s82, s82, 0xffff
  s_add_u32 m0, s82, 0x0
  s_nop 0
  buffer_load_dwordx4 v4, s[8:11], s52 offen sc1 lds
  s_add_u32 s52, s52, 0x1000
  s_add_u32 m0, s82, 0x10000
  s_nop 0
  buffer_load_dwordx4 v4, s[8:11], s53 offen sc1 lds
  s_add_u32 s53, s53, 0x1000
  s_add_u32 s82, s82, 0x1000
  s_and_b32 s82, s82, 0xffff
  s_add_u32 m0, s82, 0x0
  s_nop 0
  buffer_load_dwordx4 v4, s[8:11], s52 offen sc1 lds
  s_add_u32 s52, s52, 0x1000
  s_add_u32 m0, s82, 0x10000
  s_nop 0
  buffer_load_dwordx4 v4, s[8:11], s53 offen sc1 lds
  s_add_u32 s53, s53, 0x1000
  s_add_u32 s82, s82, 0x1000
  s_and_b32 s82, s82, 0xffff
  s_add_u32 m0, s82, 0x0
  s_nop 0
  buffer_load_dwordx4 v4, s[8:11], s52 offen sc1 lds
  s_add_u32 s52, s52, 0x1000
  s_add_u32 m0, s82, 0x10000
  s_nop 0
  buffer_load_dwordx4 v4, s[8:11], s53 offen sc1 lds
  s_add_u32 s53, s53, 0x1000
  s_add_u32 s82, s82, 0x1000
  s_and_b32 s82, s82, 0xffff
  s_add_u32 m0, s82, 0x0
  s_nop 0
  buffer_load_dwordx4 v4, s[8:11], s52 offen sc1 lds
  s_add_u32 s52, s52, 0x1000
  s_add_u32 m0, s82, 0x10000
  s_nop 0
  buffer_load_dwordx4 v4, s[8:11], s53 offen sc1 lds
  s_add_u32 s53, s53, 0x1000
  s_add_u32 s82, s82, 0x1000
  s_and_b32 s82, s82, 0xffff
  s_add_u32 m0, s82, 0x0
  s_nop 0
  buffer_load_dwordx4 v4, s[8:11], s52 offen sc1 lds
  s_add_u32 s52, s52, 0x1000
  s_add_u32 m0, s82, 0x10000
  s_nop 0
  buffer_load_dwordx4 v4, s[8:11], s53 offen sc1 lds
  s_add_u32 s53, s53, 0x1000
  s_add_u32 s82, s82, 0x1000
  s_and_b32 s82, s82, 0xffff
  s_add_u32 m0, s82, 0x0
  s_nop 0
  buffer_load_dwordx4 v4, s[8:11], s52 offen sc1 lds
  s_add_u32 s52, s52, 0x1000
  s_add_u32 m0, s82, 0x10000
  s_nop 0
  buffer_load_dwordx4 v4, s[8:11], s53 offen sc1 lds
  s_add_u32 s53, s53, 0x1000
  s_add_u32 s82, s82, 0x1000
  s_and_b32 s82, s82, 0xffff
  s_add_u32 m0, s82, 0x0
  s_nop 0
  buffer_load_dwordx4 v4, s[8:11], s52 offen sc1 lds
  s_add_u32 s52, s52, 0x1000
  s_add_u32 m0, s82, 0x10000
  s_nop 0
  buffer_load_dwordx4 v4, s[8:11], s53 offen sc1 lds
  s_add_u32 s53, s53, 0x1000
  s_add_u32 s82, s82, 0x1000
  s_and_b32 s82, s82, 0xffff
  s_add_u32 m0, s82, 0x0
  s_nop 0
  buffer_load_dwordx4 v4, s[8:11], s52 offen sc1 lds
  s_add_u32 s52, s52, 0x1000
  s_add_u32 m0, s82, 0x10000
  s_nop 0
  buffer_load_dwordx4 v4, s[8:11], s53 offen sc1 lds
  s_add_u32 s53, s53, 0x1000
  s_add_u32 s82, s82, 0x1000
  s_and_b32 s82, s82, 0xffff
  v_lshrrev_b32 v11, 2, v0
  v_lshrrev_b32 v12, 4, v0
  v_xor_b32 v11, v11, v12
  v_and_b32 v11, 1, v11
  v_cmp_eq_u32 vcc, 0, v11
  v_mov_b32 v12, 0x3f803f80
  s_nop 0
  v_cndmask_b32 v16, 0, v12, vcc
  v_cndmask_b32 v17, 0, v12, vcc
  v_cndmask_b32 v18, 0, v12, vcc
  v_cndmask_b32 v19, 0, v12, vcc
  v_mov_b32 v80, 0
  v_mov_b32 v64, 0
  v_mov_b32 v81, 0
  v_mov_b32 v65, 0
  v_mov_b32 v82, 0
  v_mov_b32 v66, 0
  v_mov_b32 v83, 0
  v_mov_b32 v67, 0
  v_mov_b32 v178, 0
  v_mov_b32 v179, 0
  v_mov_b32 v84, 0
  v_mov_b32 v85, 0
  v_mov_b32 v86, 0
  v_mov_b32 v87, 0
  v_mov_b32 v88, 0
  v_mov_b32 v89, 0
  v_mov_b32 v90, 0
  v_mov_b32 v91, 0
  v_mov_b32 v92, 0
  v_mov_b32 v93, 0
  v_mov_b32 v94, 0
  v_mov_b32 v95, 0
  v_mov_b32 v96, 0
  v_mov_b32 v97, 0
  v_mov_b32 v98, 0
  v_mov_b32 v99, 0
  v_mov_b32 v100, 0
  v_mov_b32 v101, 0
  v_mov_b32 v102, 0
  v_mov_b32 v103, 0
  v_mov_b32 v104, 0
  v_mov_b32 v105, 0
  v_mov_b32 v106, 0
  v_mov_b32 v107, 0
  v_mov_b32 v108, 0
  v_mov_b32 v109, 0
  v_mov_b32 v110, 0
  v_mov_b32 v111, 0
  v_mov_b32 v112, 0
  v_mov_b32 v113, 0
  v_mov_b32 v114, 0
  v_mov_b32 v115, 0
  v_mov_b32 v180, 0
  v_mov_b32 v181, 0
  v_mov_b32 v182, 0
  v_mov_b32 v183, 0
  v_mov_b32 v184, 0
  v_mov_b32 v185, 0
  v_mov_b32 v186, 0
  v_mov_b32 v187, 0
  v_mov_b32 v188, 0
  v_mov_b32 v189, 0
  v_mov_b32 v190, 0
  v_mov_b32 v191, 0
  v_mov_b32 v192, 0
  v_mov_b32 v193, 0
  v_mov_b32 v194, 0
  v_mov_b32 v195, 0
  v_mov_b32 v196, 0
  v_mov_b32 v197, 0
  v_mov_b32 v198, 0
  v_mov_b32 v199, 0
  v_mov_b32 v200, 0
  v_mov_b32 v201, 0
  v_mov_b32 v202, 0
  v_mov_b32 v203, 0
  v_mov_b32 v204, 0
  v_mov_b32 v205, 0
  v_mov_b32 v206, 0
  v_mov_b32 v207, 0
  v_mov_b32 v208, 0
  v_mov_b32 v209, 0
  v_mov_b32 v210, 0
  v_mov_b32 v211, 0
  v_mov_b32 v212, 0
  v_mov_b32 v228, 0
  v_mov_b32 v213, 0
  v_mov_b32 v229, 0
  v_mov_b32 v214, 0
  v_mov_b32 v230, 0
  v_mov_b32 v215, 0
  v_mov_b32 v231, 0
  v_mov_b32 v8, v4
  v_add_u32 v9, 0x10000, v4
  s_mov_b32 s56, 0xff800000
  s_mov_b32 s57, 0x41800000
  s_mov_b32 s55, 0
  s_waitcnt vmcnt(10)
  s_barrier
  s_cmp_lg_u32 s49, 255
  s_cbranch_scc1 sg_222
sb_223:
  s_mov_b32 s39, 0xffff
  v_mov_b32 v12, 0x10000
  ds_read_b128 v[36:39], v8 offset:0
  ds_read_b128 v[40:43], v8 offset:1024
  v_add_u32 v8, 0x800, v8
  v_and_b32 v8, 0xffff, v8
  ds_read_b128 v[44:47], v8 offset:0
  ds_read_b128 v[48:51], v8 offset:1024
  v_add_u32 v8, 0x800, v8
  v_and_b32 v8, 0xffff, v8
  ds_read_b128 v[52:55], v9 offset:0
  ds_read_b128 v[56:59], v9 offset:1024
  v_add_u32 v9, 0x800, v9
  v_and_or_b32 v9, v9, s39, v12
  s_waitcnt lgkmcnt(0)
  v_mfma_f32_32x32x16_bf16 v[116:131], v[36:39], v[20:23], v[84:99]
  v_mfma_f32_32x32x16_bf16 v[116:131], v[40:43], v[24:27], v[116:131]
  v_mfma_f32_32x32x16_bf16 v[132:147], v[36:39], v[28:31], v[100:115]
  v_mfma_f32_32x32x16_bf16 v[132:147], v[40:43], v[32:35], v[132:147]
  s_branch ba_224
bl_227:
  v_mov_b32 v8, v4
  v_add_u32 v9, 0x10000, v4
bl_228:
  s_waitcnt lgkmcnt(0)
  v_mfma_f32_32x32x16_bf16 v[148:163], v[44:47], v[20:23], v[84:99]
  v_exp_f32 v116, v116
  v_cvt_pk_bf16_f32 v83, v178, v179
  v_exp_f32 v117, v117
  ds_read_b128 v[36:39], v8 offset:4096
  v_exp_f32 v118, v118
  v_mfma_f32_32x32x16_bf16 v[196:211], v[64:67], v[80:83], v[196:211]
  v_cvt_pk_bf16_f32 v68, v116, v117
  v_exp_f32 v119, v119
  v_exp_f32 v120, v120
  v_cvt_pk_bf16_f32 v69, v118, v119
  v_exp_f32 v121, v121
  v_mfma_f32_16x16x32_bf16 v[228:231], v[16:19], v[80:83], v[228:231]
  ds_read_b128 v[40:43], v8 offset:5120
  v_exp_f32 v122, v122
  v_mfma_f32_32x32x16_bf16 v[148:163], v[48:51], v[24:27], v[148:163]
  v_cvt_pk_bf16_f32 v70, v120, v121
  v_exp_f32 v123, v123
  v_exp_f32 v124, v124
  v_cvt_pk_bf16_f32 v71, v122, v123
  v_exp_f32 v125, v125
  v_exp_f32 v126, v126
  v_mfma_f32_32x32x16_bf16 v[180:195], v[52:55], v[68:71], v[180:195]
  v_cvt_pk_bf16_f32 v72, v124, v125
  v_exp_f32 v127, v127
  s_add_u32 m0, s82, 0x0
  v_exp_f32 v128, v128
  v_cvt_pk_bf16_f32 v73, v126, v127
  v_mfma_f32_16x16x32_bf16 v[212:215], v[16:19], v[68:71], v[212:215]
  v_exp_f32 v129, v129
  v_mfma_f32_32x32x16_bf16 v[164:179], v[44:47], v[28:31], v[100:115]
  v_exp_f32 v130, v130
  v_cvt_pk_bf16_f32 v74, v128, v129
  v_exp_f32 v131, v131
  buffer_load_dwordx4 v4, s[8:11], s52 offen sc1 lds
  s_add_u32 s52, s52, 0x1000
  v_exp_f32 v132, v132
  v_cvt_pk_bf16_f32 v75, v130, v131
  v_exp_f32 v133, v133
  ds_read_b128 v[60:63], v9 offset:2048
  v_mfma_f32_32x32x16_bf16 v[180:195], v[56:59], v[72:75], v[180:195]
  v_exp_f32 v134, v134
  v_cvt_pk_bf16_f32 v76, v132, v133
  v_exp_f32 v135, v135
  v_exp_f32 v136, v136
  v_mfma_f32_16x16x32_bf16 v[212:215], v[16:19], v[72:75], v[212:215]
  v_cvt_pk_bf16_f32 v77, v134, v135
  v_exp_f32 v137, v137
  v_mfma_f32_32x32x16_bf16 v[164:179], v[48:51], v[32:35], v[164:179]
  ds_read_b128 v[64:67], v9 offset:3072
  v_exp_f32 v138, v138
  v_cvt_pk_bf16_f32 v78, v136, v137
  v_exp_f32 v139, v139
  v_exp_f32 v140, v140
  v_cvt_pk_bf16_f32 v79, v138, v139
  v_exp_f32 v141, v141
  v_exp_f32 v142, v142
  v_mfma_f32_32x32x16_bf16 v[196:211], v[52:55], v[76:79], v[196:211]
  v_cvt_pk_bf16_f32 v80, v140, v141
  v_exp_f32 v143, v143
  v_exp_f32 v144, v144
  v_cvt_pk_bf16_f32 v81, v142, v143
  v_mfma_f32_16x16x32_bf16 v[228:231], v[16:19], v[76:79], v[228:231]
  v_exp_f32 v145, v145
  v_exp_f32 v146, v146
  v_cvt_pk_bf16_f32 v82, v144, v145
  v_exp_f32 v147, v147
  s_waitcnt lgkmcnt(0)
  v_mfma_f32_32x32x16_bf16 v[116:131], v[36:39], v[20:23], v[84:99]
  v_exp_f32 v148, v148
  v_cvt_pk_bf16_f32 v83, v146, v147
  v_exp_f32 v149, v149
  ds_read_b128 v[44:47], v8 offset:6144
  v_exp_f32 v150, v150
  v_mfma_f32_32x32x16_bf16 v[196:211], v[56:59], v[80:83], v[196:211]
  v_cvt_pk_bf16_f32 v68, v148, v149
  v_exp_f32 v151, v151
  v_exp_f32 v152, v152
  v_cvt_pk_bf16_f32 v69, v150, v151
  v_exp_f32 v153, v153
  v_mfma_f32_16x16x32_bf16 v[228:231], v[16:19], v[80:83], v[228:231]
  ds_read_b128 v[48:51], v8 offset:7168
  v_exp_f32 v154, v154
  v_mfma_f32_32x32x16_bf16 v[116:131], v[40:43], v[24:27], v[116:131]
  v_cvt_pk_bf16_f32 v70, v152, v153
  v_exp_f32 v155, v155
  v_exp_f32 v156, v156
  v_cvt_pk_bf16_f32 v71, v154, v155
  v_exp_f32 v157, v157
  v_exp_f32 v158, v158
  v_mfma_f32_32x32x16_bf16 v[180:195], v[60:63], v[68:71], v[180:195]
  v_cvt_pk_bf16_f32 v72, v156, v157
  v_exp_f32 v159, v159
  s_add_u32 m0, s82, 0x10000
  v_exp_f32 v160, v160
  v_cvt_pk_bf16_f32 v73, v158, v159
  v_mfma_f32_16x16x32_bf16 v[212:215], v[16:19], v[68:71], v[212:215]
  v_exp_f32 v161, v161
  v_mfma_f32_32x32x16_bf16 v[132:147], v[36:39], v[28:31], v[100:115]
  v_exp_f32 v162, v162
  v_cvt_pk_bf16_f32 v74, v160, v161
  v_exp_f32 v163, v163
  buffer_load_dwordx4 v4, s[8:11], s53 offen sc1 lds
  s_add_u32 s53, s53, 0x1000
  s_add_u32 s82, s82, 0x1000
  s_and_b32 s82, s82, 0xffff
  v_exp_f32 v164, v164
  v_cvt_pk_bf16_f32 v75, v162, v163
  v_exp_f32 v165, v165
  ds_read_b128 v[52:55], v9 offset:4096
  v_mfma_f32_32x32x16_bf16 v[180:195], v[64:67], v[72:75], v[180:195]
  v_exp_f32 v166, v166
  v_cvt_pk_bf16_f32 v76, v164, v165
  v_exp_f32 v167, v167
  v_exp_f32 v168, v168
  v_mfma_f32_16x16x32_bf16 v[212:215], v[16:19], v[72:75], v[212:215]
  v_cvt_pk_bf16_f32 v77, v166, v167
  v_exp_f32 v169, v169
  v_mfma_f32_32x32x16_bf16 v[132:147], v[40:43], v[32:35], v[132:147]
  ds_read_b128 v[56:59], v9 offset:5120
  v_exp_f32 v170, v170
  v_cvt_pk_bf16_f32 v78, v168, v169
  v_exp_f32 v171, v171
  v_exp_f32 v172, v172
  v_cvt_pk_bf16_f32 v79, v170, v171
  v_exp_f32 v173, v173
  v_exp_f32 v174, v174
  v_mfma_f32_32x32x16_bf16 v[196:211], v[60:63], v[76:79], v[196:211]
  v_cvt_pk_bf16_f32 v80, v172, v173
  v_exp_f32 v175, v175
  v_exp_f32 v176, v176
  v_cvt_pk_bf16_f32 v81, v174, v175
  v_mfma_f32_16x16x32_bf16 v[228:231], v[16:19], v[76:79], v[228:231]
  v_exp_f32 v177, v177
  v_exp_f32 v178, v178
  v_cvt_pk_bf16_f32 v82, v176, v177
  v_exp_f32 v179, v179
  s_waitcnt lgkmcnt(0)
  v_mfma_f32_32x32x16_bf16 v[148:163], v[44:47], v[20:23], v[84:99]
  v_exp_f32 v116, v116
  v_cvt_pk_bf16_f32 v83, v178, v179
  v_exp_f32 v117, v117
  ds_read_b128 v[36:39], v8 offset:8192
  v_exp_f32 v118, v118
  v_mfma_f32_32x32x16_bf16 v[196:211], v[64:67], v[80:83], v[196:211]
  v_cvt_pk_bf16_f32 v68, v116, v117
  v_exp_f32 v119, v119
  v_exp_f32 v120, v120
  v_cvt_pk_bf16_f32 v69, v118, v119
  v_exp_f32 v121, v121
  v_mfma_f32_16x16x32_bf16 v[228:231], v[16:19], v[80:83], v[228:231]
  ds_read_b128 v[40:43], v8 offset:9216
  v_exp_f32 v122, v122
  v_mfma_f32_32x32x16_bf16 v[148:163], v[48:51], v[24:27], v[148:163]
  v_cvt_pk_bf16_f32 v70, v120, v121
  v_exp_f32 v123, v123
  v_exp_f32 v124, v124
  v_cvt_pk_bf16_f32 v71, v122, v123
  v_exp_f32 v125, v125
  v_exp_f32 v126, v126
  v_mfma_f32_32x32x16_bf16 v[180:195], v[52:55], v[68:71], v[180:195]
  v_cvt_pk_bf16_f32 v72, v124, v125
  v_exp_f32 v127, v127
  s_add_u32 m0, s82, 0x0
  v_exp_f32 v128, v128
  v_cvt_pk_bf16_f32 v73, v126, v127
  v_mfma_f32_16x16x32_bf16 v[212:215], v[16:19], v[68:71], v[212:215]
  v_exp_f32 v129, v129
  v_mfma_f32_32x32x16_bf16 v[164:179], v[44:47], v[28:31], v[100:115]
  v_exp_f32 v130, v130
  v_cvt_pk_bf16_f32 v74, v128, v129
  v_exp_f32 v131, v131
  buffer_load_dwordx4 v4, s[8:11], s52 offen sc1 lds
  s_add_u32 s52, s52, 0x1000
  v_exp_f32 v132, v132
  v_cvt_pk_bf16_f32 v75, v130, v131
  v_exp_f32 v133, v133
  ds_read_b128 v[60:63], v9 offset:6144
  v_mfma_f32_32x32x16_bf16 v[180:195], v[56:59], v[72:75], v[180:195]
  v_exp_f32 v134, v134
  v_cvt_pk_bf16_f32 v76, v132, v133
  v_exp_f32 v135, v135
  v_exp_f32 v136, v136
  v_mfma_f32_16x16x32_bf16 v[212:215], v[16:19], v[72:75], v[212:215]
  v_cvt_pk_bf16_f32 v77, v134, v135
  v_exp_f32 v137, v137
  v_mfma_f32_32x32x16_bf16 v[164:179], v[48:51], v[32:35], v[164:179]
  ds_read_b128 v[64:67], v9 offset:7168
  v_exp_f32 v138, v138
  v_cvt_pk_bf16_f32 v78, v136, v137
  v_exp_f32 v139, v139
  v_exp_f32 v140, v140
  v_cvt_pk_bf16_f32 v79, v138, v139
  v_exp_f32 v141, v141
  v_exp_f32 v142, v142
  v_mfma_f32_32x32x16_bf16 v[196:211], v[52:55], v[76:79], v[196:211]
  v_cvt_pk_bf16_f32 v80, v140, v141
  v_exp_f32 v143, v143
  v_exp_f32 v144, v144
  v_cvt_pk_bf16_f32 v81, v142, v143
  v_mfma_f32_16x16x32_bf16 v[228:231], v[16:19], v[76:79], v[228:231]
  v_exp_f32 v145, v145
  v_exp_f32 v146, v146
  v_cvt_pk_bf16_f32 v82, v144, v145
  v_exp_f32 v147, v147
  s_waitcnt lgkmcnt(0)
  v_mfma_f32_32x32x16_bf16 v[116:131], v[36:39], v[20:23], v[84:99]
  v_exp_f32 v148, v148
  v_cvt_pk_bf16_f32 v83, v146, v147
  v_exp_f32 v149, v149
  ds_read_b128 v[44:47], v8 offset:10240
  v_exp_f32 v150, v150
  v_mfma_f32_32x32x16_bf16 v[196:211], v[56:59], v[80:83], v[196:211]
  v_cvt_pk_bf16_f32 v68, v148, v149
  v_exp_f32 v151, v151
  v_exp_f32 v152, v152
  v_cvt_pk_bf16_f32 v69, v150, v151
  v_exp_f32 v153, v153
  v_mfma_f32_16x16x32_bf16 v[228:231], v[16:19], v[80:83], v[228:231]
  ds_read_b128 v[48:51], v8 offset:11264
  v_exp_f32 v154, v154
  v_mfma_f32_32x32x16_bf16 v[116:131], v[40:43], v[24:27], v[116:131]
  v_cvt_pk_bf16_f32 v70, v152, v153
  v_exp_f32 v155, v155
  v_exp_f32 v156, v156
  v_cvt_pk_bf16_f32 v71, v154, v155
  v_exp_f32 v157, v157
  v_exp_f32 v158, v158
  v_mfma_f32_32x32x16_bf16 v[180:195], v[60:63], v[68:71], v[180:195]
  v_cvt_pk_bf16_f32 v72, v156, v157
  v_exp_f32 v159, v159
  s_add_u32 m0, s82, 0x10000
  v_exp_f32 v160, v160
  v_cvt_pk_bf16_f32 v73, v158, v159
  v_mfma_f32_16x16x32_bf16 v[212:215], v[16:19], v[68:71], v[212:215]
  v_exp_f32 v161, v161
  v_mfma_f32_32x32x16_bf16 v[132:147], v[36:39], v[28:31], v[100:115]
  v_exp_f32 v162, v162
  v_cvt_pk_bf16_f32 v74, v160, v161
  v_exp_f32 v163, v163
  buffer_load_dwordx4 v4, s[8:11], s53 offen sc1 lds
  s_add_u32 s53, s53, 0x1000
  s_add_u32 s82, s82, 0x1000
  s_and_b32 s82, s82, 0xffff
  v_exp_f32 v164, v164
  v_cvt_pk_bf16_f32 v75, v162, v163
  v_exp_f32 v165, v165
  ds_read_b128 v[52:55], v9 offset:8192
  v_mfma_f32_32x32x16_bf16 v[180:195], v[64:67], v[72:75], v[180:195]
  v_exp_f32 v166, v166
  v_cvt_pk_bf16_f32 v76, v164, v165
  v_exp_f32 v167, v167
  v_exp_f32 v168, v168
  v_mfma_f32_16x16x32_bf16 v[212:215], v[16:19], v[72:75], v[212:215]
  v_cvt_pk_bf16_f32 v77, v166, v167
  v_exp_f32 v169, v169
  v_mfma_f32_32x32x16_bf16 v[132:147], v[40:43], v[32:35], v[132:147]
  ds_read_b128 v[56:59], v9 offset:9216
  v_exp_f32 v170, v170
  v_cvt_pk_bf16_f32 v78, v168, v169
  v_exp_f32 v171, v171
  v_exp_f32 v172, v172
  v_cvt_pk_bf16_f32 v79, v170, v171
  v_exp_f32 v173, v173
  v_exp_f32 v174, v174
  v_mfma_f32_32x32x16_bf16 v[196:211], v[60:63], v[76:79], v[196:211]
  v_cvt_pk_bf16_f32 v80, v172, v173
  v_exp_f32 v175, v175
  v_exp_f32 v176, v176
  v_cvt_pk_bf16_f32 v81, v174, v175
  v_mfma_f32_16x16x32_bf16 v[228:231], v[16:19], v[76:79], v[228:231]
  v_exp_f32 v177, v177
  v_exp_f32 v178, v178
  v_cvt_pk_bf16_f32 v82, v176, v177
  v_exp_f32 v179, v179
  s_waitcnt lgkmcnt(0)
  v_mfma_f32_32x32x16_bf16 v[148:163], v[44:47], v[20:23], v[84:99]
  v_exp_f32 v116, v116
  v_cvt_pk_bf16_f32 v83, v178, v179
  v_exp_f32 v117, v117
  ds_read_b128 v[36:39], v8 offset:12288
  v_exp_f32 v118, v118
  v_mfma_f32_32x32x16_bf16 v[196:211], v[64:67], v[80:83], v[196:211]
  v_cvt_pk_bf16_f32 v68, v116, v117
  v_exp_f32 v119, v119
  v_exp_f32 v120, v120
  v_cvt_pk_bf16_f32 v69, v118, v119
  v_exp_f32 v121, v121
  v_mfma_f32_16x16x32_bf16 v[228:231], v[16:19], v[80:83], v[228:231]
  ds_read_b128 v[40:43], v8 offset:13312
  v_exp_f32 v122, v122
  v_mfma_f32_32x32x16_bf16 v[148:163], v[48:51], v[24:27], v[148:163]
  v_cvt_pk_bf16_f32 v70, v120, v121
  v_exp_f32 v123, v123
  v_exp_f32 v124, v124
  v_cvt_pk_bf16_f32 v71, v122, v123
  v_exp_f32 v125, v125
  v_exp_f32 v126, v126
  v_mfma_f32_32x32x16_bf16 v[180:195], v[52:55], v[68:71], v[180:195]
  v_cvt_pk_bf16_f32 v72, v124, v125
  v_exp_f32 v127, v127
  s_add_u32 m0, s82, 0x0
  v_exp_f32 v128, v128
  v_cvt_pk_bf16_f32 v73, v126, v127
  v_mfma_f32_16x16x32_bf16 v[212:215], v[16:19], v[68:71], v[212:215]
  v_exp_f32 v129, v129
  v_mfma_f32_32x32x16_bf16 v[164:179], v[44:47], v[28:31], v[100:115]
  v_exp_f32 v130, v130
  v_cvt_pk_bf16_f32 v74, v128, v129
  v_exp_f32 v131, v131
  buffer_load_dwordx4 v4, s[8:11], s52 offen sc1 lds
  s_add_u32 s52, s52, 0x1000
  v_exp_f32 v132, v132
  v_cvt_pk_bf16_f32 v75, v130, v131
  v_exp_f32 v133, v133
  ds_read_b128 v[60:63], v9 offset:10240
  v_mfma_f32_32x32x16_bf16 v[180:195], v[56:59], v[72:75], v[180:195]
  v_exp_f32 v134, v134
  v_cvt_pk_bf16_f32 v76, v132, v133
  v_exp_f32 v135, v135
  v_exp_f32 v136, v136
  v_mfma_f32_16x16x32_bf16 v[212:215], v[16:19], v[72:75], v[212:215]
  v_cvt_pk_bf16_f32 v77, v134, v135
  v_exp_f32 v137, v137
  v_mfma_f32_32x32x16_bf16 v[164:179], v[48:51], v[32:35], v[164:179]
  ds_read_b128 v[64:67], v9 offset:11264
  v_exp_f32 v138, v138
  v_cvt_pk_bf16_f32 v78, v136, v137
  v_exp_f32 v139, v139
  v_exp_f32 v140, v140
  v_cvt_pk_bf16_f32 v79, v138, v139
  v_exp_f32 v141, v141
  v_exp_f32 v142, v142
  v_mfma_f32_32x32x16_bf16 v[196:211], v[52:55], v[76:79], v[196:211]
  v_cvt_pk_bf16_f32 v80, v140, v141
  v_exp_f32 v143, v143
  v_exp_f32 v144, v144
  v_cvt_pk_bf16_f32 v81, v142, v143
  v_mfma_f32_16x16x32_bf16 v[228:231], v[16:19], v[76:79], v[228:231]
  v_exp_f32 v145, v145
  v_exp_f32 v146, v146
  v_cvt_pk_bf16_f32 v82, v144, v145
  v_exp_f32 v147, v147
  s_waitcnt lgkmcnt(0)
  v_mfma_f32_32x32x16_bf16 v[116:131], v[36:39], v[20:23], v[84:99]
  v_exp_f32 v148, v148
  v_cvt_pk_bf16_f32 v83, v146, v147
  v_exp_f32 v149, v149
  ds_read_b128 v[44:47], v8 offset:14336
  v_exp_f32 v150, v150
  v_mfma_f32_32x32x16_bf16 v[196:211], v[56:59], v[80:83], v[196:211]
  v_cvt_pk_bf16_f32 v68, v148, v149
  v_exp_f32 v151, v151
  v_exp_f32 v152, v152
  v_cvt_pk_bf16_f32 v69, v150, v151
  v_exp_f32 v153, v153
  v_mfma_f32_16x16x32_bf16 v[228:231], v[16:19], v[80:83], v[228:231]
  ds_read_b128 v[48:51], v8 offset:15360
  v_exp_f32 v154, v154
  v_mfma_f32_32x32x16_bf16 v[116:131], v[40:43], v[24:27], v[116:131]
  v_cvt_pk_bf16_f32 v70, v152, v153
  v_exp_f32 v155, v155
  v_exp_f32 v156, v156
  v_cvt_pk_bf16_f32 v71, v154, v155
  v_exp_f32 v157, v157
  v_add_u32 v8, 0x4000, v8
  v_mfma_f32_32x32x16_bf16 v[180:195], v[60:63], v[68:71], v[180:195]
  v_exp_f32 v158, v158
  v_cvt_pk_bf16_f32 v72, v156, v157
  v_exp_f32 v159, v159
  s_add_u32 m0, s82, 0x10000
  v_exp_f32 v160, v160
  v_mfma_f32_16x16x32_bf16 v[212:215], v[16:19], v[68:71], v[212:215]
  v_cvt_pk_bf16_f32 v73, v158, v159
  v_exp_f32 v161, v161
  v_mfma_f32_32x32x16_bf16 v[132:147], v[36:39], v[28:31], v[100:115]
  v_and_b32 v8, 0xffff, v8
  v_exp_f32 v162, v162
  v_cvt_pk_bf16_f32 v74, v160, v161
  v_exp_f32 v163, v163
  buffer_load_dwordx4 v4, s[8:11], s53 offen sc1 lds
  s_add_u32 s53, s53, 0x1000
  s_add_u32 s82, s82, 0x1000
  s_and_b32 s82, s82, 0xffff
  v_exp_f32 v164, v164
  v_cvt_pk_bf16_f32 v75, v162, v163
  v_exp_f32 v165, v165
  ds_read_b128 v[52:55], v9 offset:12288
  v_mfma_f32_32x32x16_bf16 v[180:195], v[64:67], v[72:75], v[180:195]
  v_exp_f32 v166, v166
  v_cvt_pk_bf16_f32 v76, v164, v165
  v_exp_f32 v167, v167
  v_exp_f32 v168, v168
  v_mfma_f32_16x16x32_bf16 v[212:215], v[16:19], v[72:75], v[212:215]
  v_cvt_pk_bf16_f32 v77, v166, v167
  v_exp_f32 v169, v169
  v_mfma_f32_32x32x16_bf16 v[132:147], v[40:43], v[32:35], v[132:147]
  ds_read_b128 v[56:59], v9 offset:13312
  v_exp_f32 v170, v170
  v_cvt_pk_bf16_f32 v78, v168, v169
  v_exp_f32 v171, v171
  v_exp_f32 v172, v172
  v_cvt_pk_bf16_f32 v79, v170, v171
  v_exp_f32 v173, v173
  v_exp_f32 v174, v174
  v_mfma_f32_32x32x16_bf16 v[196:211], v[60:63], v[76:79], v[196:211]
  v_cvt_pk_bf16_f32 v80, v172, v173
  v_exp_f32 v175, v175
  v_exp_f32 v176, v176
  v_cvt_pk_bf16_f32 v81, v174, v175
  v_mfma_f32_16x16x32_bf16 v[228:231], v[16:19], v[76:79], v[228:231]
  v_exp_f32 v177, v177
  v_exp_f32 v178, v178
  v_cvt_pk_bf16_f32 v82, v176, v177
  v_exp_f32 v179, v179
  s_waitcnt vmcnt(8)
  s_barrier
  s_cmp_ge_u32 s55, 5
  s_cselect_b32 s52, 0x7f000000, s52
  s_cselect_b32 s53, 0x7f000000, s53
  s_waitcnt lgkmcnt(0)
  v_mfma_f32_32x32x16_bf16 v[148:163], v[44:47], v[20:23], v[84:99]
  v_exp_f32 v116, v116
  v_cvt_pk_bf16_f32 v83, v178, v179
  v_exp_f32 v117, v117
  ds_read_b128 v[36:39], v8 offset:0
  v_exp_f32 v118, v118
  v_mfma_f32_32x32x16_bf16 v[196:211], v[64:67], v[80:83], v[196:211]
  v_cvt_pk_bf16_f32 v68, v116, v117
  v_exp_f32 v119, v119
  v_exp_f32 v120, v120
  v_cvt_pk_bf16_f32 v69, v118, v119
  v_exp_f32 v121, v121
  v_mfma_f32_16x16x32_bf16 v[228:231], v[16:19], v[80:83], v[228:231]
  ds_read_b128 v[40:43], v8 offset:1024
  v_exp_f32 v122, v122
  v_mfma_f32_32x32x16_bf16 v[148:163], v[48:51], v[24:27], v[148:163]
  v_cvt_pk_bf16_f32 v70, v120, v121
  v_exp_f32 v123, v123
  v_exp_f32 v124, v124
  v_cvt_pk_bf16_f32 v71, v122, v123
  v_exp_f32 v125, v125
  v_exp_f32 v126, v126
  v_mfma_f32_32x32x16_bf16 v[180:195], v[52:55], v[68:71], v[180:195]
  v_cvt_pk_bf16_f32 v72, v124, v125
  v_exp_f32 v127, v127
  s_add_u32 m0, s82, 0x0
  v_exp_f32 v128, v128
  v_cvt_pk_bf16_f32 v73, v126, v127
  v_mfma_f32_16x16x32_bf16 v[212:215], v[16:19], v[68:71], v[212:215]
  v_exp_f32 v129, v129
  v_mfma_f32_32x32x16_bf16 v[164:179], v[44:47], v[28:31], v[100:115]
  v_exp_f32 v130, v130
  v_cvt_pk_bf16_f32 v74, v128, v129
  v_exp_f32 v131, v131
  buffer_load_dwordx4 v4, s[8:11], s52 offen sc1 lds
  s_add_u32 s52, s52, 0x1000
  v_exp_f32 v132, v132
  v_cvt_pk_bf16_f32 v75, v130, v131
  v_exp_f32 v133, v133
  ds_read_b128 v[60:63], v9 offset:14336
  v_mfma_f32_32x32x16_bf16 v[180:195], v[56:59], v[72:75], v[180:195]
  v_exp_f32 v134, v134
  v_cvt_pk_bf16_f32 v76, v132, v133
  v_exp_f32 v135, v135
  v_exp_f32 v136, v136
  v_mfma_f32_16x16x32_bf16 v[212:215], v[16:19], v[72:75], v[212:215]
  v_cvt_pk_bf16_f32 v77, v134, v135
  v_exp_f32 v137, v137
  v_mfma_f32_32x32x16_bf16 v[164:179], v[48:51], v[32:35], v[164:179]
  ds_read_b128 v[64:67], v9 offset:15360
  v_exp_f32 v138, v138
  v_cvt_pk_bf16_f32 v78, v136, v137
  v_exp_f32 v139, v139
  v_exp_f32 v140, v140
  v_cvt_pk_bf16_f32 v79, v138, v139
  v_exp_f32 v141, v141
  v_add_u32 v9, 0x4000, v9
  v_mfma_f32_32x32x16_bf16 v[196:211], v[52:55], v[76:79], v[196:211]
  v_exp_f32 v142, v142
  v_cvt_pk_bf16_f32 v80, v140, v141
  v_exp_f32 v143, v143
  v_exp_f32 v144, v144
  v_mfma_f32_16x16x32_bf16 v[228:231], v[16:19], v[76:79], v[228:231]
  v_cvt_pk_bf16_f32 v81, v142, v143
  v_exp_f32 v145, v145
  v_and_or_b32 v9, v9, s39, v12
  v_exp_f32 v146, v146
  v_cvt_pk_bf16_f32 v82, v144, v145
  v_exp_f32 v147, v147
  s_waitcnt lgkmcnt(0)
  v_mfma_f32_32x32x16_bf16 v[116:131], v[36:39], v[20:23], v[84:99]
  v_exp_f32 v148, v148
  v_cvt_pk_bf16_f32 v83, v146, v147
  v_exp_f32 v149, v149
  ds_read_b128 v[44:47], v8 offset:2048
  v_exp_f32 v150, v150
  v_mfma_f32_32x32x16_bf16 v[196:211], v[56:59], v[80:83], v[196:211]
  v_cvt_pk_bf16_f32 v68, v148, v149
  v_exp_f32 v151, v151
  v_exp_f32 v152, v152
  v_cvt_pk_bf16_f32 v69, v150, v151
  v_exp_f32 v153, v153
  v_mfma_f32_16x16x32_bf16 v[228:231], v[16:19], v[80:83], v[228:231]
  ds_read_b128 v[48:51], v8 offset:3072
  v_exp_f32 v154, v154
  v_mfma_f32_32x32x16_bf16 v[116:131], v[40:43], v[24:27], v[116:131]
  v_cvt_pk_bf16_f32 v70, v152, v153
  v_exp_f32 v155, v155
  v_exp_f32 v156, v156
  v_cvt_pk_bf16_f32 v71, v154, v155
  v_exp_f32 v157, v157
  v_exp_f32 v158, v158
  v_mfma_f32_32x32x16_bf16 v[180:195], v[60:63], v[68:71], v[180:195]
  v_cvt_pk_bf16_f32 v72, v156, v157
  v_exp_f32 v159, v159
  s_add_u32 m0, s82, 0x10000
  v_exp_f32 v160, v160
  v_cvt_pk_bf16_f32 v73, v158, v159
  v_mfma_f32_16x16x32_bf16 v[212:215], v[16:19], v[68:71], v[212:215]
  v_exp_f32 v161, v161
  v_mfma_f32_32x32x16_bf16 v[132:147], v[36:39], v[28:31], v[100:115]
  v_exp_f32 v162, v162
  v_cvt_pk_bf16_f32 v74, v160, v161
  v_exp_f32 v163, v163
  buffer_load_dwordx4 v4, s[8:11], s53 offen sc1 lds
  s_add_u32 s53, s53, 0x1000
  s_add_u32 s82, s82, 0x1000
  s_and_b32 s82, s82, 0xffff
  v_exp_f32 v164, v164
  v_cvt_pk_bf16_f32 v75, v162, v163
  v_exp_f32 v165, v165
  ds_read_b128 v[52:55], v9 offset:0
  v_mfma_f32_32x32x16_bf16 v[180:195], v[64:67], v[72:75], v[180:195]
  v_exp_f32 v166, v166
  v_cvt_pk_bf16_f32 v76, v164, v165
  v_exp_f32 v167, v167
  v_exp_f32 v168, v168
  v_mfma_f32_16x16x32_bf16 v[212:215], v[16:19], v[72:75], v[212:215]
  v_cvt_pk_bf16_f32 v77, v166, v167
  v_exp_f32 v169, v169
  v_mfma_f32_32x32x16_bf16 v[132:147], v[40:43], v[32:35], v[132:147]
  ds_read_b128 v[56:59], v9 offset:1024
  v_exp_f32 v170, v170
  v_cvt_pk_bf16_f32 v78, v168, v169
  v_exp_f32 v171, v171
  v_exp_f32 v172, v172
  v_cvt_pk_bf16_f32 v79, v170, v171
  v_exp_f32 v173, v173
  v_exp_f32 v174, v174
  v_mfma_f32_32x32x16_bf16 v[196:211], v[60:63], v[76:79], v[196:211]
  v_cvt_pk_bf16_f32 v80, v172, v173
  v_exp_f32 v175, v175
  v_exp_f32 v176, v176
  v_cvt_pk_bf16_f32 v81, v174, v175
  v_mfma_f32_16x16x32_bf16 v[228:231], v[16:19], v[76:79], v[228:231]
  v_exp_f32 v177, v177
  v_exp_f32 v178, v178
  v_cvt_pk_bf16_f32 v82, v176, v177
  v_exp_f32 v179, v179
  s_add_u32 s55, s55, 1
  s_cmp_lg_u32 s55, 8
  s_cbranch_scc1 bl_228
  v_cvt_pk_bf16_f32 v83, v178, v179
  s_nop 1
  v_mfma_f32_32x32x16_bf16 v[196:211], v[64:67], v[80:83], v[196:211]
  v_mfma_f32_16x16x32_bf16 v[228:231], v[16:19], v[80:83], v[228:231]
  s_nop 1
  s_branch ba_226
bl_229:
  s_and_b32 s36, s55, 3
  s_cmp_eq_u32 s36, 3
  s_cbranch_scc1 bs_232
bs_231:
  s_waitcnt lgkmcnt(0)
  v_mfma_f32_32x32x16_bf16 v[148:163], v[44:47], v[20:23], v[84:99]
  v_exp_f32 v116, v116
  v_exp_f32 v117, v117
  ds_read_b128 v[36:39], v8 offset:0
  v_exp_f32 v118, v118
  v_cvt_pk_bf16_f32 v68, v116, v117
  v_exp_f32 v119, v119
  v_mfma_f32_32x32x16_bf16 v[148:163], v[48:51], v[24:27], v[148:163]
  v_exp_f32 v120, v120
  v_cvt_pk_bf16_f32 v69, v118, v119
  v_exp_f32 v121, v121
  ds_read_b128 v[40:43], v8 offset:1024
  v_exp_f32 v122, v122
  v_cvt_pk_bf16_f32 v70, v120, v121
  v_exp_f32 v123, v123
  v_mfma_f32_32x32x16_bf16 v[164:179], v[44:47], v[28:31], v[100:115]
  v_exp_f32 v124, v124
  v_cvt_pk_bf16_f32 v71, v122, v123
  v_exp_f32 v125, v125
  v_add_u32 v8, 0x800, v8
  v_exp_f32 v126, v126
  v_mfma_f32_32x32x16_bf16 v[180:195], v[52:55], v[68:71], v[180:195]
  v_cvt_pk_bf16_f32 v72, v124, v125
  v_exp_f32 v127, v127
  s_add_u32 m0, s82, 0x0
  v_mfma_f32_32x32x16_bf16 v[164:179], v[48:51], v[32:35], v[164:179]
  v_exp_f32 v128, v128
  v_cvt_pk_bf16_f32 v73, v126, v127
  v_exp_f32 v129, v129
  v_and_b32 v8, 0xffff, v8
  v_exp_f32 v130, v130
  v_mfma_f32_16x16x32_bf16 v[212:215], v[16:19], v[68:71], v[212:215]
  v_cvt_pk_bf16_f32 v74, v128, v129
  v_exp_f32 v131, v131
  buffer_load_dwordx4 v4, s[8:11], s52 offen sc1 lds
  s_add_u32 s52, s52, 0x1000
  v_max_f32 v10, v148, v149
  v_max3_f32 v10, v10, v150, v151
  v_max3_f32 v10, v10, v152, v153
  v_exp_f32 v132, v132
  v_cvt_pk_bf16_f32 v75, v130, v131
  v_exp_f32 v133, v133
  ds_read_b128 v[60:63], v9 offset:0
  v_exp_f32 v134, v134
  v_mfma_f32_32x32x16_bf16 v[180:195], v[56:59], v[72:75], v[180:195]
  v_cvt_pk_bf16_f32 v76, v132, v133
  v_exp_f32 v135, v135
  v_max3_f32 v10, v10, v154, v155
  v_max3_f32 v10, v10, v156, v157
  v_exp_f32 v136, v136
  v_cvt_pk_bf16_f32 v77, v134, v135
  v_exp_f32 v137, v137
  ds_read_b128 v[64:67], v9 offset:1024
  v_exp_f32 v138, v138
  v_mfma_f32_16x16x32_bf16 v[212:215], v[16:19], v[72:75], v[212:215]
  v_cvt_pk_bf16_f32 v78, v136, v137
  v_exp_f32 v139, v139
  v_max3_f32 v10, v10, v158, v159
  v_max3_f32 v10, v10, v160, v161
  v_max3_f32 v10, v10, v162, v163
  v_exp_f32 v140, v140
  v_cvt_pk_bf16_f32 v79, v138, v139
  v_exp_f32 v141, v141
  v_add_u32 v9, 0x800, v9
  v_exp_f32 v142, v142
  v_mfma_f32_32x32x16_bf16 v[196:211], v[52:55], v[76:79], v[196:211]
  v_cvt_pk_bf16_f32 v80, v140, v141
  v_exp_f32 v143, v143
  v_max3_f32 v10, v10, v164, v165
  v_max3_f32 v10, v10, v166, v167
  v_max3_f32 v10, v10, v168, v169
  v_exp_f32 v144, v144
  v_cvt_pk_bf16_f32 v81, v142, v143
  v_exp_f32 v145, v145
  v_and_or_b32 v9, v9, s39, v12
  v_exp_f32 v146, v146
  v_mfma_f32_16x16x32_bf16 v[228:231], v[16:19], v[76:79], v[228:231]
  v_cvt_pk_bf16_f32 v82, v144, v145
  v_exp_f32 v147, v147
  v_max3_f32 v10, v10, v170, v171
  v_max3_f32 v10, v10, v172, v173
  v_max3_f32 v10, v10, v174, v175
  v_cvt_pk_bf16_f32 v83, v146, v147
  v_max3_f32 v10, v10, v176, v177
  v_max3_f32 v10, v10, v178, v179
  v_cmp_lt_f32 vcc, s57, v10
  v_mfma_f32_32x32x16_bf16 v[196:211], v[56:59], v[80:83], v[196:211]
  v_mfma_f32_16x16x32_bf16 v[228:231], v[16:19], v[80:83], v[228:231]
  s_cbranch_vccnz ba_225
bl_230:
  s_waitcnt lgkmcnt(0)
  v_mfma_f32_32x32x16_bf16 v[116:131], v[36:39], v[20:23], v[84:99]
  v_exp_f32 v148, v148
  v_exp_f32 v149, v149
  ds_read_b128 v[44:47], v8 offset:0
  v_exp_f32 v150, v150
  v_cvt_pk_bf16_f32 v68, v148, v149
  v_exp_f32 v151, v151
  v_mfma_f32_32x32x16_bf16 v[116:131], v[40:43], v[24:27], v[116:131]
  v_exp_f32 v152, v152
  v_cvt_pk_bf16_f32 v69, v150, v151
  v_exp_f32 v153, v153
  ds_read_b128 v[48:51], v8 offset:1024
  v_exp_f32 v154, v154
  v_cvt_pk_bf16_f32 v70, v152, v153
  v_exp_f32 v155, v155
  v_mfma_f32_32x32x16_bf16 v[132:147], v[36:39], v[28:31], v[100:115]
  v_exp_f32 v156, v156
  v_cvt_pk_bf16_f32 v71, v154, v155
  v_exp_f32 v157, v157
  v_add_u32 v8, 0x800, v8
  v_exp_f32 v158, v158
  v_mfma_f32_32x32x16_bf16 v[180:195], v[60:63], v[68:71], v[180:195]
  v_cvt_pk_bf16_f32 v72, v156, v157
  v_exp_f32 v159, v159
  s_add_u32 m0, s82, 0x10000
  v_mfma_f32_32x32x16_bf16 v[132:147], v[40:43], v[32:35], v[132:147]
  v_exp_f32 v160, v160
  v_cvt_pk_bf16_f32 v73, v158, v159
  v_exp_f32 v161, v161
  v_and_b32 v8, 0xffff, v8
  v_exp_f32 v162, v162
  v_mfma_f32_16x16x32_bf16 v[212:215], v[16:19], v[68:71], v[212:215]
  v_cvt_pk_bf16_f32 v74, v160, v161
  v_exp_f32 v163, v163
  buffer_load_dwordx4 v4, s[8:11], s53 offen sc1 lds
  s_add_u32 s53, s53, 0x1000
  s_add_u32 s82, s82, 0x1000
  s_and_b32 s82, s82, 0xffff
  v_max_f32 v10, v116, v117
  v_max3_f32 v10, v10, v118, v119
  v_max3_f32 v10, v10, v120, v121
  v_exp_f32 v164, v164
  v_cvt_pk_bf16_f32 v75, v162, v163
  v_exp_f32 v165, v165
  ds_read_b128 v[52:55], v9 offset:0
  v_exp_f32 v166, v166
  v_mfma_f32_32x32x16_bf16 v[180:195], v[64:67], v[72:75], v[180:195]
  v_cvt_pk_bf16_f32 v76, v164, v165
  v_exp_f32 v167, v167
  v_max3_f32 v10, v10, v122, v123
  v_max3_f32 v10, v10, v124, v125
  v_exp_f32 v168, v168
  v_cvt_pk_bf16_f32 v77, v166, v167
  v_exp_f32 v169, v169
  ds_read_b128 v[56:59], v9 offset:1024
  v_exp_f32 v170, v170
  v_mfma_f32_16x16x32_bf16 v[212:215], v[16:19], v[72:75], v[212:215]
  v_cvt_pk_bf16_f32 v78, v168, v169
  v_exp_f32 v171, v171
  v_max3_f32 v10, v10, v126, v127
  v_max3_f32 v10, v10, v128, v129
  v_max3_f32 v10, v10, v130, v131
  v_exp_f32 v172, v172
  v_cvt_pk_bf16_f32 v79, v170, v171
  v_exp_f32 v173, v173
  v_add_u32 v9, 0x800, v9
  v_exp_f32 v174, v174
  v_mfma_f32_32x32x16_bf16 v[196:211], v[60:63], v[76:79], v[196:211]
  v_cvt_pk_bf16_f32 v80, v172, v173
  v_exp_f32 v175, v175
  v_max3_f32 v10, v10, v132, v133
  v_max3_f32 v10, v10, v134, v135
  v_max3_f32 v10, v10, v136, v137
  v_exp_f32 v176, v176
  v_cvt_pk_bf16_f32 v81, v174, v175
  v_exp_f32 v177, v177
  v_and_or_b32 v9, v9, s39, v12
  v_exp_f32 v178, v178
  v_mfma_f32_16x16x32_bf16 v[228:231], v[16:19], v[76:79], v[228:231]
  v_cvt_pk_bf16_f32 v82, v176, v177
  v_exp_f32 v179, v179
  v_max3_f32 v10, v10, v138, v139
  v_max3_f32 v10, v10, v140, v141
  v_max3_f32 v10, v10, v142, v143
  s_add_u32 s55, s55, 1
  v_cvt_pk_bf16_f32 v83, v178, v179
  v_max3_f32 v10, v10, v144, v145
  v_max3_f32 v10, v10, v146, v147
  v_cmp_lt_f32 vcc, s57, v10
  s_cmp_eq_u32 s55, 32
  v_mfma_f32_32x32x16_bf16 v[196:211], v[64:67], v[80:83], v[196:211]
  v_mfma_f32_16x16x32_bf16 v[228:231], v[16:19], v[80:83], v[228:231]
  s_nop 1
  s_cbranch_scc1 ba_226
  s_cbranch_vccz bl_229
  s_branch ba_224
ba_224:
  v_max3_f32 v11, v116, v117, v118
  v_max3_f32 v11, v11, v119, v120
  v_max3_f32 v11, v11, v121, v122
  v_max3_f32 v11, v11, v123, v124
  v_max3_f32 v11, v11, v125, v126
  v_max3_f32 v11, v11, v127, v128
  v_max3_f32 v11, v11, v129, v130
  v_max_f32 v11, v11, v131
  v_mov_b32 v10, v11
  s_nop 1
  v_permlane32_swap_b32 v11, v10
  v_max_f32 v11, v11, v10
  v_max_f32 v14, s56, v11
  v_max_f32 v11, 0, v11
  v_exp_f32 v15, -v11
  v_sub_f32 v116, v116, v14
  v_sub_f32 v117, v117, v14
  v_sub_f32 v118, v118, v14
  v_sub_f32 v119, v119, v14
  v_sub_f32 v120, v120, v14
  v_sub_f32 v121, v121, v14
  v_sub_f32 v122, v122, v14
  v_sub_f32 v123, v123, v14
  v_sub_f32 v124, v124, v14
  v_sub_f32 v125, v125, v14
  v_sub_f32 v126, v126, v14
  v_sub_f32 v127, v127, v14
  v_sub_f32 v128, v128, v14
  v_sub_f32 v129, v129, v14
  v_sub_f32 v130, v130, v14
  v_sub_f32 v131, v131, v14
  v_sub_f32 v84, v84, v14
  v_sub_f32 v85, v85, v14
  v_sub_f32 v86, v86, v14
  v_sub_f32 v87, v87, v14
  v_sub_f32 v88, v88, v14
  v_sub_f32 v89, v89, v14
  v_sub_f32 v90, v90, v14
  v_sub_f32 v91, v91, v14
  v_sub_f32 v92, v92, v14
  v_sub_f32 v93, v93, v14
  v_sub_f32 v94, v94, v14
  v_sub_f32 v95, v95, v14
  v_sub_f32 v96, v96, v14
  v_sub_f32 v97, v97, v14
  v_sub_f32 v98, v98, v14
  v_sub_f32 v99, v99, v14
  v_mul_f32 v180, v180, v15
  v_mul_f32 v181, v181, v15
  v_mul_f32 v182, v182, v15
  v_mul_f32 v183, v183, v15
  v_mul_f32 v184, v184, v15
  v_mul_f32 v185, v185, v15
  v_mul_f32 v186, v186, v15
  v_mul_f32 v187, v187, v15
  v_mul_f32 v188, v188, v15
  v_mul_f32 v189, v189, v15
  v_mul_f32 v190, v190, v15
  v_mul_f32 v191, v191, v15
  v_mul_f32 v192, v192, v15
  v_mul_f32 v193, v193, v15
  v_mul_f32 v194, v194, v15
  v_mul_f32 v195, v195, v15
  v_mul_f32 v212, v212, v15
  v_max3_f32 v11, v132, v133, v134
  v_max3_f32 v11, v11, v135, v136
  v_max3_f32 v11, v11, v137, v138
  v_max3_f32 v11, v11, v139, v140
  v_max3_f32 v11, v11, v141, v142
  v_max3_f32 v11, v11, v143, v144
  v_max3_f32 v11, v11, v145, v146
  v_max_f32 v11, v11, v147
  v_mov_b32 v10, v11
  s_nop 1
  v_permlane32_swap_b32 v11, v10
  v_max_f32 v11, v11, v10
  v_max_f32 v14, s56, v11
  v_max_f32 v11, 0, v11
  v_exp_f32 v15, -v11
  v_sub_f32 v132, v132, v14
  v_sub_f32 v133, v133, v14
  v_sub_f32 v134, v134, v14
  v_sub_f32 v135, v135, v14
  v_sub_f32 v136, v136, v14
  v_sub_f32 v137, v137, v14
  v_sub_f32 v138, v138, v14
  v_sub_f32 v139, v139, v14
  v_sub_f32 v140, v140, v14
  v_sub_f32 v141, v141, v14
  v_sub_f32 v142, v142, v14
  v_sub_f32 v143, v143, v14
  v_sub_f32 v144, v144, v14
  v_sub_f32 v145, v145, v14
  v_sub_f32 v146, v146, v14
  v_sub_f32 v147, v147, v14
  v_sub_f32 v100, v100, v14
  v_sub_f32 v101, v101, v14
  v_sub_f32 v102, v102, v14
  v_sub_f32 v103, v103, v14
  v_sub_f32 v104, v104, v14
  v_sub_f32 v105, v105, v14
  v_sub_f32 v106, v106, v14
  v_sub_f32 v107, v107, v14
  v_sub_f32 v108, v108, v14
  v_sub_f32 v109, v109, v14
  v_sub_f32 v110, v110, v14
  v_sub_f32 v111, v111, v14
  v_sub_f32 v112, v112, v14
  v_sub_f32 v113, v113, v14
  v_sub_f32 v114, v114, v14
  v_sub_f32 v115, v115, v14
  v_mul_f32 v196, v196, v15
  v_mul_f32 v197, v197, v15
  v_mul_f32 v198, v198, v15
  v_mul_f32 v199, v199, v15
  v_mul_f32 v200, v200, v15
  v_mul_f32 v201, v201, v15
  v_mul_f32 v202, v202, v15
  v_mul_f32 v203, v203, v15
  v_mul_f32 v204, v204, v15
  v_mul_f32 v205, v205, v15
  v_mul_f32 v206, v206, v15
  v_mul_f32 v207, v207, v15
  v_mul_f32 v208, v208, v15
  v_mul_f32 v209, v209, v15
  v_mul_f32 v210, v210, v15
  v_mul_f32 v211, v211, v15
  v_mul_f32 v228, v228, v15
  s_mov_b32 s56, 0
  s_cmp_eq_u32 s54, 0
  s_cbranch_scc1 bl_227
  s_branch bl_229
ba_225:
  v_max3_f32 v11, v148, v149, v150
  v_max3_f32 v11, v11, v151, v152
  v_max3_f32 v11, v11, v153, v154
  v_max3_f32 v11, v11, v155, v156
  v_max3_f32 v11, v11, v157, v158
  v_max3_f32 v11, v11, v159, v160
  v_max3_f32 v11, v11, v161, v162
  v_max_f32 v11, v11, v163
  v_mov_b32 v10, v11
  s_nop 1
  v_permlane32_swap_b32 v11, v10
  v_max_f32 v11, v11, v10
  v_max_f32 v14, s56, v11
  v_max_f32 v11, 0, v11
  v_exp_f32 v15, -v11
  v_sub_f32 v148, v148, v14
  v_sub_f32 v149, v149, v14
  v_sub_f32 v150, v150, v14
  v_sub_f32 v151, v151, v14
  v_sub_f32 v152, v152, v14
  v_sub_f32 v153, v153, v14
  v_sub_f32 v154, v154, v14
  v_sub_f32 v155, v155, v14
  v_sub_f32 v156, v156, v14
  v_sub_f32 v157, v157, v14
  v_sub_f32 v158, v158, v14
  v_sub_f32 v159, v159, v14
  v_sub_f32 v160, v160, v14
  v_sub_f32 v161, v161, v14
  v_sub_f32 v162, v162, v14
  v_sub_f32 v163, v163, v14
  v_sub_f32 v84, v84, v14
  v_sub_f32 v85, v85, v14
  v_sub_f32 v86, v86, v14
  v_sub_f32 v87, v87, v14
  v_sub_f32 v88, v88, v14
  v_sub_f32 v89, v89, v14
  v_sub_f32 v90, v90, v14
  v_sub_f32 v91, v91, v14
  v_sub_f32 v92, v92, v14
  v_sub_f32 v93, v93, v14
  v_sub_f32 v94, v94, v14
  v_sub_f32 v95, v95, v14
  v_sub_f32 v96, v96, v14
  v_sub_f32 v97, v97, v14
  v_sub_f32 v98, v98, v14
  v_sub_f32 v99, v99, v14
  v_mul_f32 v180, v180, v15
  v_mul_f32 v181, v181, v15
  v_mul_f32 v182, v182, v15
  v_mul_f32 v183, v183, v15
  v_mul_f32 v184, v184, v15
  v_mul_f32 v185, v185, v15
  v_mul_f32 v186, v186, v15
  v_mul_f32 v187, v187, v15
  v_mul_f32 v188, v188, v15
  v_mul_f32 v189, v189, v15
  v_mul_f32 v190, v190, v15
  v_mul_f32 v191, v191, v15
  v_mul_f32 v192, v192, v15
  v_mul_f32 v193, v193, v15
  v_mul_f32 v194, v194, v15
  v_mul_f32 v195, v195, v15
  v_mul_f32 v212, v212, v15
  v_max3_f32 v11, v164, v165, v166
  v_max3_f32 v11, v11, v167, v168
  v_max3_f32 v11, v11, v169, v170
  v_max3_f32 v11, v11, v171, v172
  v_max3_f32 v11, v11, v173, v174
  v_max3_f32 v11, v11, v175, v176
  v_max3_f32 v11, v11, v177, v178
  v_max_f32 v11, v11, v179
  v_mov_b32 v10, v11
  s_nop 1
  v_permlane32_swap_b32 v11, v10
  v_max_f32 v11, v11, v10
  v_max_f32 v14, s56, v11
  v_max_f32 v11, 0, v11
  v_exp_f32 v15, -v11
  v_sub_f32 v164, v164, v14
  v_sub_f32 v165, v165, v14
  v_sub_f32 v166, v166, v14
  v_sub_f32 v167, v167, v14
  v_sub_f32 v168, v168, v14
  v_sub_f32 v169, v169, v14
  v_sub_f32 v170, v170, v14
  v_sub_f32 v171, v171, v14
  v_sub_f32 v172, v172, v14
  v_sub_f32 v173, v173, v14
  v_sub_f32 v174, v174, v14
  v_sub_f32 v175, v175, v14
  v_sub_f32 v176, v176, v14
  v_sub_f32 v177, v177, v14
  v_sub_f32 v178, v178, v14
  v_sub_f32 v179, v179, v14
  v_sub_f32 v100, v100, v14
  v_sub_f32 v101, v101, v14
  v_sub_f32 v102, v102, v14
  v_sub_f32 v103, v103, v14
  v_sub_f32 v104, v104, v14
  v_sub_f32 v105, v105, v14
  v_sub_f32 v106, v106, v14
  v_sub_f32 v107, v107, v14
  v_sub_f32 v108, v108, v14
  v_sub_f32 v109, v109, v14
  v_sub_f32 v110, v110, v14
  v_sub_f32 v111, v111, v14
  v_sub_f32 v112, v112, v14
  v_sub_f32 v113, v113, v14
  v_sub_f32 v114, v114, v14
  v_sub_f32 v115, v115, v14
  v_mul_f32 v196, v196, v15
  v_mul_f32 v197, v197, v15
  v_mul_f32 v198, v198, v15
  v_mul_f32 v199, v199, v15
  v_mul_f32 v200, v200, v15
  v_mul_f32 v201, v201, v15
  v_mul_f32 v202, v202, v15
  v_mul_f32 v203, v203, v15
  v_mul_f32 v204, v204, v15
  v_mul_f32 v205, v205, v15
  v_mul_f32 v206, v206, v15
  v_mul_f32 v207, v207, v15
  v_mul_f32 v208, v208, v15
  v_mul_f32 v209, v209, v15
  v_mul_f32 v210, v210, v15
  v_mul_f32 v211, v211, v15
  v_mul_f32 v228, v228, v15
  s_mov_b32 s56, 0
  s_branch bl_230
sg_147:
  s_lshl_b32 s38, s49, 7
  s_mov_b32 s49, 255
  s_cmp_lg_u32 s28, 0
  s_cbranch_scc1 sb_148
  s_cmp_eq_u32 s47, 1
  s_cbranch_scc1 ic_233
  v_mov_b32 v252, 0
sb_234:
  s_sub_u32 s48, s48, 1
  s_cbranch_scc1 L_fail
  buffer_load_dwordx4 v[248:251], v252, s[12:15], 0 offen sc1
  s_waitcnt vmcnt(0)
  v_readfirstlane_b32 s37, v248
  s_nop 3
  s_cmp_ge_u32 s37, 96
  s_cbranch_scc1 sb_235
  s_sleep 8
  s_branch sb_234
sb_235:
  s_mov_b32 s47, 1
ic_233:
  s_add_u32 s38, s38, 0x4c00000
  v_mov_b32 v3, 1
  s_mov_b64 exec, 1
  buffer_atomic_add v3, v6, s[8:11], s38 offen sc1
  s_mov_b64 exec, -1
  s_branch sb_148
sg_152:
  s_lshl_b32 s38, s49, 7
  s_mov_b32 s49, 255
  s_cmp_lg_u32 s28, 0
  s_cbranch_scc1 sb_153
  s_cmp_eq_u32 s47, 1
  s_cbranch_scc1 ic_236
  v_mov_b32 v252, 0
sb_237:
  s_sub_u32 s48, s48, 1
  s_cbranch_scc1 L_fail
  buffer_load_dwordx4 v[248:251], v252, s[12:15], 0 offen sc1
  s_waitcnt vmcnt(0)
  v_readfirstlane_b32 s37, v248
  s_nop 3
  s_cmp_ge_u32 s37, 96
  s_cbranch_scc1 sb_238
  s_sleep 8
  s_branch sb_237
sb_238:
  s_mov_b32 s47, 1
ic_236:
  s_add_u32 s38, s38, 0x4c00000
  v_mov_b32 v3, 1
  s_mov_b64 exec, 1
  buffer_atomic_add v3, v6, s[8:11], s38 offen sc1
  s_mov_b64 exec, -1
  s_branch sb_153
sg_157:
  s_lshl_b32 s38, s49, 7
  s_mov_b32 s49, 255
  s_cmp_lg_u32 s28, 0
  s_cbranch_scc1 sb_158
  s_cmp_eq_u32 s47, 1
  s_cbranch_scc1 ic_239
  v_mov_b32 v252, 0
sb_240:
  s_sub_u32 s48, s48, 1
  s_cbranch_scc1 L_fail
  buffer_load_dwordx4 v[248:251], v252, s[12:15], 0 offen sc1
  s_waitcnt vmcnt(0)
  v_readfirstlane_b32 s37, v248
  s_nop 3
  s_cmp_ge_u32 s37, 96
  s_cbranch_scc1 sb_241
  s_sleep 8
  s_branch sb_240
sb_241:
  s_mov_b32 s47, 1
ic_239:
  s_add_u32 s38, s38, 0x4c00000
  v_mov_b32 v3, 1
  s_mov_b64 exec, 1
  buffer_atomic_add v3, v6, s[8:11], s38 offen sc1
  s_mov_b64 exec, -1
  s_branch sb_158
sg_161:
  s_lshl_b32 s38, s49, 7
  s_mov_b32 s49, 255
  s_cmp_lg_u32 s28, 0
  s_cbranch_scc1 sb_162
  s_cmp_eq_u32 s47, 1
  s_cbranch_scc1 ic_242
  v_mov_b32 v252, 0
sb_243:
  s_sub_u32 s48, s48, 1
  s_cbranch_scc1 L_fail
  buffer_load_dwordx4 v[248:251], v252, s[12:15], 0 offen sc1
  s_waitcnt vmcnt(0)
  v_readfirstlane_b32 s37, v248
  s_nop 3
  s_cmp_ge_u32 s37, 96
  s_cbranch_scc1 sb_244
  s_sleep 8
  s_branch sb_243
sb_244:
  s_mov_b32 s47, 1
ic_242:
  s_add_u32 s38, s38, 0x4c00000
  v_mov_b32 v3, 1
  s_mov_b64 exec, 1
  buffer_atomic_add v3, v6, s[8:11], s38 offen sc1
  s_mov_b64 exec, -1
  s_branch sb_162
tk_164:
  s_mov_b32 s29, 1
  s_cmp_lg_u32 s28, 0
  s_cbranch_scc1 tb_163
  v_mov_b32 v7, 1
  s_lshl_b32 s38, s58, 2
  s_mov_b64 exec, 1
  buffer_atomic_add v7, v6, s[12:15], s38 offen offset:128 sc0 sc1
  s_mov_b64 exec, -1
  s_branch tb_163
sg_167:
  s_lshl_b32 s38, s49, 7
  s_mov_b32 s49, 255
  s_cmp_lg_u32 s28, 0
  s_cbranch_scc1 sb_168
  s_cmp_eq_u32 s47, 1
  s_cbranch_scc1 ic_245
  v_mov_b32 v252, 0
sb_246:
  s_sub_u32 s48, s48, 1
  s_cbranch_scc1 L_fail
  buffer_load_dwordx4 v[248:251], v252, s[12:15], 0 offen sc1
  s_waitcnt vmcnt(0)
  v_readfirstlane_b32 s37, v248
  s_nop 3
  s_cmp_ge_u32 s37, 96
  s_cbranch_scc1 sb_247
  s_sleep 8
  s_branch sb_246
sb_247:
  s_mov_b32 s47, 1
ic_245:
  s_add_u32 s38, s38, 0x4c00000
  v_mov_b32 v3, 1
  s_mov_b64 exec, 1
  buffer_atomic_add v3, v6, s[8:11], s38 offen sc1
  s_mov_b64 exec, -1
  s_branch sb_168
tk_170:
  s_mov_b32 s29, 1
  s_cmp_lg_u32 s28, 0
  s_cbranch_scc1 tb_169
  v_mov_b32 v7, 1
  s_lshl_b32 s38, s58, 2
  s_mov_b64 exec, 1
  buffer_atomic_add v7, v6, s[12:15], s38 offen offset:128 sc0 sc1
  s_mov_b64 exec, -1
  s_branch tb_169
sg_173:
  s_lshl_b32 s38, s49, 7
  s_mov_b32 s49, 255
  s_cmp_lg_u32 s28, 0
  s_cbranch_scc1 sb_174
  s_cmp_eq_u32 s47, 1
  s_cbranch_scc1 ic_248
  v_mov_b32 v252, 0
sb_249:
  s_sub_u32 s48, s48, 1
  s_cbranch_scc1 L_fail
  buffer_load_dwordx4 v[248:251], v252, s[12:15], 0 offen sc1
  s_waitcnt vmcnt(0)
  v_readfirstlane_b32 s37, v248
  s_nop 3
  s_cmp_ge_u32 s37, 96
  s_cbranch_scc1 sb_250
  s_sleep 8
  s_branch sb_249
sb_250:
  s_mov_b32 s47, 1
ic_248:
  s_add_u32 s38, s38, 0x4c00000
  v_mov_b32 v3, 1
  s_mov_b64 exec, 1
  buffer_atomic_add v3, v6, s[8:11], s38 offen sc1
  s_mov_b64 exec, -1
  s_branch sb_174
sg_177:
  s_lshl_b32 s38, s49, 7
  s_mov_b32 s49, 255
  s_cmp_lg_u32 s28, 0
  s_cbranch_scc1 sb_178
  s_cmp_eq_u32 s47, 1
  s_cbranch_scc1 ic_251
  v_mov_b32 v252, 0
sb_252:
  s_sub_u32 s48, s48, 1
  s_cbranch_scc1 L_fail
  buffer_load_dwordx4 v[248:251], v252, s[12:15], 0 offen sc1
  s_waitcnt vmcnt(0)
  v_readfirstlane_b32 s37, v248
  s_nop 3
  s_cmp_ge_u32 s37, 96
  s_cbranch_scc1 sb_253
  s_sleep 8
  s_branch sb_252
sb_253:
  s_mov_b32 s47, 1
ic_251:
  s_add_u32 s38, s38, 0x4c00000
  v_mov_b32 v3, 1
  s_mov_b64 exec, 1
  buffer_atomic_add v3, v6, s[8:11], s38 offen sc1
  s_mov_b64 exec, -1
  s_branch sb_178
tk_180:
  s_mov_b32 s29, 1
  s_cmp_lg_u32 s28, 0
  s_cbranch_scc1 tb_179
  v_mov_b32 v7, 1
  s_lshl_b32 s38, s58, 2
  s_mov_b64 exec, 1
  buffer_atomic_add v7, v6, s[12:15], s38 offen offset:128 sc0 sc1
  s_mov_b64 exec, -1
  s_branch tb_179
sg_183:
  s_lshl_b32 s38, s49, 7
  s_mov_b32 s49, 255
  s_cmp_lg_u32 s28, 0
  s_cbranch_scc1 sb_184
  s_cmp_eq_u32 s47, 1
  s_cbranch_scc1 ic_254
  v_mov_b32 v252, 0
sb_255:
  s_sub_u32 s48, s48, 1
  s_cbranch_scc1 L_fail
  buffer_load_dwordx4 v[248:251], v252, s[12:15], 0 offen sc1
  s_waitcnt vmcnt(0)
  v_readfirstlane_b32 s37, v248
  s_nop 3
  s_cmp_ge_u32 s37, 96
  s_cbranch_scc1 sb_256
  s_sleep 8
  s_branch sb_255
sb_256:
  s_mov_b32 s47, 1
ic_254:
  s_add_u32 s38, s38, 0x4c00000
  v_mov_b32 v3, 1
  s_mov_b64 exec, 1
  buffer_atomic_add v3, v6, s[8:11], s38 offen sc1
  s_mov_b64 exec, -1
  s_branch sb_184
tk_186:
  s_mov_b32 s29, 1
  s_cmp_lg_u32 s28, 0
  s_cbranch_scc1 tb_185
  v_mov_b32 v7, 1
  s_lshl_b32 s38, s58, 2
  s_mov_b64 exec, 1
  buffer_atomic_add v7, v6, s[12:15], s38 offen offset:128 sc0 sc1
  s_mov_b64 exec, -1
  s_branch tb_185
sg_187:
  s_lshl_b32 s38, s49, 7
  s_mov_b32 s49, 255
  s_cmp_lg_u32 s28, 0
  s_cbranch_scc1 sb_188
  s_cmp_eq_u32 s47, 1
  s_cbranch_scc1 ic_257
  v_mov_b32 v252, 0
sb_258:
  s_sub_u32 s48, s48, 1
  s_cbranch_scc1 L_fail
  buffer_load_dwordx4 v[248:251], v252, s[12:15], 0 offen sc1
  s_waitcnt vmcnt(0)
  v_readfirstlane_b32 s37, v248
  s_nop 3
  s_cmp_ge_u32 s37, 96
  s_cbranch_scc1 sb_259
  s_sleep 8
  s_branch sb_258
sb_259:
  s_mov_b32 s47, 1
ic_257:
  s_add_u32 s38, s38, 0x4c00000
  v_mov_b32 v3, 1
  s_mov_b64 exec, 1
  buffer_atomic_add v3, v6, s[8:11], s38 offen sc1
  s_mov_b64 exec, -1
  s_branch sb_188
sg_191:
  s_lshl_b32 s38, s49, 7
  s_mov_b32 s49, 255
  s_cmp_lg_u32 s28, 0
  s_cbranch_scc1 sb_192
  s_cmp_eq_u32 s47, 1
  s_cbranch_scc1 ic_260
  v_mov_b32 v252, 0
sb_261:
  s_sub_u32 s48, s48, 1
  s_cbranch_scc1 L_fail
  buffer_load_dwordx4 v[248:251], v252, s[12:15], 0 offen sc1
  s_waitcnt vmcnt(0)
  v_readfirstlane_b32 s37, v248
  s_nop 3
  s_cmp_ge_u32 s37, 96
  s_cbranch_scc1 sb_262
  s_sleep 8
  s_branch sb_261
sb_262:
  s_mov_b32 s47, 1
ic_260:
  s_add_u32 s38, s38, 0x4c00000
  v_mov_b32 v3, 1
  s_mov_b64 exec, 1
  buffer_atomic_add v3, v6, s[8:11], s38 offen sc1
  s_mov_b64 exec, -1
  s_branch sb_192
tk_194:
  s_mov_b32 s29, 1
  s_cmp_lg_u32 s28, 0
  s_cbranch_scc1 tb_193
  v_mov_b32 v7, 1
  s_lshl_b32 s38, s58, 2
  s_mov_b64 exec, 1
  buffer_atomic_add v7, v6, s[12:15], s38 offen offset:128 sc0 sc1
  s_mov_b64 exec, -1
  s_branch tb_193
sg_195:
  s_lshl_b32 s38, s49, 7
  s_mov_b32 s49, 255
  s_cmp_lg_u32 s28, 0
  s_cbranch_scc1 sb_196
  s_cmp_eq_u32 s47, 1
  s_cbranch_scc1 ic_263
  v_mov_b32 v252, 0
sb_264:
  s_sub_u32 s48, s48, 1
  s_cbranch_scc1 L_fail
  buffer_load_dwordx4 v[248:251], v252, s[12:15], 0 offen sc1
  s_waitcnt vmcnt(0)
  v_readfirstlane_b32 s37, v248
  s_nop 3
  s_cmp_ge_u32 s37, 96
  s_cbranch_scc1 sb_265
  s_sleep 8
  s_branch sb_264
sb_265:
  s_mov_b32 s47, 1
ic_263:
  s_add_u32 s38, s38, 0x4c00000
  v_mov_b32 v3, 1
  s_mov_b64 exec, 1
  buffer_atomic_add v3, v6, s[8:11], s38 offen sc1
  s_mov_b64 exec, -1
  s_branch sb_196
sg_199:
  s_lshl_b32 s38, s49, 7
  s_mov_b32 s49, 255
  s_cmp_lg_u32 s28, 0
  s_cbranch_scc1 sb_200
  s_cmp_eq_u32 s47, 1
  s_cbranch_scc1 ic_266
  v_mov_b32 v252, 0
sb_267:
  s_sub_u32 s48, s48, 1
  s_cbranch_scc1 L_fail
  buffer_load_dwordx4 v[248:251], v252, s[12:15], 0 offen sc1
  s_waitcnt vmcnt(0)
  v_readfirstlane_b32 s37, v248
  s_nop 3
  s_cmp_ge_u32 s37, 96
  s_cbranch_scc1 sb_268
  s_sleep 8
  s_branch sb_267
sb_268:
  s_mov_b32 s47, 1
ic_266:
  s_add_u32 s38, s38, 0x4c00000
  v_mov_b32 v3, 1
  s_mov_b64 exec, 1
  buffer_atomic_add v3, v6, s[8:11], s38 offen sc1
  s_mov_b64 exec, -1
  s_branch sb_200
tk_202:
  s_mov_b32 s29, 1
  s_cmp_lg_u32 s28, 0
  s_cbranch_scc1 tb_201
  v_mov_b32 v7, 1
  s_lshl_b32 s38, s58, 2
  s_mov_b64 exec, 1
  buffer_atomic_add v7, v6, s[12:15], s38 offen offset:128 sc0 sc1
  s_mov_b64 exec, -1
  s_branch tb_201
tk_204:
  s_mov_b32 s29, 1
  s_cmp_lg_u32 s28, 0
  s_cbranch_scc1 tb_203
  v_mov_b32 v7, 1
  s_lshl_b32 s38, s58, 2
  s_mov_b64 exec, 1
  buffer_atomic_add v7, v6, s[12:15], s38 offen offset:128 sc0 sc1
  s_mov_b64 exec, -1
  s_branch tb_203
tk_216:
  s_mov_b32 s29, 1
  s_cmp_lg_u32 s28, 0
  s_cbranch_scc1 tb_215
  v_mov_b32 v7, 1
  s_lshl_b32 s38, s58, 2
  s_mov_b64 exec, 1
  buffer_atomic_add v7, v6, s[12:15], s38 offen offset:128 sc0 sc1
  s_mov_b64 exec, -1
  s_branch tb_215
sg_217:
  s_lshl_b32 s38, s49, 7
  s_mov_b32 s49, 255
  s_cmp_lg_u32 s28, 0
  s_cbranch_scc1 sb_218
  s_cmp_eq_u32 s47, 1
  s_cbranch_scc1 ic_269
  v_mov_b32 v252, 0
sb_270:
  s_sub_u32 s48, s48, 1
  s_cbranch_scc1 L_fail
  buffer_load_dwordx4 v[248:251], v252, s[12:15], 0 offen sc1
  s_waitcnt vmcnt(0)
  v_readfirstlane_b32 s37, v248
  s_nop 3
  s_cmp_ge_u32 s37, 96
  s_cbranch_scc1 sb_271
  s_sleep 8
  s_branch sb_270
sb_271:
  s_mov_b32 s47, 1
ic_269:
  s_add_u32 s38, s38, 0x4c00000
  v_mov_b32 v3, 1
  s_mov_b64 exec, 1
  buffer_atomic_add v3, v6, s[8:11], s38 offen sc1
  s_mov_b64 exec, -1
  s_branch sb_218
tk_220:
  s_mov_b32 s29, 1
  s_cmp_lg_u32 s28, 0
  s_cbranch_scc1 tb_219
  v_mov_b32 v7, 1
  s_lshl_b32 s38, s58, 2
  s_mov_b64 exec, 1
  buffer_atomic_add v7, v6, s[12:15], s38 offen offset:128 sc0 sc1
  s_mov_b64 exec, -1
  s_branch tb_219
sg_222:
  s_lshl_b32 s38, s49, 7
  s_mov_b32 s49, 255
  s_cmp_lg_u32 s28, 0
  s_cbranch_scc1 sb_223
  s_cmp_eq_u32 s47, 1
  s_cbranch_scc1 ic_272
  v_mov_b32 v252, 0
sb_273:
  s_sub_u32 s48, s48, 1
  s_cbranch_scc1 L_fail
  buffer_load_dwordx4 v[248:251], v252, s[12:15], 0 offen sc1
  s_waitcnt vmcnt(0)
  v_readfirstlane_b32 s37, v248
  s_nop 3
  s_cmp_ge_u32 s37, 96
  s_cbranch_scc1 sb_274
  s_sleep 8
  s_branch sb_273
sb_274:
  s_mov_b32 s47, 1
ic_272:
  s_add_u32 s38, s38, 0x4c00000
  v_mov_b32 v3, 1
  s_mov_b64 exec, 1
  buffer_atomic_add v3, v6, s[8:11], s38 offen sc1
  s_mov_b64 exec, -1
  s_branch sb_223
bs_232:
  s_waitcnt vmcnt(8)
  s_barrier
  s_cmp_ge_u32 s55, 23
  s_cselect_b32 s52, 0x7f000000, s52
  s_cselect_b32 s53, 0x7f000000, s53
  s_branch bs_231
ba_226:
  s_cmp_eq_u32 s29, 0
  s_cbranch_scc1 tk_276
tb_275:
  s_cmp_eq_u32 s54, 1
  s_cbranch_scc1 bo_277
  s_mov_b32 s36, 0x53800000
  v_max_f32 v11, v212, v228
  v_cmp_ngt_f32 vcc, s36, v212
  v_cmp_ngt_f32 s[38:39], s36, v228
  s_or_b64 vcc, vcc, s[38:39]
  s_cmp_lg_u64 vcc, 0
  s_cselect_b32 s36, 1, 0
  v_mov_b32 v11, s36
  s_lshl_b32 s37, s28, 2
  s_add_u32 s37, s37, 0x27f10
  v_mov_b32 v12, s37
  ds_write_b32 v12, v11
  v_mov_b32 v12, 0x27f10
  s_waitcnt vmcnt(0) lgkmcnt(0)
  s_barrier
  ds_read_b128 v[36:39], v12
  s_waitcnt lgkmcnt(0)
  v_or3_b32 v11, v36, v37, v38
  v_or_b32 v11, v11, v39
  s_nop 0
  v_readfirstlane_b32 s36, v11
  s_nop 3
  s_cmp_eq_u32 s36, 0
  s_cbranch_scc1 bo_277
  s_mov_b32 s54, 1
  s_branch br_221
bo_277:
  v_and_b32 v11, 7, v0
  v_lshlrev_b32 v13, 6, v11
  v_bfe_u32 v11, v0, 3, 1
  v_lshl_add_u32 v13, v11, 10, v13
  v_bfe_u32 v11, v0, 4, 1
  v_lshl_add_u32 v13, v11, 5, v13
  v_lshrrev_b32 v11, 5, v0
  v_lshl_add_u32 v13, v11, 4, v13
  s_lshl_b32 s36, s88, 19
  s_lshr_b32 s37, s28, 1
  s_lshl_b32 s37, s37, 18
  s_add_u32 s36, s36, s37
  s_and_b32 s37, s28, 1
  s_lshl_b32 s37, s37, 12
  s_add_u32 s36, s36, s37
  s_lshl_b32 s37, s59, 13
  s_add_u32 s36, s36, s37
  s_add_u32 s36, s36, 0x7c00000
  v_rcp_f32 v14, v212
  s_nop 0
  v_pk_mul_f32 v[180:181], v[180:181], v[14:15] op_sel_hi:[1,0]
  v_pk_mul_f32 v[182:183], v[182:183], v[14:15] op_sel_hi:[1,0]
  v_pk_mul_f32 v[184:185], v[184:185], v[14:15] op_sel_hi:[1,0]
  v_pk_mul_f32 v[186:187], v[186:187], v[14:15] op_sel_hi:[1,0]
  v_pk_mul_f32 v[188:189], v[188:189], v[14:15] op_sel_hi:[1,0]
  v_pk_mul_f32 v[190:191], v[190:191], v[14:15] op_sel_hi:[1,0]
  v_pk_mul_f32 v[192:193], v[192:193], v[14:15] op_sel_hi:[1,0]
  v_pk_mul_f32 v[194:195], v[194:195], v[14:15] op_sel_hi:[1,0]
  v_cvt_pk_bf16_f32 v116, v180, v181
  v_cvt_pk_bf16_f32 v117, v182, v183
  v_cvt_pk_bf16_f32 v118, v188, v189
  v_cvt_pk_bf16_f32 v119, v190, v191
  v_cvt_pk_bf16_f32 v120, v184, v185
  v_cvt_pk_bf16_f32 v121, v186, v187
  v_cvt_pk_bf16_f32 v122, v192, v193
  v_cvt_pk_bf16_f32 v123, v194, v195
  v_permlane16_swap_b32 v116, v120
  v_permlane16_swap_b32 v117, v121
  v_permlane16_swap_b32 v118, v122
  v_permlane16_swap_b32 v119, v123
  buffer_store_dwordx4 v[116:119], v13, s[8:11], s36 offen offset:0 sc1
  buffer_store_dwordx4 v[120:123], v13, s[8:11], s36 offen offset:512 sc1
  v_rcp_f32 v14, v228
  s_nop 0
  v_pk_mul_f32 v[196:197], v[196:197], v[14:15] op_sel_hi:[1,0]
  v_pk_mul_f32 v[198:199], v[198:199], v[14:15] op_sel_hi:[1,0]
  v_pk_mul_f32 v[200:201], v[200:201], v[14:15] op_sel_hi:[1,0]
  v_pk_mul_f32 v[202:203], v[202:203], v[14:15] op_sel_hi:[1,0]
  v_pk_mul_f32 v[204:205], v[204:205], v[14:15] op_sel_hi:[1,0]
  v_pk_mul_f32 v[206:207], v[206:207], v[14:15] op_sel_hi:[1,0]
  v_pk_mul_f32 v[208:209], v[208:209], v[14:15] op_sel_hi:[1,0]
  v_pk_mul_f32 v[210:211], v[210:211], v[14:15] op_sel_hi:[1,0]
  v_cvt_pk_bf16_f32 v124, v196, v197
  v_cvt_pk_bf16_f32 v125, v198, v199
  v_cvt_pk_bf16_f32 v126, v204, v205
  v_cvt_pk_bf16_f32 v127, v206, v207
  v_cvt_pk_bf16_f32 v128, v200, v201
  v_cvt_pk_bf16_f32 v129, v202, v203
  v_cvt_pk_bf16_f32 v130, v208, v209
  v_cvt_pk_bf16_f32 v131, v210, v211
  v_permlane16_swap_b32 v124, v128
  v_permlane16_swap_b32 v125, v129
  v_permlane16_swap_b32 v126, v130
  v_permlane16_swap_b32 v127, v131
  buffer_store_dwordx4 v[124:127], v13, s[8:11], s36 offen offset:2048 sc1
  buffer_store_dwordx4 v[128:131], v13, s[8:11], s36 offen offset:2560 sc1
  s_waitcnt lgkmcnt(0)
  s_mov_b32 s56, 0x7f000000
  s_mov_b32 s57, 0x7f000000
  s_waitcnt vmcnt(4)
  s_branch W_next
tk_276:
  s_mov_b32 s29, 1
  s_cmp_lg_u32 s28, 0
  s_cbranch_scc1 tb_275
  v_mov_b32 v7, 1
  s_lshl_b32 s38, s58, 2
  s_mov_b64 exec, 1
  buffer_atomic_add v7, v6, s[12:15], s38 offen offset:128 sc0 sc1
  s_mov_b64 exec, -1
  s_branch tb_275
L_done:
  s_endpgm
.p2align 4
.type W_table,@object
W_table:
.long 0x2011, 0x22000ff, 0x80004000, 1
.long 0x13011, 0x23000ff, 0x80004040, 1
.long 0x23011, 0x23000ff, 0x80004080, 1
.long 0x3011, 0x23000ff, 0x800040c0, 1
.long 0x2041, 0x52000ff, 0x80804000, 0
.long 0x13041, 0x53000ff, 0x80804040, 0
.long 0x23041, 0x53000ff, 0x80804080, 0
.long 0x3041, 0x53000ff, 0x808040c0, 0
.long 0x1057, 0x0, 0x40, 0
.long 0x1057, 0x100000, 0x40, 0
.long 0x1057, 0x200000, 0x40, 0
.long 0x1057, 0x300000, 0x40, 0
.long 0x1067, 0x0, 0x40, 0
.long 0x1067, 0x100000, 0x40, 0
.long 0x1067, 0x200000, 0x40, 0
.long 0x1067, 0x300000, 0x40, 0
.long 0x1067, 0x400000, 0x40, 0
.long 0x1067, 0x500000, 0x40, 0
.long 0x1077, 0x0, 0x40, 0
.long 0x1077, 0x100000, 0x40, 0
.long 0xf, 0x0, 0x0, 0
.long 0xf, 0x0, 0x0, 0
.long 0x3, 0xff01890, 0x0, 0
.long 0x3, 0xff01890, 0x0, 0
.long 0x3, 0xff01890, 0x0, 0
.long 0x3, 0xff01890, 0x0, 0
.long 0x3, 0xff01890, 0x0, 0
.long 0x3, 0xff01890, 0x0, 0
.long 0x3, 0xff01890, 0x0, 0
.long 0x3, 0xff01890, 0x0, 0
.long 0x1003, 0xff01890, 0x0, 0
.long 0x1003, 0xff01890, 0x0, 0
.long 0x1003, 0xff01890, 0x0, 0
.long 0x1003, 0xff01890, 0x0, 0
.long 0x1003, 0xff01890, 0x0, 0
.long 0x1003, 0xff01890, 0x0, 0
.long 0x1003, 0xff01890, 0x0, 0
.long 0x1003, 0xff01890, 0x0, 0
.long 0x2003, 0xff01890, 0x0, 0
.long 0x2003, 0xff01890, 0x0, 0
.long 0x2003, 0xff01890, 0x0, 0
.long 0x2003, 0xff01890, 0x0, 0
.long 0x2003, 0xff01890, 0x0, 0
.long 0x2003, 0xff01890, 0x0, 0
.long 0x2003, 0xff01890, 0x0, 0
.long 0x2003, 0xff01890, 0x0, 0
.long 0x3003, 0xff01890, 0x0, 0
.long 0x3003, 0xff01890, 0x0, 0
.long 0x3003, 0xff01890, 0x0, 0
.long 0x3003, 0xff01890, 0x0, 0
.long 0x3003, 0xff01890, 0x0, 0
.long 0x3003, 0xff01890, 0x0, 0
.long 0x3003, 0xff01890, 0x0, 0
.long 0x3003, 0xff01890, 0x0, 0
.long 0x4003, 0xff01890, 0x0, 0
.long 0x4003, 0xff01890, 0x0, 0
.long 0x4003, 0xff01890, 0x0, 0
.long 0x4003, 0xff01890, 0x0, 0
.long 0x4003, 0xff01890, 0x0, 0
.long 0x4003, 0xff01890, 0x0, 0
.long 0x4003, 0xff01890, 0x0, 0
.long 0x4003, 0xff01890, 0x0, 0
.long 0x5003, 0xff01890, 0x0, 0
.long 0x5003, 0xff01890, 0x0, 0
.long 0x5003, 0xff01890, 0x0, 0
.long 0x5003, 0xff01890, 0x0, 0
.long 0x5003, 0xff01890, 0x0, 0
.long 0x5003, 0xff01890, 0x0, 0
.long 0x5003, 0xff01890, 0x0, 0
.long 0x5003, 0xff01890, 0x0, 0
.long 0x6003, 0xff01890, 0x0, 0
.long 0x6003, 0xff01890, 0x0, 0
.long 0x6003, 0xff01890, 0x0, 0
.long 0x6003, 0xff01890, 0x0, 0
.long 0x6003, 0xff01890, 0x0, 0
.long 0x6003, 0xff01890, 0x0, 0
.long 0x6003, 0xff01890, 0x0, 0
.long 0x6003, 0xff01890, 0x0, 0
.long 0x7003, 0xff01890, 0x0, 0
.long 0x7003, 0xff01890, 0x0, 0
.long 0x7003, 0xff01890, 0x0, 0
.long 0x7003, 0xff01890, 0x0, 0
.long 0x7003, 0xff01890, 0x0, 0
.long 0x7003, 0xff01890, 0x0, 0
.long 0x7003, 0xff01890, 0x0, 0
.long 0x7003, 0xff01890, 0x0, 0
.long 0xf, 0x0, 0x0, 0
.long 0xf, 0x0, 0x0, 0
.long 0xf, 0x0, 0x0, 0
.long 0xf, 0x0, 0x0, 0
.long 0xf, 0x0, 0x0, 0
.long 0xf, 0x0, 0x0, 0
.long 0xf, 0x0, 0x0, 0
.long 0xf, 0x0, 0x0, 0
.long 0xf, 0x0, 0x0, 0
.long 0xf, 0x0, 0x0, 0
.long 0xf, 0x0, 0x0, 0
.long 0xf, 0x0, 0x0, 0
.long 0xf, 0x0, 0x0, 0
.long 0xf, 0x0, 0x0, 0
.long 0xf, 0x0, 0x0, 0
.long 0xf, 0x0, 0x0, 0
.long 0xf, 0x0, 0x0, 0
.long 0xf, 0x0, 0x0, 0
.long 0xf, 0x0, 0x0, 0
.long 0xf, 0x0, 0x0, 0
.long 0xf, 0x0, 0x0, 0
.long 0xf, 0x0, 0x0, 0
.long 0xf, 0x0, 0x0, 0
.long 0xf, 0x0, 0x0, 0
.long 0xf, 0x0, 0x0, 0
.long 0xf, 0x0, 0x0, 0
.long 0xf, 0x0, 0x0, 0
.long 0xf, 0x0, 0x0, 0
.long 0xf, 0x0, 0x0, 0
.long 0xf, 0x0, 0x0, 0
.long 0xf, 0x0, 0x0, 0
.long 0xf, 0x0, 0x0, 0
.long 0xf, 0x0, 0x0, 0
.long 0xf, 0x0, 0x0, 0
.long 0xf, 0x0, 0x0, 0
.long 0xf, 0x0, 0x0, 0
.long 0xf, 0x0, 0x0, 0
.long 0xf, 0x0, 0x0, 0
.long 0xf, 0x0, 0x0, 0
.long 0xf, 0x0, 0x0, 0
.long 0xf, 0x0, 0x0, 0
.long 0xf, 0x0, 0x0, 0
.long 0xf, 0x0, 0x0, 0
.long 0xf, 0x0, 0x0, 0
.long 0xf, 0x0, 0x0, 0
.long 0xf, 0x0, 0x0, 0
.long 0xf, 0x0, 0x0, 0
.long 0xf, 0x0, 0x0, 0
.long 0xf, 0x0, 0x0, 0
.long 0xf, 0x0, 0x0, 0
.long 0xf, 0x0, 0x0, 0
.long 0xf, 0x0, 0x0, 0
.long 0xf, 0x0, 0x0, 0
.long 0xf, 0x0, 0x0, 0
.long 0xf, 0x0, 0x0, 0
.long 0xf, 0x0, 0x0, 0
.long 0xf, 0x0, 0x0, 0
.long 0xf, 0x0, 0x0, 0
.long 0xf, 0x0, 0x0, 0
.long 0xf, 0x0, 0x0, 0
.long 0xf, 0x0, 0x0, 0
.long 0xf, 0x0, 0x0, 0
.long 0xf, 0x0, 0x0, 0
.long 0xf, 0x0, 0x0, 0
.long 0xf, 0x0, 0x0, 0
.long 0xf, 0x0, 0x0, 0
.long 0xf, 0x0, 0x0, 0
.long 0xf, 0x0, 0x0, 0
.long 0xf, 0x0, 0x0, 0
.long 0xf, 0x0, 0x0, 0
.long 0xf, 0x0, 0x0, 0
.long 0xf, 0x0, 0x0, 0
.long 0xf, 0x0, 0x0, 0
.long 0xf, 0x0, 0x0, 0
.long 0xf, 0x0, 0x0, 0
.long 0xf, 0x0, 0x0, 0
.long 0xf, 0x0, 0x0, 0
.long 0xf, 0x0, 0x0, 0
.long 0xf, 0x0, 0x0, 0
.long 0xf, 0x0, 0x0, 0
.long 0xf, 0x0, 0x0, 0
.long 0xf, 0x0, 0x0, 0
.long 0xf, 0x0, 0x0, 0
.long 0xf, 0x0, 0x0, 0
.long 0xf, 0x0, 0x0, 0
.long 0xf, 0x0, 0x0, 0
.long 0xf, 0x0, 0x0, 0
.long 0xf, 0x0, 0x0, 0
.long 0xf, 0x0, 0x0, 0
.long 0xf, 0x0, 0x0, 0
.long 0xf, 0x0, 0x0, 0
.long 0xf, 0x0, 0x0, 0
.long 0xf, 0x0, 0x0, 0
.long 0xf, 0x0, 0x0, 0
.long 0xf, 0x0, 0x0, 0
.long 0xf, 0x0, 0x0, 0
.long 0xf, 0x0, 0x0, 0
.long 0xf, 0x0, 0x0, 0
.long 0xf, 0x0, 0x0, 0
.long 0xf, 0x0, 0x0, 0
.long 0xf, 0x0, 0x0, 0
.long 0xf, 0x0, 0x0, 0
.long 0xf, 0x0, 0x0, 0
.long 0xf, 0x0, 0x0, 0
.long 0xf, 0x0, 0x0, 0
.long 0xf, 0x0, 0x0, 0
.long 0xf, 0x0, 0x0, 0
.long 0xf, 0x0, 0x0, 0
.long 0xf, 0x0, 0x0, 0
.long 0xf, 0x0, 0x0, 0
.long 0xf, 0x0, 0x0, 0
.long 0xf, 0x0, 0x0, 0
.long 0xf, 0x0, 0x0, 0
.long 0xf, 0x0, 0x0, 0
.long 0xf, 0x0, 0x0, 0
.long 0xf, 0x0, 0x0, 0
.long 0xf, 0x0, 0x0, 0
.long 0xf, 0x0, 0x0, 0
.long 0xf, 0x0, 0x0, 0
.long 0xf, 0x0, 0x0, 0
.long 0xf, 0x0, 0x0, 0
.long 0xf, 0x0, 0x0, 0
.long 0xf, 0x0, 0x0, 0
.long 0xf, 0x0, 0x0, 0
.long 0xf, 0x0, 0x0, 0
.long 0xf, 0x0, 0x0, 0
.long 0xf, 0x0, 0x0, 0
.long 0xf, 0x0, 0x0, 0
.long 0xf, 0x0, 0x0, 0
.long 0xf, 0x0, 0x0, 0
.long 0xf, 0x0, 0x0, 0
.long 0xf, 0x0, 0x0, 0
.long 0xf, 0x0, 0x0, 0
.long 0xf, 0x0, 0x0, 0
.long 0xf, 0x0, 0x0, 0
.long 0xf, 0x0, 0x0, 0
.long 0xf, 0x0, 0x0, 0
.long 0xf, 0x0, 0x0, 0
.long 0xf, 0x0, 0x0, 0
.long 0xf, 0x0, 0x0, 0
.long 0xf, 0x0, 0x0, 0
.long 0xf, 0x0, 0x0, 0
.long 0xf, 0x0, 0x0, 0
.long 0xf, 0x0, 0x0, 0
.long 0xf, 0x0, 0x0, 0
.long 0xf, 0x0, 0x0, 0
.long 0xf, 0x0, 0x0, 0
.long 0xf, 0x0, 0x0, 0
.long 0xf, 0x0, 0x0, 0
.long 0xf, 0x0, 0x0, 0
.long 0xf, 0x0, 0x0, 0
.long 0xf, 0x0, 0x0, 0
.long 0xf, 0x0, 0x0, 0
.long 0xf, 0x0, 0x0, 0
.long 0xf, 0x0, 0x0, 0
.long 0xf, 0x0, 0x0, 0
.long 0xf, 0x0, 0x0, 0
.long 0xf, 0x0, 0x0, 0
.long 0xf, 0x0, 0x0, 0
.long 0xf, 0x0, 0x0, 0
.long 0xf, 0x0, 0x0, 0
.long 0xf, 0x0, 0x0, 0
.long 0xf, 0x0, 0x0, 0
.long 0xf, 0x0, 0x0, 0
.long 0xf, 0x0, 0x0, 0
.long 0xf, 0x0, 0x0, 0
.long 0xf, 0x0, 0x0, 0
.long 0xf, 0x0, 0x0, 0
.long 0xf, 0x0, 0x0, 0
.long 0xf, 0x0, 0x0, 0
.long 0xf, 0x0, 0x0, 0
.long 0xf, 0x0, 0x0, 0
.long 0xf, 0x0, 0x0, 0
.long 0x6011, 0x26000ff, 0x80004000, 1
.long 0x17011, 0x27000ff, 0x80004040, 1
.long 0x27011, 0x27000ff, 0x80004080, 1
.long 0x7011, 0x27000ff, 0x800040c0, 1
.long 0x6041, 0x56000ff, 0x80804000, 0
.long 0x17041, 0x57000ff, 0x80804040, 0
.long 0x27041, 0x57000ff, 0x80804080, 0
.long 0x7041, 0x57000ff, 0x808040c0, 0
.long 0x1057, 0x40000, 0x40, 0
.long 0x1057, 0x140000, 0x40, 0
.long 0x1057, 0x240000, 0x40, 0
.long 0x1057, 0x340000, 0x40, 0
.long 0x1067, 0x40000, 0x40, 0
.long 0x1067, 0x140000, 0x40, 0
.long 0x1067, 0x240000, 0x40, 0
.long 0x1067, 0x340000, 0x40, 0
.long 0x1067, 0x440000, 0x40, 0
.long 0x1067, 0x540000, 0x40, 0
.long 0x1077, 0x40000, 0x40, 0
.long 0x1077, 0x140000, 0x40, 0
.long 0xf, 0x0, 0x0, 0
.long 0xf, 0x0, 0x0, 0
.long 0x13, 0xff01891, 0x0, 0
.long 0x13, 0xff01891, 0x0, 0
.long 0x13, 0xff01891, 0x0, 0
.long 0x13, 0xff01891, 0x0, 0
.long 0x13, 0xff01891, 0x0, 0
.long 0x13, 0xff01891, 0x0, 0
.long 0x13, 0xff01891, 0x0, 0
.long 0x13, 0xff01891, 0x0, 0
.long 0x1013, 0xff01891, 0x0, 0
.long 0x1013, 0xff01891, 0x0, 0
.long 0x1013, 0xff01891, 0x0, 0
.long 0x1013, 0xff01891, 0x0, 0
.long 0x1013, 0xff01891, 0x0, 0
.long 0x1013, 0xff01891, 0x0, 0
.long 0x1013, 0xff01891, 0x0, 0
.long 0x1013, 0xff01891, 0x0, 0
.long 0x2013, 0xff01891, 0x0, 0
.long 0x2013, 0xff01891, 0x0, 0
.long 0x2013, 0xff01891, 0x0, 0
.long 0x2013, 0xff01891, 0x0, 0
.long 0x2013, 0xff01891, 0x0, 0
.long 0x2013, 0xff01891, 0x0, 0
.long 0x2013, 0xff01891, 0x0, 0
.long 0x2013, 0xff01891, 0x0, 0
.long 0x3013, 0xff01891, 0x0, 0
.long 0x3013, 0xff01891, 0x0, 0
.long 0x3013, 0xff01891, 0x0, 0
.long 0x3013, 0xff01891, 0x0, 0
.long 0x3013, 0xff01891, 0x0, 0
.long 0x3013, 0xff01891, 0x0, 0
.long 0x3013, 0xff01891, 0x0, 0
.long 0x3013, 0xff01891, 0x0, 0
.long 0x4013, 0xff01891, 0x0, 0
.long 0x4013, 0xff01891, 0x0, 0
.long 0x4013, 0xff01891, 0x0, 0
.long 0x4013, 0xff01891, 0x0, 0
.long 0x4013, 0xff01891, 0x0, 0
.long 0x4013, 0xff01891, 0x0, 0
.long 0x4013, 0xff01891, 0x0, 0
.long 0x4013, 0xff01891, 0x0, 0
.long 0x5013, 0xff01891, 0x0, 0
.long 0x5013, 0xff01891, 0x0, 0
.long 0x5013, 0xff01891, 0x0, 0
.long 0x5013, 0xff01891, 0x0, 0
.long 0x5013, 0xff01891, 0x0, 0
.long 0x5013, 0xff01891, 0x0, 0
.long 0x5013, 0xff01891, 0x0, 0
.long 0x5013, 0xff01891, 0x0, 0
.long 0x6013, 0xff01891, 0x0, 0
.long 0x6013, 0xff01891, 0x0, 0
.long 0x6013, 0xff01891, 0x0, 0
.long 0x6013, 0xff01891, 0x0, 0
.long 0x6013, 0xff01891, 0x0, 0
.long 0x6013, 0xff01891, 0x0, 0
.long 0x6013, 0xff01891, 0x0, 0
.long 0x6013, 0xff01891, 0x0, 0
.long 0x7013, 0xff01891, 0x0, 0
.long 0x7013, 0xff01891, 0x0, 0
.long 0x7013, 0xff01891, 0x0, 0
.long 0x7013, 0xff01891, 0x0, 0
.long 0x7013, 0xff01891, 0x0, 0
.long 0x7013, 0xff01891, 0x0, 0
.long 0x7013, 0xff01891, 0x0, 0
.long 0x7013, 0xff01891, 0x0, 0
.long 0xf, 0x0, 0x0, 0
.long 0xf, 0x0, 0x0, 0
.long 0xf, 0x0, 0x0, 0
.long 0xf, 0x0, 0x0, 0
.long 0xf, 0x0, 0x0, 0
.long 0xf, 0x0, 0x0, 0
.long 0xf, 0x0, 0x0, 0
.long 0xf, 0x0, 0x0, 0
.long 0xf, 0x0, 0x0, 0
.long 0xf, 0x0, 0x0, 0
.long 0xf, 0x0, 0x0, 0
.long 0xf, 0x0, 0x0, 0
.long 0xf, 0x0, 0x0, 0
.long 0xf, 0x0, 0x0, 0
.long 0xf, 0x0, 0x0, 0
.long 0xf, 0x0, 0x0, 0
.long 0xf, 0x0, 0x0, 0
.long 0xf, 0x0, 0x0, 0
.long 0xf, 0x0, 0x0, 0
.long 0xf, 0x0, 0x0, 0
.long 0xf, 0x0, 0x0, 0
.long 0xf, 0x0, 0x0, 0
.long 0xf, 0x0, 0x0, 0
.long 0xf, 0x0, 0x0, 0
.long 0xf, 0x0, 0x0, 0
.long 0xf, 0x0, 0x0, 0
.long 0xf, 0x0, 0x0, 0
.long 0xf, 0x0, 0x0, 0
.long 0xf, 0x0, 0x0, 0
.long 0xf, 0x0, 0x0, 0
.long 0xf, 0x0, 0x0, 0
.long 0xf, 0x0, 0x0, 0
.long 0xf, 0x0, 0x0, 0
.long 0xf, 0x0, 0x0, 0
.long 0xf, 0x0, 0x0, 0
.long 0xf, 0x0, 0x0, 0
.long 0xf, 0x0, 0x0, 0
.long 0xf, 0x0, 0x0, 0
.long 0xf, 0x0, 0x0, 0
.long 0xf, 0x0, 0x0, 0
.long 0xf, 0x0, 0x0, 0
.long 0xf, 0x0, 0x0, 0
.long 0xf, 0x0, 0x0, 0
.long 0xf, 0x0, 0x0, 0
.long 0xf, 0x0, 0x0, 0
.long 0xf, 0x0, 0x0, 0
.long 0xf, 0x0, 0x0, 0
.long 0xf, 0x0, 0x0, 0
.long 0xf, 0x0, 0x0, 0
.long 0xf, 0x0, 0x0, 0
.long 0xf, 0x0, 0x0, 0
.long 0xf, 0x0, 0x0, 0
.long 0xf, 0x0, 0x0, 0
.long 0xf, 0x0, 0x0, 0
.long 0xf, 0x0, 0x0, 0
.long 0xf, 0x0, 0x0, 0
.long 0xf, 0x0, 0x0, 0
.long 0xf, 0x0, 0x0, 0
.long 0xf, 0x0, 0x0, 0
.long 0xf, 0x0, 0x0, 0
.long 0xf, 0x0, 0x0, 0
.long 0xf, 0x0, 0x0, 0
.long 0xf, 0x0, 0x0, 0
.long 0xf, 0x0, 0x0, 0
.long 0xf, 0x0, 0x0, 0
.long 0xf, 0x0, 0x0, 0
.long 0xf, 0x0, 0x0, 0
.long 0xf, 0x0, 0x0, 0
.long 0xf, 0x0, 0x0, 0
.long 0xf, 0x0, 0x0, 0
.long 0xf, 0x0, 0x0, 0
.long 0xf, 0x0, 0x0, 0
.long 0xf, 0x0, 0x0, 0
.long 0xf, 0x0, 0x0, 0
.long 0xf, 0x0, 0x0, 0
.long 0xf, 0x0, 0x0, 0
.long 0xf, 0x0, 0x0, 0
.long 0xf, 0x0, 0x0, 0
.long 0xf, 0x0, 0x0, 0
.long 0xf, 0x0, 0x0, 0
.long 0xf, 0x0, 0x0, 0
.long 0xf, 0x0, 0x0, 0
.long 0xf, 0x0, 0x0, 0
.long 0xf, 0x0, 0x0, 0
.long 0xf, 0x0, 0x0, 0
.long 0xf, 0x0, 0x0, 0
.long 0xf, 0x0, 0x0, 0
.long 0xf, 0x0, 0x0, 0
.long 0xf, 0x0, 0x0, 0
.long 0xf, 0x0, 0x0, 0
.long 0xf, 0x0, 0x0, 0
.long 0xf, 0x0, 0x0, 0
.long 0xf, 0x0, 0x0, 0
.long 0xf, 0x0, 0x0, 0
.long 0xf, 0x0, 0x0, 0
.long 0xf, 0x0, 0x0, 0
.long 0xf, 0x0, 0x0, 0
.long 0xf, 0x0, 0x0, 0
.long 0xf, 0x0, 0x0, 0
.long 0xf, 0x0, 0x0, 0
.long 0xf, 0x0, 0x0, 0
.long 0xf, 0x0, 0x0, 0
.long 0xf, 0x0, 0x0, 0
.long 0xf, 0x0, 0x0, 0
.long 0xf, 0x0, 0x0, 0
.long 0xf, 0x0, 0x0, 0
.long 0xf, 0x0, 0x0, 0
.long 0xf, 0x0, 0x0, 0
.long 0xf, 0x0, 0x0, 0
.long 0xf, 0x0, 0x0, 0
.long 0xf, 0x0, 0x0, 0
.long 0xf, 0x0, 0x0, 0
.long 0xf, 0x0, 0x0, 0
.long 0xf, 0x0, 0x0, 0
.long 0xf, 0x0, 0x0, 0
.long 0xf, 0x0, 0x0, 0
.long 0xf, 0x0, 0x0, 0
.long 0xf, 0x0, 0x0, 0
.long 0xf, 0x0, 0x0, 0
.long 0xf, 0x0, 0x0, 0
.long 0xf, 0x0, 0x0, 0
.long 0xf, 0x0, 0x0, 0
.long 0xf, 0x0, 0x0, 0
.long 0xf, 0x0, 0x0, 0
.long 0xf, 0x0, 0x0, 0
.long 0xf, 0x0, 0x0, 0
.long 0xf, 0x0, 0x0, 0
.long 0xf, 0x0, 0x0, 0
.long 0xf, 0x0, 0x0, 0
.long 0xf, 0x0, 0x0, 0
.long 0xf, 0x0, 0x0, 0
.long 0xf, 0x0, 0x0, 0
.long 0xf, 0x0, 0x0, 0
.long 0xf, 0x0, 0x0, 0
.long 0xf, 0x0, 0x0, 0
.long 0xf, 0x0, 0x0, 0
.long 0xf, 0x0, 0x0, 0
.long 0xf, 0x0, 0x0, 0
.long 0xf, 0x0, 0x0, 0
.long 0xf, 0x0, 0x0, 0
.long 0xf, 0x0, 0x0, 0
.long 0xf, 0x0, 0x0, 0
.long 0xf, 0x0, 0x0, 0
.long 0xf, 0x0, 0x0, 0
.long 0xf, 0x0, 0x0, 0
.long 0xf, 0x0, 0x0, 0
.long 0xf, 0x0, 0x0, 0
.long 0xf, 0x0, 0x0, 0
.long 0xf, 0x0, 0x0, 0
.long 0xf, 0x0, 0x0, 0
.long 0xf, 0x0, 0x0, 0
.long 0xf, 0x0, 0x0, 0
.long 0xf, 0x0, 0x0, 0
.long 0xf, 0x0, 0x0, 0
.long 0xf, 0x0, 0x0, 0
.long 0xf, 0x0, 0x0, 0
.long 0xf, 0x0, 0x0, 0
.long 0xf, 0x0, 0x0, 0
.long 0xf, 0x0, 0x0, 0
.long 0xf, 0x0, 0x0, 0
.long 0xf, 0x0, 0x0, 0
.long 0xf, 0x0, 0x0, 0
.long 0xf, 0x0, 0x0, 0
.long 0xf, 0x0, 0x0, 0
.long 0xf, 0x0, 0x0, 0
.long 0xf, 0x0, 0x0, 0
.long 0xf, 0x0, 0x0, 0
.long 0xf, 0x0, 0x0, 0
.long 0xf, 0x0, 0x0, 0
.long 0xf, 0x0, 0x0, 0
.long 0xf, 0x0, 0x0, 0
.long 0xf, 0x0, 0x0, 0
.long 0xf, 0x0, 0x0, 0
.long 0xa011, 0x2a000ff, 0x80004000, 1
.long 0x1b011, 0x2b000ff, 0x80004040, 1
.long 0x2b011, 0x2b000ff, 0x80004080, 1
.long 0xb011, 0x2b000ff, 0x800040c0, 1
.long 0xa041, 0x5a000ff, 0x80804000, 0
.long 0x1b041, 0x5b000ff, 0x80804040, 0
.long 0x2b041, 0x5b000ff, 0x80804080, 0
.long 0xb041, 0x5b000ff, 0x808040c0, 0
.long 0x1057, 0x80000, 0x40, 0
.long 0x1057, 0x180000, 0x40, 0
.long 0x1057, 0x280000, 0x40, 0
.long 0x1057, 0x380000, 0x40, 0
.long 0x1067, 0x80000, 0x40, 0
.long 0x1067, 0x180000, 0x40, 0
.long 0x1067, 0x280000, 0x40, 0
.long 0x1067, 0x380000, 0x40, 0
.long 0x1067, 0x480000, 0x40, 0
.long 0x1067, 0x580000, 0x40, 0
.long 0x1077, 0x80000, 0x40, 0
.long 0x1077, 0x180000, 0x40, 0
.long 0xf, 0x0, 0x0, 0
.long 0xf, 0x0, 0x0, 0
.long 0x23, 0xff01892, 0x0, 0
.long 0x23, 0xff01892, 0x0, 0
.long 0x23, 0xff01892, 0x0, 0
.long 0x23, 0xff01892, 0x0, 0
.long 0x23, 0xff01892, 0x0, 0
.long 0x23, 0xff01892, 0x0, 0
.long 0x23, 0xff01892, 0x0, 0
.long 0x23, 0xff01892, 0x0, 0
.long 0x1023, 0xff01892, 0x0, 0
.long 0x1023, 0xff01892, 0x0, 0
.long 0x1023, 0xff01892, 0x0, 0
.long 0x1023, 0xff01892, 0x0, 0
.long 0x1023, 0xff01892, 0x0, 0
.long 0x1023, 0xff01892, 0x0, 0
.long 0x1023, 0xff01892, 0x0, 0
.long 0x1023, 0xff01892, 0x0, 0
.long 0x2023, 0xff01892, 0x0, 0
.long 0x2023, 0xff01892, 0x0, 0
.long 0x2023, 0xff01892, 0x0, 0
.long 0x2023, 0xff01892, 0x0, 0
.long 0x2023, 0xff01892, 0x0, 0
.long 0x2023, 0xff01892, 0x0, 0
.long 0x2023, 0xff01892, 0x0, 0
.long 0x2023, 0xff01892, 0x0, 0
.long 0x3023, 0xff01892, 0x0, 0
.long 0x3023, 0xff01892, 0x0, 0
.long 0x3023, 0xff01892, 0x0, 0
.long 0x3023, 0xff01892, 0x0, 0
.long 0x3023, 0xff01892, 0x0, 0
.long 0x3023, 0xff01892, 0x0, 0
.long 0x3023, 0xff01892, 0x0, 0
.long 0x3023, 0xff01892, 0x0, 0
.long 0x4023, 0xff01892, 0x0, 0
.long 0x4023, 0xff01892, 0x0, 0
.long 0x4023, 0xff01892, 0x0, 0
.long 0x4023, 0xff01892, 0x0, 0
.long 0x4023, 0xff01892, 0x0, 0
.long 0x4023, 0xff01892, 0x0, 0
.long 0x4023, 0xff01892, 0x0, 0
.long 0x4023, 0xff01892, 0x0, 0
.long 0x5023, 0xff01892, 0x0, 0
.long 0x5023, 0xff01892, 0x0, 0
.long 0x5023, 0xff01892, 0x0, 0
.long 0x5023, 0xff01892, 0x0, 0
.long 0x5023, 0xff01892, 0x0, 0
.long 0x5023, 0xff01892, 0x0, 0
.long 0x5023, 0xff01892, 0x0, 0
.long 0x5023, 0xff01892, 0x0, 0
.long 0x6023, 0xff01892, 0x0, 0
.long 0x6023, 0xff01892, 0x0, 0
.long 0x6023, 0xff01892, 0x0, 0
.long 0x6023, 0xff01892, 0x0, 0
.long 0x6023, 0xff01892, 0x0, 0
.long 0x6023, 0xff01892, 0x0, 0
.long 0x6023, 0xff01892, 0x0, 0
.long 0x6023, 0xff01892, 0x0, 0
.long 0x7023, 0xff01892, 0x0, 0
.long 0x7023, 0xff01892, 0x0, 0
.long 0x7023, 0xff01892, 0x0, 0
.long 0x7023, 0xff01892, 0x0, 0
.long 0x7023, 0xff01892, 0x0, 0
.long 0x7023, 0xff01892, 0x0, 0
.long 0x7023, 0xff01892, 0x0, 0
.long 0x7023, 0xff01892, 0x0, 0
.long 0xf, 0x0, 0x0, 0
.long 0xf, 0x0, 0x0, 0
.long 0xf, 0x0, 0x0, 0
.long 0xf, 0x0, 0x0, 0
.long 0xf, 0x0, 0x0, 0
.long 0xf, 0x0, 0x0, 0
.long 0xf, 0x0, 0x0, 0
.long 0xf, 0x0, 0x0, 0
.long 0xf, 0x0, 0x0, 0
.long 0xf, 0x0, 0x0, 0
.long 0xf, 0x0, 0x0, 0
.long 0xf, 0x0, 0x0, 0
.long 0xf, 0x0, 0x0, 0
.long 0xf, 0x0, 0x0, 0
.long 0xf, 0x0, 0x0, 0
.long 0xf, 0x0, 0x0, 0
.long 0xf, 0x0, 0x0, 0
.long 0xf, 0x0, 0x0, 0
.long 0xf, 0x0, 0x0, 0
.long 0xf, 0x0, 0x0, 0
.long 0xf, 0x0, 0x0, 0
.long 0xf, 0x0, 0x0, 0
.long 0xf, 0x0, 0x0, 0
.long 0xf, 0x0, 0x0, 0
.long 0xf, 0x0, 0x0, 0
.long 0xf, 0x0, 0x0, 0
.long 0xf, 0x0, 0x0, 0
.long 0xf, 0x0, 0x0, 0
.long 0xf, 0x0, 0x0, 0
.long 0xf, 0x0, 0x0, 0
.long 0xf, 0x0, 0x0, 0
.long 0xf, 0x0, 0x0, 0
.long 0xf, 0x0, 0x0, 0
.long 0xf, 0x0, 0x0, 0
.long 0xf, 0x0, 0x0, 0
.long 0xf, 0x0, 0x0, 0
.long 0xf, 0x0, 0x0, 0
.long 0xf, 0x0, 0x0, 0
.long 0xf, 0x0, 0x0, 0
.long 0xf, 0x0, 0x0, 0
.long 0xf, 0x0, 0x0, 0
.long 0xf, 0x0, 0x0, 0
.long 0xf, 0x0, 0x0, 0
.long 0xf, 0x0, 0x0, 0
.long 0xf, 0x0, 0x0, 0
.long 0xf, 0x0, 0x0, 0
.long 0xf, 0x0, 0x0, 0
.long 0xf, 0x0, 0x0, 0
.long 0xf, 0x0, 0x0, 0
.long 0xf, 0x0, 0x0, 0
.long 0xf, 0x0, 0x0, 0
.long 0xf, 0x0, 0x0, 0
.long 0xf, 0x0, 0x0, 0
.long 0xf, 0x0, 0x0, 0
.long 0xf, 0x0, 0x0, 0
.long 0xf, 0x0, 0x0, 0
.long 0xf, 0x0, 0x0, 0
.long 0xf, 0x0, 0x0, 0
.long 0xf, 0x0, 0x0, 0
.long 0xf, 0x0, 0x0, 0
.long 0xf, 0x0, 0x0, 0
.long 0xf, 0x0, 0x0, 0
.long 0xf, 0x0, 0x0, 0
.long 0xf, 0x0, 0x0, 0
.long 0xf, 0x0, 0x0, 0
.long 0xf, 0x0, 0x0, 0
.long 0xf, 0x0, 0x0, 0
.long 0xf, 0x0, 0x0, 0
.long 0xf, 0x0, 0x0, 0
.long 0xf, 0x0, 0x0, 0
.long 0xf, 0x0, 0x0, 0
.long 0xf, 0x0, 0x0, 0
.long 0xf, 0x0, 0x0, 0
.long 0xf, 0x0, 0x0, 0
.long 0xf, 0x0, 0x0, 0
.long 0xf, 0x0, 0x0, 0
.long 0xf, 0x0, 0x0, 0
.long 0xf, 0x0, 0x0, 0
.long 0xf, 0x0, 0x0, 0
.long 0xf, 0x0, 0x0, 0
.long 0xf, 0x0, 0x0, 0
.long 0xf, 0x0, 0x0, 0
.long 0xf, 0x0, 0x0, 0
.long 0xf, 0x0, 0x0, 0
.long 0xf, 0x0, 0x0, 0
.long 0xf, 0x0, 0x0, 0
.long 0xf, 0x0, 0x0, 0
.long 0xf, 0x0, 0x0, 0
.long 0xf, 0x0, 0x0, 0
.long 0xf, 0x0, 0x0, 0
.long 0xf, 0x0, 0x0, 0
.long 0xf, 0x0, 0x0, 0
.long 0xf, 0x0, 0x0, 0
.long 0xf, 0x0, 0x0, 0
.long 0xf, 0x0, 0x0, 0
.long 0xf, 0x0, 0x0, 0
.long 0xf, 0x0, 0x0, 0
.long 0xf, 0x0, 0x0, 0
.long 0xf, 0x0, 0x0, 0
.long 0xf, 0x0, 0x0, 0
.long 0xf, 0x0, 0x0, 0
.long 0xf, 0x0, 0x0, 0
.long 0xf, 0x0, 0x0, 0
.long 0xf, 0x0, 0x0, 0
.long 0xf, 0x0, 0x0, 0
.long 0xf, 0x0, 0x0, 0
.long 0xf, 0x0, 0x0, 0
.long 0xf, 0x0, 0x0, 0
.long 0xf, 0x0, 0x0, 0
.long 0xf, 0x0, 0x0, 0
.long 0xf, 0x0, 0x0, 0
.long 0xf, 0x0, 0x0, 0
.long 0xf, 0x0, 0x0, 0
.long 0xf, 0x0, 0x0, 0
.long 0xf, 0x0, 0x0, 0
.long 0xf, 0x0, 0x0, 0
.long 0xf, 0x0, 0x0, 0
.long 0xf, 0x0, 0x0, 0
.long 0xf, 0x0, 0x0, 0
.long 0xf, 0x0, 0x0, 0
.long 0xf, 0x0, 0x0, 0
.long 0xf, 0x0, 0x0, 0
.long 0xf, 0x0, 0x0, 0
.long 0xf, 0x0, 0x0, 0
.long 0xf, 0x0, 0x0, 0
.long 0xf, 0x0, 0x0, 0
.long 0xf, 0x0, 0x0, 0
.long 0xf, 0x0, 0x0, 0
.long 0xf, 0x0, 0x0, 0
.long 0xf, 0x0, 0x0, 0
.long 0xf, 0x0, 0x0, 0
.long 0xf, 0x0, 0x0, 0
.long 0xf, 0x0, 0x0, 0
.long 0xf, 0x0, 0x0, 0
.long 0xf, 0x0, 0x0, 0
.long 0xf, 0x0, 0x0, 0
.long 0xf, 0x0, 0x0, 0
.long 0xf, 0x0, 0x0, 0
.long 0xf, 0x0, 0x0, 0
.long 0xf, 0x0, 0x0, 0
.long 0xf, 0x0, 0x0, 0
.long 0xf, 0x0, 0x0, 0
.long 0xf, 0x0, 0x0, 0
.long 0xf, 0x0, 0x0, 0
.long 0xf, 0x0, 0x0, 0
.long 0xf, 0x0, 0x0, 0
.long 0xf, 0x0, 0x0, 0
.long 0xf, 0x0, 0x0, 0
.long 0xf, 0x0, 0x0, 0
.long 0xf, 0x0, 0x0, 0
.long 0xf, 0x0, 0x0, 0
.long 0xf, 0x0, 0x0, 0
.long 0xf, 0x0, 0x0, 0
.long 0xf, 0x0, 0x0, 0
.long 0xf, 0x0, 0x0, 0
.long 0xf, 0x0, 0x0, 0
.long 0xf, 0x0, 0x0, 0
.long 0xf, 0x0, 0x0, 0
.long 0xf, 0x0, 0x0, 0
.long 0xf, 0x0, 0x0, 0
.long 0xf, 0x0, 0x0, 0
.long 0xf, 0x0, 0x0, 0
.long 0xf, 0x0, 0x0, 0
.long 0xf, 0x0, 0x0, 0
.long 0xf, 0x0, 0x0, 0
.long 0xf, 0x0, 0x0, 0
.long 0xf, 0x0, 0x0, 0
.long 0xf, 0x0, 0x0, 0
.long 0xf, 0x0, 0x0, 0
.long 0xf, 0x0, 0x0, 0
.long 0xf, 0x0, 0x0, 0
.long 0xf, 0x0, 0x0, 0
.long 0xf, 0x0, 0x0, 0
.long 0xe011, 0x2e000ff, 0x80004000, 1
.long 0x1f011, 0x2f000ff, 0x80004040, 1
.long 0x2f011, 0x2f000ff, 0x80004080, 1
.long 0xf011, 0x2f000ff, 0x800040c0, 1
.long 0xe041, 0x5e000ff, 0x80804000, 0
.long 0x1f041, 0x5f000ff, 0x80804040, 0
.long 0x2f041, 0x5f000ff, 0x80804080, 0
.long 0xf041, 0x5f000ff, 0x808040c0, 0
.long 0x1057, 0xc0000, 0x40, 0
.long 0x1057, 0x1c0000, 0x40, 0
.long 0x1057, 0x2c0000, 0x40, 0
.long 0x1057, 0x3c0000, 0x40, 0
.long 0x1067, 0xc0000, 0x40, 0
.long 0x1067, 0x1c0000, 0x40, 0
.long 0x1067, 0x2c0000, 0x40, 0
.long 0x1067, 0x3c0000, 0x40, 0
.long 0x1067, 0x4c0000, 0x40, 0
.long 0x1067, 0x5c0000, 0x40, 0
.long 0x1077, 0xc0000, 0x40, 0
.long 0x1077, 0x1c0000, 0x40, 0
.long 0xf, 0x0, 0x0, 0
.long 0xf, 0x0, 0x0, 0
.long 0x33, 0xff01893, 0x0, 0
.long 0x33, 0xff01893, 0x0, 0
.long 0x33, 0xff01893, 0x0, 0
.long 0x33, 0xff01893, 0x0, 0
.long 0x33, 0xff01893, 0x0, 0
.long 0x33, 0xff01893, 0x0, 0
.long 0x33, 0xff01893, 0x0, 0
.long 0x33, 0xff01893, 0x0, 0
.long 0x1033, 0xff01893, 0x0, 0
.long 0x1033, 0xff01893, 0x0, 0
.long 0x1033, 0xff01893, 0x0, 0
.long 0x1033, 0xff01893, 0x0, 0
.long 0x1033, 0xff01893, 0x0, 0
.long 0x1033, 0xff01893, 0x0, 0
.long 0x1033, 0xff01893, 0x0, 0
.long 0x1033, 0xff01893, 0x0, 0
.long 0x2033, 0xff01893, 0x0, 0
.long 0x2033, 0xff01893, 0x0, 0
.long 0x2033, 0xff01893, 0x0, 0
.long 0x2033, 0xff01893, 0x0, 0
.long 0x2033, 0xff01893, 0x0, 0
.long 0x2033, 0xff01893, 0x0, 0
.long 0x2033, 0xff01893, 0x0, 0
.long 0x2033, 0xff01893, 0x0, 0
.long 0x3033, 0xff01893, 0x0, 0
.long 0x3033, 0xff01893, 0x0, 0
.long 0x3033, 0xff01893, 0x0, 0
.long 0x3033, 0xff01893, 0x0, 0
.long 0x3033, 0xff01893, 0x0, 0
.long 0x3033, 0xff01893, 0x0, 0
.long 0x3033, 0xff01893, 0x0, 0
.long 0x3033, 0xff01893, 0x0, 0
.long 0x4033, 0xff01893, 0x0, 0
.long 0x4033, 0xff01893, 0x0, 0
.long 0x4033, 0xff01893, 0x0, 0
.long 0x4033, 0xff01893, 0x0, 0
.long 0x4033, 0xff01893, 0x0, 0
.long 0x4033, 0xff01893, 0x0, 0
.long 0x4033, 0xff01893, 0x0, 0
.long 0x4033, 0xff01893, 0x0, 0
.long 0x5033, 0xff01893, 0x0, 0
.long 0x5033, 0xff01893, 0x0, 0
.long 0x5033, 0xff01893, 0x0, 0
.long 0x5033, 0xff01893, 0x0, 0
.long 0x5033, 0xff01893, 0x0, 0
.long 0x5033, 0xff01893, 0x0, 0
.long 0x5033, 0xff01893, 0x0, 0
.long 0x5033, 0xff01893, 0x0, 0
.long 0x6033, 0xff01893, 0x0, 0
.long 0x6033, 0xff01893, 0x0, 0
.long 0x6033, 0xff01893, 0x0, 0
.long 0x6033, 0xff01893, 0x0, 0
.long 0x6033, 0xff01893, 0x0, 0
.long 0x6033, 0xff01893, 0x0, 0
.long 0x6033, 0xff01893, 0x0, 0
.long 0x6033, 0xff01893, 0x0, 0
.long 0x7033, 0xff01893, 0x0, 0
.long 0x7033, 0xff01893, 0x0, 0
.long 0x7033, 0xff01893, 0x0, 0
.long 0x7033, 0xff01893, 0x0, 0
.long 0x7033, 0xff01893, 0x0, 0
.long 0x7033, 0xff01893, 0x0, 0
.long 0x7033, 0xff01893, 0x0, 0
.long 0x7033, 0xff01893, 0x0, 0
.long 0xf, 0x0, 0x0, 0
.long 0xf, 0x0, 0x0, 0
.long 0xf, 0x0, 0x0, 0
.long 0xf, 0x0, 0x0, 0
.long 0xf, 0x0, 0x0, 0
.long 0xf, 0x0, 0x0, 0
.long 0xf, 0x0, 0x0, 0
.long 0xf, 0x0, 0x0, 0
.long 0xf, 0x0, 0x0, 0
.long 0xf, 0x0, 0x0, 0
.long 0xf, 0x0, 0x0, 0
.long 0xf, 0x0, 0x0, 0
.long 0xf, 0x0, 0x0, 0
.long 0xf, 0x0, 0x0, 0
.long 0xf, 0x0, 0x0, 0
.long 0xf, 0x0, 0x0, 0
.long 0xf, 0x0, 0x0, 0
.long 0xf, 0x0, 0x0, 0
.long 0xf, 0x0, 0x0, 0
.long 0xf, 0x0, 0x0, 0
.long 0xf, 0x0, 0x0, 0
.long 0xf, 0x0, 0x0, 0
.long 0xf, 0x0, 0x0, 0
.long 0xf, 0x0, 0x0, 0
.long 0xf, 0x0, 0x0, 0
.long 0xf, 0x0, 0x0, 0
.long 0xf, 0x0, 0x0, 0
.long 0xf, 0x0, 0x0, 0
.long 0xf, 0x0, 0x0, 0
.long 0xf, 0x0, 0x0, 0
.long 0xf, 0x0, 0x0, 0
.long 0xf, 0x0, 0x0, 0
.long 0xf, 0x0, 0x0, 0
.long 0xf, 0x0, 0x0, 0
.long 0xf, 0x0, 0x0, 0
.long 0xf, 0x0, 0x0, 0
.long 0xf, 0x0, 0x0, 0
.long 0xf, 0x0, 0x0, 0
.long 0xf, 0x0, 0x0, 0
.long 0xf, 0x0, 0x0, 0
.long 0xf, 0x0, 0x0, 0
.long 0xf, 0x0, 0x0, 0
.long 0xf, 0x0, 0x0, 0
.long 0xf, 0x0, 0x0, 0
.long 0xf, 0x0, 0x0, 0
.long 0xf, 0x0, 0x0, 0
.long 0xf, 0x0, 0x0, 0
.long 0xf, 0x0, 0x0, 0
.long 0xf, 0x0, 0x0, 0
.long 0xf, 0x0, 0x0, 0
.long 0xf, 0x0, 0x0, 0
.long 0xf, 0x0, 0x0, 0
.long 0xf, 0x0, 0x0, 0
.long 0xf, 0x0, 0x0, 0
.long 0xf, 0x0, 0x0, 0
.long 0xf, 0x0, 0x0, 0
.long 0xf, 0x0, 0x0, 0
.long 0xf, 0x0, 0x0, 0
.long 0xf, 0x0, 0x0, 0
.long 0xf, 0x0, 0x0, 0
.long 0xf, 0x0, 0x0, 0
.long 0xf, 0x0, 0x0, 0
.long 0xf, 0x0, 0x0, 0
.long 0xf, 0x0, 0x0, 0
.long 0xf, 0x0, 0x0, 0
.long 0xf, 0x0, 0x0, 0
.long 0xf, 0x0, 0x0, 0
.long 0xf, 0x0, 0x0, 0
.long 0xf, 0x0, 0x0, 0
.long 0xf, 0x0, 0x0, 0
.long 0xf, 0x0, 0x0, 0
.long 0xf, 0x0, 0x0, 0
.long 0xf, 0x0, 0x0, 0
.long 0xf, 0x0, 0x0, 0
.long 0xf, 0x0, 0x0, 0
.long 0xf, 0x0, 0x0, 0
.long 0xf, 0x0, 0x0, 0
.long 0xf, 0x0, 0x0, 0
.long 0xf, 0x0, 0x0, 0
.long 0xf, 0x0, 0x0, 0
.long 0xf, 0x0, 0x0, 0
.long 0xf, 0x0, 0x0, 0
.long 0xf, 0x0, 0x0, 0
.long 0xf, 0x0, 0x0, 0
.long 0xf, 0x0, 0x0, 0
.long 0xf, 0x0, 0x0, 0
.long 0xf, 0x0, 0x0, 0
.long 0xf, 0x0, 0x0, 0
.long 0xf, 0x0, 0x0, 0
.long 0xf, 0x0, 0x0, 0
.long 0xf, 0x0, 0x0, 0
.long 0xf, 0x0, 0x0, 0
.long 0xf, 0x0, 0x0, 0
.long 0xf, 0x0, 0x0, 0
.long 0xf, 0x0, 0x0, 0
.long 0xf, 0x0, 0x0, 0
.long 0xf, 0x0, 0x0, 0
.long 0xf, 0x0, 0x0, 0
.long 0xf, 0x0, 0x0, 0
.long 0xf, 0x0, 0x0, 0
.long 0xf, 0x0, 0x0, 0
.long 0xf, 0x0, 0x0, 0
.long 0xf, 0x0, 0x0, 0
.long 0xf, 0x0, 0x0, 0
.long 0xf, 0x0, 0x0, 0
.long 0xf, 0x0, 0x0, 0
.long 0xf, 0x0, 0x0, 0
.long 0xf, 0x0, 0x0, 0
.long 0xf, 0x0, 0x0, 0
.long 0xf, 0x0, 0x0, 0
.long 0xf, 0x0, 0x0, 0
.long 0xf, 0x0, 0x0, 0
.long 0xf, 0x0, 0x0, 0
.long 0xf, 0x0, 0x0, 0
.long 0xf, 0x0, 0x0, 0
.long 0xf, 0x0, 0x0, 0
.long 0xf, 0x0, 0x0, 0
.long 0xf, 0x0, 0x0, 0
.long 0xf, 0x0, 0x0, 0
.long 0xf, 0x0, 0x0, 0
.long 0xf, 0x0, 0x0, 0
.long 0xf, 0x0, 0x0, 0
.long 0xf, 0x0, 0x0, 0
.long 0xf, 0x0, 0x0, 0
.long 0xf, 0x0, 0x0, 0
.long 0xf, 0x0, 0x0, 0
.long 0xf, 0x0, 0x0, 0
.long 0xf, 0x0, 0x0, 0
.long 0xf, 0x0, 0x0, 0
.long 0xf, 0x0, 0x0, 0
.long 0xf, 0x0, 0x0, 0
.long 0xf, 0x0, 0x0, 0
.long 0xf, 0x0, 0x0, 0
.long 0xf, 0x0, 0x0, 0
.long 0xf, 0x0, 0x0, 0
.long 0xf, 0x0, 0x0, 0
.long 0xf, 0x0, 0x0, 0
.long 0xf, 0x0, 0x0, 0
.long 0xf, 0x0, 0x0, 0
.long 0xf, 0x0, 0x0, 0
.long 0xf, 0x0, 0x0, 0
.long 0xf, 0x0, 0x0, 0
.long 0xf, 0x0, 0x0, 0
.long 0xf, 0x0, 0x0, 0
.long 0xf, 0x0, 0x0, 0
.long 0xf, 0x0, 0x0, 0
.long 0xf, 0x0, 0x0, 0
.long 0xf, 0x0, 0x0, 0
.long 0xf, 0x0, 0x0, 0
.long 0xf, 0x0, 0x0, 0
.long 0xf, 0x0, 0x0, 0
.long 0xf, 0x0, 0x0, 0
.long 0xf, 0x0, 0x0, 0
.long 0xf, 0x0, 0x0, 0
.long 0xf, 0x0, 0x0, 0
.long 0xf, 0x0, 0x0, 0
.long 0xf, 0x0, 0x0, 0
.long 0xf, 0x0, 0x0, 0
.long 0xf, 0x0, 0x0, 0
.long 0xf, 0x0, 0x0, 0
.long 0xf, 0x0, 0x0, 0
.long 0xf, 0x0, 0x0, 0
.long 0xf, 0x0, 0x0, 0
.long 0xf, 0x0, 0x0, 0
.long 0xf, 0x0, 0x0, 0
.long 0xf, 0x0, 0x0, 0
.long 0xf, 0x0, 0x0, 0
.long 0xf, 0x0, 0x0, 0
.long 0xf, 0x0, 0x0, 0
.long 0xf, 0x0, 0x0, 0
.long 0xf, 0x0, 0x0, 0
.long 0xf, 0x0, 0x0, 0
.long 0xf, 0x0, 0x0, 0
.long 0x1047, 0x0, 0x10, 0
.long 0x1047, 0x10000, 0x10, 0
.long 0x1047, 0x20000, 0x10, 0
.long 0x1047, 0x30000, 0x10, 0
.long 0x1047, 0x40000, 0x10, 0
.long 0x1047, 0x50000, 0x10, 0
.long 0x1047, 0x60000, 0x10, 0
.long 0x1047, 0x70000, 0x10, 0
.long 0x20000, 0xff, 0x0, 1
.long 0x40000, 0xff, 0x0, 1
.long 0x0, 0xff, 0x0, 1
.long 0x21000, 0xff, 0x0, 1
.long 0x41000, 0xff, 0x0, 1
.long 0x1000, 0xff, 0x0, 1
.long 0x22000, 0x1000ff, 0x0, 1
.long 0x42000, 0x1000ff, 0x0, 1
.long 0x2000, 0x1000ff, 0x0, 1
.long 0x23000, 0x1000ff, 0x0, 1
.long 0x43000, 0x1000ff, 0x0, 1
.long 0x3000, 0x1000ff, 0x0, 1
.long 0x24000, 0x2000ff, 0x0, 1
.long 0x44000, 0x2000ff, 0x0, 1
.long 0x4000, 0x2000ff, 0x0, 1
.long 0x25000, 0x2000ff, 0x0, 1
.long 0x45000, 0x2000ff, 0x0, 1
.long 0x5000, 0x2000ff, 0x0, 1
.long 0x26000, 0x3000ff, 0x0, 1
.long 0x46000, 0x3000ff, 0x0, 1
.long 0x6000, 0x3000ff, 0x0, 1
.long 0x27000, 0x3000ff, 0x0, 1
.long 0x47000, 0x3000ff, 0x0, 1
.long 0x7000, 0x3000ff, 0x0, 1
.long 0x7, 0x180, 0x40, 0
.long 0x7, 0x580, 0x40, 0
.long 0x17, 0x180, 0x40, 0
.long 0x17, 0x580, 0x40, 0
.long 0x27, 0x180, 0x40, 0
.long 0x27, 0x580, 0x40, 0
.long 0x10011, 0x20000ff, 0x2000, 1
.long 0x20011, 0x20000ff, 0x2020, 1
.long 0x11, 0x20000ff, 0x2040, 1
.long 0x11011, 0x21000ff, 0x2060, 1
.long 0x21011, 0x21000ff, 0x2080, 1
.long 0x1011, 0x21000ff, 0x20a0, 1
.long 0x12011, 0x22000ff, 0x20c0, 1
.long 0x22011, 0x22000ff, 0x20e0, 1
.long 0x20010, 0x10000ff, 0x0, 1
.long 0x40010, 0x10000ff, 0x0, 1
.long 0x10, 0x10000ff, 0x0, 1
.long 0x21010, 0x10000ff, 0x0, 1
.long 0x41010, 0x10000ff, 0x0, 1
.long 0x1010, 0x10000ff, 0x0, 1
.long 0x22010, 0x11000ff, 0x0, 1
.long 0x42010, 0x11000ff, 0x0, 1
.long 0x2010, 0x11000ff, 0x0, 1
.long 0x23010, 0x11000ff, 0x0, 1
.long 0x43010, 0x11000ff, 0x0, 1
.long 0x3010, 0x11000ff, 0x0, 1
.long 0x24010, 0x12000ff, 0x0, 1
.long 0x44010, 0x12000ff, 0x0, 1
.long 0x4010, 0x12000ff, 0x0, 1
.long 0x25010, 0x12000ff, 0x0, 1
.long 0x45010, 0x12000ff, 0x0, 1
.long 0x5010, 0x12000ff, 0x0, 1
.long 0x26010, 0x13000ff, 0x0, 1
.long 0x46010, 0x13000ff, 0x0, 1
.long 0x6010, 0x13000ff, 0x0, 1
.long 0x27010, 0x13000ff, 0x0, 1
.long 0x47010, 0x13000ff, 0x0, 1
.long 0x7010, 0x13000ff, 0x0, 1
.long 0x10021, 0x30000ff, 0x80001500, 1
.long 0x10031, 0x40000ff, 0x80801500, 0
.long 0x20021, 0x30000ff, 0x80001515, 1
.long 0x20031, 0x40000ff, 0x80801515, 0
.long 0x21, 0x30000ff, 0x8000162a, 1
.long 0x31, 0x40000ff, 0x8080162a, 0
.long 0x11021, 0x31000ff, 0x80001540, 1
.long 0x11031, 0x41000ff, 0x80801540, 0
.long 0x21021, 0x31000ff, 0x80001555, 1
.long 0x21031, 0x41000ff, 0x80801555, 0
.long 0x1021, 0x31000ff, 0x8000166a, 1
.long 0x1031, 0x41000ff, 0x8080166a, 0
.long 0x12021, 0x32000ff, 0x80001580, 1
.long 0x12031, 0x42000ff, 0x80801580, 0
.long 0x22021, 0x32000ff, 0x80001595, 1
.long 0x22031, 0x42000ff, 0x80801595, 0
.long 0x2021, 0x32000ff, 0x800016aa, 1
.long 0x2031, 0x42000ff, 0x808016aa, 0
.long 0x13021, 0x33000ff, 0x800015c0, 1
.long 0x13031, 0x43000ff, 0x808015c0, 0
.long 0x23021, 0x33000ff, 0x800015d5, 1
.long 0x23031, 0x43000ff, 0x808015d5, 0
.long 0x3021, 0x33000ff, 0x800016ea, 1
.long 0x3031, 0x43000ff, 0x808016ea, 0
.long 0x10041, 0x50000ff, 0x2000, 0
.long 0x20041, 0x50000ff, 0x2020, 0
.long 0x41, 0x50000ff, 0x2040, 0
.long 0x11041, 0x51000ff, 0x2060, 0
.long 0x21041, 0x51000ff, 0x2080, 0
.long 0x1041, 0x51000ff, 0x20a0, 0
.long 0x12041, 0x52000ff, 0x20c0, 0
.long 0x22041, 0x52000ff, 0x20e0, 0
.long 0x4002, 0x90000ff, 0x20005500, 1
.long 0x4012, 0x90000ff, 0x20205500, 1
.long 0x4022, 0x90000ff, 0x20405500, 1
.long 0x4032, 0x90000ff, 0x20605500, 1
.long 0x4042, 0x90000ff, 0x20805500, 1
.long 0x4052, 0x90000ff, 0x20a05500, 1
.long 0x4062, 0x90000ff, 0x20c05500, 1
.long 0x4072, 0x90000ff, 0x20e05500, 1
.long 0x8002, 0x90000ff, 0x20005555, 1
.long 0x8012, 0x90000ff, 0x20205555, 1
.long 0x8022, 0x90000ff, 0x20405555, 1
.long 0x8032, 0x90000ff, 0x20605555, 1
.long 0x8042, 0x90000ff, 0x20805555, 1
.long 0x8052, 0x90000ff, 0x20a05555, 1
.long 0x8062, 0x90000ff, 0x20c05555, 1
.long 0x8072, 0x90000ff, 0x20e05555, 1
.long 0x2, 0x90000ff, 0x200056aa, 1
.long 0x12, 0x90000ff, 0x202056aa, 1
.long 0x22, 0x90000ff, 0x204056aa, 1
.long 0x32, 0x90000ff, 0x206056aa, 1
.long 0x42, 0x90000ff, 0x208056aa, 1
.long 0x52, 0x90000ff, 0x20a056aa, 1
.long 0x62, 0x90000ff, 0x20c056aa, 1
.long 0x72, 0x90000ff, 0x20e056aa, 1
.long 0x10071, 0x80000ff, 0x2000, 0
.long 0x20071, 0x80000ff, 0x2020, 0
.long 0x71, 0x80000ff, 0x2040, 0
.long 0x11071, 0x81000ff, 0x2060, 0
.long 0x21071, 0x81000ff, 0x2080, 0
.long 0x1071, 0x81000ff, 0x20a0, 0
.long 0x12071, 0x82000ff, 0x20c0, 0
.long 0x22071, 0x82000ff, 0x20e0, 0
.long 0x10051, 0x60000ff, 0x80001500, 0
.long 0x10061, 0x70000ff, 0x80801500, 0
.long 0x20051, 0x60000ff, 0x80001515, 0
.long 0x20061, 0x70000ff, 0x80801515, 0
.long 0x51, 0x60000ff, 0x8000162a, 0
.long 0x61, 0x70000ff, 0x8080162a, 0
.long 0x11051, 0x61000ff, 0x80001540, 0
.long 0x11061, 0x71000ff, 0x80801540, 0
.long 0x21051, 0x61000ff, 0x80001555, 0
.long 0x21061, 0x71000ff, 0x80801555, 0
.long 0x1051, 0x61000ff, 0x8000166a, 0
.long 0x1061, 0x71000ff, 0x8080166a, 0
.long 0x12051, 0x62000ff, 0x80001580, 0
.long 0x12061, 0x72000ff, 0x80801580, 0
.long 0x22051, 0x62000ff, 0x80001595, 0
.long 0x22061, 0x72000ff, 0x80801595, 0
.long 0x2051, 0x62000ff, 0x800016aa, 0
.long 0x2061, 0x72000ff, 0x808016aa, 0
.long 0x13051, 0x63000ff, 0x800015c0, 0
.long 0x13061, 0x73000ff, 0x808015c0, 0
.long 0x23051, 0x63000ff, 0x800015d5, 0
.long 0x23061, 0x73000ff, 0x808015d5, 0
.long 0x3051, 0x63000ff, 0x800016ea, 0
.long 0x3061, 0x73000ff, 0x808016ea, 0
.long 0x5, 0xff1009d, 0x0, 0
.long 0x1005, 0xff1009d, 0x0, 0
.long 0x2005, 0xff1009d, 0x0, 0
.long 0x3005, 0xff1009d, 0x0, 0
.long 0x4005, 0xff1009d, 0x0, 0
.long 0x5005, 0xff1009d, 0x0, 0
.long 0x6005, 0xff1009d, 0x0, 0
.long 0x7005, 0xff1009d, 0x0, 0
.long 0x3, 0xff01890, 0x0, 0
.long 0x3, 0xff01890, 0x0, 0
.long 0x3, 0xff01890, 0x0, 0
.long 0x3, 0xff01890, 0x0, 0
.long 0x3, 0xff01890, 0x0, 0
.long 0x3, 0xff01890, 0x0, 0
.long 0x3, 0xff01890, 0x0, 0
.long 0x3, 0xff01890, 0x0, 0
.long 0x1003, 0xff01890, 0x0, 0
.long 0x1003, 0xff01890, 0x0, 0
.long 0x1003, 0xff01890, 0x0, 0
.long 0x1003, 0xff01890, 0x0, 0
.long 0x1003, 0xff01890, 0x0, 0
.long 0x1003, 0xff01890, 0x0, 0
.long 0x1003, 0xff01890, 0x0, 0
.long 0x1003, 0xff01890, 0x0, 0
.long 0x2071, 0x82000ff, 0x4000, 0
.long 0x13071, 0x83000ff, 0x4040, 0
.long 0x23071, 0x83000ff, 0x4080, 0
.long 0x3071, 0x83000ff, 0x40c0, 0
.long 0x2003, 0xff01890, 0x0, 0
.long 0x2003, 0xff01890, 0x0, 0
.long 0x2003, 0xff01890, 0x0, 0
.long 0x2003, 0xff01890, 0x0, 0
.long 0x2003, 0xff01890, 0x0, 0
.long 0x2003, 0xff01890, 0x0, 0
.long 0x2003, 0xff01890, 0x0, 0
.long 0x2003, 0xff01890, 0x0, 0
.long 0x3003, 0xff01890, 0x0, 0
.long 0x3003, 0xff01890, 0x0, 0
.long 0x3003, 0xff01890, 0x0, 0
.long 0x3003, 0xff01890, 0x0, 0
.long 0x3003, 0xff01890, 0x0, 0
.long 0x3003, 0xff01890, 0x0, 0
.long 0x3003, 0xff01890, 0x0, 0
.long 0x3003, 0xff01890, 0x0, 0
.long 0x4003, 0xff01890, 0x0, 0
.long 0x4003, 0xff01890, 0x0, 0
.long 0x4003, 0xff01890, 0x0, 0
.long 0x4003, 0xff01890, 0x0, 0
.long 0x4003, 0xff01890, 0x0, 0
.long 0x4003, 0xff01890, 0x0, 0
.long 0x4003, 0xff01890, 0x0, 0
.long 0x4003, 0xff01890, 0x0, 0
.long 0x5003, 0xff01890, 0x0, 0
.long 0x5003, 0xff01890, 0x0, 0
.long 0x5003, 0xff01890, 0x0, 0
.long 0x5003, 0xff01890, 0x0, 0
.long 0x5003, 0xff01890, 0x0, 0
.long 0x5003, 0xff01890, 0x0, 0
.long 0x5003, 0xff01890, 0x0, 0
.long 0x5003, 0xff01890, 0x0, 0
.long 0x86, 0xff100a4, 0x0, 0
.long 0x1086, 0xff100a4, 0x0, 0
.long 0x2086, 0xff100a4, 0x0, 0
.long 0x3086, 0xff100a4, 0x0, 0
.long 0x4086, 0xff100a4, 0x0, 0
.long 0x5086, 0xff100a4, 0x0, 0
.long 0x6086, 0xff100a4, 0x0, 0
.long 0x7086, 0xff100a4, 0x0, 0
.long 0x4, 0xff02094, 0x0, 0
.long 0x1004, 0xff02094, 0x0, 0
.long 0x2004, 0xff02094, 0x0, 0
.long 0x3004, 0xff02094, 0x0, 0
.long 0x4004, 0xff02094, 0x0, 0
.long 0x5004, 0xff02094, 0x0, 0
.long 0x6004, 0xff02094, 0x0, 0
.long 0x7004, 0xff02094, 0x0, 0
.long 0x60008, 0xff000ff, 0x0, 0
.long 0x60018, 0xff000ff, 0x0, 0
.long 0x60028, 0xff000ff, 0x0, 0
.long 0x60038, 0xff000ff, 0x0, 0
.long 0x60048, 0xff000ff, 0x0, 0
.long 0x60058, 0xff000ff, 0x0, 0
.long 0x60068, 0xff000ff, 0x0, 0
.long 0x60078, 0xff000ff, 0x0, 0
.long 0x60088, 0xff000ff, 0x0, 0
.long 0x60098, 0xff000ff, 0x0, 0
.long 0x600a8, 0xff000ff, 0x0, 0
.long 0x600b8, 0xff000ff, 0x0, 0
.long 0x600c8, 0xff000ff, 0x0, 0
.long 0x600d8, 0xff000ff, 0x0, 0
.long 0x600e8, 0xff000ff, 0x0, 0
.long 0x600f8, 0xff000ff, 0x0, 0
.long 0x84, 0xff02098, 0x0, 0
.long 0x1084, 0xff02098, 0x0, 0
.long 0x2084, 0xff02098, 0x0, 0
.long 0x3084, 0xff02098, 0x0, 0
.long 0x4084, 0xff02098, 0x0, 0
.long 0x5084, 0xff02098, 0x0, 0
.long 0x6084, 0xff02098, 0x0, 0
.long 0x7084, 0xff02098, 0x0, 0
.long 0xf, 0x0, 0x0, 0
.long 0x1047, 0x0, 0x10, 0
.long 0x1047, 0x10000, 0x10, 0
.long 0x1047, 0x20000, 0x10, 0
.long 0x1047, 0x30000, 0x10, 0
.long 0x1047, 0x40000, 0x10, 0
.long 0x1047, 0x50000, 0x10, 0
.long 0x1047, 0x60000, 0x10, 0
.long 0x1047, 0x70000, 0x10, 0
.long 0x28000, 0x4000ff, 0x0, 1
.long 0x48000, 0x4000ff, 0x0, 1
.long 0x8000, 0x4000ff, 0x0, 1
.long 0x29000, 0x4000ff, 0x0, 1
.long 0x49000, 0x4000ff, 0x0, 1
.long 0x9000, 0x4000ff, 0x0, 1
.long 0x2a000, 0x5000ff, 0x0, 1
.long 0x4a000, 0x5000ff, 0x0, 1
.long 0xa000, 0x5000ff, 0x0, 1
.long 0x2b000, 0x5000ff, 0x0, 1
.long 0x4b000, 0x5000ff, 0x0, 1
.long 0xb000, 0x5000ff, 0x0, 1
.long 0x2c000, 0x6000ff, 0x0, 1
.long 0x4c000, 0x6000ff, 0x0, 1
.long 0xc000, 0x6000ff, 0x0, 1
.long 0x2d000, 0x6000ff, 0x0, 1
.long 0x4d000, 0x6000ff, 0x0, 1
.long 0xd000, 0x6000ff, 0x0, 1
.long 0x2e000, 0x7000ff, 0x0, 1
.long 0x4e000, 0x7000ff, 0x0, 1
.long 0xe000, 0x7000ff, 0x0, 1
.long 0x2f000, 0x7000ff, 0x0, 1
.long 0x4f000, 0x7000ff, 0x0, 1
.long 0xf000, 0x7000ff, 0x0, 1
.long 0x7, 0x980, 0x40, 0
.long 0x7, 0xd80, 0x40, 0
.long 0x17, 0x980, 0x40, 0
.long 0x17, 0xd80, 0x40, 0
.long 0x27, 0x980, 0x40, 0
.long 0x27, 0xd80, 0x40, 0
.long 0x14011, 0x24000ff, 0x2000, 1
.long 0x24011, 0x24000ff, 0x2020, 1
.long 0x4011, 0x24000ff, 0x2040, 1
.long 0x15011, 0x25000ff, 0x2060, 1
.long 0x25011, 0x25000ff, 0x2080, 1
.long 0x5011, 0x25000ff, 0x20a0, 1
.long 0x16011, 0x26000ff, 0x20c0, 1
.long 0x26011, 0x26000ff, 0x20e0, 1
.long 0x28010, 0x14000ff, 0x0, 1
.long 0x48010, 0x14000ff, 0x0, 1
.long 0x8010, 0x14000ff, 0x0, 1
.long 0x29010, 0x14000ff, 0x0, 1
.long 0x49010, 0x14000ff, 0x0, 1
.long 0x9010, 0x14000ff, 0x0, 1
.long 0x2a010, 0x15000ff, 0x0, 1
.long 0x4a010, 0x15000ff, 0x0, 1
.long 0xa010, 0x15000ff, 0x0, 1
.long 0x2b010, 0x15000ff, 0x0, 1
.long 0x4b010, 0x15000ff, 0x0, 1
.long 0xb010, 0x15000ff, 0x0, 1
.long 0x2c010, 0x16000ff, 0x0, 1
.long 0x4c010, 0x16000ff, 0x0, 1
.long 0xc010, 0x16000ff, 0x0, 1
.long 0x2d010, 0x16000ff, 0x0, 1
.long 0x4d010, 0x16000ff, 0x0, 1
.long 0xd010, 0x16000ff, 0x0, 1
.long 0x2e010, 0x17000ff, 0x0, 1
.long 0x4e010, 0x17000ff, 0x0, 1
.long 0xe010, 0x17000ff, 0x0, 1
.long 0x2f010, 0x17000ff, 0x0, 1
.long 0x4f010, 0x17000ff, 0x0, 1
.long 0xf010, 0x17000ff, 0x0, 1
.long 0x14021, 0x34000ff, 0x80001500, 1
.long 0x14031, 0x44000ff, 0x80801500, 0
.long 0x24021, 0x34000ff, 0x80001515, 1
.long 0x24031, 0x44000ff, 0x80801515, 0
.long 0x4021, 0x34000ff, 0x8000162a, 1
.long 0x4031, 0x44000ff, 0x8080162a, 0
.long 0x15021, 0x35000ff, 0x80001540, 1
.long 0x15031, 0x45000ff, 0x80801540, 0
.long 0x25021, 0x35000ff, 0x80001555, 1
.long 0x25031, 0x45000ff, 0x80801555, 0
.long 0x5021, 0x35000ff, 0x8000166a, 1
.long 0x5031, 0x45000ff, 0x8080166a, 0
.long 0x16021, 0x36000ff, 0x80001580, 1
.long 0x16031, 0x46000ff, 0x80801580, 0
.long 0x26021, 0x36000ff, 0x80001595, 1
.long 0x26031, 0x46000ff, 0x80801595, 0
.long 0x6021, 0x36000ff, 0x800016aa, 1
.long 0x6031, 0x46000ff, 0x808016aa, 0
.long 0x17021, 0x37000ff, 0x800015c0, 1
.long 0x17031, 0x47000ff, 0x808015c0, 0
.long 0x27021, 0x37000ff, 0x800015d5, 1
.long 0x27031, 0x47000ff, 0x808015d5, 0
.long 0x7021, 0x37000ff, 0x800016ea, 1
.long 0x7031, 0x47000ff, 0x808016ea, 0
.long 0x14041, 0x54000ff, 0x2000, 0
.long 0x24041, 0x54000ff, 0x2020, 0
.long 0x4041, 0x54000ff, 0x2040, 0
.long 0x15041, 0x55000ff, 0x2060, 0
.long 0x25041, 0x55000ff, 0x2080, 0
.long 0x5041, 0x55000ff, 0x20a0, 0
.long 0x16041, 0x56000ff, 0x20c0, 0
.long 0x26041, 0x56000ff, 0x20e0, 0
.long 0x5002, 0x91000ff, 0x20005500, 1
.long 0x5012, 0x91000ff, 0x20205500, 1
.long 0x5022, 0x91000ff, 0x20405500, 1
.long 0x5032, 0x91000ff, 0x20605500, 1
.long 0x5042, 0x91000ff, 0x20805500, 1
.long 0x5052, 0x91000ff, 0x20a05500, 1
.long 0x5062, 0x91000ff, 0x20c05500, 1
.long 0x5072, 0x91000ff, 0x20e05500, 1
.long 0x9002, 0x91000ff, 0x20005555, 1
.long 0x9012, 0x91000ff, 0x20205555, 1
.long 0x9022, 0x91000ff, 0x20405555, 1
.long 0x9032, 0x91000ff, 0x20605555, 1
.long 0x9042, 0x91000ff, 0x20805555, 1
.long 0x9052, 0x91000ff, 0x20a05555, 1
.long 0x9062, 0x91000ff, 0x20c05555, 1
.long 0x9072, 0x91000ff, 0x20e05555, 1
.long 0x1002, 0x91000ff, 0x200056aa, 1
.long 0x1012, 0x91000ff, 0x202056aa, 1
.long 0x1022, 0x91000ff, 0x204056aa, 1
.long 0x1032, 0x91000ff, 0x206056aa, 1
.long 0x1042, 0x91000ff, 0x208056aa, 1
.long 0x1052, 0x91000ff, 0x20a056aa, 1
.long 0x1062, 0x91000ff, 0x20c056aa, 1
.long 0x1072, 0x91000ff, 0x20e056aa, 1
.long 0x14071, 0x84000ff, 0x2000, 0
.long 0x24071, 0x84000ff, 0x2020, 0
.long 0x4071, 0x84000ff, 0x2040, 0
.long 0x15071, 0x85000ff, 0x2060, 0
.long 0x25071, 0x85000ff, 0x2080, 0
.long 0x5071, 0x85000ff, 0x20a0, 0
.long 0x16071, 0x86000ff, 0x20c0, 0
.long 0x26071, 0x86000ff, 0x20e0, 0
.long 0x14051, 0x64000ff, 0x80001500, 0
.long 0x14061, 0x74000ff, 0x80801500, 0
.long 0x24051, 0x64000ff, 0x80001515, 0
.long 0x24061, 0x74000ff, 0x80801515, 0
.long 0x4051, 0x64000ff, 0x8000162a, 0
.long 0x4061, 0x74000ff, 0x8080162a, 0
.long 0x15051, 0x65000ff, 0x80001540, 0
.long 0x15061, 0x75000ff, 0x80801540, 0
.long 0x25051, 0x65000ff, 0x80001555, 0
.long 0x25061, 0x75000ff, 0x80801555, 0
.long 0x5051, 0x65000ff, 0x8000166a, 0
.long 0x5061, 0x75000ff, 0x8080166a, 0
.long 0x16051, 0x66000ff, 0x80001580, 0
.long 0x16061, 0x76000ff, 0x80801580, 0
.long 0x26051, 0x66000ff, 0x80001595, 0
.long 0x26061, 0x76000ff, 0x80801595, 0
.long 0x6051, 0x66000ff, 0x800016aa, 0
.long 0x6061, 0x76000ff, 0x808016aa, 0
.long 0x17051, 0x67000ff, 0x800015c0, 0
.long 0x17061, 0x77000ff, 0x808015c0, 0
.long 0x27051, 0x67000ff, 0x800015d5, 0
.long 0x27061, 0x77000ff, 0x808015d5, 0
.long 0x7051, 0x67000ff, 0x800016ea, 0
.long 0x7061, 0x77000ff, 0x808016ea, 0
.long 0x25, 0xff1009f, 0x0, 0
.long 0x1025, 0xff1009f, 0x0, 0
.long 0x2025, 0xff1009f, 0x0, 0
.long 0x3025, 0xff1009f, 0x0, 0
.long 0x4025, 0xff1009f, 0x0, 0
.long 0x5025, 0xff1009f, 0x0, 0
.long 0x6025, 0xff1009f, 0x0, 0
.long 0x7025, 0xff1009f, 0x0, 0
.long 0x13, 0xff01891, 0x0, 0
.long 0x13, 0xff01891, 0x0, 0
.long 0x13, 0xff01891, 0x0, 0
.long 0x13, 0xff01891, 0x0, 0
.long 0x13, 0xff01891, 0x0, 0
.long 0x13, 0xff01891, 0x0, 0
.long 0x13, 0xff01891, 0x0, 0
.long 0x13, 0xff01891, 0x0, 0
.long 0x1013, 0xff01891, 0x0, 0
.long 0x1013, 0xff01891, 0x0, 0
.long 0x1013, 0xff01891, 0x0, 0
.long 0x1013, 0xff01891, 0x0, 0
.long 0x1013, 0xff01891, 0x0, 0
.long 0x1013, 0xff01891, 0x0, 0
.long 0x1013, 0xff01891, 0x0, 0
.long 0x1013, 0xff01891, 0x0, 0
.long 0x6071, 0x86000ff, 0x4000, 0
.long 0x17071, 0x87000ff, 0x4040, 0
.long 0x27071, 0x87000ff, 0x4080, 0
.long 0x7071, 0x87000ff, 0x40c0, 0
.long 0x2013, 0xff01891, 0x0, 0
.long 0x2013, 0xff01891, 0x0, 0
.long 0x2013, 0xff01891, 0x0, 0
.long 0x2013, 0xff01891, 0x0, 0
.long 0x2013, 0xff01891, 0x0, 0
.long 0x2013, 0xff01891, 0x0, 0
.long 0x2013, 0xff01891, 0x0, 0
.long 0x2013, 0xff01891, 0x0, 0
.long 0x3013, 0xff01891, 0x0, 0
.long 0x3013, 0xff01891, 0x0, 0
.long 0x3013, 0xff01891, 0x0, 0
.long 0x3013, 0xff01891, 0x0, 0
.long 0x3013, 0xff01891, 0x0, 0
.long 0x3013, 0xff01891, 0x0, 0
.long 0x3013, 0xff01891, 0x0, 0
.long 0x3013, 0xff01891, 0x0, 0
.long 0x4013, 0xff01891, 0x0, 0
.long 0x4013, 0xff01891, 0x0, 0
.long 0x4013, 0xff01891, 0x0, 0
.long 0x4013, 0xff01891, 0x0, 0
.long 0x4013, 0xff01891, 0x0, 0
.long 0x4013, 0xff01891, 0x0, 0
.long 0x4013, 0xff01891, 0x0, 0
.long 0x4013, 0xff01891, 0x0, 0
.long 0x5013, 0xff01891, 0x0, 0
.long 0x5013, 0xff01891, 0x0, 0
.long 0x5013, 0xff01891, 0x0, 0
.long 0x5013, 0xff01891, 0x0, 0
.long 0x5013, 0xff01891, 0x0, 0
.long 0x5013, 0xff01891, 0x0, 0
.long 0x5013, 0xff01891, 0x0, 0
.long 0x5013, 0xff01891, 0x0, 0
.long 0x96, 0xff100a5, 0x0, 0
.long 0x1096, 0xff100a5, 0x0, 0
.long 0x2096, 0xff100a5, 0x0, 0
.long 0x3096, 0xff100a5, 0x0, 0
.long 0x4096, 0xff100a5, 0x0, 0
.long 0x5096, 0xff100a5, 0x0, 0
.long 0x6096, 0xff100a5, 0x0, 0
.long 0x7096, 0xff100a5, 0x0, 0
.long 0x24, 0xff02095, 0x0, 0
.long 0x1024, 0xff02095, 0x0, 0
.long 0x2024, 0xff02095, 0x0, 0
.long 0x3024, 0xff02095, 0x0, 0
.long 0x4024, 0xff02095, 0x0, 0
.long 0x5024, 0xff02095, 0x0, 0
.long 0x6024, 0xff02095, 0x0, 0
.long 0x7024, 0xff02095, 0x0, 0
.long 0x61008, 0xff000ff, 0x0, 0
.long 0x61018, 0xff000ff, 0x0, 0
.long 0x61028, 0xff000ff, 0x0, 0
.long 0x61038, 0xff000ff, 0x0, 0
.long 0x61048, 0xff000ff, 0x0, 0
.long 0x61058, 0xff000ff, 0x0, 0
.long 0x61068, 0xff000ff, 0x0, 0
.long 0x61078, 0xff000ff, 0x0, 0
.long 0x61088, 0xff000ff, 0x0, 0
.long 0x61098, 0xff000ff, 0x0, 0
.long 0x610a8, 0xff000ff, 0x0, 0
.long 0x610b8, 0xff000ff, 0x0, 0
.long 0x610c8, 0xff000ff, 0x0, 0
.long 0x610d8, 0xff000ff, 0x0, 0
.long 0x610e8, 0xff000ff, 0x0, 0
.long 0x610f8, 0xff000ff, 0x0, 0
.long 0xa4, 0xff02099, 0x0, 0
.long 0x10a4, 0xff02099, 0x0, 0
.long 0x20a4, 0xff02099, 0x0, 0
.long 0x30a4, 0xff02099, 0x0, 0
.long 0x40a4, 0xff02099, 0x0, 0
.long 0x50a4, 0xff02099, 0x0, 0
.long 0x60a4, 0xff02099, 0x0, 0
.long 0x70a4, 0xff02099, 0x0, 0
.long 0xf, 0x0, 0x0, 0
.long 0x1047, 0x0, 0x10, 0
.long 0x1047, 0x10000, 0x10, 0
.long 0x1047, 0x20000, 0x10, 0
.long 0x1047, 0x30000, 0x10, 0
.long 0x1047, 0x40000, 0x10, 0
.long 0x1047, 0x50000, 0x10, 0
.long 0x1047, 0x60000, 0x10, 0
.long 0x1047, 0x70000, 0x10, 0
.long 0x30000, 0x8000ff, 0x0, 1
.long 0x50000, 0x8000ff, 0x0, 1
.long 0x10000, 0x8000ff, 0x0, 1
.long 0x31000, 0x8000ff, 0x0, 1
.long 0x51000, 0x8000ff, 0x0, 1
.long 0x11000, 0x8000ff, 0x0, 1
.long 0x32000, 0x9000ff, 0x0, 1
.long 0x52000, 0x9000ff, 0x0, 1
.long 0x12000, 0x9000ff, 0x0, 1
.long 0x33000, 0x9000ff, 0x0, 1
.long 0x53000, 0x9000ff, 0x0, 1
.long 0x13000, 0x9000ff, 0x0, 1
.long 0x34000, 0xa000ff, 0x0, 1
.long 0x54000, 0xa000ff, 0x0, 1
.long 0x14000, 0xa000ff, 0x0, 1
.long 0x35000, 0xa000ff, 0x0, 1
.long 0x55000, 0xa000ff, 0x0, 1
.long 0x15000, 0xa000ff, 0x0, 1
.long 0x36000, 0xb000ff, 0x0, 1
.long 0x56000, 0xb000ff, 0x0, 1
.long 0x16000, 0xb000ff, 0x0, 1
.long 0x37000, 0xb000ff, 0x0, 1
.long 0x57000, 0xb000ff, 0x0, 1
.long 0x17000, 0xb000ff, 0x0, 1
.long 0x7, 0x1180, 0x40, 0
.long 0x7, 0x1580, 0x40, 0
.long 0x17, 0x1180, 0x40, 0
.long 0x17, 0x1580, 0x40, 0
.long 0x27, 0x1180, 0x40, 0
.long 0x27, 0x1580, 0x40, 0
.long 0x18011, 0x28000ff, 0x2000, 1
.long 0x28011, 0x28000ff, 0x2020, 1
.long 0x8011, 0x28000ff, 0x2040, 1
.long 0x19011, 0x29000ff, 0x2060, 1
.long 0x29011, 0x29000ff, 0x2080, 1
.long 0x9011, 0x29000ff, 0x20a0, 1
.long 0x1a011, 0x2a000ff, 0x20c0, 1
.long 0x2a011, 0x2a000ff, 0x20e0, 1
.long 0x30010, 0x18000ff, 0x0, 1
.long 0x50010, 0x18000ff, 0x0, 1
.long 0x10010, 0x18000ff, 0x0, 1
.long 0x31010, 0x18000ff, 0x0, 1
.long 0x51010, 0x18000ff, 0x0, 1
.long 0x11010, 0x18000ff, 0x0, 1
.long 0x32010, 0x19000ff, 0x0, 1
.long 0x52010, 0x19000ff, 0x0, 1
.long 0x12010, 0x19000ff, 0x0, 1
.long 0x33010, 0x19000ff, 0x0, 1
.long 0x53010, 0x19000ff, 0x0, 1
.long 0x13010, 0x19000ff, 0x0, 1
.long 0x34010, 0x1a000ff, 0x0, 1
.long 0x54010, 0x1a000ff, 0x0, 1
.long 0x14010, 0x1a000ff, 0x0, 1
.long 0x35010, 0x1a000ff, 0x0, 1
.long 0x55010, 0x1a000ff, 0x0, 1
.long 0x15010, 0x1a000ff, 0x0, 1
.long 0x36010, 0x1b000ff, 0x0, 1
.long 0x56010, 0x1b000ff, 0x0, 1
.long 0x16010, 0x1b000ff, 0x0, 1
.long 0x37010, 0x1b000ff, 0x0, 1
.long 0x57010, 0x1b000ff, 0x0, 1
.long 0x17010, 0x1b000ff, 0x0, 1
.long 0x18021, 0x38000ff, 0x80001500, 1
.long 0x18031, 0x48000ff, 0x80801500, 0
.long 0x28021, 0x38000ff, 0x80001515, 1
.long 0x28031, 0x48000ff, 0x80801515, 0
.long 0x8021, 0x38000ff, 0x8000162a, 1
.long 0x8031, 0x48000ff, 0x8080162a, 0
.long 0x19021, 0x39000ff, 0x80001540, 1
.long 0x19031, 0x49000ff, 0x80801540, 0
.long 0x29021, 0x39000ff, 0x80001555, 1
.long 0x29031, 0x49000ff, 0x80801555, 0
.long 0x9021, 0x39000ff, 0x8000166a, 1
.long 0x9031, 0x49000ff, 0x8080166a, 0
.long 0x1a021, 0x3a000ff, 0x80001580, 1
.long 0x1a031, 0x4a000ff, 0x80801580, 0
.long 0x2a021, 0x3a000ff, 0x80001595, 1
.long 0x2a031, 0x4a000ff, 0x80801595, 0
.long 0xa021, 0x3a000ff, 0x800016aa, 1
.long 0xa031, 0x4a000ff, 0x808016aa, 0
.long 0x1b021, 0x3b000ff, 0x800015c0, 1
.long 0x1b031, 0x4b000ff, 0x808015c0, 0
.long 0x2b021, 0x3b000ff, 0x800015d5, 1
.long 0x2b031, 0x4b000ff, 0x808015d5, 0
.long 0xb021, 0x3b000ff, 0x800016ea, 1
.long 0xb031, 0x4b000ff, 0x808016ea, 0
.long 0x18041, 0x58000ff, 0x2000, 0
.long 0x28041, 0x58000ff, 0x2020, 0
.long 0x8041, 0x58000ff, 0x2040, 0
.long 0x19041, 0x59000ff, 0x2060, 0
.long 0x29041, 0x59000ff, 0x2080, 0
.long 0x9041, 0x59000ff, 0x20a0, 0
.long 0x1a041, 0x5a000ff, 0x20c0, 0
.long 0x2a041, 0x5a000ff, 0x20e0, 0
.long 0x6002, 0x92000ff, 0x20005500, 1
.long 0x6012, 0x92000ff, 0x20205500, 1
.long 0x6022, 0x92000ff, 0x20405500, 1
.long 0x6032, 0x92000ff, 0x20605500, 1
.long 0x6042, 0x92000ff, 0x20805500, 1
.long 0x6052, 0x92000ff, 0x20a05500, 1
.long 0x6062, 0x92000ff, 0x20c05500, 1
.long 0x6072, 0x92000ff, 0x20e05500, 1
.long 0xa002, 0x92000ff, 0x20005555, 1
.long 0xa012, 0x92000ff, 0x20205555, 1
.long 0xa022, 0x92000ff, 0x20405555, 1
.long 0xa032, 0x92000ff, 0x20605555, 1
.long 0xa042, 0x92000ff, 0x20805555, 1
.long 0xa052, 0x92000ff, 0x20a05555, 1
.long 0xa062, 0x92000ff, 0x20c05555, 1
.long 0xa072, 0x92000ff, 0x20e05555, 1
.long 0x2002, 0x92000ff, 0x200056aa, 1
.long 0x2012, 0x92000ff, 0x202056aa, 1
.long 0x2022, 0x92000ff, 0x204056aa, 1
.long 0x2032, 0x92000ff, 0x206056aa, 1
.long 0x2042, 0x92000ff, 0x208056aa, 1
.long 0x2052, 0x92000ff, 0x20a056aa, 1
.long 0x2062, 0x92000ff, 0x20c056aa, 1
.long 0x2072, 0x92000ff, 0x20e056aa, 1
.long 0x18071, 0x88000ff, 0x2000, 0
.long 0x28071, 0x88000ff, 0x2020, 0
.long 0x8071, 0x88000ff, 0x2040, 0
.long 0x19071, 0x89000ff, 0x2060, 0
.long 0x29071, 0x89000ff, 0x2080, 0
.long 0x9071, 0x89000ff, 0x20a0, 0
.long 0x1a071, 0x8a000ff, 0x20c0, 0
.long 0x2a071, 0x8a000ff, 0x20e0, 0
.long 0x18051, 0x68000ff, 0x80001500, 0
.long 0x18061, 0x78000ff, 0x80801500, 0
.long 0x28051, 0x68000ff, 0x80001515, 0
.long 0x28061, 0x78000ff, 0x80801515, 0
.long 0x8051, 0x68000ff, 0x8000162a, 0
.long 0x8061, 0x78000ff, 0x8080162a, 0
.long 0x19051, 0x69000ff, 0x80001540, 0
.long 0x19061, 0x79000ff, 0x80801540, 0
.long 0x29051, 0x69000ff, 0x80001555, 0
.long 0x29061, 0x79000ff, 0x80801555, 0
.long 0x9051, 0x69000ff, 0x8000166a, 0
.long 0x9061, 0x79000ff, 0x8080166a, 0
.long 0x1a051, 0x6a000ff, 0x80001580, 0
.long 0x1a061, 0x7a000ff, 0x80801580, 0
.long 0x2a051, 0x6a000ff, 0x80001595, 0
.long 0x2a061, 0x7a000ff, 0x80801595, 0
.long 0xa051, 0x6a000ff, 0x800016aa, 0
.long 0xa061, 0x7a000ff, 0x808016aa, 0
.long 0x1b051, 0x6b000ff, 0x800015c0, 0
.long 0x1b061, 0x7b000ff, 0x808015c0, 0
.long 0x2b051, 0x6b000ff, 0x800015d5, 0
.long 0x2b061, 0x7b000ff, 0x808015d5, 0
.long 0xb051, 0x6b000ff, 0x800016ea, 0
.long 0xb061, 0x7b000ff, 0x808016ea, 0
.long 0x23, 0xff01892, 0x0, 0
.long 0x23, 0xff01892, 0x0, 0
.long 0x23, 0xff01892, 0x0, 0
.long 0x23, 0xff01892, 0x0, 0
.long 0x23, 0xff01892, 0x0, 0
.long 0x23, 0xff01892, 0x0, 0
.long 0x23, 0xff01892, 0x0, 0
.long 0x23, 0xff01892, 0x0, 0
.long 0x45, 0xff100a1, 0x0, 0
.long 0x1045, 0xff100a1, 0x0, 0
.long 0x2045, 0xff100a1, 0x0, 0
.long 0x3045, 0xff100a1, 0x0, 0
.long 0x4045, 0xff100a1, 0x0, 0
.long 0x5045, 0xff100a1, 0x0, 0
.long 0x6045, 0xff100a1, 0x0, 0
.long 0x7045, 0xff100a1, 0x0, 0
.long 0x1023, 0xff01892, 0x0, 0
.long 0x1023, 0xff01892, 0x0, 0
.long 0x1023, 0xff01892, 0x0, 0
.long 0x1023, 0xff01892, 0x0, 0
.long 0x1023, 0xff01892, 0x0, 0
.long 0x1023, 0xff01892, 0x0, 0
.long 0x1023, 0xff01892, 0x0, 0
.long 0x1023, 0xff01892, 0x0, 0
.long 0xa071, 0x8a000ff, 0x4000, 0
.long 0x1b071, 0x8b000ff, 0x4040, 0
.long 0x2b071, 0x8b000ff, 0x4080, 0
.long 0xb071, 0x8b000ff, 0x40c0, 0
.long 0x2023, 0xff01892, 0x0, 0
.long 0x2023, 0xff01892, 0x0, 0
.long 0x2023, 0xff01892, 0x0, 0
.long 0x2023, 0xff01892, 0x0, 0
.long 0x2023, 0xff01892, 0x0, 0
.long 0x2023, 0xff01892, 0x0, 0
.long 0x2023, 0xff01892, 0x0, 0
.long 0x2023, 0xff01892, 0x0, 0
.long 0x3023, 0xff01892, 0x0, 0
.long 0x3023, 0xff01892, 0x0, 0
.long 0x3023, 0xff01892, 0x0, 0
.long 0x3023, 0xff01892, 0x0, 0
.long 0x3023, 0xff01892, 0x0, 0
.long 0x3023, 0xff01892, 0x0, 0
.long 0x3023, 0xff01892, 0x0, 0
.long 0x3023, 0xff01892, 0x0, 0
.long 0x4023, 0xff01892, 0x0, 0
.long 0x4023, 0xff01892, 0x0, 0
.long 0x4023, 0xff01892, 0x0, 0
.long 0x4023, 0xff01892, 0x0, 0
.long 0x4023, 0xff01892, 0x0, 0
.long 0x4023, 0xff01892, 0x0, 0
.long 0x4023, 0xff01892, 0x0, 0
.long 0x4023, 0xff01892, 0x0, 0
.long 0x5023, 0xff01892, 0x0, 0
.long 0x5023, 0xff01892, 0x0, 0
.long 0x5023, 0xff01892, 0x0, 0
.long 0x5023, 0xff01892, 0x0, 0
.long 0x5023, 0xff01892, 0x0, 0
.long 0x5023, 0xff01892, 0x0, 0
.long 0x5023, 0xff01892, 0x0, 0
.long 0x5023, 0xff01892, 0x0, 0
.long 0x44, 0xff02096, 0x0, 0
.long 0x1044, 0xff02096, 0x0, 0
.long 0x2044, 0xff02096, 0x0, 0
.long 0x3044, 0xff02096, 0x0, 0
.long 0x4044, 0xff02096, 0x0, 0
.long 0x5044, 0xff02096, 0x0, 0
.long 0x6044, 0xff02096, 0x0, 0
.long 0x7044, 0xff02096, 0x0, 0
.long 0xa6, 0xff040ab, 0x0, 0
.long 0x10a6, 0xff040ab, 0x0, 0
.long 0x20a6, 0xff040ab, 0x0, 0
.long 0x30a6, 0xff040ab, 0x0, 0
.long 0x40a6, 0xff040ab, 0x0, 0
.long 0x50a6, 0xff040ab, 0x0, 0
.long 0x60a6, 0xff040ab, 0x0, 0
.long 0x70a6, 0xff040ab, 0x0, 0
.long 0x60108, 0xff000ff, 0x0, 0
.long 0x60118, 0xff000ff, 0x0, 0
.long 0x60128, 0xff000ff, 0x0, 0
.long 0x60138, 0xff000ff, 0x0, 0
.long 0x60148, 0xff000ff, 0x0, 0
.long 0x60158, 0xff000ff, 0x0, 0
.long 0x60168, 0xff000ff, 0x0, 0
.long 0x60178, 0xff000ff, 0x0, 0
.long 0x60188, 0xff000ff, 0x0, 0
.long 0x60198, 0xff000ff, 0x0, 0
.long 0x601a8, 0xff000ff, 0x0, 0
.long 0x601b8, 0xff000ff, 0x0, 0
.long 0x601c8, 0xff000ff, 0x0, 0
.long 0x601d8, 0xff000ff, 0x0, 0
.long 0x601e8, 0xff000ff, 0x0, 0
.long 0x601f8, 0xff000ff, 0x0, 0
.long 0xc4, 0xff0209a, 0x0, 0
.long 0x10c4, 0xff0209a, 0x0, 0
.long 0x20c4, 0xff0209a, 0x0, 0
.long 0x30c4, 0xff0209a, 0x0, 0
.long 0x40c4, 0xff0209a, 0x0, 0
.long 0x50c4, 0xff0209a, 0x0, 0
.long 0x60c4, 0xff0209a, 0x0, 0
.long 0x70c4, 0xff0209a, 0x0, 0
.long 0xf, 0x0, 0x0, 0
.long 0x1047, 0x0, 0x10, 0
.long 0x1047, 0x10000, 0x10, 0
.long 0x1047, 0x20000, 0x10, 0
.long 0x1047, 0x30000, 0x10, 0
.long 0x1047, 0x40000, 0x10, 0
.long 0x1047, 0x50000, 0x10, 0
.long 0x1047, 0x60000, 0x10, 0
.long 0x1047, 0x70000, 0x10, 0
.long 0x38000, 0xc000ff, 0x0, 1
.long 0x58000, 0xc000ff, 0x0, 1
.long 0x18000, 0xc000ff, 0x0, 1
.long 0x39000, 0xc000ff, 0x0, 1
.long 0x59000, 0xc000ff, 0x0, 1
.long 0x19000, 0xc000ff, 0x0, 1
.long 0x3a000, 0xd000ff, 0x0, 1
.long 0x5a000, 0xd000ff, 0x0, 1
.long 0x1a000, 0xd000ff, 0x0, 1
.long 0x3b000, 0xd000ff, 0x0, 1
.long 0x5b000, 0xd000ff, 0x0, 1
.long 0x1b000, 0xd000ff, 0x0, 1
.long 0x3c000, 0xe000ff, 0x0, 1
.long 0x5c000, 0xe000ff, 0x0, 1
.long 0x1c000, 0xe000ff, 0x0, 1
.long 0x3d000, 0xe000ff, 0x0, 1
.long 0x5d000, 0xe000ff, 0x0, 1
.long 0x1d000, 0xe000ff, 0x0, 1
.long 0x3e000, 0xf000ff, 0x0, 1
.long 0x5e000, 0xf000ff, 0x0, 1
.long 0x1e000, 0xf000ff, 0x0, 1
.long 0x3f000, 0xf000ff, 0x0, 1
.long 0x5f000, 0xf000ff, 0x0, 1
.long 0x1f000, 0xf000ff, 0x0, 1
.long 0x7, 0x1980, 0x40, 0
.long 0x7, 0x1d80, 0x40, 0
.long 0x17, 0x1980, 0x40, 0
.long 0x17, 0x1d80, 0x40, 0
.long 0x27, 0x1980, 0x40, 0
.long 0x27, 0x1d80, 0x40, 0
.long 0x1c011, 0x2c000ff, 0x2000, 1
.long 0x2c011, 0x2c000ff, 0x2020, 1
.long 0xc011, 0x2c000ff, 0x2040, 1
.long 0x1d011, 0x2d000ff, 0x2060, 1
.long 0x2d011, 0x2d000ff, 0x2080, 1
.long 0xd011, 0x2d000ff, 0x20a0, 1
.long 0x1e011, 0x2e000ff, 0x20c0, 1
.long 0x2e011, 0x2e000ff, 0x20e0, 1
.long 0x38010, 0x1c000ff, 0x0, 1
.long 0x58010, 0x1c000ff, 0x0, 1
.long 0x18010, 0x1c000ff, 0x0, 1
.long 0x39010, 0x1c000ff, 0x0, 1
.long 0x59010, 0x1c000ff, 0x0, 1
.long 0x19010, 0x1c000ff, 0x0, 1
.long 0x3a010, 0x1d000ff, 0x0, 1
.long 0x5a010, 0x1d000ff, 0x0, 1
.long 0x1a010, 0x1d000ff, 0x0, 1
.long 0x3b010, 0x1d000ff, 0x0, 1
.long 0x5b010, 0x1d000ff, 0x0, 1
.long 0x1b010, 0x1d000ff, 0x0, 1
.long 0x3c010, 0x1e000ff, 0x0, 1
.long 0x5c010, 0x1e000ff, 0x0, 1
.long 0x1c010, 0x1e000ff, 0x0, 1
.long 0x3d010, 0x1e000ff, 0x0, 1
.long 0x5d010, 0x1e000ff, 0x0, 1
.long 0x1d010, 0x1e000ff, 0x0, 1
.long 0x3e010, 0x1f000ff, 0x0, 1
.long 0x5e010, 0x1f000ff, 0x0, 1
.long 0x1e010, 0x1f000ff, 0x0, 1
.long 0x3f010, 0x1f000ff, 0x0, 1
.long 0x5f010, 0x1f000ff, 0x0, 1
.long 0x1f010, 0x1f000ff, 0x0, 1
.long 0x1c021, 0x3c000ff, 0x80001500, 1
.long 0x1c031, 0x4c000ff, 0x80801500, 0
.long 0x2c021, 0x3c000ff, 0x80001515, 1
.long 0x2c031, 0x4c000ff, 0x80801515, 0
.long 0xc021, 0x3c000ff, 0x8000162a, 1
.long 0xc031, 0x4c000ff, 0x8080162a, 0
.long 0x1d021, 0x3d000ff, 0x80001540, 1
.long 0x1d031, 0x4d000ff, 0x80801540, 0
.long 0x2d021, 0x3d000ff, 0x80001555, 1
.long 0x2d031, 0x4d000ff, 0x80801555, 0
.long 0xd021, 0x3d000ff, 0x8000166a, 1
.long 0xd031, 0x4d000ff, 0x8080166a, 0
.long 0x1e021, 0x3e000ff, 0x80001580, 1
.long 0x1e031, 0x4e000ff, 0x80801580, 0
.long 0x2e021, 0x3e000ff, 0x80001595, 1
.long 0x2e031, 0x4e000ff, 0x80801595, 0
.long 0xe021, 0x3e000ff, 0x800016aa, 1
.long 0xe031, 0x4e000ff, 0x808016aa, 0
.long 0x1f021, 0x3f000ff, 0x800015c0, 1
.long 0x1f031, 0x4f000ff, 0x808015c0, 0
.long 0x2f021, 0x3f000ff, 0x800015d5, 1
.long 0x2f031, 0x4f000ff, 0x808015d5, 0
.long 0xf021, 0x3f000ff, 0x800016ea, 1
.long 0xf031, 0x4f000ff, 0x808016ea, 0
.long 0x1c041, 0x5c000ff, 0x2000, 0
.long 0x2c041, 0x5c000ff, 0x2020, 0
.long 0xc041, 0x5c000ff, 0x2040, 0
.long 0x1d041, 0x5d000ff, 0x2060, 0
.long 0x2d041, 0x5d000ff, 0x2080, 0
.long 0xd041, 0x5d000ff, 0x20a0, 0
.long 0x1e041, 0x5e000ff, 0x20c0, 0
.long 0x2e041, 0x5e000ff, 0x20e0, 0
.long 0x7002, 0x93000ff, 0x20005500, 1
.long 0x7012, 0x93000ff, 0x20205500, 1
.long 0x7022, 0x93000ff, 0x20405500, 1
.long 0x7032, 0x93000ff, 0x20605500, 1
.long 0x7042, 0x93000ff, 0x20805500, 1
.long 0x7052, 0x93000ff, 0x20a05500, 1
.long 0x7062, 0x93000ff, 0x20c05500, 1
.long 0x7072, 0x93000ff, 0x20e05500, 1
.long 0xb002, 0x93000ff, 0x20005555, 1
.long 0xb012, 0x93000ff, 0x20205555, 1
.long 0xb022, 0x93000ff, 0x20405555, 1
.long 0xb032, 0x93000ff, 0x20605555, 1
.long 0xb042, 0x93000ff, 0x20805555, 1
.long 0xb052, 0x93000ff, 0x20a05555, 1
.long 0xb062, 0x93000ff, 0x20c05555, 1
.long 0xb072, 0x93000ff, 0x20e05555, 1
.long 0x3002, 0x93000ff, 0x200056aa, 1
.long 0x3012, 0x93000ff, 0x202056aa, 1
.long 0x3022, 0x93000ff, 0x204056aa, 1
.long 0x3032, 0x93000ff, 0x206056aa, 1
.long 0x3042, 0x93000ff, 0x208056aa, 1
.long 0x3052, 0x93000ff, 0x20a056aa, 1
.long 0x3062, 0x93000ff, 0x20c056aa, 1
.long 0x3072, 0x93000ff, 0x20e056aa, 1
.long 0x1c071, 0x8c000ff, 0x2000, 0
.long 0x2c071, 0x8c000ff, 0x2020, 0
.long 0xc071, 0x8c000ff, 0x2040, 0
.long 0x1d071, 0x8d000ff, 0x2060, 0
.long 0x2d071, 0x8d000ff, 0x2080, 0
.long 0xd071, 0x8d000ff, 0x20a0, 0
.long 0x1e071, 0x8e000ff, 0x20c0, 0
.long 0x2e071, 0x8e000ff, 0x20e0, 0
.long 0x1c051, 0x6c000ff, 0x80001500, 0
.long 0x1c061, 0x7c000ff, 0x80801500, 0
.long 0x2c051, 0x6c000ff, 0x80001515, 0
.long 0x2c061, 0x7c000ff, 0x80801515, 0
.long 0xc051, 0x6c000ff, 0x8000162a, 0
.long 0xc061, 0x7c000ff, 0x8080162a, 0
.long 0x1d051, 0x6d000ff, 0x80001540, 0
.long 0x1d061, 0x7d000ff, 0x80801540, 0
.long 0x2d051, 0x6d000ff, 0x80001555, 0
.long 0x2d061, 0x7d000ff, 0x80801555, 0
.long 0xd051, 0x6d000ff, 0x8000166a, 0
.long 0xd061, 0x7d000ff, 0x8080166a, 0
.long 0x1e051, 0x6e000ff, 0x80001580, 0
.long 0x1e061, 0x7e000ff, 0x80801580, 0
.long 0x2e051, 0x6e000ff, 0x80001595, 0
.long 0x2e061, 0x7e000ff, 0x80801595, 0
.long 0xe051, 0x6e000ff, 0x800016aa, 0
.long 0xe061, 0x7e000ff, 0x808016aa, 0
.long 0x1f051, 0x6f000ff, 0x800015c0, 0
.long 0x1f061, 0x7f000ff, 0x808015c0, 0
.long 0x2f051, 0x6f000ff, 0x800015d5, 0
.long 0x2f061, 0x7f000ff, 0x808015d5, 0
.long 0xf051, 0x6f000ff, 0x800016ea, 0
.long 0xf061, 0x7f000ff, 0x808016ea, 0
.long 0x33, 0xff01893, 0x0, 0
.long 0x33, 0xff01893, 0x0, 0
.long 0x33, 0xff01893, 0x0, 0
.long 0x33, 0xff01893, 0x0, 0
.long 0x33, 0xff01893, 0x0, 0
.long 0x33, 0xff01893, 0x0, 0
.long 0x33, 0xff01893, 0x0, 0
.long 0x33, 0xff01893, 0x0, 0
.long 0x1033, 0xff01893, 0x0, 0
.long 0x1033, 0xff01893, 0x0, 0
.long 0x1033, 0xff01893, 0x0, 0
.long 0x1033, 0xff01893, 0x0, 0
.long 0x1033, 0xff01893, 0x0, 0
.long 0x1033, 0xff01893, 0x0, 0
.long 0x1033, 0xff01893, 0x0, 0
.long 0x1033, 0xff01893, 0x0, 0
.long 0x2033, 0xff01893, 0x0, 0
.long 0x2033, 0xff01893, 0x0, 0
.long 0x2033, 0xff01893, 0x0, 0
.long 0x2033, 0xff01893, 0x0, 0
.long 0x2033, 0xff01893, 0x0, 0
.long 0x2033, 0xff01893, 0x0, 0
.long 0x2033, 0xff01893, 0x0, 0
.long 0x2033, 0xff01893, 0x0, 0
.long 0xe071, 0x8e000ff, 0x4000, 0
.long 0x1f071, 0x8f000ff, 0x4040, 0
.long 0x2f071, 0x8f000ff, 0x4080, 0
.long 0xf071, 0x8f000ff, 0x40c0, 0
.long 0x65, 0xff100a3, 0x0, 0
.long 0x1065, 0xff100a3, 0x0, 0
.long 0x2065, 0xff100a3, 0x0, 0
.long 0x3065, 0xff100a3, 0x0, 0
.long 0x4065, 0xff100a3, 0x0, 0
.long 0x5065, 0xff100a3, 0x0, 0
.long 0x6065, 0xff100a3, 0x0, 0
.long 0x7065, 0xff100a3, 0x0, 0
.long 0x3033, 0xff01893, 0x0, 0
.long 0x3033, 0xff01893, 0x0, 0
.long 0x3033, 0xff01893, 0x0, 0
.long 0x3033, 0xff01893, 0x0, 0
.long 0x3033, 0xff01893, 0x0, 0
.long 0x3033, 0xff01893, 0x0, 0
.long 0x3033, 0xff01893, 0x0, 0
.long 0x3033, 0xff01893, 0x0, 0
.long 0x4033, 0xff01893, 0x0, 0
.long 0x4033, 0xff01893, 0x0, 0
.long 0x4033, 0xff01893, 0x0, 0
.long 0x4033, 0xff01893, 0x0, 0
.long 0x4033, 0xff01893, 0x0, 0
.long 0x4033, 0xff01893, 0x0, 0
.long 0x4033, 0xff01893, 0x0, 0
.long 0x4033, 0xff01893, 0x0, 0
.long 0x5033, 0xff01893, 0x0, 0
.long 0x5033, 0xff01893, 0x0, 0
.long 0x5033, 0xff01893, 0x0, 0
.long 0x5033, 0xff01893, 0x0, 0
.long 0x5033, 0xff01893, 0x0, 0
.long 0x5033, 0xff01893, 0x0, 0
.long 0x5033, 0xff01893, 0x0, 0
.long 0x5033, 0xff01893, 0x0, 0
.long 0x64, 0xff02097, 0x0, 0
.long 0x1064, 0xff02097, 0x0, 0
.long 0x2064, 0xff02097, 0x0, 0
.long 0x3064, 0xff02097, 0x0, 0
.long 0x4064, 0xff02097, 0x0, 0
.long 0x5064, 0xff02097, 0x0, 0
.long 0x6064, 0xff02097, 0x0, 0
.long 0x7064, 0xff02097, 0x0, 0
.long 0x61108, 0xff000ff, 0x0, 0
.long 0x61118, 0xff000ff, 0x0, 0
.long 0x61128, 0xff000ff, 0x0, 0
.long 0x61138, 0xff000ff, 0x0, 0
.long 0x61148, 0xff000ff, 0x0, 0
.long 0x61158, 0xff000ff, 0x0, 0
.long 0x61168, 0xff000ff, 0x0, 0
.long 0x61178, 0xff000ff, 0x0, 0
.long 0xb6, 0xff040af, 0x0, 0
.long 0x10b6, 0xff040af, 0x0, 0
.long 0x20b6, 0xff040af, 0x0, 0
.long 0x30b6, 0xff040af, 0x0, 0
.long 0x40b6, 0xff040af, 0x0, 0
.long 0x50b6, 0xff040af, 0x0, 0
.long 0x60b6, 0xff040af, 0x0, 0
.long 0x70b6, 0xff040af, 0x0, 0
.long 0x61188, 0xff000ff, 0x0, 0
.long 0x61198, 0xff000ff, 0x0, 0
.long 0x611a8, 0xff000ff, 0x0, 0
.long 0x611b8, 0xff000ff, 0x0, 0
.long 0x611c8, 0xff000ff, 0x0, 0
.long 0x611d8, 0xff000ff, 0x0, 0
.long 0x611e8, 0xff000ff, 0x0, 0
.long 0x611f8, 0xff000ff, 0x0, 0
.long 0xe4, 0xff0209b, 0x0, 0
.long 0x10e4, 0xff0209b, 0x0, 0
.long 0x20e4, 0xff0209b, 0x0, 0
.long 0x30e4, 0xff0209b, 0x0, 0
.long 0x40e4, 0xff0209b, 0x0, 0
.long 0x50e4, 0xff0209b, 0x0, 0
.long 0x60e4, 0xff0209b, 0x0, 0
.long 0x70e4, 0xff0209b, 0x0, 0
.long 0xf, 0x0, 0x0, 0
.size W_table, 33152

.section .rodata,"a"
.p2align 6
.amdhsa_kernel concat_heads__memory_aug_recurrent_mem_tr__mha_block__prompt_kernel
  .amdhsa_next_free_vgpr 512
  .amdhsa_next_free_sgpr 102
  .amdhsa_accum_offset 256
  .amdhsa_group_segment_fixed_size 0
  .amdhsa_kernarg_size 104
  .amdhsa_user_sgpr_count 2
  .amdhsa_user_sgpr_kernarg_segment_ptr 1
  .amdhsa_system_sgpr_workgroup_id_x 1
.end_amdhsa_kernel
```
